```python
import torch

def _softmax(x, axis=-1):
    return torch.softmax(x, dim=axis)
def _gelu(x):
    return torch.nn.functional.gelu(x, approximate="tanh")
def _silu(x):
    return torch.nn.functional.silu(x)
def _sigmoid(x):
    return torch.sigmoid(x)
def _layernorm(x, axis=-1, eps=1e-5):
    m = x.mean(dim=axis, keepdim=True)
    v = x.var(dim=axis, keepdim=True, unbiased=False)
    return (x - m) / torch.sqrt(v + eps)
def _scatter_add(tgt, idx, src, axis=0):
    return tgt.clone().index_add_(axis, idx, src)
def _segment_sum(src, seg, n):
    out = torch.zeros((n,) + src.shape[1:], dtype=src.dtype)
    return out.index_add_(0, seg, src)
def _pad(x, pw):
    flat = tuple(v for pair in reversed(pw) for v in pair)
    return torch.nn.functional.pad(x, flat)

kernel_name = 'standalone__mha_softmax__near_ridge'

def setup_inputs():

    _w = (lambda a: (lambda t: t.to(torch.bfloat16) if t.is_floating_point() else t)(torch.as_tensor(a)))
    B, H, Sq, Sk, D = 8, 16, 496, 1024, 256
    return {
        "q": _w((lambda *s: torch.randn(*s, dtype=torch.bfloat16) * 0.8)(B, H, Sq, D)),
        "k": _w((lambda *s: torch.randn(*s, dtype=torch.bfloat16) * 0.8)(B, H, Sk, D)),
        "v": _w((lambda *s: torch.randn(*s, dtype=torch.bfloat16) * 0.05)(B, H, Sk, D)),
    }

def reference(q, k, v):
    scale = q.shape[-1] ** -0.5
    scores = torch.einsum("bhqd,bhkd->bhqk", q, k) * scale
    p = _softmax(scores, axis=-1)
    return torch.einsum("bhqk,bhkd->bhqd", p, v)
```

```asm
; @launch grid=(256,1,1) block=(256,1,1) lds=156672
.amdgcn_target "amdgcn-amd-amdhsa--gfx950"
.text
.globl standalone__mha_softmax__near_ridge_kernel
.p2align 8
.type standalone__mha_softmax__near_ridge_kernel,@function
standalone__mha_softmax__near_ridge_kernel:
    s_cmpk_ge_u32 s2, 0x100
    s_cbranch_scc1 L_end
    s_load_dwordx8 s[28:35], s[0:1], 0
    s_getpc_b64 s[96:97]
L_pc:
    v_lshlrev_b32 v250, 7, v0
    v_add_co_u32 v250, vcc, s96, v250
    v_mov_b32 v251, s97
    v_lshrrev_b32 v249, 6, v0
    v_addc_co_u32 v251, vcc, 0, v251, vcc
    v_and_b32 v248, 63, v0
    global_load_dword v255, v[250:251], off
    v_and_b32 v251, 32, v0
    v_readfirstlane_b32 s23, v249
    v_lshlrev_b32 v227, 4, v248
    v_xor_b32 v227, v227, v251
    s_lshr_b32 s3, s2, 4
    s_and_b32 s87, s2, 7
    s_lshl3_add_u32 s3, s3, s87
    s_and_b32 s87, s2, 8
    s_lshl1_add_u32 s27, s23, s87
    s_lshl_b32 s86, s27, 14
    s_lshl_b32 s21, s23, 12
    s_mulk_i32 s23, 4352
    s_mul_i32 s87, s3, 253952
    s_mov_b32 s6, 253952
    s_mov_b32 s7, 0x20000
    s_add_u32 m0, s23, 139264
    s_movk_i32 s24, 2
    s_waitcnt lgkmcnt(0)
    s_add_u32 s4, s28, s87
    s_addc_u32 s5, s29, 0
L_q:
    buffer_load_dwordx4 v227, s[4:7], s86 offen offset:0 nt lds
    s_addk_i32 m0, 64
    s_sub_u32 s24, s24, 1
    buffer_load_dwordx4 v227, s[4:7], s86 offen offset:1024 nt lds
    s_addk_i32 m0, 64
    s_nop 0
    buffer_load_dwordx4 v227, s[4:7], s86 offen offset:2048 nt lds
    s_addk_i32 m0, 64
    s_nop 0
    buffer_load_dwordx4 v227, s[4:7], s86 offen offset:3072 nt lds
    s_addk_i32 m0, -17600
    s_addk_i32 s86, 4096
    s_cmp_lg_u32 s24, 0
    s_cbranch_scc1 L_q
    s_lshl_b32 s3, s3, 19
    s_add_u32 s8, s30, s3
    s_addc_u32 s9, s31, 0
    s_mov_b32 s10, 524288
    s_mov_b32 s11, 0x20000
    s_add_u32 s12, s32, s3
    s_addc_u32 s13, s33, 0
    s_mov_b32 s14, 524288
    s_mov_b32 s15, 0x20000
    s_mov_b32 s22, s21
    s_add_u32 m0, s23, 0
    s_nop 0
    buffer_load_dwordx4 v227, s[8:11], s21 offen offset:0 nt lds
    s_addk_i32 m0, 64
    s_nop 0
    buffer_load_dwordx4 v227, s[8:11], s21 offen offset:1024 nt lds
    s_addk_i32 m0, 64
    s_nop 0
    buffer_load_dwordx4 v227, s[8:11], s21 offen offset:2048 nt lds
    s_addk_i32 m0, 64
    s_nop 0
    buffer_load_dwordx4 v227, s[8:11], s21 offen offset:3072 nt lds
    s_addk_i32 s21, 16384
    s_add_u32 m0, s23, 17408
    s_nop 0
    buffer_load_dwordx4 v227, s[8:11], s21 offen offset:0 nt lds
    s_addk_i32 m0, 64
    s_nop 0
    buffer_load_dwordx4 v227, s[8:11], s21 offen offset:1024 nt lds
    s_addk_i32 m0, 64
    s_nop 0
    buffer_load_dwordx4 v227, s[8:11], s21 offen offset:2048 nt lds
    s_addk_i32 m0, 64
    s_nop 0
    buffer_load_dwordx4 v227, s[8:11], s21 offen offset:3072 nt lds
    s_addk_i32 s21, 16384
    s_add_u32 m0, s23, 69632
    s_nop 0
    buffer_load_dwordx4 v227, s[12:15], s22 offen offset:0 nt lds
    s_addk_i32 m0, 64
    s_nop 0
    buffer_load_dwordx4 v227, s[12:15], s22 offen offset:1024 nt lds
    s_addk_i32 m0, 64
    s_nop 0
    buffer_load_dwordx4 v227, s[12:15], s22 offen offset:2048 nt lds
    s_addk_i32 m0, 64
    s_nop 0
    buffer_load_dwordx4 v227, s[12:15], s22 offen offset:3072 nt lds
    s_addk_i32 s22, 16384
    s_add_u32 s16, s34, s87
    s_addc_u32 s17, s35, 0
    s_mov_b32 s18, 253952
    s_mov_b32 s19, 0x20000
    s_lshl_b32 s27, s27, 14
    s_add_u32 s88, s27, 4096
    s_add_u32 s89, s27, 8192
    s_add_u32 s90, s27, 12288
    s_add_u32 s91, s27, 16384
    s_add_u32 s92, s27, 20480
    s_add_u32 s93, s27, 24576
    s_add_u32 s94, s27, 28672
    v_and_b32 v252, 1, v248
    v_lshlrev_b32 v250, 9, v252
    v_lshlrev_b32 v252, 5, v252
    v_lshrrev_b32 v251, 4, v248
    v_lshlrev_b32 v251, 4, v251
    v_xor_b32 v251, v251, v252
    v_add_u32 v250, v250, v251
    v_bfe_u32 v251, v248, 1, 2
    v_mul_u32_u24 v251, 1088, v251
    v_add_u32 v250, v250, v251
    v_bfe_u32 v251, v248, 3, 1
    v_mul_u32_u24 v224, 4352, v251
    v_add_u32 v224, v224, v250
    v_xor_b32 v251, 1, v251
    v_mul_u32_u24 v254, 17408, v251
    v_add_u32 v254, v254, v250
    s_add_u32 s87, s23, 87040
    v_add_u32 v254, s87, v254
    v_subrev_u32 v253, 52224, v254
    v_lshrrev_b32 v250, 3, v248
    v_mul_u32_u24 v250, 1088, v250
    v_bfe_u32 v252, v248, 2, 1
    v_lshl_add_u32 v250, v252, 9, v250
    v_and_b32 v251, 3, v248
    v_lshl_add_u32 v250, v251, 3, v250
    v_add_u32 v250, 69632, v250
    v_lshl_add_u32 v225, v252, 5, v250
    v_xor_b32 v226, 32, v225
    s_mov_b32 s20, 0x3db8aa3b
    s_mov_b32 s25, 0xbdb8aa3b
    s_mov_b32 s26, 0x49800000
    s_movk_i32 s24, 7
    s_mov_b32 s95, 0xffff0000
    s_add_u32 m0, s23, 104448
    s_nop 0
    buffer_load_dwordx4 v227, s[4:7], s86 offen offset:0 nt lds
    s_addk_i32 m0, 64
    s_nop 0
    buffer_load_dwordx4 v227, s[4:7], s86 offen offset:1024 nt lds
    s_addk_i32 m0, 64
    s_nop 0
    buffer_load_dwordx4 v227, s[4:7], s86 offen offset:2048 nt lds
    s_addk_i32 m0, 64
    s_nop 0
    buffer_load_dwordx4 v227, s[4:7], s86 offen offset:3072 nt lds
    s_addk_i32 s86, 4096
    s_add_u32 m0, s23, 87040
    s_nop 0
    buffer_load_dwordx4 v227, s[4:7], s86 offen offset:0 nt lds
    s_addk_i32 m0, 64
    s_nop 0
    buffer_load_dwordx4 v227, s[4:7], s86 offen offset:1024 nt lds
    s_addk_i32 m0, 64
    s_nop 0
    buffer_load_dwordx4 v227, s[4:7], s86 offen offset:2048 nt lds
    s_addk_i32 m0, 64
    s_nop 0
    buffer_load_dwordx4 v227, s[4:7], s86 offen offset:3072 nt lds
    s_addk_i32 s86, 4096
    s_waitcnt vmcnt(20)
    ds_read_b128 v[0:3], v254 offset:34816
    ds_read_b128 v[4:7], v254 offset:34880
    ds_read_b128 v[8:11], v254 offset:34944
    ds_read_b128 v[12:15], v254 offset:35008
    ds_read_b128 v[16:19], v254 offset:35072
    ds_read_b128 v[20:23], v254 offset:35136
    ds_read_b128 v[24:27], v254 offset:35200
    ds_read_b128 v[28:31], v254 offset:35264
    s_waitcnt lgkmcnt(0)
    v_lshlrev_b32 v128, 16, v0
    v_lshlrev_b32 v130, 16, v1
    v_lshlrev_b32 v132, 16, v2
    v_lshlrev_b32 v134, 16, v3
    v_and_b32 v129, s95, v0
    v_and_b32 v131, s95, v1
    v_and_b32 v133, s95, v2
    v_and_b32 v135, s95, v3
    v_pk_mul_f32 v[128:129], v[128:129], s[20:21] op_sel_hi:[1,0]
    v_pk_mul_f32 v[130:131], v[130:131], s[20:21] op_sel_hi:[1,0]
    v_pk_mul_f32 v[132:133], v[132:133], s[20:21] op_sel_hi:[1,0]
    v_pk_mul_f32 v[134:135], v[134:135], s[20:21] op_sel_hi:[1,0]
    v_cvt_pk_bf16_f32 v0, v128, v129
    v_cvt_pk_bf16_f32 v1, v130, v131
    v_cvt_pk_bf16_f32 v2, v132, v133
    v_cvt_pk_bf16_f32 v3, v134, v135
    v_lshlrev_b32 v128, 16, v4
    v_lshlrev_b32 v130, 16, v5
    v_lshlrev_b32 v132, 16, v6
    v_lshlrev_b32 v134, 16, v7
    v_and_b32 v129, s95, v4
    v_and_b32 v131, s95, v5
    v_and_b32 v133, s95, v6
    v_and_b32 v135, s95, v7
    v_pk_mul_f32 v[128:129], v[128:129], s[20:21] op_sel_hi:[1,0]
    v_pk_mul_f32 v[130:131], v[130:131], s[20:21] op_sel_hi:[1,0]
    v_pk_mul_f32 v[132:133], v[132:133], s[20:21] op_sel_hi:[1,0]
    v_pk_mul_f32 v[134:135], v[134:135], s[20:21] op_sel_hi:[1,0]
    v_cvt_pk_bf16_f32 v4, v128, v129
    v_cvt_pk_bf16_f32 v5, v130, v131
    v_cvt_pk_bf16_f32 v6, v132, v133
    v_cvt_pk_bf16_f32 v7, v134, v135
    v_lshlrev_b32 v128, 16, v8
    v_lshlrev_b32 v130, 16, v9
    v_lshlrev_b32 v132, 16, v10
    v_lshlrev_b32 v134, 16, v11
    v_and_b32 v129, s95, v8
    v_and_b32 v131, s95, v9
    v_and_b32 v133, s95, v10
    v_and_b32 v135, s95, v11
    v_pk_mul_f32 v[128:129], v[128:129], s[20:21] op_sel_hi:[1,0]
    v_pk_mul_f32 v[130:131], v[130:131], s[20:21] op_sel_hi:[1,0]
    v_pk_mul_f32 v[132:133], v[132:133], s[20:21] op_sel_hi:[1,0]
    v_pk_mul_f32 v[134:135], v[134:135], s[20:21] op_sel_hi:[1,0]
    v_cvt_pk_bf16_f32 v8, v128, v129
    v_cvt_pk_bf16_f32 v9, v130, v131
    v_cvt_pk_bf16_f32 v10, v132, v133
    v_cvt_pk_bf16_f32 v11, v134, v135
    v_lshlrev_b32 v128, 16, v12
    v_lshlrev_b32 v130, 16, v13
    v_lshlrev_b32 v132, 16, v14
    v_lshlrev_b32 v134, 16, v15
    v_and_b32 v129, s95, v12
    v_and_b32 v131, s95, v13
    v_and_b32 v133, s95, v14
    v_and_b32 v135, s95, v15
    v_pk_mul_f32 v[128:129], v[128:129], s[20:21] op_sel_hi:[1,0]
    v_pk_mul_f32 v[130:131], v[130:131], s[20:21] op_sel_hi:[1,0]
    v_pk_mul_f32 v[132:133], v[132:133], s[20:21] op_sel_hi:[1,0]
    v_pk_mul_f32 v[134:135], v[134:135], s[20:21] op_sel_hi:[1,0]
    v_cvt_pk_bf16_f32 v12, v128, v129
    v_cvt_pk_bf16_f32 v13, v130, v131
    v_cvt_pk_bf16_f32 v14, v132, v133
    v_cvt_pk_bf16_f32 v15, v134, v135
    v_lshlrev_b32 v128, 16, v16
    v_lshlrev_b32 v130, 16, v17
    v_lshlrev_b32 v132, 16, v18
    v_lshlrev_b32 v134, 16, v19
    v_and_b32 v129, s95, v16
    v_and_b32 v131, s95, v17
    v_and_b32 v133, s95, v18
    v_and_b32 v135, s95, v19
    v_pk_mul_f32 v[128:129], v[128:129], s[20:21] op_sel_hi:[1,0]
    v_pk_mul_f32 v[130:131], v[130:131], s[20:21] op_sel_hi:[1,0]
    v_pk_mul_f32 v[132:133], v[132:133], s[20:21] op_sel_hi:[1,0]
    v_pk_mul_f32 v[134:135], v[134:135], s[20:21] op_sel_hi:[1,0]
    v_cvt_pk_bf16_f32 v16, v128, v129
    v_cvt_pk_bf16_f32 v17, v130, v131
    v_cvt_pk_bf16_f32 v18, v132, v133
    v_cvt_pk_bf16_f32 v19, v134, v135
    v_lshlrev_b32 v128, 16, v20
    v_lshlrev_b32 v130, 16, v21
    v_lshlrev_b32 v132, 16, v22
    v_lshlrev_b32 v134, 16, v23
    v_and_b32 v129, s95, v20
    v_and_b32 v131, s95, v21
    v_and_b32 v133, s95, v22
    v_and_b32 v135, s95, v23
    v_pk_mul_f32 v[128:129], v[128:129], s[20:21] op_sel_hi:[1,0]
    v_pk_mul_f32 v[130:131], v[130:131], s[20:21] op_sel_hi:[1,0]
    v_pk_mul_f32 v[132:133], v[132:133], s[20:21] op_sel_hi:[1,0]
    v_pk_mul_f32 v[134:135], v[134:135], s[20:21] op_sel_hi:[1,0]
    v_cvt_pk_bf16_f32 v20, v128, v129
    v_cvt_pk_bf16_f32 v21, v130, v131
    v_cvt_pk_bf16_f32 v22, v132, v133
    v_cvt_pk_bf16_f32 v23, v134, v135
    v_lshlrev_b32 v128, 16, v24
    v_lshlrev_b32 v130, 16, v25
    v_lshlrev_b32 v132, 16, v26
    v_lshlrev_b32 v134, 16, v27
    v_and_b32 v129, s95, v24
    v_and_b32 v131, s95, v25
    v_and_b32 v133, s95, v26
    v_and_b32 v135, s95, v27
    v_pk_mul_f32 v[128:129], v[128:129], s[20:21] op_sel_hi:[1,0]
    v_pk_mul_f32 v[130:131], v[130:131], s[20:21] op_sel_hi:[1,0]
    v_pk_mul_f32 v[132:133], v[132:133], s[20:21] op_sel_hi:[1,0]
    v_pk_mul_f32 v[134:135], v[134:135], s[20:21] op_sel_hi:[1,0]
    v_cvt_pk_bf16_f32 v24, v128, v129
    v_cvt_pk_bf16_f32 v25, v130, v131
    v_cvt_pk_bf16_f32 v26, v132, v133
    v_cvt_pk_bf16_f32 v27, v134, v135
    v_lshlrev_b32 v128, 16, v28
    v_lshlrev_b32 v130, 16, v29
    v_lshlrev_b32 v132, 16, v30
    v_lshlrev_b32 v134, 16, v31
    v_and_b32 v129, s95, v28
    v_and_b32 v131, s95, v29
    v_and_b32 v133, s95, v30
    v_and_b32 v135, s95, v31
    v_pk_mul_f32 v[128:129], v[128:129], s[20:21] op_sel_hi:[1,0]
    v_pk_mul_f32 v[130:131], v[130:131], s[20:21] op_sel_hi:[1,0]
    v_pk_mul_f32 v[132:133], v[132:133], s[20:21] op_sel_hi:[1,0]
    v_pk_mul_f32 v[134:135], v[134:135], s[20:21] op_sel_hi:[1,0]
    v_cvt_pk_bf16_f32 v28, v128, v129
    v_cvt_pk_bf16_f32 v29, v130, v131
    v_cvt_pk_bf16_f32 v30, v132, v133
    v_cvt_pk_bf16_f32 v31, v134, v135
    s_add_u32 m0, s23, 52224
    s_nop 0
    buffer_load_dwordx4 v227, s[4:7], s86 offen offset:0 nt lds
    s_addk_i32 m0, 64
    s_nop 0
    buffer_load_dwordx4 v227, s[4:7], s86 offen offset:1024 nt lds
    s_addk_i32 m0, 64
    s_nop 0
    buffer_load_dwordx4 v227, s[4:7], s86 offen offset:2048 nt lds
    s_addk_i32 m0, 64
    s_nop 0
    buffer_load_dwordx4 v227, s[4:7], s86 offen offset:3072 nt lds
    s_addk_i32 s86, 4096
    s_waitcnt vmcnt(12)
    s_barrier
    ds_read_b128 a[192:195], v224 offset:0
    ds_read_b128 a[196:199], v224 offset:64
    ds_read_b128 a[200:203], v224 offset:128
    ds_read_b128 a[204:207], v224 offset:192
    ds_read_b128 a[208:211], v224 offset:256
    ds_read_b128 a[212:215], v224 offset:320
    s_waitcnt lgkmcnt(5)
    v_mfma_f32_16x16x32_bf16 v[128:131], a[192:195], v[0:3], 0
    s_waitcnt lgkmcnt(4)
    s_add_u32 m0, s23, 34816
    ds_read_b128 a[216:219], v224 offset:384
    ds_read_b128 a[220:223], v224 offset:448
    v_mfma_f32_16x16x32_bf16 v[128:131], a[196:199], v[4:7], v[128:131]
    s_waitcnt lgkmcnt(5)
    ds_read_b128 a[224:227], v224 offset:8704
    ds_read_b128 a[228:231], v224 offset:8768
    v_mfma_f32_16x16x32_bf16 v[128:131], a[200:203], v[8:11], v[128:131]
    s_waitcnt lgkmcnt(6)
    ds_read_b128 a[232:235], v224 offset:8832
    ds_read_b128 a[236:239], v224 offset:8896
    v_mfma_f32_16x16x32_bf16 v[128:131], a[204:207], v[12:15], v[128:131]
    s_waitcnt lgkmcnt(7)
    ds_read_b128 a[240:243], v224 offset:8960
    ds_read_b128 a[244:247], v224 offset:9024
    v_mfma_f32_16x16x32_bf16 v[128:131], a[208:211], v[16:19], v[128:131]
    s_waitcnt lgkmcnt(8)
    ds_read_b128 a[248:251], v224 offset:9088
    ds_read_b128 a[252:255], v224 offset:9152
    buffer_load_dwordx4 v227, s[4:7], s86 offen offset:0 nt lds
    v_mfma_f32_16x16x32_bf16 v[128:131], a[212:215], v[20:23], v[128:131]
    s_waitcnt lgkmcnt(9)
    s_add_u32 m0, s23, 34880
    ds_read_b128 v[96:99], v224 offset:17408
    ds_read_b128 v[100:103], v224 offset:17472
    v_mfma_f32_16x16x32_bf16 v[128:131], a[216:219], v[24:27], v[128:131]
    s_waitcnt lgkmcnt(10)
    ds_read_b128 v[104:107], v224 offset:17536
    ds_read_b128 v[108:111], v224 offset:17600
    v_mfma_f32_16x16x32_bf16 v[128:131], a[220:223], v[28:31], v[128:131]
    s_waitcnt lgkmcnt(11)
    ds_read_b128 v[112:115], v224 offset:17664
    ds_read_b128 v[116:119], v224 offset:17728
    v_mfma_f32_16x16x32_bf16 v[132:135], a[224:227], v[0:3], 0
    s_waitcnt lgkmcnt(12)
    ds_read_b128 v[120:123], v224 offset:17792
    ds_read_b128 v[124:127], v224 offset:17856
    v_mfma_f32_16x16x32_bf16 v[132:135], a[228:231], v[4:7], v[132:135]
    s_waitcnt lgkmcnt(13)
    ds_read_b128 v[192:195], v224 offset:26112
    ds_read_b128 v[196:199], v224 offset:26176
    v_max3_f32 v236, v128, v129, v130
    v_mfma_f32_16x16x32_bf16 v[132:135], a[232:235], v[8:11], v[132:135]
    s_waitcnt lgkmcnt(14)
    ds_read_b128 v[200:203], v224 offset:26240
    ds_read_b128 v[204:207], v224 offset:26304
    buffer_load_dwordx4 v227, s[4:7], s86 offen offset:1024 nt lds
    v_mfma_f32_16x16x32_bf16 v[132:135], a[236:239], v[12:15], v[132:135]
    s_waitcnt lgkmcnt(14)
    s_add_u32 m0, s23, 34944
    ds_read_b128 v[208:211], v224 offset:26368
    ds_read_b128 v[212:215], v224 offset:26432
    v_mfma_f32_16x16x32_bf16 v[132:135], a[240:243], v[16:19], v[132:135]
    ds_read_b128 v[216:219], v224 offset:26496
    ds_read_b128 v[220:223], v224 offset:26560
    v_mfma_f32_16x16x32_bf16 v[132:135], a[244:247], v[20:23], v[132:135]
    s_waitcnt lgkmcnt(14)
    ds_read_b64_tr_b16 a[4:5], v225 offset:0
    ds_read_b64_tr_b16 a[6:7], v225 offset:8704
    v_mfma_f32_16x16x32_bf16 v[132:135], a[248:251], v[24:27], v[132:135]
    ds_read_b64_tr_b16 a[8:9], v226 offset:0
    ds_read_b64_tr_b16 a[10:11], v226 offset:8704
    v_mfma_f32_16x16x32_bf16 v[132:135], a[252:255], v[28:31], v[132:135]
    ds_read_b64_tr_b16 a[12:13], v225 offset:64
    ds_read_b64_tr_b16 a[14:15], v225 offset:8768
    v_mfma_f32_16x16x32_bf16 v[160:163], v[96:99], v[0:3], 0
    ds_read_b64_tr_b16 a[16:17], v226 offset:64
    ds_read_b64_tr_b16 a[18:19], v226 offset:8768
    buffer_load_dwordx4 v227, s[4:7], s86 offen offset:2048 nt lds
    v_mfma_f32_16x16x32_bf16 v[160:163], v[100:103], v[4:7], v[160:163]
    s_waitcnt lgkmcnt(14)
    s_add_u32 m0, s23, 35008
    ds_read_b64_tr_b16 a[20:21], v225 offset:128
    ds_read_b64_tr_b16 a[22:23], v225 offset:8832
    v_max3_f32 v236, v236, v131, v132
    v_max3_f32 v236, v236, v133, v134
    v_mfma_f32_16x16x32_bf16 v[160:163], v[104:107], v[8:11], v[160:163]
    ds_read_b64_tr_b16 a[24:25], v226 offset:128
    ds_read_b64_tr_b16 a[26:27], v226 offset:8832
    v_mfma_f32_16x16x32_bf16 v[160:163], v[108:111], v[12:15], v[160:163]
    ds_read_b64_tr_b16 a[28:29], v225 offset:192
    ds_read_b64_tr_b16 a[30:31], v225 offset:8896
    v_mfma_f32_16x16x32_bf16 v[160:163], v[112:115], v[16:19], v[160:163]
    ds_read_b64_tr_b16 a[32:33], v226 offset:192
    ds_read_b64_tr_b16 a[34:35], v226 offset:8896
    v_mfma_f32_16x16x32_bf16 v[160:163], v[116:119], v[20:23], v[160:163]
    ds_read_b64_tr_b16 a[36:37], v225 offset:256
    ds_read_b64_tr_b16 a[38:39], v225 offset:8960
    v_mfma_f32_16x16x32_bf16 v[160:163], v[120:123], v[24:27], v[160:163]
    ds_read_b64_tr_b16 a[40:41], v226 offset:256
    ds_read_b64_tr_b16 a[42:43], v226 offset:8960
    buffer_load_dwordx4 v227, s[4:7], s86 offen offset:3072 nt lds
    v_mfma_f32_16x16x32_bf16 v[160:163], v[124:127], v[28:31], v[160:163]
    s_addk_i32 s86, 4096
    ds_read_b64_tr_b16 a[44:45], v225 offset:320
    ds_read_b64_tr_b16 a[46:47], v225 offset:9024
    v_mfma_f32_16x16x32_bf16 v[164:167], v[192:195], v[0:3], 0
    ds_read_b64_tr_b16 a[48:49], v226 offset:320
    ds_read_b64_tr_b16 a[50:51], v226 offset:9024
    v_mfma_f32_16x16x32_bf16 v[164:167], v[196:199], v[4:7], v[164:167]
    s_waitcnt lgkmcnt(14)
    ds_read_b64_tr_b16 a[52:53], v225 offset:384
    ds_read_b64_tr_b16 a[54:55], v225 offset:9088
    v_max3_f32 v236, v236, v135, v160
    v_max3_f32 v236, v236, v161, v162
    v_mfma_f32_16x16x32_bf16 v[164:167], v[200:203], v[8:11], v[164:167]
    ds_read_b64_tr_b16 a[56:57], v226 offset:384
    ds_read_b64_tr_b16 a[58:59], v226 offset:9088
    v_mfma_f32_16x16x32_bf16 v[164:167], v[204:207], v[12:15], v[164:167]
    ds_read_b64_tr_b16 a[60:61], v225 offset:448
    ds_read_b64_tr_b16 a[62:63], v225 offset:9152
    v_mfma_f32_16x16x32_bf16 v[164:167], v[208:211], v[16:19], v[164:167]
    ds_read_b64_tr_b16 a[64:65], v226 offset:448
    ds_read_b64_tr_b16 a[66:67], v226 offset:9152
    v_mfma_f32_16x16x32_bf16 v[164:167], v[212:215], v[20:23], v[164:167]
    ds_read_b64_tr_b16 a[68:69], v225 offset:0
    ds_read_b64_tr_b16 a[70:71], v225 offset:8704
    v_mfma_f32_16x16x32_bf16 v[164:167], v[216:219], v[24:27], v[164:167]
    ds_read_b64_tr_b16 a[72:73], v226 offset:0
    ds_read_b64_tr_b16 a[74:75], v226 offset:8704
    v_mfma_f32_16x16x32_bf16 v[164:167], v[220:223], v[28:31], v[164:167]
    ds_read_b64_tr_b16 a[76:77], v225 offset:64
    ds_read_b64_tr_b16 a[78:79], v225 offset:8768
    ds_read_b64_tr_b16 a[80:81], v226 offset:64
    ds_read_b64_tr_b16 a[82:83], v226 offset:8768
    ds_read_b64_tr_b16 a[84:85], v225 offset:128
    ds_read_b64_tr_b16 a[86:87], v225 offset:8832
    ds_read_b64_tr_b16 a[88:89], v226 offset:128
    ds_read_b64_tr_b16 a[90:91], v226 offset:8832
    v_max3_f32 v236, v236, v163, v164
    v_max3_f32 v236, v236, v165, v166
    v_max_f32 v236, v236, v167
    v_mov_b32 v237, v236
    ds_read_b64_tr_b16 a[92:93], v225 offset:192
    ds_read_b64_tr_b16 a[94:95], v225 offset:8896
    v_permlane16_swap_b32 v236, v237
    ds_read_b64_tr_b16 a[96:97], v226 offset:192
    v_max_f32 v236, v236, v237
    v_mov_b32 v237, v236
    ds_read_b64_tr_b16 a[98:99], v226 offset:8896
    ds_read_b64_tr_b16 a[100:101], v225 offset:256
    v_permlane32_swap_b32 v236, v237
    ds_read_b64_tr_b16 a[102:103], v225 offset:8960
    v_max_f32 v236, v236, v237
    v_mul_f32 v240, -1.0, v236
    v_fma_f32 v128, v128, 1.0, v240
    v_fma_f32 v129, v129, 1.0, v240
    v_fma_f32 v130, v130, 1.0, v240
    v_fma_f32 v131, v131, 1.0, v240
    v_fma_f32 v132, v132, 1.0, v240
    v_fma_f32 v133, v133, 1.0, v240
    v_fma_f32 v134, v134, 1.0, v240
    v_fma_f32 v135, v135, 1.0, v240
    v_exp_f32 v128, v128
    v_exp_f32 v129, v129
    v_exp_f32 v130, v130
    v_add_f32 v228, v128, v129
    v_cvt_pk_bf16_f32 v128, v128, v129
    v_add_f32 v228, v228, v130
    v_exp_f32 v131, v131
    v_exp_f32 v132, v132
    v_add_f32 v228, v228, v131
    v_cvt_pk_bf16_f32 v129, v130, v131
    v_exp_f32 v133, v133
    v_exp_f32 v134, v134
    v_cvt_pk_bf16_f32 v130, v132, v133
    v_exp_f32 v135, v135
    v_add_f32 v228, v228, v132
    v_cvt_pk_bf16_f32 v131, v134, v135
    v_add_f32 v228, v228, v133
    v_add_f32 v228, v228, v134
    v_mfma_f32_16x16x32_bf16 a[0:3], a[4:7], v[128:131], 0
    ds_read_b64_tr_b16 a[104:105], v226 offset:256
    ds_read_b64_tr_b16 a[106:107], v226 offset:8960
    v_add_f32 v228, v228, v135
    v_mov_b32 v241, v240
    v_mfma_f32_16x16x32_bf16 a[4:7], a[8:11], v[128:131], 0
    ds_read_b64_tr_b16 a[108:109], v225 offset:320
    ds_read_b64_tr_b16 a[110:111], v225 offset:9024
    v_mov_b32 v242, v240
    v_mov_b32 v243, v240
    v_mfma_f32_16x16x32_bf16 a[8:11], a[12:15], v[128:131], 0
    ds_read_b64_tr_b16 a[112:113], v226 offset:320
    ds_read_b64_tr_b16 a[114:115], v226 offset:9024
    v_fma_f32 v160, v160, 1.0, v240
    v_fma_f32 v161, v161, 1.0, v240
    v_mfma_f32_16x16x32_bf16 a[12:15], a[16:19], v[128:131], 0
    ds_read_b64_tr_b16 a[116:117], v225 offset:384
    ds_read_b64_tr_b16 a[118:119], v225 offset:9088
    v_fma_f32 v162, v162, 1.0, v240
    v_fma_f32 v163, v163, 1.0, v240
    v_mfma_f32_16x16x32_bf16 a[16:19], a[20:23], v[128:131], 0
    s_waitcnt lgkmcnt(14)
    ds_read_b64_tr_b16 a[120:121], v226 offset:384
    ds_read_b64_tr_b16 a[122:123], v226 offset:9088
    v_exp_f32 v160, v160
    v_mfma_f32_16x16x32_bf16 a[20:23], a[24:27], v[128:131], 0
    ds_read_b64_tr_b16 a[124:125], v225 offset:448
    ds_read_b64_tr_b16 a[126:127], v225 offset:9152
    v_exp_f32 v161, v161
    v_mfma_f32_16x16x32_bf16 a[24:27], a[28:31], v[128:131], 0
    ds_read_b64_tr_b16 a[128:129], v226 offset:448
    ds_read_b64_tr_b16 a[130:131], v226 offset:9152
    v_fma_f32 v164, v164, 1.0, v240
    v_fma_f32 v165, v165, 1.0, v240
    v_mfma_f32_16x16x32_bf16 a[28:31], a[32:35], v[128:131], 0
    v_exp_f32 v162, v162
    v_exp_f32 v163, v163
    v_mfma_f32_16x16x32_bf16 a[32:35], a[36:39], v[128:131], 0
    v_exp_f32 v164, v164
    v_exp_f32 v165, v165
    v_mfma_f32_16x16x32_bf16 a[36:39], a[40:43], v[128:131], 0
    v_fma_f32 v166, v166, 1.0, v240
    v_exp_f32 v166, v166
    v_fma_f32 v167, v167, 1.0, v240
    v_mfma_f32_16x16x32_bf16 a[40:43], a[44:47], v[128:131], 0
    v_exp_f32 v167, v167
    v_add_f32 v232, v160, v161
    v_cvt_pk_bf16_f32 v160, v160, v161
    v_mfma_f32_16x16x32_bf16 a[44:47], a[48:51], v[128:131], 0
    v_add_f32 v232, v232, v162
    v_add_f32 v232, v232, v163
    v_cvt_pk_bf16_f32 v161, v162, v163
    v_add_f32 v232, v232, v164
    v_mfma_f32_16x16x32_bf16 a[48:51], a[52:55], v[128:131], 0
    v_add_f32 v232, v232, v165
    v_cvt_pk_bf16_f32 v162, v164, v165
    v_add_f32 v232, v232, v166
    v_add_f32 v232, v232, v167
    v_mfma_f32_16x16x32_bf16 a[52:55], a[56:59], v[128:131], 0
    v_cvt_pk_bf16_f32 v163, v166, v167
    v_mfma_f32_16x16x32_bf16 a[56:59], a[60:63], v[128:131], 0
    v_mfma_f32_16x16x32_bf16 a[60:63], a[64:67], v[128:131], 0
    s_waitcnt vmcnt(8)
    ds_read_b128 v[32:35], v254 offset:0
    ds_read_b128 v[36:39], v254 offset:64
    ds_read_b128 v[40:43], v254 offset:128
    ds_read_b128 v[44:47], v254 offset:192
    ds_read_b128 v[48:51], v254 offset:256
    ds_read_b128 v[52:55], v254 offset:320
    ds_read_b128 v[56:59], v254 offset:384
    ds_read_b128 v[60:63], v254 offset:448
    s_waitcnt lgkmcnt(0)
    s_add_u32 m0, s23, 139264
    v_lshlrev_b32 v128, 16, v32
    buffer_load_dwordx4 v227, s[4:7], s86 offen offset:0 nt lds
    s_add_u32 m0, s23, 139328
    v_lshlrev_b32 v130, 16, v33
    buffer_load_dwordx4 v227, s[4:7], s86 offen offset:1024 nt lds
    s_add_u32 m0, s23, 139392
    v_lshlrev_b32 v132, 16, v34
    buffer_load_dwordx4 v227, s[4:7], s86 offen offset:2048 nt lds
    s_add_u32 m0, s23, 139456
    v_lshlrev_b32 v134, 16, v35
    buffer_load_dwordx4 v227, s[4:7], s86 offen offset:3072 nt lds
    s_addk_i32 s86, 4096
    v_and_b32 v129, s95, v32
    v_and_b32 v131, s95, v33
    v_and_b32 v133, s95, v34
    v_and_b32 v135, s95, v35
    v_pk_mul_f32 v[128:129], v[128:129], s[20:21] op_sel_hi:[1,0]
    v_pk_mul_f32 v[130:131], v[130:131], s[20:21] op_sel_hi:[1,0]
    v_pk_mul_f32 v[132:133], v[132:133], s[20:21] op_sel_hi:[1,0]
    v_pk_mul_f32 v[134:135], v[134:135], s[20:21] op_sel_hi:[1,0]
    v_cvt_pk_bf16_f32 v32, v128, v129
    v_cvt_pk_bf16_f32 v33, v130, v131
    v_cvt_pk_bf16_f32 v34, v132, v133
    v_cvt_pk_bf16_f32 v35, v134, v135
    v_lshlrev_b32 v128, 16, v36
    v_lshlrev_b32 v130, 16, v37
    v_lshlrev_b32 v132, 16, v38
    v_lshlrev_b32 v134, 16, v39
    v_and_b32 v129, s95, v36
    v_and_b32 v131, s95, v37
    v_and_b32 v133, s95, v38
    v_and_b32 v135, s95, v39
    v_pk_mul_f32 v[128:129], v[128:129], s[20:21] op_sel_hi:[1,0]
    v_pk_mul_f32 v[130:131], v[130:131], s[20:21] op_sel_hi:[1,0]
    v_pk_mul_f32 v[132:133], v[132:133], s[20:21] op_sel_hi:[1,0]
    v_pk_mul_f32 v[134:135], v[134:135], s[20:21] op_sel_hi:[1,0]
    v_cvt_pk_bf16_f32 v36, v128, v129
    v_cvt_pk_bf16_f32 v37, v130, v131
    v_cvt_pk_bf16_f32 v38, v132, v133
    v_cvt_pk_bf16_f32 v39, v134, v135
    v_lshlrev_b32 v128, 16, v40
    v_lshlrev_b32 v130, 16, v41
    v_lshlrev_b32 v132, 16, v42
    v_lshlrev_b32 v134, 16, v43
    v_and_b32 v129, s95, v40
    v_and_b32 v131, s95, v41
    v_and_b32 v133, s95, v42
    v_and_b32 v135, s95, v43
    v_pk_mul_f32 v[128:129], v[128:129], s[20:21] op_sel_hi:[1,0]
    v_pk_mul_f32 v[130:131], v[130:131], s[20:21] op_sel_hi:[1,0]
    v_pk_mul_f32 v[132:133], v[132:133], s[20:21] op_sel_hi:[1,0]
    v_pk_mul_f32 v[134:135], v[134:135], s[20:21] op_sel_hi:[1,0]
    v_cvt_pk_bf16_f32 v40, v128, v129
    v_cvt_pk_bf16_f32 v41, v130, v131
    v_cvt_pk_bf16_f32 v42, v132, v133
    v_cvt_pk_bf16_f32 v43, v134, v135
    v_lshlrev_b32 v128, 16, v44
    v_lshlrev_b32 v130, 16, v45
    v_lshlrev_b32 v132, 16, v46
    v_lshlrev_b32 v134, 16, v47
    v_and_b32 v129, s95, v44
    v_and_b32 v131, s95, v45
    v_and_b32 v133, s95, v46
    v_and_b32 v135, s95, v47
    v_pk_mul_f32 v[128:129], v[128:129], s[20:21] op_sel_hi:[1,0]
    v_pk_mul_f32 v[130:131], v[130:131], s[20:21] op_sel_hi:[1,0]
    v_pk_mul_f32 v[132:133], v[132:133], s[20:21] op_sel_hi:[1,0]
    v_pk_mul_f32 v[134:135], v[134:135], s[20:21] op_sel_hi:[1,0]
    v_cvt_pk_bf16_f32 v44, v128, v129
    v_cvt_pk_bf16_f32 v45, v130, v131
    v_cvt_pk_bf16_f32 v46, v132, v133
    v_cvt_pk_bf16_f32 v47, v134, v135
    v_lshlrev_b32 v128, 16, v48
    v_lshlrev_b32 v130, 16, v49
    v_lshlrev_b32 v132, 16, v50
    v_lshlrev_b32 v134, 16, v51
    v_and_b32 v129, s95, v48
    v_and_b32 v131, s95, v49
    v_and_b32 v133, s95, v50
    v_and_b32 v135, s95, v51
    v_pk_mul_f32 v[128:129], v[128:129], s[20:21] op_sel_hi:[1,0]
    v_pk_mul_f32 v[130:131], v[130:131], s[20:21] op_sel_hi:[1,0]
    v_pk_mul_f32 v[132:133], v[132:133], s[20:21] op_sel_hi:[1,0]
    v_pk_mul_f32 v[134:135], v[134:135], s[20:21] op_sel_hi:[1,0]
    v_cvt_pk_bf16_f32 v48, v128, v129
    v_cvt_pk_bf16_f32 v49, v130, v131
    v_cvt_pk_bf16_f32 v50, v132, v133
    v_cvt_pk_bf16_f32 v51, v134, v135
    v_lshlrev_b32 v128, 16, v52
    v_lshlrev_b32 v130, 16, v53
    v_lshlrev_b32 v132, 16, v54
    v_lshlrev_b32 v134, 16, v55
    v_and_b32 v129, s95, v52
    v_and_b32 v131, s95, v53
    v_and_b32 v133, s95, v54
    v_and_b32 v135, s95, v55
    v_pk_mul_f32 v[128:129], v[128:129], s[20:21] op_sel_hi:[1,0]
    v_pk_mul_f32 v[130:131], v[130:131], s[20:21] op_sel_hi:[1,0]
    v_pk_mul_f32 v[132:133], v[132:133], s[20:21] op_sel_hi:[1,0]
    v_pk_mul_f32 v[134:135], v[134:135], s[20:21] op_sel_hi:[1,0]
    v_cvt_pk_bf16_f32 v52, v128, v129
    v_cvt_pk_bf16_f32 v53, v130, v131
    v_cvt_pk_bf16_f32 v54, v132, v133
    v_cvt_pk_bf16_f32 v55, v134, v135
    v_lshlrev_b32 v128, 16, v56
    v_lshlrev_b32 v130, 16, v57
    v_lshlrev_b32 v132, 16, v58
    v_lshlrev_b32 v134, 16, v59
    v_and_b32 v129, s95, v56
    v_and_b32 v131, s95, v57
    v_and_b32 v133, s95, v58
    v_and_b32 v135, s95, v59
    v_pk_mul_f32 v[128:129], v[128:129], s[20:21] op_sel_hi:[1,0]
    v_pk_mul_f32 v[130:131], v[130:131], s[20:21] op_sel_hi:[1,0]
    v_pk_mul_f32 v[132:133], v[132:133], s[20:21] op_sel_hi:[1,0]
    v_pk_mul_f32 v[134:135], v[134:135], s[20:21] op_sel_hi:[1,0]
    v_cvt_pk_bf16_f32 v56, v128, v129
    v_cvt_pk_bf16_f32 v57, v130, v131
    v_cvt_pk_bf16_f32 v58, v132, v133
    v_cvt_pk_bf16_f32 v59, v134, v135
    v_lshlrev_b32 v128, 16, v60
    v_lshlrev_b32 v130, 16, v61
    v_lshlrev_b32 v132, 16, v62
    v_lshlrev_b32 v134, 16, v63
    v_and_b32 v129, s95, v60
    v_and_b32 v131, s95, v61
    v_and_b32 v133, s95, v62
    v_and_b32 v135, s95, v63
    v_pk_mul_f32 v[128:129], v[128:129], s[20:21] op_sel_hi:[1,0]
    v_pk_mul_f32 v[130:131], v[130:131], s[20:21] op_sel_hi:[1,0]
    v_pk_mul_f32 v[132:133], v[132:133], s[20:21] op_sel_hi:[1,0]
    v_pk_mul_f32 v[134:135], v[134:135], s[20:21] op_sel_hi:[1,0]
    v_cvt_pk_bf16_f32 v60, v128, v129
    v_cvt_pk_bf16_f32 v61, v130, v131
    v_cvt_pk_bf16_f32 v62, v132, v133
    v_cvt_pk_bf16_f32 v63, v134, v135
    s_nop 1
    v_mfma_f32_16x16x32_bf16 v[136:139], a[192:195], v[32:35], 0
    s_add_u32 m0, s23, 121856
    ds_read_b64_tr_b16 a[132:133], v225 offset:0
    v_mfma_f32_16x16x32_bf16 v[136:139], a[196:199], v[36:39], v[136:139]
    buffer_load_dwordx4 v227, s[4:7], s86 offen offset:0 nt lds
    ds_read_b64_tr_b16 a[134:135], v225 offset:8704
    v_mfma_f32_16x16x32_bf16 v[136:139], a[200:203], v[40:43], v[136:139]
    s_add_u32 m0, s23, 121920
    ds_read_b64_tr_b16 a[136:137], v226 offset:0
    v_mfma_f32_16x16x32_bf16 v[136:139], a[204:207], v[44:47], v[136:139]
    ds_read_b64_tr_b16 a[138:139], v226 offset:8704
    v_mfma_f32_16x16x32_bf16 v[136:139], a[208:211], v[48:51], v[136:139]
    ds_read_b64_tr_b16 a[140:141], v225 offset:64
    v_mfma_f32_16x16x32_bf16 v[136:139], a[212:215], v[52:55], v[136:139]
    ds_read_b64_tr_b16 a[142:143], v225 offset:8768
    v_mfma_f32_16x16x32_bf16 v[136:139], a[216:219], v[56:59], v[136:139]
    ds_read_b64_tr_b16 a[144:145], v226 offset:64
    v_mfma_f32_16x16x32_bf16 v[136:139], a[220:223], v[60:63], v[136:139]
    ds_read_b64_tr_b16 a[146:147], v226 offset:8768
    v_mfma_f32_16x16x32_bf16 v[140:143], a[224:227], v[32:35], 0
    buffer_load_dwordx4 v227, s[4:7], s86 offen offset:1024 nt lds
    ds_read_b64_tr_b16 a[148:149], v225 offset:128
    v_mfma_f32_16x16x32_bf16 v[140:143], a[228:231], v[36:39], v[140:143]
    s_add_u32 m0, s23, 121984
    ds_read_b64_tr_b16 a[150:151], v225 offset:8832
    v_mfma_f32_16x16x32_bf16 v[140:143], a[232:235], v[40:43], v[140:143]
    ds_read_b64_tr_b16 a[152:153], v226 offset:128
    v_max3_f32 v236, v136, v137, v138
    v_mfma_f32_16x16x32_bf16 v[140:143], a[236:239], v[44:47], v[140:143]
    ds_read_b64_tr_b16 a[154:155], v226 offset:8832
    v_mfma_f32_16x16x32_bf16 v[140:143], a[240:243], v[48:51], v[140:143]
    ds_read_b64_tr_b16 a[156:157], v225 offset:192
    v_mfma_f32_16x16x32_bf16 v[140:143], a[244:247], v[52:55], v[140:143]
    ds_read_b64_tr_b16 a[158:159], v225 offset:8896
    v_mfma_f32_16x16x32_bf16 v[140:143], a[248:251], v[56:59], v[140:143]
    ds_read_b64_tr_b16 a[160:161], v226 offset:192
    v_mfma_f32_16x16x32_bf16 v[140:143], a[252:255], v[60:63], v[140:143]
    ds_read_b64_tr_b16 a[162:163], v226 offset:8896
    v_mfma_f32_16x16x32_bf16 v[168:171], v[96:99], v[32:35], 0
    buffer_load_dwordx4 v227, s[4:7], s86 offen offset:2048 nt lds
    ds_read_b64_tr_b16 a[164:165], v225 offset:256
    v_mfma_f32_16x16x32_bf16 v[168:171], v[100:103], v[36:39], v[168:171]
    s_add_u32 m0, s23, 122048
    ds_read_b64_tr_b16 a[166:167], v225 offset:8960
    v_mfma_f32_16x16x32_bf16 v[168:171], v[104:107], v[40:43], v[168:171]
    ds_read_b64_tr_b16 a[168:169], v226 offset:256
    v_max3_f32 v236, v236, v139, v140
    v_max3_f32 v236, v236, v141, v142
    v_mfma_f32_16x16x32_bf16 v[168:171], v[108:111], v[44:47], v[168:171]
    ds_read_b64_tr_b16 a[170:171], v226 offset:8960
    v_mfma_f32_16x16x32_bf16 v[168:171], v[112:115], v[48:51], v[168:171]
    ds_read_b64_tr_b16 a[172:173], v225 offset:320
    v_mfma_f32_16x16x32_bf16 v[168:171], v[116:119], v[52:55], v[168:171]
    ds_read_b64_tr_b16 a[174:175], v225 offset:9024
    v_mfma_f32_16x16x32_bf16 v[168:171], v[120:123], v[56:59], v[168:171]
    ds_read_b64_tr_b16 a[176:177], v226 offset:320
    v_mfma_f32_16x16x32_bf16 v[168:171], v[124:127], v[60:63], v[168:171]
    ds_read_b64_tr_b16 a[178:179], v226 offset:9024
    v_mfma_f32_16x16x32_bf16 v[172:175], v[192:195], v[32:35], 0
    buffer_load_dwordx4 v227, s[4:7], s86 offen offset:3072 nt lds
    ds_read_b64_tr_b16 a[180:181], v225 offset:384
    v_mfma_f32_16x16x32_bf16 v[172:175], v[196:199], v[36:39], v[172:175]
    s_addk_i32 s86, 4096
    ds_read_b64_tr_b16 a[182:183], v225 offset:9088
    v_mfma_f32_16x16x32_bf16 v[172:175], v[200:203], v[40:43], v[172:175]
    ds_read_b64_tr_b16 a[184:185], v226 offset:384
    v_max3_f32 v236, v236, v143, v168
    v_max3_f32 v236, v236, v169, v170
    v_mfma_f32_16x16x32_bf16 v[172:175], v[204:207], v[44:47], v[172:175]
    ds_read_b64_tr_b16 a[186:187], v226 offset:9088
    v_mfma_f32_16x16x32_bf16 v[172:175], v[208:211], v[48:51], v[172:175]
    ds_read_b64_tr_b16 a[188:189], v225 offset:448
    v_mfma_f32_16x16x32_bf16 v[172:175], v[212:215], v[52:55], v[172:175]
    ds_read_b64_tr_b16 a[190:191], v225 offset:9152
    v_mfma_f32_16x16x32_bf16 v[172:175], v[216:219], v[56:59], v[172:175]
    ds_read_b64_tr_b16 v[152:153], v226 offset:448
    v_mfma_f32_16x16x32_bf16 v[172:175], v[220:223], v[60:63], v[172:175]
    ds_read_b64_tr_b16 v[154:155], v226 offset:9152
    s_nop 6
    v_max3_f32 v236, v236, v171, v172
    v_max3_f32 v236, v236, v173, v174
    v_max_f32 v236, v236, v175
    v_mov_b32 v237, v236
    s_nop 1
    v_permlane16_swap_b32 v236, v237
    s_nop 0
    v_max_f32 v236, v236, v237
    v_mov_b32 v237, v236
    s_nop 1
    v_permlane32_swap_b32 v236, v237
    s_nop 0
    v_max_f32 v236, v236, v237
    v_mul_f32 v244, -1.0, v236
    v_fma_f32 v136, v136, 1.0, v244
    v_fma_f32 v137, v137, 1.0, v244
    v_fma_f32 v138, v138, 1.0, v244
    v_fma_f32 v139, v139, 1.0, v244
    v_fma_f32 v140, v140, 1.0, v244
    v_fma_f32 v141, v141, 1.0, v244
    v_fma_f32 v142, v142, 1.0, v244
    v_fma_f32 v143, v143, 1.0, v244
    v_exp_f32 v136, v136
    v_exp_f32 v137, v137
    v_exp_f32 v138, v138
    v_add_f32 v229, v136, v137
    v_cvt_pk_bf16_f32 v136, v136, v137
    v_add_f32 v229, v229, v138
    v_exp_f32 v139, v139
    v_exp_f32 v140, v140
    v_add_f32 v229, v229, v139
    v_cvt_pk_bf16_f32 v137, v138, v139
    v_exp_f32 v141, v141
    v_exp_f32 v142, v142
    v_cvt_pk_bf16_f32 v138, v140, v141
    v_exp_f32 v143, v143
    v_add_f32 v229, v229, v140
    v_cvt_pk_bf16_f32 v139, v142, v143
    v_add_f32 v229, v229, v141
    v_add_f32 v229, v229, v142
    v_mfma_f32_16x16x32_bf16 a[64:67], a[68:71], v[136:139], 0
    v_add_f32 v229, v229, v143
    v_mov_b32 v245, v244
    v_mov_b32 v246, v244
    v_mfma_f32_16x16x32_bf16 a[68:71], a[72:75], v[136:139], 0
    v_mov_b32 v247, v244
    v_fma_f32 v168, v168, 1.0, v244
    v_fma_f32 v169, v169, 1.0, v244
    v_mfma_f32_16x16x32_bf16 a[72:75], a[76:79], v[136:139], 0
    v_fma_f32 v170, v170, 1.0, v244
    v_fma_f32 v171, v171, 1.0, v244
    v_fma_f32 v172, v172, 1.0, v244
    v_mfma_f32_16x16x32_bf16 a[76:79], a[80:83], v[136:139], 0
    v_exp_f32 v168, v168
    v_fma_f32 v173, v173, 1.0, v244
    v_mfma_f32_16x16x32_bf16 a[80:83], a[84:87], v[136:139], 0
    v_exp_f32 v169, v169
    v_fma_f32 v174, v174, 1.0, v244
    v_mfma_f32_16x16x32_bf16 a[84:87], a[88:91], v[136:139], 0
    v_exp_f32 v170, v170
    v_fma_f32 v175, v175, 1.0, v244
    v_mfma_f32_16x16x32_bf16 a[88:91], a[92:95], v[136:139], 0
    v_exp_f32 v171, v171
    v_add_f32 v233, v168, v169
    v_mfma_f32_16x16x32_bf16 a[92:95], a[96:99], v[136:139], 0
    v_exp_f32 v172, v172
    v_cvt_pk_bf16_f32 v168, v168, v169
    v_mfma_f32_16x16x32_bf16 a[96:99], a[100:103], v[136:139], 0
    v_exp_f32 v173, v173
    v_add_f32 v233, v233, v170
    v_mfma_f32_16x16x32_bf16 a[100:103], a[104:107], v[136:139], 0
    v_exp_f32 v174, v174
    v_add_f32 v233, v233, v171
    v_mfma_f32_16x16x32_bf16 a[104:107], a[108:111], v[136:139], 0
    v_exp_f32 v175, v175
    v_cvt_pk_bf16_f32 v169, v170, v171
    v_mfma_f32_16x16x32_bf16 a[108:111], a[112:115], v[136:139], 0
    v_add_f32 v233, v233, v172
    v_add_f32 v233, v233, v173
    v_cvt_pk_bf16_f32 v170, v172, v173
    v_mfma_f32_16x16x32_bf16 a[112:115], a[116:119], v[136:139], 0
    v_add_f32 v233, v233, v174
    v_add_f32 v233, v233, v175
    v_cvt_pk_bf16_f32 v171, v174, v175
    v_mfma_f32_16x16x32_bf16 a[116:119], a[120:123], v[136:139], 0
    v_mfma_f32_16x16x32_bf16 a[120:123], a[124:127], v[136:139], 0
    v_mfma_f32_16x16x32_bf16 a[124:127], a[128:131], v[136:139], 0
    s_waitcnt vmcnt(8)
    ds_read_b128 v[64:67], v253 offset:0
    ds_read_b128 v[68:71], v253 offset:64
    ds_read_b128 v[72:75], v253 offset:128
    ds_read_b128 v[76:79], v253 offset:192
    ds_read_b128 v[80:83], v253 offset:256
    ds_read_b128 v[84:87], v253 offset:320
    ds_read_b128 v[88:91], v253 offset:384
    ds_read_b128 v[92:95], v253 offset:448
    s_waitcnt lgkmcnt(0)
    s_add_u32 m0, s23, 34816
    v_lshlrev_b32 v128, 16, v64
    buffer_load_dwordx4 v227, s[8:11], s21 offen offset:0 nt lds
    s_add_u32 m0, s23, 34880
    v_lshlrev_b32 v130, 16, v65
    buffer_load_dwordx4 v227, s[8:11], s21 offen offset:1024 nt lds
    s_add_u32 m0, s23, 34944
    v_lshlrev_b32 v132, 16, v66
    buffer_load_dwordx4 v227, s[8:11], s21 offen offset:2048 nt lds
    s_add_u32 m0, s23, 35008
    v_lshlrev_b32 v134, 16, v67
    buffer_load_dwordx4 v227, s[8:11], s21 offen offset:3072 nt lds
    s_addk_i32 s21, 16384
    v_and_b32 v129, s95, v64
    v_and_b32 v131, s95, v65
    v_and_b32 v133, s95, v66
    v_and_b32 v135, s95, v67
    v_pk_mul_f32 v[128:129], v[128:129], s[20:21] op_sel_hi:[1,0]
    v_pk_mul_f32 v[130:131], v[130:131], s[20:21] op_sel_hi:[1,0]
    v_pk_mul_f32 v[132:133], v[132:133], s[20:21] op_sel_hi:[1,0]
    v_pk_mul_f32 v[134:135], v[134:135], s[20:21] op_sel_hi:[1,0]
    v_cvt_pk_bf16_f32 v64, v128, v129
    v_cvt_pk_bf16_f32 v65, v130, v131
    v_cvt_pk_bf16_f32 v66, v132, v133
    v_cvt_pk_bf16_f32 v67, v134, v135
    v_lshlrev_b32 v128, 16, v68
    v_lshlrev_b32 v130, 16, v69
    v_lshlrev_b32 v132, 16, v70
    v_lshlrev_b32 v134, 16, v71
    v_and_b32 v129, s95, v68
    v_and_b32 v131, s95, v69
    v_and_b32 v133, s95, v70
    v_and_b32 v135, s95, v71
    v_pk_mul_f32 v[128:129], v[128:129], s[20:21] op_sel_hi:[1,0]
    v_pk_mul_f32 v[130:131], v[130:131], s[20:21] op_sel_hi:[1,0]
    v_pk_mul_f32 v[132:133], v[132:133], s[20:21] op_sel_hi:[1,0]
    v_pk_mul_f32 v[134:135], v[134:135], s[20:21] op_sel_hi:[1,0]
    v_cvt_pk_bf16_f32 v68, v128, v129
    v_cvt_pk_bf16_f32 v69, v130, v131
    v_cvt_pk_bf16_f32 v70, v132, v133
    v_cvt_pk_bf16_f32 v71, v134, v135
    v_lshlrev_b32 v128, 16, v72
    v_lshlrev_b32 v130, 16, v73
    v_lshlrev_b32 v132, 16, v74
    v_lshlrev_b32 v134, 16, v75
    v_and_b32 v129, s95, v72
    v_and_b32 v131, s95, v73
    v_and_b32 v133, s95, v74
    v_and_b32 v135, s95, v75
    v_pk_mul_f32 v[128:129], v[128:129], s[20:21] op_sel_hi:[1,0]
    v_pk_mul_f32 v[130:131], v[130:131], s[20:21] op_sel_hi:[1,0]
    v_pk_mul_f32 v[132:133], v[132:133], s[20:21] op_sel_hi:[1,0]
    v_pk_mul_f32 v[134:135], v[134:135], s[20:21] op_sel_hi:[1,0]
    v_cvt_pk_bf16_f32 v72, v128, v129
    v_cvt_pk_bf16_f32 v73, v130, v131
    v_cvt_pk_bf16_f32 v74, v132, v133
    v_cvt_pk_bf16_f32 v75, v134, v135
    v_lshlrev_b32 v128, 16, v76
    v_lshlrev_b32 v130, 16, v77
    v_lshlrev_b32 v132, 16, v78
    v_lshlrev_b32 v134, 16, v79
    v_and_b32 v129, s95, v76
    v_and_b32 v131, s95, v77
    v_and_b32 v133, s95, v78
    v_and_b32 v135, s95, v79
    v_pk_mul_f32 v[128:129], v[128:129], s[20:21] op_sel_hi:[1,0]
    v_pk_mul_f32 v[130:131], v[130:131], s[20:21] op_sel_hi:[1,0]
    v_pk_mul_f32 v[132:133], v[132:133], s[20:21] op_sel_hi:[1,0]
    v_pk_mul_f32 v[134:135], v[134:135], s[20:21] op_sel_hi:[1,0]
    v_cvt_pk_bf16_f32 v76, v128, v129
    v_cvt_pk_bf16_f32 v77, v130, v131
    v_cvt_pk_bf16_f32 v78, v132, v133
    v_cvt_pk_bf16_f32 v79, v134, v135
    v_lshlrev_b32 v128, 16, v80
    v_lshlrev_b32 v130, 16, v81
    v_lshlrev_b32 v132, 16, v82
    v_lshlrev_b32 v134, 16, v83
    v_and_b32 v129, s95, v80
    v_and_b32 v131, s95, v81
    v_and_b32 v133, s95, v82
    v_and_b32 v135, s95, v83
    v_pk_mul_f32 v[128:129], v[128:129], s[20:21] op_sel_hi:[1,0]
    v_pk_mul_f32 v[130:131], v[130:131], s[20:21] op_sel_hi:[1,0]
    v_pk_mul_f32 v[132:133], v[132:133], s[20:21] op_sel_hi:[1,0]
    v_pk_mul_f32 v[134:135], v[134:135], s[20:21] op_sel_hi:[1,0]
    v_cvt_pk_bf16_f32 v80, v128, v129
    v_cvt_pk_bf16_f32 v81, v130, v131
    v_cvt_pk_bf16_f32 v82, v132, v133
    v_cvt_pk_bf16_f32 v83, v134, v135
    v_lshlrev_b32 v128, 16, v84
    v_lshlrev_b32 v130, 16, v85
    v_lshlrev_b32 v132, 16, v86
    v_lshlrev_b32 v134, 16, v87
    v_and_b32 v129, s95, v84
    v_and_b32 v131, s95, v85
    v_and_b32 v133, s95, v86
    v_and_b32 v135, s95, v87
    v_pk_mul_f32 v[128:129], v[128:129], s[20:21] op_sel_hi:[1,0]
    v_pk_mul_f32 v[130:131], v[130:131], s[20:21] op_sel_hi:[1,0]
    v_pk_mul_f32 v[132:133], v[132:133], s[20:21] op_sel_hi:[1,0]
    v_pk_mul_f32 v[134:135], v[134:135], s[20:21] op_sel_hi:[1,0]
    v_cvt_pk_bf16_f32 v84, v128, v129
    v_cvt_pk_bf16_f32 v85, v130, v131
    v_cvt_pk_bf16_f32 v86, v132, v133
    v_cvt_pk_bf16_f32 v87, v134, v135
    v_lshlrev_b32 v128, 16, v88
    v_lshlrev_b32 v130, 16, v89
    v_lshlrev_b32 v132, 16, v90
    v_lshlrev_b32 v134, 16, v91
    v_and_b32 v129, s95, v88
    v_and_b32 v131, s95, v89
    v_and_b32 v133, s95, v90
    v_and_b32 v135, s95, v91
    v_pk_mul_f32 v[128:129], v[128:129], s[20:21] op_sel_hi:[1,0]
    v_pk_mul_f32 v[130:131], v[130:131], s[20:21] op_sel_hi:[1,0]
    v_pk_mul_f32 v[132:133], v[132:133], s[20:21] op_sel_hi:[1,0]
    v_pk_mul_f32 v[134:135], v[134:135], s[20:21] op_sel_hi:[1,0]
    v_cvt_pk_bf16_f32 v88, v128, v129
    v_cvt_pk_bf16_f32 v89, v130, v131
    v_cvt_pk_bf16_f32 v90, v132, v133
    v_cvt_pk_bf16_f32 v91, v134, v135
    v_lshlrev_b32 v128, 16, v92
    v_lshlrev_b32 v130, 16, v93
    v_lshlrev_b32 v132, 16, v94
    v_lshlrev_b32 v134, 16, v95
    v_and_b32 v129, s95, v92
    v_and_b32 v131, s95, v93
    v_and_b32 v133, s95, v94
    v_and_b32 v135, s95, v95
    v_pk_mul_f32 v[128:129], v[128:129], s[20:21] op_sel_hi:[1,0]
    v_pk_mul_f32 v[130:131], v[130:131], s[20:21] op_sel_hi:[1,0]
    v_pk_mul_f32 v[132:133], v[132:133], s[20:21] op_sel_hi:[1,0]
    v_pk_mul_f32 v[134:135], v[134:135], s[20:21] op_sel_hi:[1,0]
    v_cvt_pk_bf16_f32 v92, v128, v129
    v_cvt_pk_bf16_f32 v93, v130, v131
    v_cvt_pk_bf16_f32 v94, v132, v133
    v_cvt_pk_bf16_f32 v95, v134, v135
    s_nop 1
    v_mfma_f32_16x16x32_bf16 v[144:147], a[192:195], v[64:67], 0
    s_add_u32 m0, s23, 52224
    ds_read_b128 v[128:131], v224 offset:17408
    v_mfma_f32_16x16x32_bf16 v[144:147], a[196:199], v[68:71], v[144:147]
    buffer_load_dwordx4 v227, s[8:11], s21 offen offset:0 nt lds
    ds_read_b128 v[132:135], v224 offset:17472
    v_mfma_f32_16x16x32_bf16 v[144:147], a[200:203], v[72:75], v[144:147]
    s_add_u32 m0, s23, 52288
    ds_read_b128 v[136:139], v224 offset:17536
    v_mfma_f32_16x16x32_bf16 v[144:147], a[204:207], v[76:79], v[144:147]
    ds_read_b128 v[140:143], v224 offset:17600
    v_mfma_f32_16x16x32_bf16 v[144:147], a[208:211], v[80:83], v[144:147]
    ds_read_b128 v[164:167], v224 offset:17664
    v_mfma_f32_16x16x32_bf16 v[144:147], a[212:215], v[84:87], v[144:147]
    ds_read_b128 v[172:175], v224 offset:17728
    v_mfma_f32_16x16x32_bf16 v[144:147], a[216:219], v[88:91], v[144:147]
    v_mfma_f32_16x16x32_bf16 v[144:147], a[220:223], v[92:95], v[144:147]
    v_mfma_f32_16x16x32_bf16 v[148:151], a[224:227], v[64:67], 0
    buffer_load_dwordx4 v227, s[8:11], s21 offen offset:1024 nt lds
    v_mfma_f32_16x16x32_bf16 v[148:151], a[228:231], v[68:71], v[148:151]
    s_add_u32 m0, s23, 52352
    v_mfma_f32_16x16x32_bf16 v[148:151], a[232:235], v[72:75], v[148:151]
    v_mfma_f32_16x16x32_bf16 v[148:151], a[236:239], v[76:79], v[148:151]
    v_mfma_f32_16x16x32_bf16 v[148:151], a[240:243], v[80:83], v[148:151]
    v_mfma_f32_16x16x32_bf16 v[148:151], a[244:247], v[84:87], v[148:151]
    v_max3_f32 v236, v144, v145, v146
    v_mfma_f32_16x16x32_bf16 v[148:151], a[248:251], v[88:91], v[148:151]
    v_mfma_f32_16x16x32_bf16 v[148:151], a[252:255], v[92:95], v[148:151]
    v_mfma_f32_16x16x32_bf16 v[176:179], v[96:99], v[64:67], 0
    buffer_load_dwordx4 v227, s[8:11], s21 offen offset:2048 nt lds
    v_mfma_f32_16x16x32_bf16 v[176:179], v[100:103], v[68:71], v[176:179]
    s_add_u32 m0, s23, 52416
    v_mfma_f32_16x16x32_bf16 v[176:179], v[104:107], v[72:75], v[176:179]
    v_mfma_f32_16x16x32_bf16 v[176:179], v[108:111], v[76:79], v[176:179]
    v_mfma_f32_16x16x32_bf16 v[176:179], v[112:115], v[80:83], v[176:179]
    v_mfma_f32_16x16x32_bf16 v[176:179], v[116:119], v[84:87], v[176:179]
    v_max3_f32 v236, v236, v147, v148
    v_max3_f32 v236, v236, v149, v150
    v_mfma_f32_16x16x32_bf16 v[176:179], v[120:123], v[88:91], v[176:179]
    v_mfma_f32_16x16x32_bf16 v[176:179], v[124:127], v[92:95], v[176:179]
    v_mfma_f32_16x16x32_bf16 v[180:183], v[192:195], v[64:67], 0
    buffer_load_dwordx4 v227, s[8:11], s21 offen offset:3072 nt lds
    v_mfma_f32_16x16x32_bf16 v[180:183], v[196:199], v[68:71], v[180:183]
    s_addk_i32 s21, 16384
    v_mfma_f32_16x16x32_bf16 v[180:183], v[200:203], v[72:75], v[180:183]
    v_mfma_f32_16x16x32_bf16 v[180:183], v[204:207], v[76:79], v[180:183]
    v_mfma_f32_16x16x32_bf16 v[180:183], v[208:211], v[80:83], v[180:183]
    v_mfma_f32_16x16x32_bf16 v[180:183], v[212:215], v[84:87], v[180:183]
    v_max3_f32 v236, v236, v151, v176
    v_max3_f32 v236, v236, v177, v178
    v_mfma_f32_16x16x32_bf16 v[180:183], v[216:219], v[88:91], v[180:183]
    v_mfma_f32_16x16x32_bf16 v[180:183], v[220:223], v[92:95], v[180:183]
    s_nop 7
    v_max3_f32 v236, v236, v179, v180
    v_max3_f32 v236, v236, v181, v182
    v_max_f32 v236, v236, v183
    v_mov_b32 v237, v236
    s_nop 1
    v_permlane16_swap_b32 v236, v237
    s_nop 0
    v_max_f32 v236, v236, v237
    v_mov_b32 v237, v236
    s_nop 1
    v_permlane32_swap_b32 v236, v237
    s_nop 0
    v_max_f32 v236, v236, v237
    v_mul_f32 v248, -1.0, v236
    v_fma_f32 v144, v144, 1.0, v248
    v_fma_f32 v145, v145, 1.0, v248
    v_fma_f32 v146, v146, 1.0, v248
    v_fma_f32 v147, v147, 1.0, v248
    v_fma_f32 v148, v148, 1.0, v248
    v_fma_f32 v149, v149, 1.0, v248
    v_fma_f32 v150, v150, 1.0, v248
    v_fma_f32 v151, v151, 1.0, v248
    v_exp_f32 v144, v144
    v_exp_f32 v145, v145
    v_exp_f32 v146, v146
    v_add_f32 v230, v144, v145
    v_cvt_pk_bf16_f32 v144, v144, v145
    v_add_f32 v230, v230, v146
    v_exp_f32 v147, v147
    v_exp_f32 v148, v148
    v_add_f32 v230, v230, v147
    v_cvt_pk_bf16_f32 v145, v146, v147
    v_exp_f32 v149, v149
    v_exp_f32 v150, v150
    v_cvt_pk_bf16_f32 v146, v148, v149
    v_exp_f32 v151, v151
    v_add_f32 v230, v230, v148
    v_cvt_pk_bf16_f32 v147, v150, v151
    v_add_f32 v230, v230, v149
    v_add_f32 v230, v230, v150
    v_mfma_f32_16x16x32_bf16 a[128:131], a[132:135], v[144:147], 0
    v_add_f32 v230, v230, v151
    v_mov_b32 v249, v248
    v_mov_b32 v250, v248
    v_mfma_f32_16x16x32_bf16 a[132:135], a[136:139], v[144:147], 0
    v_mov_b32 v251, v248
    v_fma_f32 v176, v176, 1.0, v248
    v_fma_f32 v177, v177, 1.0, v248
    v_mfma_f32_16x16x32_bf16 a[136:139], a[140:143], v[144:147], 0
    v_fma_f32 v178, v178, 1.0, v248
    v_fma_f32 v179, v179, 1.0, v248
    v_fma_f32 v180, v180, 1.0, v248
    v_mfma_f32_16x16x32_bf16 a[140:143], a[144:147], v[144:147], 0
    v_exp_f32 v176, v176
    v_fma_f32 v181, v181, 1.0, v248
    v_mfma_f32_16x16x32_bf16 a[144:147], a[148:151], v[144:147], 0
    v_exp_f32 v177, v177
    v_fma_f32 v182, v182, 1.0, v248
    v_mfma_f32_16x16x32_bf16 a[148:151], a[152:155], v[144:147], 0
    v_exp_f32 v178, v178
    v_fma_f32 v183, v183, 1.0, v248
    v_mfma_f32_16x16x32_bf16 a[152:155], a[156:159], v[144:147], 0
    v_exp_f32 v179, v179
    v_add_f32 v234, v176, v177
    v_mfma_f32_16x16x32_bf16 a[156:159], a[160:163], v[144:147], 0
    v_exp_f32 v180, v180
    v_cvt_pk_bf16_f32 v176, v176, v177
    v_mfma_f32_16x16x32_bf16 a[160:163], a[164:167], v[144:147], 0
    v_exp_f32 v181, v181
    v_add_f32 v234, v234, v178
    v_mfma_f32_16x16x32_bf16 a[164:167], a[168:171], v[144:147], 0
    v_exp_f32 v182, v182
    v_add_f32 v234, v234, v179
    v_mfma_f32_16x16x32_bf16 a[168:171], a[172:175], v[144:147], 0
    v_exp_f32 v183, v183
    v_cvt_pk_bf16_f32 v177, v178, v179
    v_mfma_f32_16x16x32_bf16 a[172:175], a[176:179], v[144:147], 0
    v_add_f32 v234, v234, v180
    v_add_f32 v234, v234, v181
    v_cvt_pk_bf16_f32 v178, v180, v181
    v_mfma_f32_16x16x32_bf16 a[176:179], a[180:183], v[144:147], 0
    v_mfma_f32_16x16x32_bf16 a[180:183], a[184:187], v[144:147], 0
    v_mfma_f32_16x16x32_bf16 a[184:187], a[188:191], v[144:147], 0
    v_mfma_f32_16x16x32_bf16 a[188:191], v[152:155], v[144:147], 0
    ds_read_b128 v[144:147], v224 offset:17792
    ds_read_b128 v[148:151], v224 offset:17856
    s_waitcnt vmcnt(8)
    ds_read_b128 v[96:99], v254 offset:34816
    ds_read_b128 v[100:103], v254 offset:34880
    ds_read_b128 v[104:107], v254 offset:34944
    ds_read_b128 v[108:111], v254 offset:35008
    ds_read_b128 v[112:115], v254 offset:35072
    ds_read_b128 v[116:119], v254 offset:35136
    ds_read_b128 v[120:123], v254 offset:35200
    ds_read_b128 v[124:127], v254 offset:35264
    s_waitcnt lgkmcnt(7)
    v_mfma_f32_16x16x32_bf16 v[152:155], a[192:195], v[96:99], 0
    s_waitcnt lgkmcnt(6)
    v_mfma_f32_16x16x32_bf16 v[152:155], a[196:199], v[100:103], v[152:155]
    s_waitcnt lgkmcnt(5)
    ds_read_b64_tr_b16 a[196:197], v225 offset:0
    v_mfma_f32_16x16x32_bf16 v[152:155], a[200:203], v[104:107], v[152:155]
    s_waitcnt lgkmcnt(5)
    s_add_u32 m0, s23, 87040
    ds_read_b64_tr_b16 a[198:199], v225 offset:8704
    buffer_load_dwordx4 v227, s[12:15], s22 offen offset:0 nt lds
    v_mfma_f32_16x16x32_bf16 v[152:155], a[204:207], v[108:111], v[152:155]
    s_waitcnt lgkmcnt(5)
    s_add_u32 m0, s23, 87104
    ds_read_b64_tr_b16 a[200:201], v226 offset:0
    buffer_load_dwordx4 v227, s[12:15], s22 offen offset:1024 nt lds
    v_mfma_f32_16x16x32_bf16 v[152:155], a[208:211], v[112:115], v[152:155]
    s_waitcnt lgkmcnt(5)
    s_add_u32 m0, s23, 87168
    ds_read_b64_tr_b16 a[202:203], v226 offset:8704
    buffer_load_dwordx4 v227, s[12:15], s22 offen offset:2048 nt lds
    v_mfma_f32_16x16x32_bf16 v[152:155], a[212:215], v[116:119], v[152:155]
    s_waitcnt lgkmcnt(5)
    s_add_u32 m0, s23, 87232
    ds_read_b64_tr_b16 a[204:205], v225 offset:64
    buffer_load_dwordx4 v227, s[12:15], s22 offen offset:3072 nt lds
    v_mfma_f32_16x16x32_bf16 v[152:155], a[216:219], v[120:123], v[152:155]
    s_waitcnt lgkmcnt(5)
    s_addk_i32 s22, 16384
    ds_read_b64_tr_b16 a[206:207], v225 offset:8768
    v_mfma_f32_16x16x32_bf16 v[152:155], a[220:223], v[124:127], v[152:155]
    s_add_u32 m0, s23, 104448
    ds_read_b64_tr_b16 a[208:209], v226 offset:64
    buffer_load_dwordx4 v227, s[12:15], s22 offen offset:0 nt lds
    v_mfma_f32_16x16x32_bf16 v[156:159], a[224:227], v[96:99], 0
    s_add_u32 m0, s23, 104512
    ds_read_b64_tr_b16 a[210:211], v226 offset:8768
    buffer_load_dwordx4 v227, s[12:15], s22 offen offset:1024 nt lds
    v_mfma_f32_16x16x32_bf16 v[156:159], a[228:231], v[100:103], v[156:159]
    s_add_u32 m0, s23, 104576
    ds_read_b64_tr_b16 a[212:213], v225 offset:128
    buffer_load_dwordx4 v227, s[12:15], s22 offen offset:2048 nt lds
    v_mfma_f32_16x16x32_bf16 v[156:159], a[232:235], v[104:107], v[156:159]
    s_add_u32 m0, s23, 104640
    ds_read_b64_tr_b16 a[214:215], v225 offset:8832
    buffer_load_dwordx4 v227, s[12:15], s22 offen offset:3072 nt lds
    v_mfma_f32_16x16x32_bf16 v[156:159], a[236:239], v[108:111], v[156:159]
    s_addk_i32 s22, 16384
    ds_read_b64_tr_b16 a[216:217], v226 offset:128
    v_max3_f32 v236, v152, v153, v154
    v_mfma_f32_16x16x32_bf16 v[156:159], a[240:243], v[112:115], v[156:159]
    ds_read_b64_tr_b16 a[218:219], v226 offset:8832
    v_mfma_f32_16x16x32_bf16 v[156:159], a[244:247], v[116:119], v[156:159]
    ds_read_b64_tr_b16 a[220:221], v225 offset:192
    v_mfma_f32_16x16x32_bf16 v[156:159], a[248:251], v[120:123], v[156:159]
    ds_read_b64_tr_b16 a[222:223], v225 offset:8896
    v_mfma_f32_16x16x32_bf16 v[156:159], a[252:255], v[124:127], v[156:159]
    ds_read_b64_tr_b16 a[224:225], v226 offset:192
    v_mfma_f32_16x16x32_bf16 v[184:187], v[128:131], v[96:99], 0
    ds_read_b64_tr_b16 a[226:227], v226 offset:8896
    v_mfma_f32_16x16x32_bf16 v[184:187], v[132:135], v[100:103], v[184:187]
    ds_read_b64_tr_b16 a[228:229], v225 offset:256
    v_mfma_f32_16x16x32_bf16 v[184:187], v[136:139], v[104:107], v[184:187]
    ds_read_b64_tr_b16 a[230:231], v225 offset:8960
    v_mfma_f32_16x16x32_bf16 v[184:187], v[140:143], v[108:111], v[184:187]
    ds_read_b64_tr_b16 a[232:233], v226 offset:256
    v_max3_f32 v236, v236, v155, v156
    v_max3_f32 v236, v236, v157, v158
    v_mfma_f32_16x16x32_bf16 v[184:187], v[164:167], v[112:115], v[184:187]
    ds_read_b64_tr_b16 a[234:235], v226 offset:8960
    v_mfma_f32_16x16x32_bf16 v[184:187], v[172:175], v[116:119], v[184:187]
    ds_read_b64_tr_b16 a[236:237], v225 offset:320
    v_mfma_f32_16x16x32_bf16 v[184:187], v[144:147], v[120:123], v[184:187]
    ds_read_b64_tr_b16 a[238:239], v225 offset:9024
    v_mfma_f32_16x16x32_bf16 v[184:187], v[148:151], v[124:127], v[184:187]
    ds_read_b64_tr_b16 a[240:241], v226 offset:320
    v_mfma_f32_16x16x32_bf16 v[188:191], v[192:195], v[96:99], 0
    ds_read_b64_tr_b16 a[242:243], v226 offset:9024
    v_mfma_f32_16x16x32_bf16 v[188:191], v[196:199], v[100:103], v[188:191]
    ds_read_b64_tr_b16 a[244:245], v225 offset:384
    v_mfma_f32_16x16x32_bf16 v[188:191], v[200:203], v[104:107], v[188:191]
    ds_read_b64_tr_b16 a[246:247], v225 offset:9088
    v_mfma_f32_16x16x32_bf16 v[188:191], v[204:207], v[108:111], v[188:191]
    ds_read_b64_tr_b16 a[248:249], v226 offset:384
    v_max3_f32 v236, v236, v159, v184
    v_max3_f32 v236, v236, v185, v186
    v_mfma_f32_16x16x32_bf16 v[188:191], v[208:211], v[112:115], v[188:191]
    ds_read_b64_tr_b16 a[250:251], v226 offset:9088
    v_mfma_f32_16x16x32_bf16 v[188:191], v[212:215], v[116:119], v[188:191]
    ds_read_b64_tr_b16 a[252:253], v225 offset:448
    v_mfma_f32_16x16x32_bf16 v[188:191], v[216:219], v[120:123], v[188:191]
    ds_read_b64_tr_b16 a[254:255], v225 offset:9152
    v_mfma_f32_16x16x32_bf16 v[188:191], v[220:223], v[124:127], v[188:191]
    s_waitcnt lgkmcnt(14)
    ds_read_b64_tr_b16 v[128:129], v226 offset:448
    v_lshlrev_b32 v132, 16, v96
    v_lshlrev_b32 v134, 16, v97
    ds_read_b64_tr_b16 v[130:131], v226 offset:9152
    v_lshlrev_b32 v136, 16, v98
    v_lshlrev_b32 v138, 16, v99
    v_and_b32 v133, s95, v96
    v_and_b32 v135, s95, v97
    v_max3_f32 v236, v236, v187, v188
    v_max3_f32 v236, v236, v189, v190
    v_max_f32 v236, v236, v191
    v_mov_b32 v237, v236
    v_and_b32 v137, s95, v98
    v_and_b32 v139, s95, v99
    v_permlane16_swap_b32 v236, v237
    v_mul_f32 v132, s20, v132
    v_max_f32 v236, v236, v237
    v_mov_b32 v237, v236
    v_mul_f32 v133, s20, v133
    v_mul_f32 v134, s20, v134
    v_permlane32_swap_b32 v236, v237
    v_mul_f32 v135, s20, v135
    v_max_f32 v236, v236, v237
    v_mul_f32 v252, s25, v236
    v_fma_f32 v152, v152, s20, v252
    v_fma_f32 v153, v153, s20, v252
    v_fma_f32 v154, v154, s20, v252
    v_fma_f32 v155, v155, s20, v252
    v_fma_f32 v156, v156, s20, v252
    v_fma_f32 v157, v157, s20, v252
    v_fma_f32 v158, v158, s20, v252
    v_fma_f32 v159, v159, s20, v252
    v_exp_f32 v152, v152
    v_exp_f32 v153, v153
    v_exp_f32 v154, v154
    v_add_f32 v231, v152, v153
    v_cvt_pk_bf16_f32 v152, v152, v153
    v_add_f32 v231, v231, v154
    v_exp_f32 v155, v155
    v_exp_f32 v156, v156
    v_add_f32 v231, v231, v155
    v_cvt_pk_bf16_f32 v153, v154, v155
    v_exp_f32 v157, v157
    v_exp_f32 v158, v158
    v_cvt_pk_bf16_f32 v154, v156, v157
    v_exp_f32 v159, v159
    v_add_f32 v231, v231, v156
    v_cvt_pk_bf16_f32 v155, v158, v159
    v_add_f32 v231, v231, v157
    v_add_f32 v231, v231, v158
    v_mfma_f32_16x16x32_bf16 a[192:195], a[196:199], v[152:155], 0
    v_add_f32 v231, v231, v159
    v_mov_b32 v253, v252
    v_mov_b32 v254, v252
    v_mov_b32 v255, v252
    v_fma_f32 v184, v184, s20, v252
    v_fma_f32 v185, v185, s20, v252
    v_fma_f32 v186, v186, s20, v252
    v_fma_f32 v187, v187, s20, v252
    v_fma_f32 v188, v188, s20, v252
    v_fma_f32 v189, v189, s20, v252
    v_fma_f32 v190, v190, s20, v252
    v_fma_f32 v191, v191, s20, v252
    v_mfma_f32_16x16x32_bf16 a[196:199], a[200:203], v[152:155], 0
    v_mul_f32 v136, s20, v136
    v_mul_f32 v137, s20, v137
    v_mul_f32 v138, s20, v138
    v_mul_f32 v139, s20, v139
    v_cvt_pk_bf16_f32 v96, v132, v133
    v_cvt_pk_bf16_f32 v97, v134, v135
    v_cvt_pk_bf16_f32 v98, v136, v137
    v_cvt_pk_bf16_f32 v99, v138, v139
    v_lshlrev_b32 v132, 16, v100
    v_lshlrev_b32 v134, 16, v101
    v_lshlrev_b32 v136, 16, v102
    v_lshlrev_b32 v138, 16, v103
    v_mfma_f32_16x16x32_bf16 a[200:203], a[204:207], v[152:155], 0
    v_and_b32 v133, s95, v100
    v_and_b32 v135, s95, v101
    v_and_b32 v137, s95, v102
    v_and_b32 v139, s95, v103
    v_mul_f32 v132, s20, v132
    v_mul_f32 v133, s20, v133
    v_mul_f32 v134, s20, v134
    v_mul_f32 v135, s20, v135
    v_mul_f32 v136, s20, v136
    v_mul_f32 v137, s20, v137
    v_mul_f32 v138, s20, v138
    v_mul_f32 v139, s20, v139
    v_mfma_f32_16x16x32_bf16 a[204:207], a[208:211], v[152:155], 0
    v_cvt_pk_bf16_f32 v100, v132, v133
    v_cvt_pk_bf16_f32 v101, v134, v135
    v_cvt_pk_bf16_f32 v102, v136, v137
    v_cvt_pk_bf16_f32 v103, v138, v139
    v_lshlrev_b32 v132, 16, v104
    v_lshlrev_b32 v134, 16, v105
    v_lshlrev_b32 v136, 16, v106
    v_lshlrev_b32 v138, 16, v107
    v_and_b32 v133, s95, v104
    v_and_b32 v135, s95, v105
    v_and_b32 v137, s95, v106
    v_and_b32 v139, s95, v107
    v_mfma_f32_16x16x32_bf16 a[208:211], a[212:215], v[152:155], 0
    v_mul_f32 v132, s20, v132
    v_mul_f32 v133, s20, v133
    v_mul_f32 v134, s20, v134
    v_mul_f32 v135, s20, v135
    v_mul_f32 v136, s20, v136
    v_mul_f32 v137, s20, v137
    v_mul_f32 v138, s20, v138
    v_mul_f32 v139, s20, v139
    v_cvt_pk_bf16_f32 v104, v132, v133
    v_cvt_pk_bf16_f32 v105, v134, v135
    v_cvt_pk_bf16_f32 v106, v136, v137
    v_cvt_pk_bf16_f32 v107, v138, v139
    v_mfma_f32_16x16x32_bf16 a[212:215], a[216:219], v[152:155], 0
    v_lshlrev_b32 v132, 16, v108
    v_lshlrev_b32 v134, 16, v109
    v_lshlrev_b32 v136, 16, v110
    v_lshlrev_b32 v138, 16, v111
    v_and_b32 v133, s95, v108
    v_and_b32 v135, s95, v109
    v_and_b32 v137, s95, v110
    v_and_b32 v139, s95, v111
    v_mul_f32 v132, s20, v132
    v_mul_f32 v133, s20, v133
    v_mul_f32 v134, s20, v134
    v_mul_f32 v135, s20, v135
    v_mfma_f32_16x16x32_bf16 a[216:219], a[220:223], v[152:155], 0
    v_mul_f32 v136, s20, v136
    v_mul_f32 v137, s20, v137
    v_mul_f32 v138, s20, v138
    v_mul_f32 v139, s20, v139
    v_cvt_pk_bf16_f32 v108, v132, v133
    v_cvt_pk_bf16_f32 v109, v134, v135
    v_cvt_pk_bf16_f32 v110, v136, v137
    v_cvt_pk_bf16_f32 v111, v138, v139
    v_lshlrev_b32 v132, 16, v112
    v_lshlrev_b32 v134, 16, v113
    v_lshlrev_b32 v136, 16, v114
    v_lshlrev_b32 v138, 16, v115
    v_mfma_f32_16x16x32_bf16 a[220:223], a[224:227], v[152:155], 0
    s_waitcnt lgkmcnt(14)
    v_and_b32 v133, s95, v112
    v_and_b32 v135, s95, v113
    v_and_b32 v137, s95, v114
    v_and_b32 v139, s95, v115
    v_mul_f32 v132, s20, v132
    v_mul_f32 v133, s20, v133
    v_mul_f32 v134, s20, v134
    v_mul_f32 v135, s20, v135
    v_mul_f32 v136, s20, v136
    v_mul_f32 v137, s20, v137
    v_mul_f32 v138, s20, v138
    v_mul_f32 v139, s20, v139
    v_mfma_f32_16x16x32_bf16 a[224:227], a[228:231], v[152:155], 0
    s_waitcnt lgkmcnt(12)
    v_cvt_pk_bf16_f32 v112, v132, v133
    v_cvt_pk_bf16_f32 v113, v134, v135
    v_cvt_pk_bf16_f32 v114, v136, v137
    v_cvt_pk_bf16_f32 v115, v138, v139
    v_lshlrev_b32 v132, 16, v116
    v_lshlrev_b32 v134, 16, v117
    v_lshlrev_b32 v136, 16, v118
    v_lshlrev_b32 v138, 16, v119
    v_and_b32 v133, s95, v116
    v_and_b32 v135, s95, v117
    v_and_b32 v137, s95, v118
    v_and_b32 v139, s95, v119
    v_mfma_f32_16x16x32_bf16 a[228:231], a[232:235], v[152:155], 0
    s_waitcnt lgkmcnt(10)
    v_mul_f32 v132, s20, v132
    v_mul_f32 v133, s20, v133
    v_mul_f32 v134, s20, v134
    v_mul_f32 v135, s20, v135
    v_mul_f32 v136, s20, v136
    v_mul_f32 v137, s20, v137
    v_mul_f32 v138, s20, v138
    v_mul_f32 v139, s20, v139
    v_cvt_pk_bf16_f32 v116, v132, v133
    v_cvt_pk_bf16_f32 v117, v134, v135
    v_cvt_pk_bf16_f32 v118, v136, v137
    v_cvt_pk_bf16_f32 v119, v138, v139
    v_mfma_f32_16x16x32_bf16 a[232:235], a[236:239], v[152:155], 0
    s_waitcnt lgkmcnt(8)
    v_lshlrev_b32 v132, 16, v120
    v_lshlrev_b32 v134, 16, v121
    v_lshlrev_b32 v136, 16, v122
    v_lshlrev_b32 v138, 16, v123
    v_and_b32 v133, s95, v120
    v_and_b32 v135, s95, v121
    v_and_b32 v137, s95, v122
    v_and_b32 v139, s95, v123
    v_mul_f32 v132, s20, v132
    v_mul_f32 v133, s20, v133
    v_mul_f32 v134, s20, v134
    v_mul_f32 v135, s20, v135
    v_mfma_f32_16x16x32_bf16 a[236:239], a[240:243], v[152:155], 0
    s_waitcnt lgkmcnt(6)
    s_waitcnt vmcnt(12) lgkmcnt(0)
    s_barrier
    ds_read_b128 v[192:195], v224 offset:34816
    v_mul_f32 v136, s20, v136
    v_mul_f32 v137, s20, v137
    v_mul_f32 v138, s20, v138
    v_mul_f32 v139, s20, v139
    v_cvt_pk_bf16_f32 v120, v132, v133
    v_cvt_pk_bf16_f32 v121, v134, v135
    v_cvt_pk_bf16_f32 v122, v136, v137
    v_cvt_pk_bf16_f32 v123, v138, v139
    v_lshlrev_b32 v132, 16, v124
    v_lshlrev_b32 v134, 16, v125
    v_lshlrev_b32 v136, 16, v126
    v_mfma_f32_16x16x32_bf16 a[240:243], a[244:247], v[152:155], 0
    s_and_b32 s87, s22, 0x3000
    s_add_u32 s87, s87, 507904
    ds_read_b128 v[196:199], v224 offset:34880
    v_lshlrev_b32 v138, 16, v127
    v_and_b32 v133, s95, v124
    v_and_b32 v135, s95, v125
    v_and_b32 v137, s95, v126
    v_and_b32 v139, s95, v127
    v_mul_f32 v132, s20, v132
    v_mul_f32 v133, s20, v133
    v_mul_f32 v134, s20, v134
    v_mul_f32 v135, s20, v135
    v_mul_f32 v136, s20, v136
    v_mul_f32 v137, s20, v137
    v_mfma_f32_16x16x32_bf16 a[244:247], a[248:251], v[152:155], 0
    s_add_u32 m0, s23, 139264
    ds_read_b128 v[200:203], v224 offset:34944
    buffer_load_dwordx4 v227, s[12:15], s87 offen offset:0 nt lds
    v_mul_f32 v138, s20, v138
    v_mul_f32 v139, s20, v139
    v_cvt_pk_bf16_f32 v124, v132, v133
    v_cvt_pk_bf16_f32 v125, v134, v135
    v_cvt_pk_bf16_f32 v126, v136, v137
    v_cvt_pk_bf16_f32 v127, v138, v139
    v_mfma_f32_16x16x32_bf16 a[248:251], a[252:255], v[152:155], 0
    s_add_u32 m0, s23, 139328
    ds_read_b128 v[204:207], v224 offset:35008
    buffer_load_dwordx4 v227, s[12:15], s87 offen offset:1024 nt lds
    v_mfma_f32_16x16x32_bf16 a[252:255], v[128:131], v[152:155], 0
    s_add_u32 m0, s23, 139392
    ds_read_b128 v[208:211], v224 offset:35072
    buffer_load_dwordx4 v227, s[12:15], s87 offen offset:2048 nt lds
    s_add_u32 m0, s23, 139456
    ds_read_b128 v[212:215], v224 offset:35136
    buffer_load_dwordx4 v227, s[12:15], s87 offen offset:3072 nt lds
    s_nop 1
    s_waitcnt lgkmcnt(4)
.p2align 6
L_loop:
    v_mfma_f32_16x16x32_bf16 v[128:131], v[192:195], v[0:3], v[240:243]
    ds_read_b128 v[216:219], v224 offset:35200
    v_add_f32 v234, v234, v182
    v_mfma_f32_16x16x32_bf16 v[128:131], v[196:199], v[4:7], v[128:131]
    s_add_u32 m0, s23, 0
    v_exp_f32 v184, v184
    v_mfma_f32_16x16x32_bf16 v[136:139], v[196:199], v[36:39], v[244:247]
    buffer_load_dwordx4 v227, s[8:11], s21 offen offset:0 nt lds
    v_mfma_f32_16x16x32_bf16 v[136:139], v[192:195], v[32:35], v[136:139]
    v_exp_f32 v185, v185
    v_mfma_f32_16x16x32_bf16 v[144:147], v[192:195], v[64:67], v[248:251]
    ds_read_b128 v[220:223], v224 offset:35264
    v_add_f32 v234, v234, v183
    v_mfma_f32_16x16x32_bf16 v[144:147], v[196:199], v[68:71], v[144:147]
    s_add_u32 m0, s23, 64
    v_exp_f32 v186, v186
    v_mfma_f32_16x16x32_bf16 v[152:155], v[196:199], v[100:103], v[252:255]
    buffer_load_dwordx4 v227, s[8:11], s21 offen offset:1024 nt lds
    v_mfma_f32_16x16x32_bf16 v[152:155], v[192:195], v[96:99], v[152:155]
    s_waitcnt lgkmcnt(4)
    v_exp_f32 v187, v187
    v_mfma_f32_16x16x32_bf16 v[152:155], v[200:203], v[104:107], v[152:155]
    ds_read_b128 v[192:195], v224 offset:43520
    v_cvt_pk_bf16_f32 v179, v182, v183
    v_mfma_f32_16x16x32_bf16 v[152:155], v[204:207], v[108:111], v[152:155]
    s_add_u32 m0, s23, 128
    v_add_f32 v235, v184, v185
    v_max3_f32 v236, v232, v233, v234
    v_mfma_f32_16x16x32_bf16 v[144:147], v[204:207], v[76:79], v[144:147]
    buffer_load_dwordx4 v227, s[8:11], s21 offen offset:2048 nt lds
    v_mfma_f32_16x16x32_bf16 v[144:147], v[200:203], v[72:75], v[144:147]
    v_exp_f32 v188, v188
    v_mfma_f32_16x16x32_bf16 v[136:139], v[200:203], v[40:43], v[136:139]
    ds_read_b128 v[196:199], v224 offset:43584
    v_cvt_pk_bf16_f32 v184, v184, v185
    v_mfma_f32_16x16x32_bf16 v[136:139], v[204:207], v[44:47], v[136:139]
    s_add_u32 m0, s23, 192
    v_exp_f32 v189, v189
    v_mfma_f32_16x16x32_bf16 v[128:131], v[204:207], v[12:15], v[128:131]
    buffer_load_dwordx4 v227, s[8:11], s21 offen offset:3072 nt lds
    v_mfma_f32_16x16x32_bf16 v[128:131], v[200:203], v[8:11], v[128:131]
    s_waitcnt lgkmcnt(4)
    v_add_f32 v235, v235, v186
    v_cvt_pk_bf16_f32 v185, v186, v187
    v_mfma_f32_16x16x32_bf16 v[128:131], v[208:211], v[16:19], v[128:131]
    s_addk_i32 s21, 16384
    ds_read_b128 v[200:203], v224 offset:43648
    v_add_f32 v235, v235, v187
    v_mfma_f32_16x16x32_bf16 v[128:131], v[212:215], v[20:23], v[128:131]
    v_exp_f32 v190, v190
    v_mfma_f32_16x16x32_bf16 v[136:139], v[212:215], v[52:55], v[136:139]
    v_exp_f32 v191, v191
    v_mfma_f32_16x16x32_bf16 v[136:139], v[208:211], v[48:51], v[136:139]
    v_add_f32 v235, v235, v188
    v_cvt_pk_bf16_f32 v186, v188, v189
    v_mfma_f32_16x16x32_bf16 v[144:147], v[208:211], v[80:83], v[144:147]
    ds_read_b128 v[204:207], v224 offset:43712
    v_add_f32 v235, v235, v189
    v_mfma_f32_16x16x32_bf16 v[144:147], v[212:215], v[84:87], v[144:147]
    v_add_f32 v235, v235, v190
    v_cvt_pk_bf16_f32 v187, v190, v191
    v_mfma_f32_16x16x32_bf16 v[152:155], v[212:215], v[116:119], v[152:155]
    v_add_f32 v235, v235, v191
    v_mfma_f32_16x16x32_bf16 v[152:155], v[208:211], v[112:115], v[152:155]
    s_waitcnt lgkmcnt(4)
    v_max_f32 v236, v236, v235
    v_mfma_f32_16x16x32_bf16 v[152:155], v[216:219], v[120:123], v[152:155]
    ds_read_b128 v[208:211], v224 offset:43776
    v_cmp_lt_f32 vcc, s26, v236
    v_mfma_f32_16x16x32_bf16 v[152:155], v[220:223], v[124:127], v[152:155]
    v_mfma_f32_16x16x32_bf16 v[144:147], v[220:223], v[92:95], v[144:147]
    s_cbranch_vccnz L_rare0
L_back0:
    v_add_f32 v228, v228, v232
    v_add_f32 v229, v229, v233
    v_mfma_f32_16x16x32_bf16 v[144:147], v[216:219], v[88:91], v[144:147]
    v_add_f32 v230, v230, v234
    v_add_f32 v231, v231, v235
    v_mfma_f32_16x16x32_bf16 v[136:139], v[216:219], v[56:59], v[136:139]
    ds_read_b128 v[212:215], v224 offset:43840
    v_mfma_f32_16x16x32_bf16 v[136:139], v[220:223], v[60:63], v[136:139]
    v_mfma_f32_16x16x32_bf16 v[128:131], v[220:223], v[28:31], v[128:131]
    v_exp_f32 v152, v152
    v_mfma_f32_16x16x32_bf16 v[128:131], v[216:219], v[24:27], v[128:131]
    s_waitcnt lgkmcnt(4)
    v_exp_f32 v153, v153
    v_mfma_f32_16x16x32_bf16 v[164:167], v[192:195], v[0:3], v[240:243]
    ds_read_b128 v[216:219], v224 offset:43904
    v_add_f32 v235, v152, v153
    v_mfma_f32_16x16x32_bf16 v[164:167], v[196:199], v[4:7], v[164:167]
    v_exp_f32 v154, v154
    v_mfma_f32_16x16x32_bf16 v[172:175], v[196:199], v[36:39], v[244:247]
    v_exp_f32 v155, v155
    v_mfma_f32_16x16x32_bf16 v[172:175], v[192:195], v[32:35], v[172:175]
    v_exp_f32 v144, v144
    v_mfma_f32_16x16x32_bf16 v[180:183], v[192:195], v[64:67], v[248:251]
    ds_read_b128 v[220:223], v224 offset:43968
    v_cvt_pk_bf16_f32 v152, v152, v153
    v_mfma_f32_16x16x32_bf16 v[180:183], v[196:199], v[68:71], v[180:183]
    s_waitcnt vmcnt(12)
    v_exp_f32 v145, v145
    v_mfma_f32_16x16x32_bf16 v[188:191], v[196:199], v[100:103], v[252:255]
    s_barrier
    v_add_f32 v235, v235, v154
    v_cvt_pk_bf16_f32 v153, v154, v155
    v_mfma_f32_16x16x32_bf16 v[188:191], v[192:195], v[96:99], v[188:191]
    s_waitcnt lgkmcnt(4)
    v_exp_f32 v146, v146
    v_mfma_f32_16x16x32_bf16 v[188:191], v[200:203], v[104:107], v[188:191]
    ds_read_b128 v[192:195], v224 offset:52224
    v_add_f32 v235, v235, v155
    v_mfma_f32_16x16x32_bf16 v[188:191], v[204:207], v[108:111], v[188:191]
    v_exp_f32 v147, v147
    v_mfma_f32_16x16x32_bf16 v[180:183], v[204:207], v[76:79], v[180:183]
    v_add_f32 v234, v144, v145
    v_mfma_f32_16x16x32_bf16 v[180:183], v[200:203], v[72:75], v[180:183]
    v_exp_f32 v136, v136
    v_mfma_f32_16x16x32_bf16 v[172:175], v[200:203], v[40:43], v[172:175]
    ds_read_b128 v[196:199], v224 offset:52288
    v_cvt_pk_bf16_f32 v144, v144, v145
    v_mfma_f32_16x16x32_bf16 v[172:175], v[204:207], v[44:47], v[172:175]
    v_exp_f32 v137, v137
    v_mfma_f32_16x16x32_bf16 v[164:167], v[204:207], v[12:15], v[164:167]
    v_add_f32 v234, v234, v146
    v_cvt_pk_bf16_f32 v145, v146, v147
    v_mfma_f32_16x16x32_bf16 v[164:167], v[200:203], v[8:11], v[164:167]
    s_waitcnt lgkmcnt(4)
    v_exp_f32 v138, v138
    v_mfma_f32_16x16x32_bf16 v[164:167], v[208:211], v[16:19], v[164:167]
    ds_read_b128 v[200:203], v224 offset:52352
    v_add_f32 v234, v234, v147
    v_mfma_f32_16x16x32_bf16 v[164:167], v[212:215], v[20:23], v[164:167]
    v_exp_f32 v139, v139
    v_mfma_f32_16x16x32_bf16 v[172:175], v[212:215], v[52:55], v[172:175]
    v_add_f32 v233, v136, v137
    v_mfma_f32_16x16x32_bf16 v[172:175], v[208:211], v[48:51], v[172:175]
    v_exp_f32 v128, v128
    v_mfma_f32_16x16x32_bf16 v[180:183], v[208:211], v[80:83], v[180:183]
    ds_read_b128 v[204:207], v224 offset:52416
    v_cvt_pk_bf16_f32 v136, v136, v137
    v_mfma_f32_16x16x32_bf16 v[180:183], v[212:215], v[84:87], v[180:183]
    v_exp_f32 v129, v129
    v_mfma_f32_16x16x32_bf16 v[188:191], v[212:215], v[116:119], v[188:191]
    v_add_f32 v233, v233, v138
    v_cvt_pk_bf16_f32 v137, v138, v139
    v_mfma_f32_16x16x32_bf16 v[188:191], v[208:211], v[112:115], v[188:191]
    s_waitcnt lgkmcnt(4)
    v_exp_f32 v130, v130
    v_mfma_f32_16x16x32_bf16 v[188:191], v[216:219], v[120:123], v[188:191]
    ds_read_b128 v[208:211], v224 offset:52480
    v_add_f32 v233, v233, v139
    v_mfma_f32_16x16x32_bf16 v[188:191], v[220:223], v[124:127], v[188:191]
    v_exp_f32 v131, v131
    v_mfma_f32_16x16x32_bf16 v[180:183], v[220:223], v[92:95], v[180:183]
    v_add_f32 v232, v128, v129
    v_mfma_f32_16x16x32_bf16 v[180:183], v[216:219], v[88:91], v[180:183]
    v_cvt_pk_bf16_f32 v128, v128, v129
    v_add_f32 v232, v232, v130
    v_mfma_f32_16x16x32_bf16 v[172:175], v[216:219], v[56:59], v[172:175]
    ds_read_b128 v[212:215], v224 offset:52544
    v_add_f32 v232, v232, v131
    v_mfma_f32_16x16x32_bf16 v[172:175], v[220:223], v[60:63], v[172:175]
    v_cvt_pk_bf16_f32 v129, v130, v131
    v_mfma_f32_16x16x32_bf16 v[164:167], v[220:223], v[28:31], v[164:167]
    v_exp_f32 v188, v188
    v_mfma_f32_16x16x32_bf16 v[164:167], v[216:219], v[24:27], v[164:167]
    s_waitcnt lgkmcnt(4)
    v_exp_f32 v189, v189
    v_mfma_f32_16x16x32_bf16 v[156:159], v[192:195], v[96:99], v[252:255]
    ds_read_b128 v[216:219], v224 offset:52608
    v_add_f32 v235, v235, v188
    v_mfma_f32_16x16x32_bf16 v[156:159], v[196:199], v[100:103], v[156:159]
    v_exp_f32 v190, v190
    v_mfma_f32_16x16x32_bf16 v[148:151], v[196:199], v[68:71], v[248:251]
    v_exp_f32 v191, v191
    v_mfma_f32_16x16x32_bf16 v[148:151], v[192:195], v[64:67], v[148:151]
    v_add_f32 v235, v235, v189
    v_cvt_pk_bf16_f32 v154, v188, v189
    v_mfma_f32_16x16x32_bf16 v[140:143], v[192:195], v[32:35], v[244:247]
    ds_read_b128 v[220:223], v224 offset:52672
    v_add_f32 v235, v235, v190
    v_mfma_f32_16x16x32_bf16 v[140:143], v[196:199], v[36:39], v[140:143]
    v_exp_f32 v180, v180
    v_mfma_f32_16x16x32_bf16 v[132:135], v[196:199], v[4:7], v[240:243]
    v_exp_f32 v181, v181
    v_mfma_f32_16x16x32_bf16 v[132:135], v[192:195], v[0:3], v[132:135]
    s_waitcnt lgkmcnt(4)
    v_add_f32 v235, v235, v191
    v_cvt_pk_bf16_f32 v155, v190, v191
    v_mfma_f32_16x16x32_bf16 v[132:135], v[200:203], v[8:11], v[132:135]
    ds_read_b128 v[192:195], v224 offset:60928
    v_add_f32 v234, v234, v180
    v_mfma_f32_16x16x32_bf16 v[132:135], v[204:207], v[12:15], v[132:135]
    v_exp_f32 v182, v182
    v_mfma_f32_16x16x32_bf16 v[140:143], v[204:207], v[44:47], v[140:143]
    v_exp_f32 v183, v183
    v_mfma_f32_16x16x32_bf16 v[140:143], v[200:203], v[40:43], v[140:143]
    v_add_f32 v234, v234, v181
    v_cvt_pk_bf16_f32 v146, v180, v181
    v_mfma_f32_16x16x32_bf16 v[148:151], v[200:203], v[72:75], v[148:151]
    ds_read_b128 v[196:199], v224 offset:60992
    v_add_f32 v234, v234, v182
    v_mfma_f32_16x16x32_bf16 v[148:151], v[204:207], v[76:79], v[148:151]
    v_exp_f32 v172, v172
    v_mfma_f32_16x16x32_bf16 v[156:159], v[204:207], v[108:111], v[156:159]
    v_exp_f32 v173, v173
    v_mfma_f32_16x16x32_bf16 v[156:159], v[200:203], v[104:107], v[156:159]
    s_waitcnt lgkmcnt(4)
    v_add_f32 v234, v234, v183
    v_cvt_pk_bf16_f32 v147, v182, v183
    v_mfma_f32_16x16x32_bf16 v[156:159], v[208:211], v[112:115], v[156:159]
    ds_read_b128 v[200:203], v224 offset:61056
    v_add_f32 v233, v233, v172
    v_mfma_f32_16x16x32_bf16 v[156:159], v[212:215], v[116:119], v[156:159]
    v_exp_f32 v174, v174
    v_mfma_f32_16x16x32_bf16 v[148:151], v[212:215], v[84:87], v[148:151]
    v_exp_f32 v175, v175
    v_mfma_f32_16x16x32_bf16 v[148:151], v[208:211], v[80:83], v[148:151]
    v_add_f32 v233, v233, v173
    v_cvt_pk_bf16_f32 v138, v172, v173
    v_mfma_f32_16x16x32_bf16 v[140:143], v[208:211], v[48:51], v[140:143]
    ds_read_b128 v[204:207], v224 offset:61120
    v_add_f32 v233, v233, v174
    v_mfma_f32_16x16x32_bf16 v[140:143], v[212:215], v[52:55], v[140:143]
    v_exp_f32 v164, v164
    v_mfma_f32_16x16x32_bf16 v[132:135], v[212:215], v[20:23], v[132:135]
    v_exp_f32 v165, v165
    v_mfma_f32_16x16x32_bf16 v[132:135], v[208:211], v[16:19], v[132:135]
    s_waitcnt lgkmcnt(4)
    v_add_f32 v233, v233, v175
    v_cvt_pk_bf16_f32 v139, v174, v175
    v_mfma_f32_16x16x32_bf16 v[132:135], v[216:219], v[24:27], v[132:135]
    ds_read_b128 v[208:211], v224 offset:61184
    v_add_f32 v232, v232, v164
    v_mfma_f32_16x16x32_bf16 v[132:135], v[220:223], v[28:31], v[132:135]
    v_exp_f32 v166, v166
    v_mfma_f32_16x16x32_bf16 v[140:143], v[220:223], v[60:63], v[140:143]
    v_exp_f32 v167, v167
    v_mfma_f32_16x16x32_bf16 v[140:143], v[216:219], v[56:59], v[140:143]
    v_add_f32 v232, v232, v165
    v_cvt_pk_bf16_f32 v130, v164, v165
    v_mfma_f32_16x16x32_bf16 v[148:151], v[216:219], v[88:91], v[148:151]
    ds_read_b128 v[212:215], v224 offset:61248
    v_add_f32 v232, v232, v166
    v_mfma_f32_16x16x32_bf16 v[148:151], v[220:223], v[92:95], v[148:151]
    v_add_f32 v232, v232, v167
    v_cvt_pk_bf16_f32 v131, v166, v167
    v_mfma_f32_16x16x32_bf16 v[156:159], v[220:223], v[124:127], v[156:159]
    v_max3_f32 v236, v232, v233, v234
    v_mfma_f32_16x16x32_bf16 v[156:159], v[216:219], v[120:123], v[156:159]
    s_waitcnt lgkmcnt(4)
    v_max_f32 v236, v236, v235
    v_mfma_f32_16x16x32_bf16 v[188:191], v[192:195], v[96:99], v[252:255]
    ds_read_b128 v[216:219], v224 offset:61312
    v_cmp_lt_f32 vcc, s26, v236
    v_mfma_f32_16x16x32_bf16 v[188:191], v[196:199], v[100:103], v[188:191]
    v_mfma_f32_16x16x32_bf16 v[180:183], v[196:199], v[68:71], v[248:251]
    s_cbranch_vccnz L_rare1
L_back1:
    v_add_f32 v228, v228, v232
    v_add_f32 v229, v229, v233
    v_mfma_f32_16x16x32_bf16 v[180:183], v[192:195], v[64:67], v[180:183]
    v_add_f32 v230, v230, v234
    v_add_f32 v231, v231, v235
    v_mfma_f32_16x16x32_bf16 v[172:175], v[192:195], v[32:35], v[244:247]
    ds_read_b128 v[220:223], v224 offset:61376
    v_mfma_f32_16x16x32_bf16 v[172:175], v[196:199], v[36:39], v[172:175]
    s_waitcnt vmcnt(4)
    v_mfma_f32_16x16x32_bf16 v[164:167], v[196:199], v[4:7], v[240:243]
    s_barrier
    v_mfma_f32_16x16x32_bf16 v[164:167], v[192:195], v[0:3], v[164:167]
    s_waitcnt lgkmcnt(4)
    v_mfma_f32_16x16x32_bf16 v[164:167], v[200:203], v[8:11], v[164:167]
    ds_read_b64_tr_b16 v[192:193], v225 offset:17408
    v_mfma_f32_16x16x32_bf16 v[164:167], v[204:207], v[12:15], v[164:167]
    s_add_u32 m0, s23, 17408
    ds_read_b64_tr_b16 v[194:195], v225 offset:26112
    v_mfma_f32_16x16x32_bf16 v[172:175], v[204:207], v[44:47], v[172:175]
    buffer_load_dwordx4 v227, s[8:11], s21 offen offset:0 nt lds
    v_mfma_f32_16x16x32_bf16 v[172:175], v[200:203], v[40:43], v[172:175]
    v_mfma_f32_16x16x32_bf16 v[180:183], v[200:203], v[72:75], v[180:183]
    ds_read_b64_tr_b16 v[196:197], v225 offset:34816
    v_mfma_f32_16x16x32_bf16 v[180:183], v[204:207], v[76:79], v[180:183]
    ds_read_b64_tr_b16 v[198:199], v225 offset:43520
    v_mfma_f32_16x16x32_bf16 v[188:191], v[204:207], v[108:111], v[188:191]
    v_mfma_f32_16x16x32_bf16 v[188:191], v[200:203], v[104:107], v[188:191]
    s_waitcnt lgkmcnt(6)
    v_mfma_f32_16x16x32_bf16 v[188:191], v[208:211], v[112:115], v[188:191]
    ds_read_b64_tr_b16 v[200:201], v226 offset:17408
    v_mfma_f32_16x16x32_bf16 v[188:191], v[212:215], v[116:119], v[188:191]
    s_add_u32 m0, s23, 17472
    ds_read_b64_tr_b16 v[202:203], v226 offset:26112
    v_mfma_f32_16x16x32_bf16 v[180:183], v[212:215], v[84:87], v[180:183]
    buffer_load_dwordx4 v227, s[8:11], s21 offen offset:1024 nt lds
    v_mfma_f32_16x16x32_bf16 v[180:183], v[208:211], v[80:83], v[180:183]
    v_mfma_f32_16x16x32_bf16 v[172:175], v[208:211], v[48:51], v[172:175]
    ds_read_b64_tr_b16 v[204:205], v226 offset:34816
    v_mfma_f32_16x16x32_bf16 v[172:175], v[212:215], v[52:55], v[172:175]
    ds_read_b64_tr_b16 v[206:207], v226 offset:43520
    v_mfma_f32_16x16x32_bf16 v[164:167], v[212:215], v[20:23], v[164:167]
    v_mfma_f32_16x16x32_bf16 v[164:167], v[208:211], v[16:19], v[164:167]
    s_waitcnt lgkmcnt(8)
    v_mfma_f32_16x16x32_bf16 v[164:167], v[216:219], v[24:27], v[164:167]
    ds_read_b64_tr_b16 v[208:209], v225 offset:17472
    v_mfma_f32_16x16x32_bf16 v[164:167], v[220:223], v[28:31], v[164:167]
    s_add_u32 m0, s23, 17536
    ds_read_b64_tr_b16 v[210:211], v225 offset:26176
    v_mfma_f32_16x16x32_bf16 v[172:175], v[220:223], v[60:63], v[172:175]
    buffer_load_dwordx4 v227, s[8:11], s21 offen offset:2048 nt lds
    v_mfma_f32_16x16x32_bf16 v[172:175], v[216:219], v[56:59], v[172:175]
    v_mfma_f32_16x16x32_bf16 v[180:183], v[216:219], v[88:91], v[180:183]
    ds_read_b64_tr_b16 v[212:213], v225 offset:34880
    v_mfma_f32_16x16x32_bf16 v[180:183], v[220:223], v[92:95], v[180:183]
    ds_read_b64_tr_b16 v[214:215], v225 offset:43584
    v_mfma_f32_16x16x32_bf16 v[188:191], v[220:223], v[124:127], v[188:191]
    v_mfma_f32_16x16x32_bf16 v[188:191], v[216:219], v[120:123], v[188:191]
    s_waitcnt lgkmcnt(8)
    v_mfma_f32_16x16x32_bf16 a[0:3], v[192:195], v[160:163], a[0:3]
    ds_read_b64_tr_b16 v[216:217], v226 offset:17472
    v_mfma_f32_16x16x32_bf16 a[0:3], v[196:199], v[128:131], a[0:3]
    s_add_u32 m0, s23, 17600
    ds_read_b64_tr_b16 v[218:219], v226 offset:26176
    v_mfma_f32_16x16x32_bf16 a[64:67], v[196:199], v[136:139], a[64:67]
    buffer_load_dwordx4 v227, s[8:11], s21 offen offset:3072 nt lds
    v_mfma_f32_16x16x32_bf16 a[64:67], v[192:195], v[168:171], a[64:67]
    v_mfma_f32_16x16x32_bf16 a[128:131], v[192:195], v[176:179], a[128:131]
    s_addk_i32 s21, 16384
    ds_read_b64_tr_b16 v[220:221], v226 offset:34880
    v_mfma_f32_16x16x32_bf16 a[128:131], v[196:199], v[144:147], a[128:131]
    ds_read_b64_tr_b16 v[222:223], v226 offset:43584
    v_mfma_f32_16x16x32_bf16 a[192:195], v[196:199], v[152:155], a[192:195]
    v_mfma_f32_16x16x32_bf16 a[192:195], v[192:195], v[184:187], a[192:195]
    s_waitcnt lgkmcnt(8)
    v_mfma_f32_16x16x32_bf16 a[196:199], v[200:203], v[184:187], a[196:199]
    ds_read_b64_tr_b16 v[192:193], v225 offset:17536
    v_mfma_f32_16x16x32_bf16 a[196:199], v[204:207], v[152:155], a[196:199]
    s_add_u32 m0, s23, 121856
    ds_read_b64_tr_b16 v[194:195], v225 offset:26240
    v_mfma_f32_16x16x32_bf16 a[132:135], v[204:207], v[144:147], a[132:135]
    buffer_load_dwordx4 v227, s[12:15], s22 offen offset:0 nt lds
    v_mfma_f32_16x16x32_bf16 a[132:135], v[200:203], v[176:179], a[132:135]
    v_mfma_f32_16x16x32_bf16 a[68:71], v[200:203], v[168:171], a[68:71]
    ds_read_b64_tr_b16 v[196:197], v225 offset:34944
    v_mfma_f32_16x16x32_bf16 a[68:71], v[204:207], v[136:139], a[68:71]
    ds_read_b64_tr_b16 v[198:199], v225 offset:43648
    v_mfma_f32_16x16x32_bf16 a[4:7], v[204:207], v[128:131], a[4:7]
    v_mfma_f32_16x16x32_bf16 a[4:7], v[200:203], v[160:163], a[4:7]
    s_waitcnt lgkmcnt(8)
    v_mfma_f32_16x16x32_bf16 a[8:11], v[208:211], v[160:163], a[8:11]
    ds_read_b64_tr_b16 v[200:201], v226 offset:17536
    v_mfma_f32_16x16x32_bf16 a[8:11], v[212:215], v[128:131], a[8:11]
    s_add_u32 m0, s23, 121920
    ds_read_b64_tr_b16 v[202:203], v226 offset:26240
    v_mfma_f32_16x16x32_bf16 a[72:75], v[212:215], v[136:139], a[72:75]
    buffer_load_dwordx4 v227, s[12:15], s22 offen offset:1024 nt lds
    v_mfma_f32_16x16x32_bf16 a[72:75], v[208:211], v[168:171], a[72:75]
    v_mfma_f32_16x16x32_bf16 a[136:139], v[208:211], v[176:179], a[136:139]
    ds_read_b64_tr_b16 v[204:205], v226 offset:34944
    v_mfma_f32_16x16x32_bf16 a[136:139], v[212:215], v[144:147], a[136:139]
    ds_read_b64_tr_b16 v[206:207], v226 offset:43648
    v_mfma_f32_16x16x32_bf16 a[200:203], v[212:215], v[152:155], a[200:203]
    v_mfma_f32_16x16x32_bf16 a[200:203], v[208:211], v[184:187], a[200:203]
    s_waitcnt lgkmcnt(8)
    v_mfma_f32_16x16x32_bf16 a[204:207], v[216:219], v[184:187], a[204:207]
    ds_read_b64_tr_b16 v[208:209], v225 offset:17600
    v_mfma_f32_16x16x32_bf16 a[204:207], v[220:223], v[152:155], a[204:207]
    s_add_u32 m0, s23, 121984
    ds_read_b64_tr_b16 v[210:211], v225 offset:26304
    v_mfma_f32_16x16x32_bf16 a[140:143], v[220:223], v[144:147], a[140:143]
    buffer_load_dwordx4 v227, s[12:15], s22 offen offset:2048 nt lds
    v_mfma_f32_16x16x32_bf16 a[140:143], v[216:219], v[176:179], a[140:143]
    v_mfma_f32_16x16x32_bf16 a[76:79], v[216:219], v[168:171], a[76:79]
    ds_read_b64_tr_b16 v[212:213], v225 offset:35008
    v_mfma_f32_16x16x32_bf16 a[76:79], v[220:223], v[136:139], a[76:79]
    ds_read_b64_tr_b16 v[214:215], v225 offset:43712
    v_mfma_f32_16x16x32_bf16 a[12:15], v[220:223], v[128:131], a[12:15]
    v_mfma_f32_16x16x32_bf16 a[12:15], v[216:219], v[160:163], a[12:15]
    s_waitcnt lgkmcnt(8)
    v_mfma_f32_16x16x32_bf16 a[16:19], v[192:195], v[160:163], a[16:19]
    ds_read_b64_tr_b16 v[216:217], v226 offset:17600
    v_mfma_f32_16x16x32_bf16 a[16:19], v[196:199], v[128:131], a[16:19]
    s_add_u32 m0, s23, 122048
    ds_read_b64_tr_b16 v[218:219], v226 offset:26304
    v_mfma_f32_16x16x32_bf16 a[80:83], v[196:199], v[136:139], a[80:83]
    buffer_load_dwordx4 v227, s[12:15], s22 offen offset:3072 nt lds
    v_mfma_f32_16x16x32_bf16 a[80:83], v[192:195], v[168:171], a[80:83]
    v_mfma_f32_16x16x32_bf16 a[144:147], v[192:195], v[176:179], a[144:147]
    s_addk_i32 s22, 16384
    ds_read_b64_tr_b16 v[220:221], v226 offset:35008
    v_mfma_f32_16x16x32_bf16 a[144:147], v[196:199], v[144:147], a[144:147]
    ds_read_b64_tr_b16 v[222:223], v226 offset:43712
    v_mfma_f32_16x16x32_bf16 a[208:211], v[196:199], v[152:155], a[208:211]
    v_mfma_f32_16x16x32_bf16 a[208:211], v[192:195], v[184:187], a[208:211]
    s_waitcnt lgkmcnt(8)
    v_mfma_f32_16x16x32_bf16 a[212:215], v[200:203], v[184:187], a[212:215]
    ds_read_b64_tr_b16 v[192:193], v225 offset:17664
    v_mfma_f32_16x16x32_bf16 a[212:215], v[204:207], v[152:155], a[212:215]
    s_add_u32 m0, s23, 69632
    ds_read_b64_tr_b16 v[194:195], v225 offset:26368
    v_mfma_f32_16x16x32_bf16 a[148:151], v[204:207], v[144:147], a[148:151]
    buffer_load_dwordx4 v227, s[12:15], s22 offen offset:0 nt lds
    v_mfma_f32_16x16x32_bf16 a[148:151], v[200:203], v[176:179], a[148:151]
    v_mfma_f32_16x16x32_bf16 a[84:87], v[200:203], v[168:171], a[84:87]
    ds_read_b64_tr_b16 v[196:197], v225 offset:35072
    v_mfma_f32_16x16x32_bf16 a[84:87], v[204:207], v[136:139], a[84:87]
    ds_read_b64_tr_b16 v[198:199], v225 offset:43776
    v_mfma_f32_16x16x32_bf16 a[20:23], v[204:207], v[128:131], a[20:23]
    v_mfma_f32_16x16x32_bf16 a[20:23], v[200:203], v[160:163], a[20:23]
    s_waitcnt lgkmcnt(8)
    v_mfma_f32_16x16x32_bf16 a[24:27], v[208:211], v[160:163], a[24:27]
    ds_read_b64_tr_b16 v[200:201], v226 offset:17664
    v_mfma_f32_16x16x32_bf16 a[24:27], v[212:215], v[128:131], a[24:27]
    s_add_u32 m0, s23, 69696
    ds_read_b64_tr_b16 v[202:203], v226 offset:26368
    v_mfma_f32_16x16x32_bf16 a[88:91], v[212:215], v[136:139], a[88:91]
    buffer_load_dwordx4 v227, s[12:15], s22 offen offset:1024 nt lds
    v_mfma_f32_16x16x32_bf16 a[88:91], v[208:211], v[168:171], a[88:91]
    v_mfma_f32_16x16x32_bf16 a[152:155], v[208:211], v[176:179], a[152:155]
    ds_read_b64_tr_b16 v[204:205], v226 offset:35072
    v_mfma_f32_16x16x32_bf16 a[152:155], v[212:215], v[144:147], a[152:155]
    ds_read_b64_tr_b16 v[206:207], v226 offset:43776
    v_mfma_f32_16x16x32_bf16 a[216:219], v[212:215], v[152:155], a[216:219]
    v_mfma_f32_16x16x32_bf16 a[216:219], v[208:211], v[184:187], a[216:219]
    s_waitcnt lgkmcnt(8)
    v_mfma_f32_16x16x32_bf16 a[220:223], v[216:219], v[184:187], a[220:223]
    ds_read_b64_tr_b16 v[208:209], v225 offset:17728
    v_mfma_f32_16x16x32_bf16 a[220:223], v[220:223], v[152:155], a[220:223]
    s_add_u32 m0, s23, 69760
    ds_read_b64_tr_b16 v[210:211], v225 offset:26432
    v_mfma_f32_16x16x32_bf16 a[156:159], v[220:223], v[144:147], a[156:159]
    buffer_load_dwordx4 v227, s[12:15], s22 offen offset:2048 nt lds
    v_mfma_f32_16x16x32_bf16 a[156:159], v[216:219], v[176:179], a[156:159]
    v_mfma_f32_16x16x32_bf16 a[92:95], v[216:219], v[168:171], a[92:95]
    ds_read_b64_tr_b16 v[212:213], v225 offset:35136
    v_mfma_f32_16x16x32_bf16 a[92:95], v[220:223], v[136:139], a[92:95]
    ds_read_b64_tr_b16 v[214:215], v225 offset:43840
    v_mfma_f32_16x16x32_bf16 a[28:31], v[220:223], v[128:131], a[28:31]
    v_mfma_f32_16x16x32_bf16 a[28:31], v[216:219], v[160:163], a[28:31]
    s_waitcnt lgkmcnt(8)
    v_mfma_f32_16x16x32_bf16 a[32:35], v[192:195], v[160:163], a[32:35]
    ds_read_b64_tr_b16 v[216:217], v226 offset:17728
    v_mfma_f32_16x16x32_bf16 a[32:35], v[196:199], v[128:131], a[32:35]
    s_add_u32 m0, s23, 69824
    ds_read_b64_tr_b16 v[218:219], v226 offset:26432
    v_mfma_f32_16x16x32_bf16 a[96:99], v[196:199], v[136:139], a[96:99]
    buffer_load_dwordx4 v227, s[12:15], s22 offen offset:3072 nt lds
    v_mfma_f32_16x16x32_bf16 a[96:99], v[192:195], v[168:171], a[96:99]
    v_mfma_f32_16x16x32_bf16 a[160:163], v[192:195], v[176:179], a[160:163]
    s_addk_i32 s22, 16384
    ds_read_b64_tr_b16 v[220:221], v226 offset:35136
    v_mfma_f32_16x16x32_bf16 a[160:163], v[196:199], v[144:147], a[160:163]
    ds_read_b64_tr_b16 v[222:223], v226 offset:43840
    v_mfma_f32_16x16x32_bf16 a[224:227], v[196:199], v[152:155], a[224:227]
    v_mfma_f32_16x16x32_bf16 a[224:227], v[192:195], v[184:187], a[224:227]
    s_waitcnt lgkmcnt(8)
    v_mfma_f32_16x16x32_bf16 a[228:231], v[200:203], v[184:187], a[228:231]
    ds_read_b64_tr_b16 v[192:193], v225 offset:17792
    v_mfma_f32_16x16x32_bf16 a[228:231], v[204:207], v[152:155], a[228:231]
    ds_read_b64_tr_b16 v[194:195], v225 offset:26496
    v_mfma_f32_16x16x32_bf16 a[164:167], v[204:207], v[144:147], a[164:167]
    v_mfma_f32_16x16x32_bf16 a[164:167], v[200:203], v[176:179], a[164:167]
    v_mfma_f32_16x16x32_bf16 a[100:103], v[200:203], v[168:171], a[100:103]
    ds_read_b64_tr_b16 v[196:197], v225 offset:35200
    v_mfma_f32_16x16x32_bf16 a[100:103], v[204:207], v[136:139], a[100:103]
    ds_read_b64_tr_b16 v[198:199], v225 offset:43904
    v_mfma_f32_16x16x32_bf16 a[36:39], v[204:207], v[128:131], a[36:39]
    v_exp_f32 v132, v132
    v_mfma_f32_16x16x32_bf16 a[36:39], v[200:203], v[160:163], a[36:39]
    s_waitcnt lgkmcnt(8)
    v_exp_f32 v133, v133
    v_mfma_f32_16x16x32_bf16 a[40:43], v[208:211], v[160:163], a[40:43]
    ds_read_b64_tr_b16 v[200:201], v226 offset:17792
    v_add_f32 v232, v132, v133
    v_mfma_f32_16x16x32_bf16 a[40:43], v[212:215], v[128:131], a[40:43]
    ds_read_b64_tr_b16 v[202:203], v226 offset:26496
    v_cvt_pk_bf16_f32 v132, v132, v133
    v_mfma_f32_16x16x32_bf16 a[104:107], v[212:215], v[136:139], a[104:107]
    v_exp_f32 v134, v134
    v_mfma_f32_16x16x32_bf16 a[104:107], v[208:211], v[168:171], a[104:107]
    v_exp_f32 v135, v135
    v_mfma_f32_16x16x32_bf16 a[168:171], v[208:211], v[176:179], a[168:171]
    ds_read_b64_tr_b16 v[204:205], v226 offset:35200
    v_add_f32 v232, v232, v134
    v_mfma_f32_16x16x32_bf16 a[168:171], v[212:215], v[144:147], a[168:171]
    ds_read_b64_tr_b16 v[206:207], v226 offset:43904
    v_add_f32 v232, v232, v135
    v_mfma_f32_16x16x32_bf16 a[232:235], v[212:215], v[152:155], a[232:235]
    v_exp_f32 v164, v164
    v_mfma_f32_16x16x32_bf16 a[232:235], v[208:211], v[184:187], a[232:235]
    s_waitcnt lgkmcnt(8)
    v_exp_f32 v165, v165
    v_mfma_f32_16x16x32_bf16 a[236:239], v[216:219], v[184:187], a[236:239]
    ds_read_b64_tr_b16 v[208:209], v225 offset:17856
    v_cvt_pk_bf16_f32 v133, v134, v135
    v_mfma_f32_16x16x32_bf16 a[236:239], v[220:223], v[152:155], a[236:239]
    ds_read_b64_tr_b16 v[210:211], v225 offset:26560
    v_add_f32 v232, v232, v164
    v_mfma_f32_16x16x32_bf16 a[172:175], v[220:223], v[144:147], a[172:175]
    v_exp_f32 v166, v166
    v_mfma_f32_16x16x32_bf16 a[172:175], v[216:219], v[176:179], a[172:175]
    v_exp_f32 v167, v167
    v_mfma_f32_16x16x32_bf16 a[108:111], v[216:219], v[168:171], a[108:111]
    ds_read_b64_tr_b16 v[212:213], v225 offset:35264
    v_add_f32 v232, v232, v165
    v_mfma_f32_16x16x32_bf16 a[108:111], v[220:223], v[136:139], a[108:111]
    ds_read_b64_tr_b16 v[214:215], v225 offset:43968
    v_cvt_pk_bf16_f32 v134, v164, v165
    v_mfma_f32_16x16x32_bf16 a[44:47], v[220:223], v[128:131], a[44:47]
    v_exp_f32 v140, v140
    v_mfma_f32_16x16x32_bf16 a[44:47], v[216:219], v[160:163], a[44:47]
    s_waitcnt lgkmcnt(8)
    v_exp_f32 v141, v141
    v_mfma_f32_16x16x32_bf16 a[48:51], v[192:195], v[160:163], a[48:51]
    ds_read_b64_tr_b16 v[216:217], v226 offset:17856
    v_add_f32 v232, v232, v166
    v_mfma_f32_16x16x32_bf16 a[48:51], v[196:199], v[128:131], a[48:51]
    ds_read_b64_tr_b16 v[218:219], v226 offset:26560
    v_add_f32 v232, v232, v167
    v_mfma_f32_16x16x32_bf16 a[112:115], v[196:199], v[136:139], a[112:115]
    v_exp_f32 v142, v142
    v_mfma_f32_16x16x32_bf16 a[112:115], v[192:195], v[168:171], a[112:115]
    v_exp_f32 v143, v143
    v_mfma_f32_16x16x32_bf16 a[176:179], v[192:195], v[176:179], a[176:179]
    ds_read_b64_tr_b16 v[220:221], v226 offset:35264
    v_cvt_pk_bf16_f32 v135, v166, v167
    v_mfma_f32_16x16x32_bf16 a[176:179], v[196:199], v[144:147], a[176:179]
    ds_read_b64_tr_b16 v[222:223], v226 offset:43968
    v_add_f32 v233, v140, v141
    v_mfma_f32_16x16x32_bf16 a[240:243], v[196:199], v[152:155], a[240:243]
    v_exp_f32 v172, v172
    v_mfma_f32_16x16x32_bf16 a[240:243], v[192:195], v[184:187], a[240:243]
    s_waitcnt lgkmcnt(8)
    v_cvt_pk_bf16_f32 v140, v140, v141
    v_add_f32 v233, v233, v142
    v_mfma_f32_16x16x32_bf16 a[244:247], v[200:203], v[184:187], a[244:247]
    v_exp_f32 v173, v173
    v_mfma_f32_16x16x32_bf16 a[244:247], v[204:207], v[152:155], a[244:247]
    v_add_f32 v233, v233, v143
    v_cvt_pk_bf16_f32 v141, v142, v143
    v_mfma_f32_16x16x32_bf16 a[180:183], v[204:207], v[144:147], a[180:183]
    v_exp_f32 v174, v174
    v_mfma_f32_16x16x32_bf16 a[180:183], v[200:203], v[176:179], a[180:183]
    v_exp_f32 v175, v175
    v_mfma_f32_16x16x32_bf16 a[116:119], v[200:203], v[168:171], a[116:119]
    v_add_f32 v233, v233, v172
    v_cvt_pk_bf16_f32 v142, v172, v173
    v_mfma_f32_16x16x32_bf16 a[116:119], v[204:207], v[136:139], a[116:119]
    v_exp_f32 v148, v148
    v_mfma_f32_16x16x32_bf16 a[52:55], v[204:207], v[128:131], a[52:55]
    v_exp_f32 v149, v149
    v_mfma_f32_16x16x32_bf16 a[52:55], v[200:203], v[160:163], a[52:55]
    s_waitcnt lgkmcnt(4)
    v_add_f32 v233, v233, v173
    v_cvt_pk_bf16_f32 v143, v174, v175
    v_mfma_f32_16x16x32_bf16 a[56:59], v[208:211], v[160:163], a[56:59]
    s_waitcnt vmcnt(12) lgkmcnt(0)
    v_exp_f32 v150, v150
    v_mfma_f32_16x16x32_bf16 a[56:59], v[212:215], v[128:131], a[56:59]
    s_barrier
    v_mfma_f32_16x16x32_bf16 a[120:123], v[212:215], v[136:139], a[120:123]
    ds_read_b128 v[192:195], v224 offset:0
    v_add_f32 v233, v233, v174
    v_mfma_f32_16x16x32_bf16 a[120:123], v[208:211], v[168:171], a[120:123]
    v_exp_f32 v151, v151
    v_mfma_f32_16x16x32_bf16 a[184:187], v[208:211], v[176:179], a[184:187]
    ds_read_b128 v[196:199], v224 offset:64
    v_add_f32 v233, v233, v175
    v_mfma_f32_16x16x32_bf16 a[184:187], v[212:215], v[144:147], a[184:187]
    v_add_f32 v234, v148, v149
    v_mfma_f32_16x16x32_bf16 a[248:251], v[212:215], v[152:155], a[248:251]
    ds_read_b128 v[200:203], v224 offset:128
    v_cvt_pk_bf16_f32 v148, v148, v149
    v_mfma_f32_16x16x32_bf16 a[248:251], v[208:211], v[184:187], a[248:251]
    v_exp_f32 v180, v180
    v_mfma_f32_16x16x32_bf16 a[252:255], v[216:219], v[184:187], a[252:255]
    ds_read_b128 v[204:207], v224 offset:192
    v_add_f32 v234, v234, v150
    v_mfma_f32_16x16x32_bf16 a[252:255], v[220:223], v[152:155], a[252:255]
    v_exp_f32 v181, v181
    v_mfma_f32_16x16x32_bf16 a[188:191], v[220:223], v[144:147], a[188:191]
    ds_read_b128 v[208:211], v224 offset:256
    v_add_f32 v234, v234, v151
    v_mfma_f32_16x16x32_bf16 a[188:191], v[216:219], v[176:179], a[188:191]
    v_exp_f32 v182, v182
    v_mfma_f32_16x16x32_bf16 a[124:127], v[216:219], v[168:171], a[124:127]
    ds_read_b128 v[212:215], v224 offset:320
    v_cvt_pk_bf16_f32 v149, v150, v151
    v_mfma_f32_16x16x32_bf16 a[124:127], v[220:223], v[136:139], a[124:127]
    v_exp_f32 v183, v183
    v_mfma_f32_16x16x32_bf16 a[60:63], v[220:223], v[128:131], a[60:63]
    v_add_f32 v234, v234, v180
    v_cvt_pk_bf16_f32 v150, v180, v181
    v_mfma_f32_16x16x32_bf16 a[60:63], v[216:219], v[160:163], a[60:63]
    s_waitcnt lgkmcnt(4)
    v_add_f32 v234, v234, v181
    v_mfma_f32_16x16x32_bf16 v[128:131], v[192:195], v[0:3], v[240:243]
    ds_read_b128 v[216:219], v224 offset:384
    v_add_f32 v234, v234, v182
    v_mfma_f32_16x16x32_bf16 v[128:131], v[196:199], v[4:7], v[128:131]
    s_add_u32 m0, s23, 34816
    v_exp_f32 v156, v156
    v_mfma_f32_16x16x32_bf16 v[136:139], v[196:199], v[36:39], v[244:247]
    buffer_load_dwordx4 v227, s[8:11], s21 offen offset:0 nt lds
    v_mfma_f32_16x16x32_bf16 v[136:139], v[192:195], v[32:35], v[136:139]
    v_exp_f32 v157, v157
    v_mfma_f32_16x16x32_bf16 v[144:147], v[192:195], v[64:67], v[248:251]
    ds_read_b128 v[220:223], v224 offset:448
    v_add_f32 v234, v234, v183
    v_mfma_f32_16x16x32_bf16 v[144:147], v[196:199], v[68:71], v[144:147]
    s_add_u32 m0, s23, 34880
    v_exp_f32 v158, v158
    v_mfma_f32_16x16x32_bf16 v[152:155], v[196:199], v[100:103], v[252:255]
    buffer_load_dwordx4 v227, s[8:11], s21 offen offset:1024 nt lds
    v_mfma_f32_16x16x32_bf16 v[152:155], v[192:195], v[96:99], v[152:155]
    s_waitcnt lgkmcnt(4)
    v_exp_f32 v159, v159
    v_mfma_f32_16x16x32_bf16 v[152:155], v[200:203], v[104:107], v[152:155]
    ds_read_b128 v[192:195], v224 offset:8704
    v_cvt_pk_bf16_f32 v151, v182, v183
    v_mfma_f32_16x16x32_bf16 v[152:155], v[204:207], v[108:111], v[152:155]
    s_add_u32 m0, s23, 34944
    v_add_f32 v235, v156, v157
    v_max3_f32 v236, v232, v233, v234
    v_mfma_f32_16x16x32_bf16 v[144:147], v[204:207], v[76:79], v[144:147]
    buffer_load_dwordx4 v227, s[8:11], s21 offen offset:2048 nt lds
    v_mfma_f32_16x16x32_bf16 v[144:147], v[200:203], v[72:75], v[144:147]
    v_exp_f32 v188, v188
    v_mfma_f32_16x16x32_bf16 v[136:139], v[200:203], v[40:43], v[136:139]
    ds_read_b128 v[196:199], v224 offset:8768
    v_cvt_pk_bf16_f32 v156, v156, v157
    v_mfma_f32_16x16x32_bf16 v[136:139], v[204:207], v[44:47], v[136:139]
    s_add_u32 m0, s23, 35008
    v_exp_f32 v189, v189
    v_mfma_f32_16x16x32_bf16 v[128:131], v[204:207], v[12:15], v[128:131]
    buffer_load_dwordx4 v227, s[8:11], s21 offen offset:3072 nt lds
    v_mfma_f32_16x16x32_bf16 v[128:131], v[200:203], v[8:11], v[128:131]
    s_waitcnt lgkmcnt(4)
    v_add_f32 v235, v235, v158
    v_cvt_pk_bf16_f32 v157, v158, v159
    v_mfma_f32_16x16x32_bf16 v[128:131], v[208:211], v[16:19], v[128:131]
    s_addk_i32 s21, 16384
    ds_read_b128 v[200:203], v224 offset:8832
    v_add_f32 v235, v235, v159
    v_mfma_f32_16x16x32_bf16 v[128:131], v[212:215], v[20:23], v[128:131]
    v_exp_f32 v190, v190
    v_mfma_f32_16x16x32_bf16 v[136:139], v[212:215], v[52:55], v[136:139]
    v_exp_f32 v191, v191
    v_mfma_f32_16x16x32_bf16 v[136:139], v[208:211], v[48:51], v[136:139]
    v_add_f32 v235, v235, v188
    v_cvt_pk_bf16_f32 v158, v188, v189
    v_mfma_f32_16x16x32_bf16 v[144:147], v[208:211], v[80:83], v[144:147]
    ds_read_b128 v[204:207], v224 offset:8896
    v_add_f32 v235, v235, v189
    v_mfma_f32_16x16x32_bf16 v[144:147], v[212:215], v[84:87], v[144:147]
    v_add_f32 v235, v235, v190
    v_cvt_pk_bf16_f32 v159, v190, v191
    v_mfma_f32_16x16x32_bf16 v[152:155], v[212:215], v[116:119], v[152:155]
    v_add_f32 v235, v235, v191
    v_mfma_f32_16x16x32_bf16 v[152:155], v[208:211], v[112:115], v[152:155]
    s_waitcnt lgkmcnt(4)
    v_max_f32 v236, v236, v235
    v_mfma_f32_16x16x32_bf16 v[152:155], v[216:219], v[120:123], v[152:155]
    ds_read_b128 v[208:211], v224 offset:8960
    v_cmp_lt_f32 vcc, s26, v236
    v_mfma_f32_16x16x32_bf16 v[152:155], v[220:223], v[124:127], v[152:155]
    v_mfma_f32_16x16x32_bf16 v[144:147], v[220:223], v[92:95], v[144:147]
    s_cbranch_vccnz L_rare2
L_back2:
    v_add_f32 v228, v228, v232
    v_add_f32 v229, v229, v233
    v_mfma_f32_16x16x32_bf16 v[144:147], v[216:219], v[88:91], v[144:147]
    v_add_f32 v230, v230, v234
    v_add_f32 v231, v231, v235
    v_mfma_f32_16x16x32_bf16 v[136:139], v[216:219], v[56:59], v[136:139]
    ds_read_b128 v[212:215], v224 offset:9024
    v_mfma_f32_16x16x32_bf16 v[136:139], v[220:223], v[60:63], v[136:139]
    v_mfma_f32_16x16x32_bf16 v[128:131], v[220:223], v[28:31], v[128:131]
    v_exp_f32 v152, v152
    v_mfma_f32_16x16x32_bf16 v[128:131], v[216:219], v[24:27], v[128:131]
    s_waitcnt lgkmcnt(4)
    v_exp_f32 v153, v153
    v_mfma_f32_16x16x32_bf16 v[164:167], v[192:195], v[0:3], v[240:243]
    ds_read_b128 v[216:219], v224 offset:9088
    v_add_f32 v235, v152, v153
    v_mfma_f32_16x16x32_bf16 v[164:167], v[196:199], v[4:7], v[164:167]
    v_exp_f32 v154, v154
    v_mfma_f32_16x16x32_bf16 v[172:175], v[196:199], v[36:39], v[244:247]
    v_exp_f32 v155, v155
    v_mfma_f32_16x16x32_bf16 v[172:175], v[192:195], v[32:35], v[172:175]
    v_exp_f32 v144, v144
    v_mfma_f32_16x16x32_bf16 v[180:183], v[192:195], v[64:67], v[248:251]
    ds_read_b128 v[220:223], v224 offset:9152
    v_cvt_pk_bf16_f32 v152, v152, v153
    v_mfma_f32_16x16x32_bf16 v[180:183], v[196:199], v[68:71], v[180:183]
    s_waitcnt vmcnt(12)
    v_exp_f32 v145, v145
    v_mfma_f32_16x16x32_bf16 v[188:191], v[196:199], v[100:103], v[252:255]
    s_barrier
    v_add_f32 v235, v235, v154
    v_cvt_pk_bf16_f32 v153, v154, v155
    v_mfma_f32_16x16x32_bf16 v[188:191], v[192:195], v[96:99], v[188:191]
    s_waitcnt lgkmcnt(4)
    v_exp_f32 v146, v146
    v_mfma_f32_16x16x32_bf16 v[188:191], v[200:203], v[104:107], v[188:191]
    ds_read_b128 v[192:195], v224 offset:17408
    v_add_f32 v235, v235, v155
    v_mfma_f32_16x16x32_bf16 v[188:191], v[204:207], v[108:111], v[188:191]
    v_exp_f32 v147, v147
    v_mfma_f32_16x16x32_bf16 v[180:183], v[204:207], v[76:79], v[180:183]
    v_add_f32 v234, v144, v145
    v_mfma_f32_16x16x32_bf16 v[180:183], v[200:203], v[72:75], v[180:183]
    v_exp_f32 v136, v136
    v_mfma_f32_16x16x32_bf16 v[172:175], v[200:203], v[40:43], v[172:175]
    ds_read_b128 v[196:199], v224 offset:17472
    v_cvt_pk_bf16_f32 v144, v144, v145
    v_mfma_f32_16x16x32_bf16 v[172:175], v[204:207], v[44:47], v[172:175]
    v_exp_f32 v137, v137
    v_mfma_f32_16x16x32_bf16 v[164:167], v[204:207], v[12:15], v[164:167]
    v_add_f32 v234, v234, v146
    v_cvt_pk_bf16_f32 v145, v146, v147
    v_mfma_f32_16x16x32_bf16 v[164:167], v[200:203], v[8:11], v[164:167]
    s_waitcnt lgkmcnt(4)
    v_exp_f32 v138, v138
    v_mfma_f32_16x16x32_bf16 v[164:167], v[208:211], v[16:19], v[164:167]
    ds_read_b128 v[200:203], v224 offset:17536
    v_add_f32 v234, v234, v147
    v_mfma_f32_16x16x32_bf16 v[164:167], v[212:215], v[20:23], v[164:167]
    v_exp_f32 v139, v139
    v_mfma_f32_16x16x32_bf16 v[172:175], v[212:215], v[52:55], v[172:175]
    v_add_f32 v233, v136, v137
    v_mfma_f32_16x16x32_bf16 v[172:175], v[208:211], v[48:51], v[172:175]
    v_exp_f32 v128, v128
    v_mfma_f32_16x16x32_bf16 v[180:183], v[208:211], v[80:83], v[180:183]
    ds_read_b128 v[204:207], v224 offset:17600
    v_cvt_pk_bf16_f32 v136, v136, v137
    v_mfma_f32_16x16x32_bf16 v[180:183], v[212:215], v[84:87], v[180:183]
    v_exp_f32 v129, v129
    v_mfma_f32_16x16x32_bf16 v[188:191], v[212:215], v[116:119], v[188:191]
    v_add_f32 v233, v233, v138
    v_cvt_pk_bf16_f32 v137, v138, v139
    v_mfma_f32_16x16x32_bf16 v[188:191], v[208:211], v[112:115], v[188:191]
    s_waitcnt lgkmcnt(4)
    v_exp_f32 v130, v130
    v_mfma_f32_16x16x32_bf16 v[188:191], v[216:219], v[120:123], v[188:191]
    ds_read_b128 v[208:211], v224 offset:17664
    v_add_f32 v233, v233, v139
    v_mfma_f32_16x16x32_bf16 v[188:191], v[220:223], v[124:127], v[188:191]
    v_exp_f32 v131, v131
    v_mfma_f32_16x16x32_bf16 v[180:183], v[220:223], v[92:95], v[180:183]
    v_add_f32 v232, v128, v129
    v_mfma_f32_16x16x32_bf16 v[180:183], v[216:219], v[88:91], v[180:183]
    v_cvt_pk_bf16_f32 v128, v128, v129
    v_add_f32 v232, v232, v130
    v_mfma_f32_16x16x32_bf16 v[172:175], v[216:219], v[56:59], v[172:175]
    ds_read_b128 v[212:215], v224 offset:17728
    v_add_f32 v232, v232, v131
    v_mfma_f32_16x16x32_bf16 v[172:175], v[220:223], v[60:63], v[172:175]
    v_cvt_pk_bf16_f32 v129, v130, v131
    v_mfma_f32_16x16x32_bf16 v[164:167], v[220:223], v[28:31], v[164:167]
    v_exp_f32 v188, v188
    v_mfma_f32_16x16x32_bf16 v[164:167], v[216:219], v[24:27], v[164:167]
    s_waitcnt lgkmcnt(4)
    v_exp_f32 v189, v189
    v_mfma_f32_16x16x32_bf16 v[184:187], v[192:195], v[96:99], v[252:255]
    ds_read_b128 v[216:219], v224 offset:17792
    v_add_f32 v235, v235, v188
    v_mfma_f32_16x16x32_bf16 v[184:187], v[196:199], v[100:103], v[184:187]
    v_exp_f32 v190, v190
    v_mfma_f32_16x16x32_bf16 v[176:179], v[196:199], v[68:71], v[248:251]
    v_exp_f32 v191, v191
    v_mfma_f32_16x16x32_bf16 v[176:179], v[192:195], v[64:67], v[176:179]
    v_add_f32 v235, v235, v189
    v_cvt_pk_bf16_f32 v154, v188, v189
    v_mfma_f32_16x16x32_bf16 v[168:171], v[192:195], v[32:35], v[244:247]
    ds_read_b128 v[220:223], v224 offset:17856
    v_add_f32 v235, v235, v190
    v_mfma_f32_16x16x32_bf16 v[168:171], v[196:199], v[36:39], v[168:171]
    v_exp_f32 v180, v180
    v_mfma_f32_16x16x32_bf16 v[160:163], v[196:199], v[4:7], v[240:243]
    v_exp_f32 v181, v181
    v_mfma_f32_16x16x32_bf16 v[160:163], v[192:195], v[0:3], v[160:163]
    s_waitcnt lgkmcnt(4)
    v_add_f32 v235, v235, v191
    v_cvt_pk_bf16_f32 v155, v190, v191
    v_mfma_f32_16x16x32_bf16 v[160:163], v[200:203], v[8:11], v[160:163]
    ds_read_b128 v[192:195], v224 offset:26112
    v_add_f32 v234, v234, v180
    v_mfma_f32_16x16x32_bf16 v[160:163], v[204:207], v[12:15], v[160:163]
    v_exp_f32 v182, v182
    v_mfma_f32_16x16x32_bf16 v[168:171], v[204:207], v[44:47], v[168:171]
    v_exp_f32 v183, v183
    v_mfma_f32_16x16x32_bf16 v[168:171], v[200:203], v[40:43], v[168:171]
    v_add_f32 v234, v234, v181
    v_cvt_pk_bf16_f32 v146, v180, v181
    v_mfma_f32_16x16x32_bf16 v[176:179], v[200:203], v[72:75], v[176:179]
    ds_read_b128 v[196:199], v224 offset:26176
    v_add_f32 v234, v234, v182
    v_mfma_f32_16x16x32_bf16 v[176:179], v[204:207], v[76:79], v[176:179]
    v_exp_f32 v172, v172
    v_mfma_f32_16x16x32_bf16 v[184:187], v[204:207], v[108:111], v[184:187]
    v_exp_f32 v173, v173
    v_mfma_f32_16x16x32_bf16 v[184:187], v[200:203], v[104:107], v[184:187]
    s_waitcnt lgkmcnt(4)
    v_add_f32 v234, v234, v183
    v_cvt_pk_bf16_f32 v147, v182, v183
    v_mfma_f32_16x16x32_bf16 v[184:187], v[208:211], v[112:115], v[184:187]
    ds_read_b128 v[200:203], v224 offset:26240
    v_add_f32 v233, v233, v172
    v_mfma_f32_16x16x32_bf16 v[184:187], v[212:215], v[116:119], v[184:187]
    v_exp_f32 v174, v174
    v_mfma_f32_16x16x32_bf16 v[176:179], v[212:215], v[84:87], v[176:179]
    v_exp_f32 v175, v175
    v_mfma_f32_16x16x32_bf16 v[176:179], v[208:211], v[80:83], v[176:179]
    v_add_f32 v233, v233, v173
    v_cvt_pk_bf16_f32 v138, v172, v173
    v_mfma_f32_16x16x32_bf16 v[168:171], v[208:211], v[48:51], v[168:171]
    ds_read_b128 v[204:207], v224 offset:26304
    v_add_f32 v233, v233, v174
    v_mfma_f32_16x16x32_bf16 v[168:171], v[212:215], v[52:55], v[168:171]
    v_exp_f32 v164, v164
    v_mfma_f32_16x16x32_bf16 v[160:163], v[212:215], v[20:23], v[160:163]
    v_exp_f32 v165, v165
    v_mfma_f32_16x16x32_bf16 v[160:163], v[208:211], v[16:19], v[160:163]
    s_waitcnt lgkmcnt(4)
    v_add_f32 v233, v233, v175
    v_cvt_pk_bf16_f32 v139, v174, v175
    v_mfma_f32_16x16x32_bf16 v[160:163], v[216:219], v[24:27], v[160:163]
    ds_read_b128 v[208:211], v224 offset:26368
    v_add_f32 v232, v232, v164
    v_mfma_f32_16x16x32_bf16 v[160:163], v[220:223], v[28:31], v[160:163]
    v_exp_f32 v166, v166
    v_mfma_f32_16x16x32_bf16 v[168:171], v[220:223], v[60:63], v[168:171]
    v_exp_f32 v167, v167
    v_mfma_f32_16x16x32_bf16 v[168:171], v[216:219], v[56:59], v[168:171]
    v_add_f32 v232, v232, v165
    v_cvt_pk_bf16_f32 v130, v164, v165
    v_mfma_f32_16x16x32_bf16 v[176:179], v[216:219], v[88:91], v[176:179]
    ds_read_b128 v[212:215], v224 offset:26432
    v_add_f32 v232, v232, v166
    v_mfma_f32_16x16x32_bf16 v[176:179], v[220:223], v[92:95], v[176:179]
    v_add_f32 v232, v232, v167
    v_cvt_pk_bf16_f32 v131, v166, v167
    v_mfma_f32_16x16x32_bf16 v[184:187], v[220:223], v[124:127], v[184:187]
    v_max3_f32 v236, v232, v233, v234
    v_mfma_f32_16x16x32_bf16 v[184:187], v[216:219], v[120:123], v[184:187]
    s_waitcnt lgkmcnt(4)
    v_max_f32 v236, v236, v235
    v_mfma_f32_16x16x32_bf16 v[188:191], v[192:195], v[96:99], v[252:255]
    ds_read_b128 v[216:219], v224 offset:26496
    v_cmp_lt_f32 vcc, s26, v236
    v_mfma_f32_16x16x32_bf16 v[188:191], v[196:199], v[100:103], v[188:191]
    v_mfma_f32_16x16x32_bf16 v[180:183], v[196:199], v[68:71], v[248:251]
    s_cbranch_vccnz L_rare3
L_back3:
    v_add_f32 v228, v228, v232
    v_add_f32 v229, v229, v233
    v_mfma_f32_16x16x32_bf16 v[180:183], v[192:195], v[64:67], v[180:183]
    v_add_f32 v230, v230, v234
    v_add_f32 v231, v231, v235
    v_mfma_f32_16x16x32_bf16 v[172:175], v[192:195], v[32:35], v[244:247]
    ds_read_b128 v[220:223], v224 offset:26560
    v_mfma_f32_16x16x32_bf16 v[172:175], v[196:199], v[36:39], v[172:175]
    s_waitcnt vmcnt(4)
    v_mfma_f32_16x16x32_bf16 v[164:167], v[196:199], v[4:7], v[240:243]
    s_barrier
    v_mfma_f32_16x16x32_bf16 v[164:167], v[192:195], v[0:3], v[164:167]
    s_waitcnt lgkmcnt(4)
    v_mfma_f32_16x16x32_bf16 v[164:167], v[200:203], v[8:11], v[164:167]
    ds_read_b64_tr_b16 v[192:193], v225 offset:52224
    v_mfma_f32_16x16x32_bf16 v[164:167], v[204:207], v[12:15], v[164:167]
    s_add_u32 m0, s23, 52224
    ds_read_b64_tr_b16 v[194:195], v225 offset:60928
    v_mfma_f32_16x16x32_bf16 v[172:175], v[204:207], v[44:47], v[172:175]
    buffer_load_dwordx4 v227, s[8:11], s21 offen offset:0 nt lds
    v_mfma_f32_16x16x32_bf16 v[172:175], v[200:203], v[40:43], v[172:175]
    v_mfma_f32_16x16x32_bf16 v[180:183], v[200:203], v[72:75], v[180:183]
    ds_read_b64_tr_b16 v[196:197], v225 offset:0
    v_mfma_f32_16x16x32_bf16 v[180:183], v[204:207], v[76:79], v[180:183]
    ds_read_b64_tr_b16 v[198:199], v225 offset:8704
    v_mfma_f32_16x16x32_bf16 v[188:191], v[204:207], v[108:111], v[188:191]
    v_mfma_f32_16x16x32_bf16 v[188:191], v[200:203], v[104:107], v[188:191]
    s_waitcnt lgkmcnt(6)
    v_mfma_f32_16x16x32_bf16 v[188:191], v[208:211], v[112:115], v[188:191]
    ds_read_b64_tr_b16 v[200:201], v226 offset:52224
    v_mfma_f32_16x16x32_bf16 v[188:191], v[212:215], v[116:119], v[188:191]
    s_add_u32 m0, s23, 52288
    ds_read_b64_tr_b16 v[202:203], v226 offset:60928
    v_mfma_f32_16x16x32_bf16 v[180:183], v[212:215], v[84:87], v[180:183]
    buffer_load_dwordx4 v227, s[8:11], s21 offen offset:1024 nt lds
    v_mfma_f32_16x16x32_bf16 v[180:183], v[208:211], v[80:83], v[180:183]
    v_mfma_f32_16x16x32_bf16 v[172:175], v[208:211], v[48:51], v[172:175]
    ds_read_b64_tr_b16 v[204:205], v226 offset:0
    v_mfma_f32_16x16x32_bf16 v[172:175], v[212:215], v[52:55], v[172:175]
    ds_read_b64_tr_b16 v[206:207], v226 offset:8704
    v_mfma_f32_16x16x32_bf16 v[164:167], v[212:215], v[20:23], v[164:167]
    v_mfma_f32_16x16x32_bf16 v[164:167], v[208:211], v[16:19], v[164:167]
    s_waitcnt lgkmcnt(8)
    v_mfma_f32_16x16x32_bf16 v[164:167], v[216:219], v[24:27], v[164:167]
    ds_read_b64_tr_b16 v[208:209], v225 offset:52288
    v_mfma_f32_16x16x32_bf16 v[164:167], v[220:223], v[28:31], v[164:167]
    s_add_u32 m0, s23, 52352
    ds_read_b64_tr_b16 v[210:211], v225 offset:60992
    v_mfma_f32_16x16x32_bf16 v[172:175], v[220:223], v[60:63], v[172:175]
    buffer_load_dwordx4 v227, s[8:11], s21 offen offset:2048 nt lds
    v_mfma_f32_16x16x32_bf16 v[172:175], v[216:219], v[56:59], v[172:175]
    v_mfma_f32_16x16x32_bf16 v[180:183], v[216:219], v[88:91], v[180:183]
    ds_read_b64_tr_b16 v[212:213], v225 offset:64
    v_mfma_f32_16x16x32_bf16 v[180:183], v[220:223], v[92:95], v[180:183]
    ds_read_b64_tr_b16 v[214:215], v225 offset:8768
    v_mfma_f32_16x16x32_bf16 v[188:191], v[220:223], v[124:127], v[188:191]
    v_mfma_f32_16x16x32_bf16 v[188:191], v[216:219], v[120:123], v[188:191]
    s_waitcnt lgkmcnt(8)
    v_mfma_f32_16x16x32_bf16 a[0:3], v[192:195], v[132:135], a[0:3]
    ds_read_b64_tr_b16 v[216:217], v226 offset:52288
    v_mfma_f32_16x16x32_bf16 a[0:3], v[196:199], v[128:131], a[0:3]
    s_add_u32 m0, s23, 52416
    ds_read_b64_tr_b16 v[218:219], v226 offset:60992
    v_mfma_f32_16x16x32_bf16 a[64:67], v[196:199], v[136:139], a[64:67]
    buffer_load_dwordx4 v227, s[8:11], s21 offen offset:3072 nt lds
    v_mfma_f32_16x16x32_bf16 a[64:67], v[192:195], v[140:143], a[64:67]
    v_mfma_f32_16x16x32_bf16 a[128:131], v[192:195], v[148:151], a[128:131]
    s_addk_i32 s21, 16384
    ds_read_b64_tr_b16 v[220:221], v226 offset:64
    v_mfma_f32_16x16x32_bf16 a[128:131], v[196:199], v[144:147], a[128:131]
    ds_read_b64_tr_b16 v[222:223], v226 offset:8768
    v_mfma_f32_16x16x32_bf16 a[192:195], v[196:199], v[152:155], a[192:195]
    v_mfma_f32_16x16x32_bf16 a[192:195], v[192:195], v[156:159], a[192:195]
    s_waitcnt lgkmcnt(8)
    v_mfma_f32_16x16x32_bf16 a[196:199], v[200:203], v[156:159], a[196:199]
    ds_read_b64_tr_b16 v[192:193], v225 offset:52352
    v_mfma_f32_16x16x32_bf16 a[196:199], v[204:207], v[152:155], a[196:199]
    s_add_u32 m0, s23, 87040
    ds_read_b64_tr_b16 v[194:195], v225 offset:61056
    v_mfma_f32_16x16x32_bf16 a[132:135], v[204:207], v[144:147], a[132:135]
    buffer_load_dwordx4 v227, s[12:15], s22 offen offset:0 nt lds
    v_mfma_f32_16x16x32_bf16 a[132:135], v[200:203], v[148:151], a[132:135]
    v_mfma_f32_16x16x32_bf16 a[68:71], v[200:203], v[140:143], a[68:71]
    ds_read_b64_tr_b16 v[196:197], v225 offset:128
    v_mfma_f32_16x16x32_bf16 a[68:71], v[204:207], v[136:139], a[68:71]
    ds_read_b64_tr_b16 v[198:199], v225 offset:8832
    v_mfma_f32_16x16x32_bf16 a[4:7], v[204:207], v[128:131], a[4:7]
    v_mfma_f32_16x16x32_bf16 a[4:7], v[200:203], v[132:135], a[4:7]
    s_waitcnt lgkmcnt(8)
    v_mfma_f32_16x16x32_bf16 a[8:11], v[208:211], v[132:135], a[8:11]
    ds_read_b64_tr_b16 v[200:201], v226 offset:52352
    v_mfma_f32_16x16x32_bf16 a[8:11], v[212:215], v[128:131], a[8:11]
    s_add_u32 m0, s23, 87104
    ds_read_b64_tr_b16 v[202:203], v226 offset:61056
    v_mfma_f32_16x16x32_bf16 a[72:75], v[212:215], v[136:139], a[72:75]
    buffer_load_dwordx4 v227, s[12:15], s22 offen offset:1024 nt lds
    v_mfma_f32_16x16x32_bf16 a[72:75], v[208:211], v[140:143], a[72:75]
    v_mfma_f32_16x16x32_bf16 a[136:139], v[208:211], v[148:151], a[136:139]
    ds_read_b64_tr_b16 v[204:205], v226 offset:128
    v_mfma_f32_16x16x32_bf16 a[136:139], v[212:215], v[144:147], a[136:139]
    ds_read_b64_tr_b16 v[206:207], v226 offset:8832
    v_mfma_f32_16x16x32_bf16 a[200:203], v[212:215], v[152:155], a[200:203]
    v_mfma_f32_16x16x32_bf16 a[200:203], v[208:211], v[156:159], a[200:203]
    s_waitcnt lgkmcnt(8)
    v_mfma_f32_16x16x32_bf16 a[204:207], v[216:219], v[156:159], a[204:207]
    ds_read_b64_tr_b16 v[208:209], v225 offset:52416
    v_mfma_f32_16x16x32_bf16 a[204:207], v[220:223], v[152:155], a[204:207]
    s_add_u32 m0, s23, 87168
    ds_read_b64_tr_b16 v[210:211], v225 offset:61120
    v_mfma_f32_16x16x32_bf16 a[140:143], v[220:223], v[144:147], a[140:143]
    buffer_load_dwordx4 v227, s[12:15], s22 offen offset:2048 nt lds
    v_mfma_f32_16x16x32_bf16 a[140:143], v[216:219], v[148:151], a[140:143]
    v_mfma_f32_16x16x32_bf16 a[76:79], v[216:219], v[140:143], a[76:79]
    ds_read_b64_tr_b16 v[212:213], v225 offset:192
    v_mfma_f32_16x16x32_bf16 a[76:79], v[220:223], v[136:139], a[76:79]
    ds_read_b64_tr_b16 v[214:215], v225 offset:8896
    v_mfma_f32_16x16x32_bf16 a[12:15], v[220:223], v[128:131], a[12:15]
    v_mfma_f32_16x16x32_bf16 a[12:15], v[216:219], v[132:135], a[12:15]
    s_waitcnt lgkmcnt(8)
    v_mfma_f32_16x16x32_bf16 a[16:19], v[192:195], v[132:135], a[16:19]
    ds_read_b64_tr_b16 v[216:217], v226 offset:52416
    v_mfma_f32_16x16x32_bf16 a[16:19], v[196:199], v[128:131], a[16:19]
    s_add_u32 m0, s23, 87232
    ds_read_b64_tr_b16 v[218:219], v226 offset:61120
    v_mfma_f32_16x16x32_bf16 a[80:83], v[196:199], v[136:139], a[80:83]
    buffer_load_dwordx4 v227, s[12:15], s22 offen offset:3072 nt lds
    v_mfma_f32_16x16x32_bf16 a[80:83], v[192:195], v[140:143], a[80:83]
    v_mfma_f32_16x16x32_bf16 a[144:147], v[192:195], v[148:151], a[144:147]
    s_addk_i32 s22, 16384
    ds_read_b64_tr_b16 v[220:221], v226 offset:192
    v_mfma_f32_16x16x32_bf16 a[144:147], v[196:199], v[144:147], a[144:147]
    ds_read_b64_tr_b16 v[222:223], v226 offset:8896
    v_mfma_f32_16x16x32_bf16 a[208:211], v[196:199], v[152:155], a[208:211]
    v_mfma_f32_16x16x32_bf16 a[208:211], v[192:195], v[156:159], a[208:211]
    s_waitcnt lgkmcnt(8)
    v_mfma_f32_16x16x32_bf16 a[212:215], v[200:203], v[156:159], a[212:215]
    ds_read_b64_tr_b16 v[192:193], v225 offset:52480
    v_mfma_f32_16x16x32_bf16 a[212:215], v[204:207], v[152:155], a[212:215]
    s_add_u32 m0, s23, 104448
    ds_read_b64_tr_b16 v[194:195], v225 offset:61184
    v_mfma_f32_16x16x32_bf16 a[148:151], v[204:207], v[144:147], a[148:151]
    buffer_load_dwordx4 v227, s[12:15], s22 offen offset:0 nt lds
    v_mfma_f32_16x16x32_bf16 a[148:151], v[200:203], v[148:151], a[148:151]
    v_mfma_f32_16x16x32_bf16 a[84:87], v[200:203], v[140:143], a[84:87]
    ds_read_b64_tr_b16 v[196:197], v225 offset:256
    v_mfma_f32_16x16x32_bf16 a[84:87], v[204:207], v[136:139], a[84:87]
    ds_read_b64_tr_b16 v[198:199], v225 offset:8960
    v_mfma_f32_16x16x32_bf16 a[20:23], v[204:207], v[128:131], a[20:23]
    v_mfma_f32_16x16x32_bf16 a[20:23], v[200:203], v[132:135], a[20:23]
    s_waitcnt lgkmcnt(8)
    v_mfma_f32_16x16x32_bf16 a[24:27], v[208:211], v[132:135], a[24:27]
    ds_read_b64_tr_b16 v[200:201], v226 offset:52480
    v_mfma_f32_16x16x32_bf16 a[24:27], v[212:215], v[128:131], a[24:27]
    s_add_u32 m0, s23, 104512
    ds_read_b64_tr_b16 v[202:203], v226 offset:61184
    v_mfma_f32_16x16x32_bf16 a[88:91], v[212:215], v[136:139], a[88:91]
    buffer_load_dwordx4 v227, s[12:15], s22 offen offset:1024 nt lds
    v_mfma_f32_16x16x32_bf16 a[88:91], v[208:211], v[140:143], a[88:91]
    v_mfma_f32_16x16x32_bf16 a[152:155], v[208:211], v[148:151], a[152:155]
    ds_read_b64_tr_b16 v[204:205], v226 offset:256
    v_mfma_f32_16x16x32_bf16 a[152:155], v[212:215], v[144:147], a[152:155]
    ds_read_b64_tr_b16 v[206:207], v226 offset:8960
    v_mfma_f32_16x16x32_bf16 a[216:219], v[212:215], v[152:155], a[216:219]
    v_mfma_f32_16x16x32_bf16 a[216:219], v[208:211], v[156:159], a[216:219]
    s_waitcnt lgkmcnt(8)
    v_mfma_f32_16x16x32_bf16 a[220:223], v[216:219], v[156:159], a[220:223]
    ds_read_b64_tr_b16 v[208:209], v225 offset:52544
    v_mfma_f32_16x16x32_bf16 a[220:223], v[220:223], v[152:155], a[220:223]
    s_add_u32 m0, s23, 104576
    ds_read_b64_tr_b16 v[210:211], v225 offset:61248
    v_mfma_f32_16x16x32_bf16 a[156:159], v[220:223], v[144:147], a[156:159]
    buffer_load_dwordx4 v227, s[12:15], s22 offen offset:2048 nt lds
    v_mfma_f32_16x16x32_bf16 a[156:159], v[216:219], v[148:151], a[156:159]
    v_mfma_f32_16x16x32_bf16 a[92:95], v[216:219], v[140:143], a[92:95]
    ds_read_b64_tr_b16 v[212:213], v225 offset:320
    v_mfma_f32_16x16x32_bf16 a[92:95], v[220:223], v[136:139], a[92:95]
    ds_read_b64_tr_b16 v[214:215], v225 offset:9024
    v_mfma_f32_16x16x32_bf16 a[28:31], v[220:223], v[128:131], a[28:31]
    v_mfma_f32_16x16x32_bf16 a[28:31], v[216:219], v[132:135], a[28:31]
    s_waitcnt lgkmcnt(8)
    v_mfma_f32_16x16x32_bf16 a[32:35], v[192:195], v[132:135], a[32:35]
    ds_read_b64_tr_b16 v[216:217], v226 offset:52544
    v_mfma_f32_16x16x32_bf16 a[32:35], v[196:199], v[128:131], a[32:35]
    s_add_u32 m0, s23, 104640
    ds_read_b64_tr_b16 v[218:219], v226 offset:61248
    v_mfma_f32_16x16x32_bf16 a[96:99], v[196:199], v[136:139], a[96:99]
    buffer_load_dwordx4 v227, s[12:15], s22 offen offset:3072 nt lds
    v_mfma_f32_16x16x32_bf16 a[96:99], v[192:195], v[140:143], a[96:99]
    v_mfma_f32_16x16x32_bf16 a[160:163], v[192:195], v[148:151], a[160:163]
    s_addk_i32 s22, 16384
    ds_read_b64_tr_b16 v[220:221], v226 offset:320
    v_mfma_f32_16x16x32_bf16 a[160:163], v[196:199], v[144:147], a[160:163]
    ds_read_b64_tr_b16 v[222:223], v226 offset:9024
    v_mfma_f32_16x16x32_bf16 a[224:227], v[196:199], v[152:155], a[224:227]
    v_mfma_f32_16x16x32_bf16 a[224:227], v[192:195], v[156:159], a[224:227]
    s_waitcnt lgkmcnt(8)
    v_mfma_f32_16x16x32_bf16 a[228:231], v[200:203], v[156:159], a[228:231]
    ds_read_b64_tr_b16 v[192:193], v225 offset:52608
    v_mfma_f32_16x16x32_bf16 a[228:231], v[204:207], v[152:155], a[228:231]
    ds_read_b64_tr_b16 v[194:195], v225 offset:61312
    v_mfma_f32_16x16x32_bf16 a[164:167], v[204:207], v[144:147], a[164:167]
    v_mfma_f32_16x16x32_bf16 a[164:167], v[200:203], v[148:151], a[164:167]
    v_mfma_f32_16x16x32_bf16 a[100:103], v[200:203], v[140:143], a[100:103]
    ds_read_b64_tr_b16 v[196:197], v225 offset:384
    v_mfma_f32_16x16x32_bf16 a[100:103], v[204:207], v[136:139], a[100:103]
    ds_read_b64_tr_b16 v[198:199], v225 offset:9088
    v_mfma_f32_16x16x32_bf16 a[36:39], v[204:207], v[128:131], a[36:39]
    v_exp_f32 v160, v160
    v_mfma_f32_16x16x32_bf16 a[36:39], v[200:203], v[132:135], a[36:39]
    s_waitcnt lgkmcnt(8)
    v_exp_f32 v161, v161
    v_mfma_f32_16x16x32_bf16 a[40:43], v[208:211], v[132:135], a[40:43]
    ds_read_b64_tr_b16 v[200:201], v226 offset:52608
    v_add_f32 v232, v160, v161
    v_mfma_f32_16x16x32_bf16 a[40:43], v[212:215], v[128:131], a[40:43]
    ds_read_b64_tr_b16 v[202:203], v226 offset:61312
    v_cvt_pk_bf16_f32 v160, v160, v161
    v_mfma_f32_16x16x32_bf16 a[104:107], v[212:215], v[136:139], a[104:107]
    v_exp_f32 v162, v162
    v_mfma_f32_16x16x32_bf16 a[104:107], v[208:211], v[140:143], a[104:107]
    v_exp_f32 v163, v163
    v_mfma_f32_16x16x32_bf16 a[168:171], v[208:211], v[148:151], a[168:171]
    ds_read_b64_tr_b16 v[204:205], v226 offset:384
    v_add_f32 v232, v232, v162
    v_mfma_f32_16x16x32_bf16 a[168:171], v[212:215], v[144:147], a[168:171]
    ds_read_b64_tr_b16 v[206:207], v226 offset:9088
    v_add_f32 v232, v232, v163
    v_mfma_f32_16x16x32_bf16 a[232:235], v[212:215], v[152:155], a[232:235]
    v_exp_f32 v164, v164
    v_mfma_f32_16x16x32_bf16 a[232:235], v[208:211], v[156:159], a[232:235]
    s_waitcnt lgkmcnt(8)
    v_exp_f32 v165, v165
    v_mfma_f32_16x16x32_bf16 a[236:239], v[216:219], v[156:159], a[236:239]
    ds_read_b64_tr_b16 v[208:209], v225 offset:52672
    v_cvt_pk_bf16_f32 v161, v162, v163
    v_mfma_f32_16x16x32_bf16 a[236:239], v[220:223], v[152:155], a[236:239]
    ds_read_b64_tr_b16 v[210:211], v225 offset:61376
    v_add_f32 v232, v232, v164
    v_mfma_f32_16x16x32_bf16 a[172:175], v[220:223], v[144:147], a[172:175]
    v_exp_f32 v166, v166
    v_mfma_f32_16x16x32_bf16 a[172:175], v[216:219], v[148:151], a[172:175]
    v_exp_f32 v167, v167
    v_mfma_f32_16x16x32_bf16 a[108:111], v[216:219], v[140:143], a[108:111]
    ds_read_b64_tr_b16 v[212:213], v225 offset:448
    v_add_f32 v232, v232, v165
    v_mfma_f32_16x16x32_bf16 a[108:111], v[220:223], v[136:139], a[108:111]
    ds_read_b64_tr_b16 v[214:215], v225 offset:9152
    v_cvt_pk_bf16_f32 v162, v164, v165
    v_mfma_f32_16x16x32_bf16 a[44:47], v[220:223], v[128:131], a[44:47]
    v_exp_f32 v168, v168
    v_mfma_f32_16x16x32_bf16 a[44:47], v[216:219], v[132:135], a[44:47]
    s_waitcnt lgkmcnt(8)
    v_exp_f32 v169, v169
    v_mfma_f32_16x16x32_bf16 a[48:51], v[192:195], v[132:135], a[48:51]
    ds_read_b64_tr_b16 v[216:217], v226 offset:52672
    v_add_f32 v232, v232, v166
    v_mfma_f32_16x16x32_bf16 a[48:51], v[196:199], v[128:131], a[48:51]
    ds_read_b64_tr_b16 v[218:219], v226 offset:61376
    v_add_f32 v232, v232, v167
    v_mfma_f32_16x16x32_bf16 a[112:115], v[196:199], v[136:139], a[112:115]
    v_exp_f32 v170, v170
    v_mfma_f32_16x16x32_bf16 a[112:115], v[192:195], v[140:143], a[112:115]
    v_exp_f32 v171, v171
    v_mfma_f32_16x16x32_bf16 a[176:179], v[192:195], v[148:151], a[176:179]
    ds_read_b64_tr_b16 v[220:221], v226 offset:448
    v_cvt_pk_bf16_f32 v163, v166, v167
    v_mfma_f32_16x16x32_bf16 a[176:179], v[196:199], v[144:147], a[176:179]
    ds_read_b64_tr_b16 v[222:223], v226 offset:9152
    v_add_f32 v233, v168, v169
    v_mfma_f32_16x16x32_bf16 a[240:243], v[196:199], v[152:155], a[240:243]
    v_exp_f32 v172, v172
    v_mfma_f32_16x16x32_bf16 a[240:243], v[192:195], v[156:159], a[240:243]
    s_waitcnt lgkmcnt(8)
    v_cvt_pk_bf16_f32 v168, v168, v169
    v_add_f32 v233, v233, v170
    v_mfma_f32_16x16x32_bf16 a[244:247], v[200:203], v[156:159], a[244:247]
    v_exp_f32 v173, v173
    v_mfma_f32_16x16x32_bf16 a[244:247], v[204:207], v[152:155], a[244:247]
    v_add_f32 v233, v233, v171
    v_cvt_pk_bf16_f32 v169, v170, v171
    v_mfma_f32_16x16x32_bf16 a[180:183], v[204:207], v[144:147], a[180:183]
    v_exp_f32 v174, v174
    v_mfma_f32_16x16x32_bf16 a[180:183], v[200:203], v[148:151], a[180:183]
    v_exp_f32 v175, v175
    v_mfma_f32_16x16x32_bf16 a[116:119], v[200:203], v[140:143], a[116:119]
    v_add_f32 v233, v233, v172
    v_cvt_pk_bf16_f32 v170, v172, v173
    v_mfma_f32_16x16x32_bf16 a[116:119], v[204:207], v[136:139], a[116:119]
    v_exp_f32 v176, v176
    v_mfma_f32_16x16x32_bf16 a[52:55], v[204:207], v[128:131], a[52:55]
    v_exp_f32 v177, v177
    v_mfma_f32_16x16x32_bf16 a[52:55], v[200:203], v[132:135], a[52:55]
    s_waitcnt lgkmcnt(4)
    v_add_f32 v233, v233, v173
    v_cvt_pk_bf16_f32 v171, v174, v175
    v_mfma_f32_16x16x32_bf16 a[56:59], v[208:211], v[132:135], a[56:59]
    s_waitcnt vmcnt(12) lgkmcnt(0)
    v_exp_f32 v178, v178
    v_mfma_f32_16x16x32_bf16 a[56:59], v[212:215], v[128:131], a[56:59]
    s_barrier
    v_mfma_f32_16x16x32_bf16 a[120:123], v[212:215], v[136:139], a[120:123]
    ds_read_b128 v[192:195], v224 offset:34816
    v_add_f32 v233, v233, v174
    v_mfma_f32_16x16x32_bf16 a[120:123], v[208:211], v[140:143], a[120:123]
    v_exp_f32 v179, v179
    v_mfma_f32_16x16x32_bf16 a[184:187], v[208:211], v[148:151], a[184:187]
    ds_read_b128 v[196:199], v224 offset:34880
    v_add_f32 v233, v233, v175
    v_mfma_f32_16x16x32_bf16 a[184:187], v[212:215], v[144:147], a[184:187]
    v_add_f32 v234, v176, v177
    v_mfma_f32_16x16x32_bf16 a[248:251], v[212:215], v[152:155], a[248:251]
    ds_read_b128 v[200:203], v224 offset:34944
    v_cvt_pk_bf16_f32 v176, v176, v177
    v_mfma_f32_16x16x32_bf16 a[248:251], v[208:211], v[156:159], a[248:251]
    v_exp_f32 v180, v180
    v_mfma_f32_16x16x32_bf16 a[252:255], v[216:219], v[156:159], a[252:255]
    ds_read_b128 v[204:207], v224 offset:35008
    v_add_f32 v234, v234, v178
    v_mfma_f32_16x16x32_bf16 a[252:255], v[220:223], v[152:155], a[252:255]
    v_exp_f32 v181, v181
    v_mfma_f32_16x16x32_bf16 a[188:191], v[220:223], v[144:147], a[188:191]
    ds_read_b128 v[208:211], v224 offset:35072
    v_add_f32 v234, v234, v179
    v_mfma_f32_16x16x32_bf16 a[188:191], v[216:219], v[148:151], a[188:191]
    v_exp_f32 v182, v182
    v_mfma_f32_16x16x32_bf16 a[124:127], v[216:219], v[140:143], a[124:127]
    ds_read_b128 v[212:215], v224 offset:35136
    v_cvt_pk_bf16_f32 v177, v178, v179
    v_mfma_f32_16x16x32_bf16 a[124:127], v[220:223], v[136:139], a[124:127]
    s_sub_u32 s24, s24, 1
    v_exp_f32 v183, v183
    v_mfma_f32_16x16x32_bf16 a[60:63], v[220:223], v[128:131], a[60:63]
    s_cmp_lg_u32 s24, 0
    v_add_f32 v234, v234, v180
    v_cvt_pk_bf16_f32 v178, v180, v181
    v_mfma_f32_16x16x32_bf16 a[60:63], v[216:219], v[132:135], a[60:63]
    s_waitcnt lgkmcnt(4)
    v_add_f32 v234, v234, v181
    s_cbranch_scc1 L_loop
L_tail:
    v_mfma_f32_16x16x32_bf16 v[128:131], v[192:195], v[0:3], v[240:243]
    s_nop 0
    ds_read_b128 v[216:219], v224 offset:35200
    v_add_f32 v234, v234, v182
    v_mfma_f32_16x16x32_bf16 v[128:131], v[196:199], v[4:7], v[128:131]
    ds_read_b128 v[220:223], v224 offset:35264
    v_add_f32 v234, v234, v183
    v_mfma_f32_16x16x32_bf16 v[136:139], v[196:199], v[36:39], v[244:247]
    v_exp_f32 v184, v184
    v_mfma_f32_16x16x32_bf16 v[136:139], v[192:195], v[32:35], v[136:139]
    v_exp_f32 v185, v185
    v_mfma_f32_16x16x32_bf16 v[144:147], v[192:195], v[64:67], v[248:251]
    v_exp_f32 v186, v186
    v_mfma_f32_16x16x32_bf16 v[144:147], v[196:199], v[68:71], v[144:147]
    v_exp_f32 v187, v187
    v_mfma_f32_16x16x32_bf16 v[152:155], v[196:199], v[100:103], v[252:255]
    v_exp_f32 v188, v188
    v_mfma_f32_16x16x32_bf16 v[152:155], v[192:195], v[96:99], v[152:155]
    s_waitcnt lgkmcnt(5)
    ds_read_b128 v[192:195], v224 offset:43520
    v_cvt_pk_bf16_f32 v179, v182, v183
    v_mfma_f32_16x16x32_bf16 v[152:155], v[200:203], v[104:107], v[152:155]
    s_waitcnt lgkmcnt(5)
    ds_read_b128 v[196:199], v224 offset:43584
    v_add_f32 v235, v184, v185
    v_mfma_f32_16x16x32_bf16 v[152:155], v[204:207], v[108:111], v[152:155]
    v_exp_f32 v189, v189
    v_mfma_f32_16x16x32_bf16 v[144:147], v[204:207], v[76:79], v[144:147]
    v_exp_f32 v190, v190
    v_mfma_f32_16x16x32_bf16 v[144:147], v[200:203], v[72:75], v[144:147]
    v_exp_f32 v191, v191
    v_mfma_f32_16x16x32_bf16 v[136:139], v[200:203], v[40:43], v[136:139]
    v_cvt_pk_bf16_f32 v184, v184, v185
    v_add_f32 v235, v235, v186
    v_mfma_f32_16x16x32_bf16 v[136:139], v[204:207], v[44:47], v[136:139]
    v_add_f32 v235, v235, v187
    v_cvt_pk_bf16_f32 v185, v186, v187
    v_mfma_f32_16x16x32_bf16 v[128:131], v[204:207], v[12:15], v[128:131]
    v_add_f32 v235, v235, v188
    v_add_f32 v235, v235, v189
    v_mfma_f32_16x16x32_bf16 v[128:131], v[200:203], v[8:11], v[128:131]
    s_waitcnt lgkmcnt(5)
    ds_read_b128 v[200:203], v224 offset:43648
    v_cvt_pk_bf16_f32 v186, v188, v189
    v_mfma_f32_16x16x32_bf16 v[128:131], v[208:211], v[16:19], v[128:131]
    s_waitcnt lgkmcnt(5)
    ds_read_b128 v[204:207], v224 offset:43712
    v_add_f32 v235, v235, v190
    v_mfma_f32_16x16x32_bf16 v[128:131], v[212:215], v[20:23], v[128:131]
    v_add_f32 v235, v235, v191
    v_cvt_pk_bf16_f32 v187, v190, v191
    v_mfma_f32_16x16x32_bf16 v[136:139], v[212:215], v[52:55], v[136:139]
    v_max3_f32 v236, v232, v233, v234
    v_max_f32 v236, v236, v235
    v_mfma_f32_16x16x32_bf16 v[136:139], v[208:211], v[48:51], v[136:139]
    v_cmp_lt_f32 vcc, s26, v236
    v_mfma_f32_16x16x32_bf16 v[144:147], v[208:211], v[80:83], v[144:147]
    s_cbranch_vccnz L_rare29
L_back29:
    v_add_f32 v228, v228, v232
    v_add_f32 v229, v229, v233
    v_mfma_f32_16x16x32_bf16 v[144:147], v[212:215], v[84:87], v[144:147]
    v_add_f32 v230, v230, v234
    v_add_f32 v231, v231, v235
    v_mfma_f32_16x16x32_bf16 v[152:155], v[212:215], v[116:119], v[152:155]
    v_mov_b32 v237, v240
    v_mov_b32 v238, v244
    v_mfma_f32_16x16x32_bf16 v[152:155], v[208:211], v[112:115], v[152:155]
    s_waitcnt lgkmcnt(5)
    ds_read_b128 v[208:211], v224 offset:43776
    v_mov_b32 v239, v248
    v_mfma_f32_16x16x32_bf16 v[152:155], v[216:219], v[120:123], v[152:155]
    s_waitcnt lgkmcnt(5)
    ds_read_b128 v[212:215], v224 offset:43840
    v_mov_b32 v227, v252
    v_mfma_f32_16x16x32_bf16 v[152:155], v[220:223], v[124:127], v[152:155]
    v_mfma_f32_16x16x32_bf16 v[144:147], v[220:223], v[92:95], v[144:147]
    v_mfma_f32_16x16x32_bf16 v[144:147], v[216:219], v[88:91], v[144:147]
    v_mfma_f32_16x16x32_bf16 v[136:139], v[216:219], v[56:59], v[136:139]
    v_mfma_f32_16x16x32_bf16 v[136:139], v[220:223], v[60:63], v[136:139]
    v_mfma_f32_16x16x32_bf16 v[128:131], v[220:223], v[28:31], v[128:131]
    s_waitcnt vmcnt(8)
    s_barrier
    v_mfma_f32_16x16x32_bf16 v[128:131], v[216:219], v[24:27], v[128:131]
    s_waitcnt lgkmcnt(5)
    ds_read_b128 v[216:219], v224 offset:43904
    v_mfma_f32_16x16x32_bf16 v[132:135], v[192:195], v[0:3], v[240:243]
    s_waitcnt lgkmcnt(5)
    ds_read_b128 v[220:223], v224 offset:43968
    v_mfma_f32_16x16x32_bf16 v[132:135], v[196:199], v[4:7], v[132:135]
    v_exp_f32 v136, v136
    v_mfma_f32_16x16x32_bf16 v[140:143], v[196:199], v[36:39], v[244:247]
    v_exp_f32 v137, v137
    v_mfma_f32_16x16x32_bf16 v[140:143], v[192:195], v[32:35], v[140:143]
    v_exp_f32 v128, v128
    v_mfma_f32_16x16x32_bf16 v[148:151], v[192:195], v[64:67], v[248:251]
    v_exp_f32 v129, v129
    v_mfma_f32_16x16x32_bf16 v[148:151], v[196:199], v[68:71], v[148:151]
    v_exp_f32 v130, v130
    v_mfma_f32_16x16x32_bf16 v[156:159], v[196:199], v[100:103], v[252:255]
    v_exp_f32 v131, v131
    v_mfma_f32_16x16x32_bf16 v[156:159], v[192:195], v[96:99], v[156:159]
    s_waitcnt lgkmcnt(5)
    ds_read_b128 v[192:195], v224 offset:52224
    v_add_f32 v232, v128, v129
    v_mfma_f32_16x16x32_bf16 v[156:159], v[200:203], v[104:107], v[156:159]
    s_waitcnt lgkmcnt(5)
    ds_read_b128 v[196:199], v224 offset:52288
    v_cvt_pk_bf16_f32 v128, v128, v129
    v_mfma_f32_16x16x32_bf16 v[156:159], v[204:207], v[108:111], v[156:159]
    v_exp_f32 v138, v138
    v_mfma_f32_16x16x32_bf16 v[148:151], v[204:207], v[76:79], v[148:151]
    v_exp_f32 v139, v139
    v_mfma_f32_16x16x32_bf16 v[148:151], v[200:203], v[72:75], v[148:151]
    v_exp_f32 v144, v144
    v_mfma_f32_16x16x32_bf16 v[140:143], v[200:203], v[40:43], v[140:143]
    v_exp_f32 v145, v145
    v_mfma_f32_16x16x32_bf16 v[140:143], v[204:207], v[44:47], v[140:143]
    v_exp_f32 v146, v146
    v_mfma_f32_16x16x32_bf16 v[132:135], v[204:207], v[12:15], v[132:135]
    v_exp_f32 v147, v147
    v_mfma_f32_16x16x32_bf16 v[132:135], v[200:203], v[8:11], v[132:135]
    s_waitcnt lgkmcnt(5)
    ds_read_b128 v[200:203], v224 offset:52352
    v_add_f32 v232, v232, v130
    v_mfma_f32_16x16x32_bf16 v[132:135], v[208:211], v[16:19], v[132:135]
    s_waitcnt lgkmcnt(5)
    ds_read_b128 v[204:207], v224 offset:52416
    v_add_f32 v232, v232, v131
    v_mfma_f32_16x16x32_bf16 v[132:135], v[212:215], v[20:23], v[132:135]
    v_exp_f32 v152, v152
    v_mfma_f32_16x16x32_bf16 v[140:143], v[212:215], v[52:55], v[140:143]
    v_exp_f32 v153, v153
    v_mfma_f32_16x16x32_bf16 v[140:143], v[208:211], v[48:51], v[140:143]
    v_exp_f32 v154, v154
    v_mfma_f32_16x16x32_bf16 v[148:151], v[208:211], v[80:83], v[148:151]
    v_exp_f32 v155, v155
    v_mfma_f32_16x16x32_bf16 v[148:151], v[212:215], v[84:87], v[148:151]
    v_cvt_pk_bf16_f32 v129, v130, v131
    v_add_f32 v233, v136, v137
    v_mfma_f32_16x16x32_bf16 v[156:159], v[212:215], v[116:119], v[156:159]
    v_cvt_pk_bf16_f32 v136, v136, v137
    v_add_f32 v233, v233, v138
    v_mfma_f32_16x16x32_bf16 v[156:159], v[208:211], v[112:115], v[156:159]
    s_waitcnt lgkmcnt(5)
    ds_read_b128 v[208:211], v224 offset:52480
    v_add_f32 v233, v233, v139
    v_mfma_f32_16x16x32_bf16 v[156:159], v[216:219], v[120:123], v[156:159]
    s_waitcnt lgkmcnt(5)
    ds_read_b128 v[212:215], v224 offset:52544
    v_cvt_pk_bf16_f32 v137, v138, v139
    v_mfma_f32_16x16x32_bf16 v[156:159], v[220:223], v[124:127], v[156:159]
    v_add_f32 v234, v144, v145
    v_cvt_pk_bf16_f32 v144, v144, v145
    v_mfma_f32_16x16x32_bf16 v[148:151], v[220:223], v[92:95], v[148:151]
    v_add_f32 v234, v234, v146
    v_add_f32 v234, v234, v147
    v_mfma_f32_16x16x32_bf16 v[148:151], v[216:219], v[88:91], v[148:151]
    v_cvt_pk_bf16_f32 v145, v146, v147
    v_add_f32 v235, v152, v153
    v_mfma_f32_16x16x32_bf16 v[140:143], v[216:219], v[56:59], v[140:143]
    v_exp_f32 v156, v156
    v_mfma_f32_16x16x32_bf16 v[140:143], v[220:223], v[60:63], v[140:143]
    v_exp_f32 v157, v157
    v_mfma_f32_16x16x32_bf16 v[132:135], v[220:223], v[28:31], v[132:135]
    v_exp_f32 v158, v158
    v_mfma_f32_16x16x32_bf16 v[132:135], v[216:219], v[24:27], v[132:135]
    s_waitcnt lgkmcnt(5)
    ds_read_b128 v[216:219], v224 offset:52608
    v_cvt_pk_bf16_f32 v152, v152, v153
    v_mfma_f32_16x16x32_bf16 v[164:167], v[192:195], v[0:3], v[240:243]
    s_waitcnt lgkmcnt(5)
    ds_read_b128 v[220:223], v224 offset:52672
    v_add_f32 v235, v235, v154
    v_mfma_f32_16x16x32_bf16 v[164:167], v[196:199], v[4:7], v[164:167]
    v_exp_f32 v140, v140
    v_mfma_f32_16x16x32_bf16 v[172:175], v[196:199], v[36:39], v[244:247]
    v_exp_f32 v132, v132
    v_mfma_f32_16x16x32_bf16 v[172:175], v[192:195], v[32:35], v[172:175]
    v_exp_f32 v133, v133
    v_mfma_f32_16x16x32_bf16 v[180:183], v[192:195], v[64:67], v[248:251]
    v_add_f32 v232, v232, v132
    v_add_f32 v232, v232, v133
    v_mfma_f32_16x16x32_bf16 v[180:183], v[196:199], v[68:71], v[180:183]
    v_exp_f32 v134, v134
    v_mfma_f32_16x16x32_bf16 v[188:191], v[196:199], v[100:103], v[252:255]
    v_cvt_pk_bf16_f32 v130, v132, v133
    v_add_f32 v232, v232, v134
    v_mfma_f32_16x16x32_bf16 v[188:191], v[192:195], v[96:99], v[188:191]
    s_waitcnt lgkmcnt(5)
    ds_read_b128 v[192:195], v224 offset:60928
    v_add_f32 v233, v233, v140
    v_mfma_f32_16x16x32_bf16 v[188:191], v[200:203], v[104:107], v[188:191]
    s_waitcnt lgkmcnt(5)
    ds_read_b128 v[196:199], v224 offset:60992
    v_add_f32 v235, v235, v155
    v_mfma_f32_16x16x32_bf16 v[188:191], v[204:207], v[108:111], v[188:191]
    v_exp_f32 v135, v135
    v_mfma_f32_16x16x32_bf16 v[180:183], v[204:207], v[76:79], v[180:183]
    v_exp_f32 v141, v141
    v_mfma_f32_16x16x32_bf16 v[180:183], v[200:203], v[72:75], v[180:183]
    v_add_f32 v232, v232, v135
    v_cvt_pk_bf16_f32 v131, v134, v135
    v_mfma_f32_16x16x32_bf16 v[172:175], v[200:203], v[40:43], v[172:175]
    v_exp_f32 v142, v142
    v_mfma_f32_16x16x32_bf16 v[172:175], v[204:207], v[44:47], v[172:175]
    v_exp_f32 v143, v143
    v_mfma_f32_16x16x32_bf16 v[164:167], v[204:207], v[12:15], v[164:167]
    v_add_f32 v233, v233, v141
    v_cvt_pk_bf16_f32 v138, v140, v141
    v_mfma_f32_16x16x32_bf16 v[164:167], v[200:203], v[8:11], v[164:167]
    s_waitcnt lgkmcnt(5)
    ds_read_b128 v[200:203], v224 offset:61056
    v_add_f32 v233, v233, v142
    v_mfma_f32_16x16x32_bf16 v[164:167], v[208:211], v[16:19], v[164:167]
    s_waitcnt lgkmcnt(5)
    ds_read_b128 v[204:207], v224 offset:61120
    v_add_f32 v233, v233, v143
    v_mfma_f32_16x16x32_bf16 v[164:167], v[212:215], v[20:23], v[164:167]
    v_exp_f32 v148, v148
    v_mfma_f32_16x16x32_bf16 v[172:175], v[212:215], v[52:55], v[172:175]
    v_exp_f32 v149, v149
    v_mfma_f32_16x16x32_bf16 v[172:175], v[208:211], v[48:51], v[172:175]
    v_cvt_pk_bf16_f32 v139, v142, v143
    v_add_f32 v234, v234, v148
    v_mfma_f32_16x16x32_bf16 v[180:183], v[208:211], v[80:83], v[180:183]
    v_exp_f32 v150, v150
    v_mfma_f32_16x16x32_bf16 v[180:183], v[212:215], v[84:87], v[180:183]
    v_exp_f32 v151, v151
    v_mfma_f32_16x16x32_bf16 v[188:191], v[212:215], v[116:119], v[188:191]
    v_add_f32 v234, v234, v149
    v_cvt_pk_bf16_f32 v146, v148, v149
    v_mfma_f32_16x16x32_bf16 v[188:191], v[208:211], v[112:115], v[188:191]
    s_waitcnt lgkmcnt(5)
    ds_read_b128 v[208:211], v224 offset:61184
    v_add_f32 v234, v234, v150
    v_mfma_f32_16x16x32_bf16 v[188:191], v[216:219], v[120:123], v[188:191]
    s_waitcnt lgkmcnt(5)
    ds_read_b128 v[212:215], v224 offset:61248
    v_add_f32 v234, v234, v151
    v_mfma_f32_16x16x32_bf16 v[188:191], v[220:223], v[124:127], v[188:191]
    v_exp_f32 v159, v159
    v_mfma_f32_16x16x32_bf16 v[180:183], v[220:223], v[92:95], v[180:183]
    v_cvt_pk_bf16_f32 v147, v150, v151
    v_cvt_pk_bf16_f32 v153, v154, v155
    v_mfma_f32_16x16x32_bf16 v[180:183], v[216:219], v[88:91], v[180:183]
    v_add_f32 v235, v235, v156
    v_add_f32 v235, v235, v157
    v_mfma_f32_16x16x32_bf16 v[172:175], v[216:219], v[56:59], v[172:175]
    v_cvt_pk_bf16_f32 v154, v156, v157
    v_add_f32 v235, v235, v158
    v_mfma_f32_16x16x32_bf16 v[172:175], v[220:223], v[60:63], v[172:175]
    v_add_f32 v235, v235, v159
    v_cvt_pk_bf16_f32 v155, v158, v159
    v_mfma_f32_16x16x32_bf16 v[164:167], v[220:223], v[28:31], v[164:167]
    s_waitcnt vmcnt(0)
    s_barrier
    v_max3_f32 v236, v232, v233, v234
    v_max_f32 v236, v236, v235
    v_mfma_f32_16x16x32_bf16 v[164:167], v[216:219], v[24:27], v[164:167]
    s_waitcnt lgkmcnt(5)
    ds_read_b128 v[216:219], v224 offset:61312
    v_cmp_lt_f32 vcc, s26, v236
    v_mfma_f32_16x16x32_bf16 v[240:243], v[192:195], v[0:3], v[240:243]
    s_waitcnt lgkmcnt(5)
    s_cbranch_vccnz L_rare30
L_back30:
    ds_read_b128 v[220:223], v224 offset:61376
    v_add_u32 v132, 69632, v225
    v_mfma_f32_16x16x32_bf16 v[240:243], v[196:199], v[4:7], v[240:243]
    v_add_u32 v133, 69632, v226
    v_add_f32 v228, v228, v232
    v_mfma_f32_16x16x32_bf16 v[244:247], v[196:199], v[36:39], v[244:247]
    v_exp_f32 v164, v164
    v_mfma_f32_16x16x32_bf16 v[244:247], v[192:195], v[32:35], v[244:247]
    v_exp_f32 v165, v165
    v_mfma_f32_16x16x32_bf16 v[248:251], v[192:195], v[64:67], v[248:251]
    v_exp_f32 v166, v166
    v_mfma_f32_16x16x32_bf16 v[248:251], v[196:199], v[68:71], v[248:251]
    v_exp_f32 v167, v167
    v_mfma_f32_16x16x32_bf16 v[252:255], v[196:199], v[100:103], v[252:255]
    v_exp_f32 v172, v172
    v_mfma_f32_16x16x32_bf16 v[252:255], v[192:195], v[96:99], v[252:255]
    s_waitcnt lgkmcnt(5)
    ds_read_b64_tr_b16 v[192:193], v225 offset:17408
    v_add_f32 v229, v229, v233
    v_mfma_f32_16x16x32_bf16 v[252:255], v[200:203], v[104:107], v[252:255]
    s_waitcnt lgkmcnt(5)
    ds_read_b64_tr_b16 v[194:195], v225 offset:26112
    v_add_f32 v230, v230, v234
    v_mfma_f32_16x16x32_bf16 v[252:255], v[204:207], v[108:111], v[252:255]
    ds_read_b64_tr_b16 v[196:197], v225 offset:34816
    v_add_f32 v231, v231, v235
    v_mfma_f32_16x16x32_bf16 v[248:251], v[204:207], v[76:79], v[248:251]
    ds_read_b64_tr_b16 v[198:199], v225 offset:43520
    v_add_f32 v232, v164, v165
    v_mfma_f32_16x16x32_bf16 v[248:251], v[200:203], v[72:75], v[248:251]
    v_exp_f32 v173, v173
    v_mfma_f32_16x16x32_bf16 v[244:247], v[200:203], v[40:43], v[244:247]
    v_exp_f32 v174, v174
    v_mfma_f32_16x16x32_bf16 v[244:247], v[204:207], v[44:47], v[244:247]
    v_exp_f32 v175, v175
    v_mfma_f32_16x16x32_bf16 v[240:243], v[204:207], v[12:15], v[240:243]
    v_exp_f32 v180, v180
    v_mfma_f32_16x16x32_bf16 v[240:243], v[200:203], v[8:11], v[240:243]
    s_waitcnt lgkmcnt(7)
    ds_read_b64_tr_b16 v[200:201], v226 offset:17408
    v_cvt_pk_bf16_f32 v164, v164, v165
    v_mfma_f32_16x16x32_bf16 v[240:243], v[208:211], v[16:19], v[240:243]
    s_waitcnt lgkmcnt(7)
    ds_read_b64_tr_b16 v[202:203], v226 offset:26112
    v_add_f32 v232, v232, v166
    v_mfma_f32_16x16x32_bf16 v[240:243], v[212:215], v[20:23], v[240:243]
    ds_read_b64_tr_b16 v[204:205], v226 offset:34816
    v_add_f32 v232, v232, v167
    v_mfma_f32_16x16x32_bf16 v[244:247], v[212:215], v[52:55], v[244:247]
    ds_read_b64_tr_b16 v[206:207], v226 offset:43520
    v_cvt_pk_bf16_f32 v165, v166, v167
    v_mfma_f32_16x16x32_bf16 v[244:247], v[208:211], v[48:51], v[244:247]
    v_exp_f32 v181, v181
    v_mfma_f32_16x16x32_bf16 v[248:251], v[208:211], v[80:83], v[248:251]
    v_exp_f32 v182, v182
    v_mfma_f32_16x16x32_bf16 v[248:251], v[212:215], v[84:87], v[248:251]
    v_exp_f32 v183, v183
    v_mfma_f32_16x16x32_bf16 v[252:255], v[212:215], v[116:119], v[252:255]
    v_exp_f32 v188, v188
    v_mfma_f32_16x16x32_bf16 v[252:255], v[208:211], v[112:115], v[252:255]
    s_waitcnt lgkmcnt(9)
    ds_read_b64_tr_b16 v[208:209], v225 offset:17472
    v_add_f32 v233, v172, v173
    v_mfma_f32_16x16x32_bf16 v[252:255], v[216:219], v[120:123], v[252:255]
    s_waitcnt lgkmcnt(9)
    ds_read_b64_tr_b16 v[210:211], v225 offset:26176
    v_cvt_pk_bf16_f32 v172, v172, v173
    v_mfma_f32_16x16x32_bf16 v[252:255], v[220:223], v[124:127], v[252:255]
    ds_read_b64_tr_b16 v[212:213], v225 offset:34880
    v_add_f32 v233, v233, v174
    v_mfma_f32_16x16x32_bf16 v[248:251], v[220:223], v[92:95], v[248:251]
    ds_read_b64_tr_b16 v[214:215], v225 offset:43584
    v_add_f32 v233, v233, v175
    v_mfma_f32_16x16x32_bf16 v[248:251], v[216:219], v[88:91], v[248:251]
    v_exp_f32 v189, v189
    v_mfma_f32_16x16x32_bf16 v[244:247], v[216:219], v[56:59], v[244:247]
    v_exp_f32 v190, v190
    v_mfma_f32_16x16x32_bf16 v[244:247], v[220:223], v[60:63], v[244:247]
    v_exp_f32 v191, v191
    v_mfma_f32_16x16x32_bf16 v[240:243], v[220:223], v[28:31], v[240:243]
    v_exp_f32 v252, v252
    v_mfma_f32_16x16x32_bf16 v[240:243], v[216:219], v[24:27], v[240:243]
    s_waitcnt lgkmcnt(10)
    ds_read_b64_tr_b16 v[216:217], v226 offset:17472
    v_cvt_pk_bf16_f32 v173, v174, v175
    v_mfma_f32_16x16x32_bf16 a[0:3], v[192:195], v[160:163], a[0:3]
    s_waitcnt lgkmcnt(9)
    ds_read_b64_tr_b16 v[218:219], v226 offset:26176
    v_exp_f32 v244, v244
    v_exp_f32 v245, v245
    v_exp_f32 v246, v246
    v_mfma_f32_16x16x32_bf16 a[0:3], v[196:199], v[128:131], a[0:3]
    ds_read_b64_tr_b16 v[220:221], v226 offset:34880
    v_exp_f32 v240, v240
    v_exp_f32 v241, v241
    v_add_f32 v232, v232, v240
    v_add_f32 v232, v232, v241
    v_mfma_f32_16x16x32_bf16 a[64:67], v[196:199], v[136:139], a[64:67]
    ds_read_b64_tr_b16 v[222:223], v226 offset:43584
    v_cvt_pk_bf16_f32 v166, v240, v241
    v_exp_f32 v242, v242
    v_exp_f32 v243, v243
    v_add_f32 v232, v232, v242
    v_mfma_f32_16x16x32_bf16 a[64:67], v[192:195], v[168:171], a[64:67]
    v_add_f32 v232, v232, v243
    v_cvt_pk_bf16_f32 v167, v242, v243
    v_exp_f32 v247, v247
    v_exp_f32 v248, v248
    v_add_f32 v233, v233, v244
    v_mfma_f32_16x16x32_bf16 a[128:131], v[192:195], v[176:179], a[128:131]
    v_add_f32 v233, v233, v245
    v_cvt_pk_bf16_f32 v174, v244, v245
    v_exp_f32 v249, v249
    v_exp_f32 v250, v250
    v_add_f32 v233, v233, v246
    v_mfma_f32_16x16x32_bf16 a[128:131], v[196:199], v[144:147], a[128:131]
    v_exp_f32 v251, v251
    v_exp_f32 v253, v253
    v_exp_f32 v254, v254
    v_add_f32 v233, v233, v247
    v_mfma_f32_16x16x32_bf16 a[192:195], v[196:199], v[152:155], a[192:195]
    v_exp_f32 v255, v255
    v_cvt_pk_bf16_f32 v175, v246, v247
    v_add_f32 v234, v180, v181
    v_cvt_pk_bf16_f32 v180, v180, v181
    v_add_f32 v234, v234, v182
    v_add_f32 v234, v234, v183
    v_mfma_f32_16x16x32_bf16 a[192:195], v[192:195], v[184:187], a[192:195]
    s_waitcnt lgkmcnt(10)
    ds_read_b64_tr_b16 v[192:193], v132 offset:0
    v_cvt_pk_bf16_f32 v181, v182, v183
    v_add_f32 v234, v234, v248
    v_add_f32 v234, v234, v249
    v_cvt_pk_bf16_f32 v182, v248, v249
    v_add_f32 v234, v234, v250
    v_add_f32 v234, v234, v251
    v_mfma_f32_16x16x32_bf16 a[196:199], v[200:203], v[184:187], a[196:199]
    s_waitcnt lgkmcnt(9)
    ds_read_b64_tr_b16 v[194:195], v132 offset:8704
    v_cvt_pk_bf16_f32 v183, v250, v251
    v_add_f32 v235, v188, v189
    v_cvt_pk_bf16_f32 v188, v188, v189
    v_add_f32 v235, v235, v190
    v_add_f32 v235, v235, v191
    v_cvt_pk_bf16_f32 v189, v190, v191
    v_mfma_f32_16x16x32_bf16 a[196:199], v[204:207], v[152:155], a[196:199]
    ds_read_b64_tr_b16 v[196:197], v133 offset:0
    v_add_f32 v235, v235, v252
    v_add_f32 v235, v235, v253
    v_cvt_pk_bf16_f32 v190, v252, v253
    v_add_f32 v235, v235, v254
    v_add_f32 v235, v235, v255
    v_cvt_pk_bf16_f32 v191, v254, v255
    v_mfma_f32_16x16x32_bf16 a[132:135], v[204:207], v[144:147], a[132:135]
    ds_read_b64_tr_b16 v[198:199], v133 offset:8704
    v_max3_f32 v236, v232, v233, v234
    v_max_f32 v236, v236, v235
    v_cmp_lt_f32 vcc, s26, v236
    v_mfma_f32_16x16x32_bf16 a[132:135], v[200:203], v[176:179], a[132:135]
    s_cbranch_vccnz L_rare31
L_back31:
    v_add_f32 v228, v228, v232
    v_add_f32 v229, v229, v233
    v_add_f32 v230, v230, v234
    v_add_f32 v231, v231, v235
    v_mov_b32 v113, v228
    v_mov_b32 v115, v229
    v_mov_b32 v117, v230
    v_mfma_f32_16x16x32_bf16 a[68:71], v[200:203], v[168:171], a[68:71]
    v_mov_b32 v119, v231
    v_permlane16_swap_b32 v228, v113
    v_permlane16_swap_b32 v229, v115
    v_permlane16_swap_b32 v230, v117
    v_permlane16_swap_b32 v231, v119
    v_add_f32 v112, v228, v113
    v_add_f32 v114, v229, v115
    v_mfma_f32_16x16x32_bf16 a[68:71], v[204:207], v[136:139], a[68:71]
    v_add_f32 v116, v230, v117
    v_add_f32 v118, v231, v119
    v_mov_b32 v113, v112
    v_mov_b32 v115, v114
    v_mov_b32 v117, v116
    v_mov_b32 v119, v118
    v_permlane32_swap_b32 v112, v113
    v_mfma_f32_16x16x32_bf16 a[4:7], v[204:207], v[128:131], a[4:7]
    v_permlane32_swap_b32 v114, v115
    v_permlane32_swap_b32 v116, v117
    v_permlane32_swap_b32 v118, v119
    v_add_f32 v112, v112, v113
    v_rcp_f32 v112, v112
    v_add_f32 v114, v114, v115
    v_mfma_f32_16x16x32_bf16 a[4:7], v[200:203], v[160:163], a[4:7]
    s_waitcnt lgkmcnt(10)
    ds_read_b64_tr_b16 v[200:201], v132 offset:64
    v_rcp_f32 v114, v114
    v_add_f32 v116, v116, v117
    v_rcp_f32 v116, v116
    v_add_f32 v118, v118, v119
    v_mfma_f32_16x16x32_bf16 a[8:11], v[208:211], v[160:163], a[8:11]
    s_waitcnt lgkmcnt(9)
    ds_read_b64_tr_b16 v[202:203], v132 offset:8768
    v_rcp_f32 v118, v118
    v_mbcnt_lo_u32_b32 v108, -1, 0
    v_mbcnt_hi_u32_b32 v108, -1, v108
    v_and_b32 v109, 15, v108
    v_lshlrev_b32 v109, 7, v109
    v_mfma_f32_16x16x32_bf16 a[8:11], v[212:215], v[128:131], a[8:11]
    ds_read_b64_tr_b16 v[204:205], v133 offset:64
    v_bfe_u32 v110, v108, 4, 1
    v_lshl_add_u32 v109, v110, 3, v109
    v_add_u32 v109, s23, v109
    v_lshrrev_b32 v110, 5, v108
    v_and_b32 v111, 7, v108
    v_xor_b32 v110, v110, v111
    v_mfma_f32_16x16x32_bf16 a[72:75], v[212:215], v[136:139], a[72:75]
    ds_read_b64_tr_b16 v[206:207], v133 offset:8768
    v_lshl_add_u32 v123, v110, 4, v109
    v_lshrrev_b32 v109, 3, v108
    v_xor_b32 v110, v109, v111
    v_lshlrev_b32 v110, 4, v110
    v_lshl_add_u32 v124, v109, 7, v110
    v_add_u32 v124, s23, v124
    v_mfma_f32_16x16x32_bf16 a[72:75], v[208:211], v[168:171], a[72:75]
    v_lshlrev_b32 v111, 4, v111
    v_lshl_add_u32 v125, v109, 9, v111
    v_xor_b32 v120, 32, v123
    v_xor_b32 v121, 64, v123
    v_xor_b32 v122, 96, v123
    v_mfma_f32_16x16x32_bf16 a[136:139], v[208:211], v[176:179], a[136:139]
    v_mfma_f32_16x16x32_bf16 a[136:139], v[212:215], v[144:147], a[136:139]
    v_mfma_f32_16x16x32_bf16 a[200:203], v[212:215], v[152:155], a[200:203]
    v_mfma_f32_16x16x32_bf16 a[200:203], v[208:211], v[184:187], a[200:203]
    s_waitcnt lgkmcnt(10)
    ds_read_b64_tr_b16 v[208:209], v225 offset:17536
    v_mfma_f32_16x16x32_bf16 a[204:207], v[216:219], v[184:187], a[204:207]
    s_waitcnt lgkmcnt(9)
    ds_read_b64_tr_b16 v[210:211], v225 offset:26240
    v_mfma_f32_16x16x32_bf16 a[204:207], v[220:223], v[152:155], a[204:207]
    ds_read_b64_tr_b16 v[212:213], v225 offset:34944
    v_mfma_f32_16x16x32_bf16 a[140:143], v[220:223], v[144:147], a[140:143]
    ds_read_b64_tr_b16 v[214:215], v225 offset:43648
    v_mfma_f32_16x16x32_bf16 a[140:143], v[216:219], v[176:179], a[140:143]
    v_mfma_f32_16x16x32_bf16 a[76:79], v[216:219], v[168:171], a[76:79]
    v_mfma_f32_16x16x32_bf16 a[76:79], v[220:223], v[136:139], a[76:79]
    v_mfma_f32_16x16x32_bf16 a[12:15], v[220:223], v[128:131], a[12:15]
    v_mfma_f32_16x16x32_bf16 a[12:15], v[216:219], v[160:163], a[12:15]
    s_waitcnt lgkmcnt(10)
    ds_read_b64_tr_b16 v[216:217], v132 offset:128
    v_mfma_f32_16x16x32_bf16 a[0:3], v[192:195], v[164:167], a[0:3]
    s_waitcnt lgkmcnt(9)
    ds_read_b64_tr_b16 v[218:219], v132 offset:8832
    v_mfma_f32_16x16x32_bf16 a[4:7], v[196:199], v[164:167], a[4:7]
    s_waitcnt lgkmcnt(8)
    ds_read_b64_tr_b16 v[220:221], v226 offset:17536
    v_mfma_f32_16x16x32_bf16 a[8:11], v[200:203], v[164:167], a[8:11]
    s_waitcnt lgkmcnt(7)
    ds_read_b64_tr_b16 v[222:223], v226 offset:26240
    v_mfma_f32_16x16x32_bf16 a[12:15], v[204:207], v[164:167], a[12:15]
    v_mfma_f32_16x16x32_bf16 a[76:79], v[204:207], v[172:175], a[76:79]
    v_mfma_f32_16x16x32_bf16 a[72:75], v[200:203], v[172:175], a[72:75]
    v_accvgpr_read_b32 v0, a0
    v_accvgpr_read_b32 v1, a1
    v_accvgpr_read_b32 v2, a2
    v_mfma_f32_16x16x32_bf16 a[68:71], v[196:199], v[172:175], a[68:71]
    v_accvgpr_read_b32 v3, a3
    v_accvgpr_read_b32 v4, a4
    v_accvgpr_read_b32 v5, a5
    v_mfma_f32_16x16x32_bf16 a[64:67], v[192:195], v[172:175], a[64:67]
    v_accvgpr_read_b32 v6, a6
    v_accvgpr_read_b32 v7, a7
    v_accvgpr_read_b32 v8, a8
    v_mfma_f32_16x16x32_bf16 a[128:131], v[192:195], v[180:183], a[128:131]
    v_accvgpr_read_b32 v9, a9
    v_accvgpr_read_b32 v10, a10
    v_accvgpr_read_b32 v11, a11
    v_mfma_f32_16x16x32_bf16 a[132:135], v[196:199], v[180:183], a[132:135]
    v_accvgpr_read_b32 v12, a12
    v_accvgpr_read_b32 v13, a13
    v_accvgpr_read_b32 v14, a14
    v_mfma_f32_16x16x32_bf16 a[136:139], v[200:203], v[180:183], a[136:139]
    v_accvgpr_read_b32 v15, a15
    v_mul_f32 v0, v0, v112
    v_mul_f32 v1, v1, v112
    v_mfma_f32_16x16x32_bf16 a[140:143], v[204:207], v[180:183], a[140:143]
    v_mul_f32 v2, v2, v112
    v_mul_f32 v3, v3, v112
    v_mul_f32 v4, v4, v112
    v_mfma_f32_16x16x32_bf16 a[204:207], v[204:207], v[188:191], a[204:207]
    v_mul_f32 v5, v5, v112
    v_mul_f32 v6, v6, v112
    v_mul_f32 v7, v7, v112
    v_mfma_f32_16x16x32_bf16 a[200:203], v[200:203], v[188:191], a[200:203]
    v_mul_f32 v8, v8, v112
    v_mul_f32 v9, v9, v112
    v_mul_f32 v10, v10, v112
    v_mfma_f32_16x16x32_bf16 a[196:199], v[196:199], v[188:191], a[196:199]
    v_mul_f32 v11, v11, v112
    v_mul_f32 v12, v12, v112
    v_mul_f32 v13, v13, v112
    v_mfma_f32_16x16x32_bf16 a[192:195], v[192:195], v[188:191], a[192:195]
    s_waitcnt lgkmcnt(6)
    ds_read_b64_tr_b16 v[192:193], v226 offset:34944
    v_mul_f32 v14, v14, v112
    v_mul_f32 v15, v15, v112
    v_mfma_f32_16x16x32_bf16 a[208:211], v[208:211], v[184:187], a[208:211]
    s_waitcnt lgkmcnt(5)
    ds_read_b64_tr_b16 v[194:195], v226 offset:43648
    v_cvt_pk_bf16_f32 v0, v0, v1
    v_cvt_pk_bf16_f32 v1, v2, v3
    v_cvt_pk_bf16_f32 v2, v4, v5
    v_cvt_pk_bf16_f32 v3, v6, v7
    v_mfma_f32_16x16x32_bf16 a[208:211], v[212:215], v[152:155], a[208:211]
    s_waitcnt lgkmcnt(4)
    ds_read_b64_tr_b16 v[196:197], v133 offset:128
    v_cvt_pk_bf16_f32 v4, v8, v9
    v_cvt_pk_bf16_f32 v5, v10, v11
    v_cvt_pk_bf16_f32 v6, v12, v13
    v_cvt_pk_bf16_f32 v7, v14, v15
    v_mfma_f32_16x16x32_bf16 a[208:211], v[216:219], v[188:191], a[208:211]
    ds_read_b64_tr_b16 v[198:199], v133 offset:8832
    v_accvgpr_read_b32 v16, a64
    v_accvgpr_read_b32 v17, a65
    v_accvgpr_read_b32 v18, a66
    v_accvgpr_read_b32 v19, a67
    v_mfma_f32_16x16x32_bf16 a[144:147], v[216:219], v[180:183], a[144:147]
    ds_read_b64_tr_b16 v[200:201], v225 offset:17600
    v_accvgpr_read_b32 v20, a68
    v_accvgpr_read_b32 v21, a69
    v_accvgpr_read_b32 v22, a70
    v_accvgpr_read_b32 v23, a71
    v_mfma_f32_16x16x32_bf16 a[144:147], v[212:215], v[144:147], a[144:147]
    ds_read_b64_tr_b16 v[202:203], v225 offset:26304
    v_accvgpr_read_b32 v24, a72
    v_accvgpr_read_b32 v25, a73
    v_accvgpr_read_b32 v26, a74
    v_accvgpr_read_b32 v27, a75
    v_mfma_f32_16x16x32_bf16 a[144:147], v[208:211], v[176:179], a[144:147]
    ds_read_b64_tr_b16 v[204:205], v225 offset:35008
    v_accvgpr_read_b32 v28, a76
    v_accvgpr_read_b32 v29, a77
    v_accvgpr_read_b32 v30, a78
    v_accvgpr_read_b32 v31, a79
    v_mfma_f32_16x16x32_bf16 a[80:83], v[208:211], v[168:171], a[80:83]
    ds_read_b64_tr_b16 v[206:207], v225 offset:43712
    v_mul_f32 v16, v16, v114
    v_mul_f32 v17, v17, v114
    v_mul_f32 v18, v18, v114
    v_mul_f32 v19, v19, v114
    v_mfma_f32_16x16x32_bf16 a[80:83], v[212:215], v[136:139], a[80:83]
    ds_write_b64 v123, v[0:1] offset:0
    v_mul_f32 v20, v20, v114
    v_mul_f32 v21, v21, v114
    v_mul_f32 v22, v22, v114
    v_mul_f32 v23, v23, v114
    v_mfma_f32_16x16x32_bf16 a[80:83], v[216:219], v[172:175], a[80:83]
    ds_write_b64 v120, v[2:3] offset:0
    v_mul_f32 v24, v24, v114
    v_mul_f32 v25, v25, v114
    v_mul_f32 v26, v26, v114
    v_mul_f32 v27, v27, v114
    v_mfma_f32_16x16x32_bf16 a[16:19], v[216:219], v[164:167], a[16:19]
    ds_write_b64 v121, v[4:5] offset:0
    v_mul_f32 v28, v28, v114
    v_mul_f32 v29, v29, v114
    v_mul_f32 v30, v30, v114
    v_mul_f32 v31, v31, v114
    v_mfma_f32_16x16x32_bf16 a[16:19], v[212:215], v[128:131], a[16:19]
    ds_write_b64 v122, v[6:7] offset:0
    v_cvt_pk_bf16_f32 v16, v16, v17
    v_cvt_pk_bf16_f32 v17, v18, v19
    v_cvt_pk_bf16_f32 v18, v20, v21
    v_cvt_pk_bf16_f32 v19, v22, v23
    v_mfma_f32_16x16x32_bf16 a[16:19], v[208:211], v[160:163], a[16:19]
    s_waitcnt lgkmcnt(12)
    ds_read_b64_tr_b16 v[208:209], v132 offset:192
    v_cvt_pk_bf16_f32 v20, v24, v25
    v_cvt_pk_bf16_f32 v21, v26, v27
    v_cvt_pk_bf16_f32 v22, v28, v29
    v_cvt_pk_bf16_f32 v23, v30, v31
    v_mfma_f32_16x16x32_bf16 a[20:23], v[220:223], v[160:163], a[20:23]
    s_waitcnt lgkmcnt(11)
    ds_read_b64_tr_b16 v[210:211], v132 offset:8896
    v_accvgpr_read_b32 v32, a128
    v_accvgpr_read_b32 v33, a129
    v_accvgpr_read_b32 v34, a130
    v_accvgpr_read_b32 v35, a131
    v_mfma_f32_16x16x32_bf16 a[20:23], v[192:195], v[128:131], a[20:23]
    s_waitcnt lgkmcnt(10)
    ds_read_b64_tr_b16 v[212:213], v226 offset:17600
    v_accvgpr_read_b32 v36, a132
    v_accvgpr_read_b32 v37, a133
    v_accvgpr_read_b32 v38, a134
    v_accvgpr_read_b32 v39, a135
    v_mfma_f32_16x16x32_bf16 a[20:23], v[196:199], v[164:167], a[20:23]
    ds_read_b64_tr_b16 v[214:215], v226 offset:26304
    v_accvgpr_read_b32 v40, a136
    v_accvgpr_read_b32 v41, a137
    v_accvgpr_read_b32 v42, a138
    v_accvgpr_read_b32 v43, a139
    v_mfma_f32_16x16x32_bf16 a[84:87], v[196:199], v[172:175], a[84:87]
    ds_read_b64_tr_b16 v[216:217], v226 offset:35008
    v_accvgpr_read_b32 v44, a140
    v_accvgpr_read_b32 v45, a141
    v_accvgpr_read_b32 v46, a142
    v_accvgpr_read_b32 v47, a143
    v_mfma_f32_16x16x32_bf16 a[84:87], v[192:195], v[136:139], a[84:87]
    ds_read_b64_tr_b16 v[218:219], v226 offset:43712
    v_mul_f32 v32, v32, v116
    v_mul_f32 v33, v33, v116
    v_mul_f32 v34, v34, v116
    v_mul_f32 v35, v35, v116
    v_mfma_f32_16x16x32_bf16 a[84:87], v[220:223], v[168:171], a[84:87]
    ds_write_b64 v123, v[16:17] offset:2048
    v_mul_f32 v36, v36, v116
    v_mul_f32 v37, v37, v116
    v_mul_f32 v38, v38, v116
    v_mul_f32 v39, v39, v116
    v_mfma_f32_16x16x32_bf16 a[148:151], v[220:223], v[176:179], a[148:151]
    ds_write_b64 v120, v[18:19] offset:2048
    v_mul_f32 v40, v40, v116
    v_mul_f32 v41, v41, v116
    v_mul_f32 v42, v42, v116
    v_mul_f32 v43, v43, v116
    v_mfma_f32_16x16x32_bf16 a[148:151], v[192:195], v[144:147], a[148:151]
    ds_write_b64 v121, v[20:21] offset:2048
    v_mul_f32 v44, v44, v116
    v_mul_f32 v45, v45, v116
    v_mul_f32 v46, v46, v116
    v_mul_f32 v47, v47, v116
    v_mfma_f32_16x16x32_bf16 a[148:151], v[196:199], v[180:183], a[148:151]
    ds_write_b64 v122, v[22:23] offset:2048
    v_cvt_pk_bf16_f32 v32, v32, v33
    v_cvt_pk_bf16_f32 v33, v34, v35
    v_cvt_pk_bf16_f32 v34, v36, v37
    v_cvt_pk_bf16_f32 v35, v38, v39
    v_mfma_f32_16x16x32_bf16 a[212:215], v[196:199], v[188:191], a[212:215]
    ds_read_b128 v[64:67], v124 offset:0
    v_cvt_pk_bf16_f32 v36, v40, v41
    v_cvt_pk_bf16_f32 v37, v42, v43
    v_cvt_pk_bf16_f32 v38, v44, v45
    v_cvt_pk_bf16_f32 v39, v46, v47
    v_mfma_f32_16x16x32_bf16 a[212:215], v[192:195], v[152:155], a[212:215]
    ds_read_b128 v[68:71], v124 offset:1024
    v_accvgpr_read_b32 v48, a192
    v_accvgpr_read_b32 v49, a193
    v_accvgpr_read_b32 v50, a194
    v_accvgpr_read_b32 v51, a195
    v_mfma_f32_16x16x32_bf16 a[212:215], v[220:223], v[184:187], a[212:215]
    s_waitcnt lgkmcnt(14)
    ds_read_b64_tr_b16 v[220:221], v133 offset:192
    v_accvgpr_read_b32 v52, a196
    v_accvgpr_read_b32 v53, a197
    v_accvgpr_read_b32 v54, a198
    v_accvgpr_read_b32 v55, a199
    v_mfma_f32_16x16x32_bf16 a[216:219], v[200:203], v[184:187], a[216:219]
    ds_read_b64_tr_b16 v[222:223], v133 offset:8896
    v_accvgpr_read_b32 v56, a200
    v_accvgpr_read_b32 v57, a201
    v_accvgpr_read_b32 v58, a202
    v_accvgpr_read_b32 v59, a203
    v_mfma_f32_16x16x32_bf16 a[216:219], v[204:207], v[152:155], a[216:219]
    s_waitcnt lgkmcnt(12)
    ds_read_b64_tr_b16 v[192:193], v225 offset:17664
    s_waitcnt lgkmcnt(4)
    buffer_store_dwordx4 v[64:67], v125, s[16:19], s27 offen offset:0 nt
    v_accvgpr_read_b32 v60, a204
    v_accvgpr_read_b32 v61, a205
    v_mfma_f32_16x16x32_bf16 a[216:219], v[208:211], v[188:191], a[216:219]
    ds_read_b64_tr_b16 v[194:195], v225 offset:26368
    v_accvgpr_read_b32 v62, a206
    v_accvgpr_read_b32 v63, a207
    v_mul_f32 v48, v48, v118
    v_mul_f32 v49, v49, v118
    v_mfma_f32_16x16x32_bf16 a[152:155], v[208:211], v[180:183], a[152:155]
    ds_read_b64_tr_b16 v[196:197], v225 offset:35072
    s_waitcnt lgkmcnt(5)
    buffer_store_dwordx4 v[68:71], v125, s[16:19], s88 offen offset:0 nt
    v_mul_f32 v50, v50, v118
    v_mul_f32 v51, v51, v118
    v_mfma_f32_16x16x32_bf16 a[152:155], v[204:207], v[144:147], a[152:155]
    ds_read_b64_tr_b16 v[198:199], v225 offset:43776
    v_mul_f32 v52, v52, v118
    v_mul_f32 v53, v53, v118
    v_mul_f32 v54, v54, v118
    v_mul_f32 v55, v55, v118
    v_mfma_f32_16x16x32_bf16 a[152:155], v[200:203], v[176:179], a[152:155]
    ds_read_b128 v[72:75], v124 offset:2048
    v_mul_f32 v56, v56, v118
    v_mul_f32 v57, v57, v118
    v_mul_f32 v58, v58, v118
    v_mul_f32 v59, v59, v118
    v_mfma_f32_16x16x32_bf16 a[88:91], v[200:203], v[168:171], a[88:91]
    ds_read_b128 v[76:79], v124 offset:3072
    v_mul_f32 v60, v60, v118
    v_mul_f32 v61, v61, v118
    v_mul_f32 v62, v62, v118
    v_mul_f32 v63, v63, v118
    v_mfma_f32_16x16x32_bf16 a[88:91], v[204:207], v[136:139], a[88:91]
    ds_write_b64 v123, v[32:33] offset:17408
    v_cvt_pk_bf16_f32 v48, v48, v49
    v_cvt_pk_bf16_f32 v49, v50, v51
    v_cvt_pk_bf16_f32 v50, v52, v53
    v_cvt_pk_bf16_f32 v51, v54, v55
    v_mfma_f32_16x16x32_bf16 a[88:91], v[208:211], v[172:175], a[88:91]
    ds_write_b64 v120, v[34:35] offset:17408
    v_cvt_pk_bf16_f32 v52, v56, v57
    v_cvt_pk_bf16_f32 v53, v58, v59
    v_cvt_pk_bf16_f32 v54, v60, v61
    v_cvt_pk_bf16_f32 v55, v62, v63
    v_mfma_f32_16x16x32_bf16 a[24:27], v[208:211], v[164:167], a[24:27]
    ds_write_b64 v121, v[36:37] offset:17408
    s_waitcnt lgkmcnt(4)
    buffer_store_dwordx4 v[72:75], v125, s[16:19], s89 offen offset:0 nt
    v_accvgpr_read_b32 v0, a16
    v_accvgpr_read_b32 v1, a17
    v_mfma_f32_16x16x32_bf16 a[24:27], v[204:207], v[128:131], a[24:27]
    ds_write_b64 v122, v[38:39] offset:17408
    v_accvgpr_read_b32 v2, a18
    v_accvgpr_read_b32 v3, a19
    v_accvgpr_read_b32 v4, a20
    v_accvgpr_read_b32 v5, a21
    v_mfma_f32_16x16x32_bf16 a[24:27], v[200:203], v[160:163], a[24:27]
    ds_read_b64_tr_b16 v[200:201], v132 offset:256
    s_waitcnt lgkmcnt(5)
    buffer_store_dwordx4 v[76:79], v125, s[16:19], s90 offen offset:0 nt
    v_accvgpr_read_b32 v6, a22
    v_accvgpr_read_b32 v7, a23
    v_mfma_f32_16x16x32_bf16 a[28:31], v[212:215], v[160:163], a[28:31]
    ds_read_b64_tr_b16 v[202:203], v132 offset:8960
    v_mul_f32 v0, v0, v112
    v_mul_f32 v1, v1, v112
    v_accvgpr_read_b32 v8, a24
    v_accvgpr_read_b32 v9, a25
    v_mfma_f32_16x16x32_bf16 a[28:31], v[216:219], v[128:131], a[28:31]
    ds_read_b64_tr_b16 v[204:205], v226 offset:17664
    v_accvgpr_read_b32 v10, a26
    v_accvgpr_read_b32 v11, a27
    v_mul_f32 v2, v2, v112
    v_mul_f32 v3, v3, v112
    v_mfma_f32_16x16x32_bf16 a[28:31], v[220:223], v[164:167], a[28:31]
    ds_read_b64_tr_b16 v[206:207], v226 offset:26368
    v_mul_f32 v4, v4, v112
    v_mul_f32 v5, v5, v112
    v_mul_f32 v6, v6, v112
    v_mul_f32 v7, v7, v112
    v_mfma_f32_16x16x32_bf16 a[92:95], v[220:223], v[172:175], a[92:95]
    ds_read_b64_tr_b16 v[208:209], v226 offset:35072
    v_mul_f32 v8, v8, v112
    v_accvgpr_read_b32 v12, a28
    v_accvgpr_read_b32 v13, a29
    v_accvgpr_read_b32 v14, a30
    v_mfma_f32_16x16x32_bf16 a[92:95], v[216:219], v[136:139], a[92:95]
    ds_read_b64_tr_b16 v[210:211], v226 offset:43776
    v_accvgpr_read_b32 v15, a31
    v_mul_f32 v9, v9, v112
    v_mul_f32 v10, v10, v112
    v_mul_f32 v11, v11, v112
    v_mfma_f32_16x16x32_bf16 a[92:95], v[212:215], v[168:171], a[92:95]
    ds_write_b64 v123, v[48:49] offset:19456
    v_mul_f32 v12, v12, v112
    v_mul_f32 v13, v13, v112
    v_mul_f32 v14, v14, v112
    v_mul_f32 v15, v15, v112
    v_mfma_f32_16x16x32_bf16 a[156:159], v[212:215], v[176:179], a[156:159]
    ds_write_b64 v120, v[50:51] offset:19456
    v_cvt_pk_bf16_f32 v0, v0, v1
    v_cvt_pk_bf16_f32 v1, v2, v3
    v_cvt_pk_bf16_f32 v2, v4, v5
    v_cvt_pk_bf16_f32 v3, v6, v7
    v_mfma_f32_16x16x32_bf16 a[156:159], v[216:219], v[144:147], a[156:159]
    ds_write_b64 v121, v[52:53] offset:19456
    v_cvt_pk_bf16_f32 v4, v8, v9
    v_cvt_pk_bf16_f32 v5, v10, v11
    v_cvt_pk_bf16_f32 v6, v12, v13
    v_cvt_pk_bf16_f32 v7, v14, v15
    v_mfma_f32_16x16x32_bf16 a[156:159], v[220:223], v[180:183], a[156:159]
    ds_write_b64 v122, v[54:55] offset:19456
    v_accvgpr_read_b32 v16, a80
    v_accvgpr_read_b32 v17, a81
    v_accvgpr_read_b32 v18, a82
    v_accvgpr_read_b32 v19, a83
    v_mfma_f32_16x16x32_bf16 a[220:223], v[220:223], v[188:191], a[220:223]
    ds_read_b128 v[80:83], v124 offset:17408
    v_accvgpr_read_b32 v20, a84
    v_accvgpr_read_b32 v21, a85
    v_accvgpr_read_b32 v22, a86
    v_accvgpr_read_b32 v23, a87
    v_mfma_f32_16x16x32_bf16 a[220:223], v[216:219], v[152:155], a[220:223]
    ds_read_b128 v[84:87], v124 offset:18432
    v_accvgpr_read_b32 v24, a88
    v_accvgpr_read_b32 v25, a89
    v_accvgpr_read_b32 v26, a90
    v_accvgpr_read_b32 v27, a91
    v_mfma_f32_16x16x32_bf16 a[220:223], v[212:215], v[184:187], a[220:223]
    ds_read_b64_tr_b16 v[212:213], v133 offset:256
    v_accvgpr_read_b32 v28, a92
    v_accvgpr_read_b32 v29, a93
    v_accvgpr_read_b32 v30, a94
    v_accvgpr_read_b32 v31, a95
    v_mfma_f32_16x16x32_bf16 a[224:227], v[192:195], v[184:187], a[224:227]
    ds_read_b64_tr_b16 v[214:215], v133 offset:8960
    v_mul_f32 v16, v16, v114
    v_mul_f32 v17, v17, v114
    v_mul_f32 v18, v18, v114
    v_mul_f32 v19, v19, v114
    v_mfma_f32_16x16x32_bf16 a[224:227], v[196:199], v[152:155], a[224:227]
    s_waitcnt lgkmcnt(12)
    ds_read_b64_tr_b16 v[216:217], v225 offset:17728
    s_waitcnt lgkmcnt(4)
    buffer_store_dwordx4 v[80:83], v125, s[16:19], s91 offen offset:0 nt
    v_mul_f32 v20, v20, v114
    v_mul_f32 v21, v21, v114
    v_mfma_f32_16x16x32_bf16 a[224:227], v[200:203], v[188:191], a[224:227]
    ds_read_b64_tr_b16 v[218:219], v225 offset:26432
    v_mul_f32 v22, v22, v114
    v_mul_f32 v23, v23, v114
    v_mul_f32 v24, v24, v114
    v_mul_f32 v25, v25, v114
    v_mfma_f32_16x16x32_bf16 a[160:163], v[200:203], v[180:183], a[160:163]
    ds_read_b64_tr_b16 v[220:221], v225 offset:35136
    s_waitcnt lgkmcnt(5)
    buffer_store_dwordx4 v[84:87], v125, s[16:19], s92 offen offset:0 nt
    v_mul_f32 v26, v26, v114
    v_mul_f32 v27, v27, v114
    v_mfma_f32_16x16x32_bf16 a[160:163], v[196:199], v[144:147], a[160:163]
    ds_read_b64_tr_b16 v[222:223], v225 offset:43840
    v_mul_f32 v28, v28, v114
    v_mul_f32 v29, v29, v114
    v_mul_f32 v30, v30, v114
    v_mul_f32 v31, v31, v114
    v_mfma_f32_16x16x32_bf16 a[160:163], v[192:195], v[176:179], a[160:163]
    ds_read_b128 v[88:91], v124 offset:19456
    v_cvt_pk_bf16_f32 v16, v16, v17
    v_cvt_pk_bf16_f32 v17, v18, v19
    v_cvt_pk_bf16_f32 v18, v20, v21
    v_cvt_pk_bf16_f32 v19, v22, v23
    v_mfma_f32_16x16x32_bf16 a[96:99], v[192:195], v[168:171], a[96:99]
    ds_read_b128 v[92:95], v124 offset:20480
    v_cvt_pk_bf16_f32 v20, v24, v25
    v_cvt_pk_bf16_f32 v21, v26, v27
    v_cvt_pk_bf16_f32 v22, v28, v29
    v_cvt_pk_bf16_f32 v23, v30, v31
    v_mfma_f32_16x16x32_bf16 a[96:99], v[196:199], v[136:139], a[96:99]
    ds_write_b64 v123, v[0:1] offset:0
    v_accvgpr_read_b32 v32, a144
    v_accvgpr_read_b32 v33, a145
    v_accvgpr_read_b32 v34, a146
    v_accvgpr_read_b32 v35, a147
    v_mfma_f32_16x16x32_bf16 a[96:99], v[200:203], v[172:175], a[96:99]
    ds_write_b64 v120, v[2:3] offset:0
    v_accvgpr_read_b32 v36, a148
    v_accvgpr_read_b32 v37, a149
    v_accvgpr_read_b32 v38, a150
    v_accvgpr_read_b32 v39, a151
    v_mfma_f32_16x16x32_bf16 a[32:35], v[200:203], v[164:167], a[32:35]
    ds_write_b64 v121, v[4:5] offset:0
    s_waitcnt lgkmcnt(4)
    buffer_store_dwordx4 v[88:91], v125, s[16:19], s93 offen offset:0 nt
    v_accvgpr_read_b32 v40, a152
    v_accvgpr_read_b32 v41, a153
    v_mfma_f32_16x16x32_bf16 a[32:35], v[196:199], v[128:131], a[32:35]
    ds_write_b64 v122, v[6:7] offset:0
    v_accvgpr_read_b32 v42, a154
    v_accvgpr_read_b32 v43, a155
    v_accvgpr_read_b32 v44, a156
    v_accvgpr_read_b32 v45, a157
    v_mfma_f32_16x16x32_bf16 a[32:35], v[192:195], v[160:163], a[32:35]
    ds_read_b64_tr_b16 v[192:193], v132 offset:320
    s_waitcnt lgkmcnt(5)
    buffer_store_dwordx4 v[92:95], v125, s[16:19], s94 offen offset:0 nt
    v_accvgpr_read_b32 v46, a158
    v_accvgpr_read_b32 v47, a159
    v_mfma_f32_16x16x32_bf16 a[36:39], v[204:207], v[160:163], a[36:39]
    ds_read_b64_tr_b16 v[194:195], v132 offset:9024
    v_mul_f32 v32, v32, v116
    v_mul_f32 v33, v33, v116
    v_mul_f32 v34, v34, v116
    v_mul_f32 v35, v35, v116
    v_mfma_f32_16x16x32_bf16 a[36:39], v[208:211], v[128:131], a[36:39]
    ds_read_b64_tr_b16 v[196:197], v226 offset:17728
    v_mul_f32 v36, v36, v116
    v_mul_f32 v37, v37, v116
    v_mul_f32 v38, v38, v116
    v_mul_f32 v39, v39, v116
    v_mfma_f32_16x16x32_bf16 a[36:39], v[212:215], v[164:167], a[36:39]
    ds_read_b64_tr_b16 v[198:199], v226 offset:26432
    v_mul_f32 v40, v40, v116
    v_mul_f32 v41, v41, v116
    v_mul_f32 v42, v42, v116
    v_mul_f32 v43, v43, v116
    v_mfma_f32_16x16x32_bf16 a[100:103], v[212:215], v[172:175], a[100:103]
    ds_read_b64_tr_b16 v[200:201], v226 offset:35136
    v_mul_f32 v44, v44, v116
    v_mul_f32 v45, v45, v116
    v_mul_f32 v46, v46, v116
    v_mul_f32 v47, v47, v116
    v_mfma_f32_16x16x32_bf16 a[100:103], v[208:211], v[136:139], a[100:103]
    ds_read_b64_tr_b16 v[202:203], v226 offset:43840
    v_cvt_pk_bf16_f32 v32, v32, v33
    v_cvt_pk_bf16_f32 v33, v34, v35
    v_cvt_pk_bf16_f32 v34, v36, v37
    v_cvt_pk_bf16_f32 v35, v38, v39
    v_mfma_f32_16x16x32_bf16 a[100:103], v[204:207], v[168:171], a[100:103]
    ds_write_b64 v123, v[16:17] offset:2048
    v_cvt_pk_bf16_f32 v36, v40, v41
    v_cvt_pk_bf16_f32 v37, v42, v43
    v_cvt_pk_bf16_f32 v38, v44, v45
    v_cvt_pk_bf16_f32 v39, v46, v47
    v_mfma_f32_16x16x32_bf16 a[164:167], v[204:207], v[176:179], a[164:167]
    ds_write_b64 v120, v[18:19] offset:2048
    v_accvgpr_read_b32 v48, a208
    v_accvgpr_read_b32 v49, a209
    v_accvgpr_read_b32 v50, a210
    v_accvgpr_read_b32 v51, a211
    v_mfma_f32_16x16x32_bf16 a[164:167], v[208:211], v[144:147], a[164:167]
    ds_write_b64 v121, v[20:21] offset:2048
    v_accvgpr_read_b32 v52, a212
    v_accvgpr_read_b32 v53, a213
    v_accvgpr_read_b32 v54, a214
    v_accvgpr_read_b32 v55, a215
    v_mfma_f32_16x16x32_bf16 a[164:167], v[212:215], v[180:183], a[164:167]
    ds_write_b64 v122, v[22:23] offset:2048
    v_accvgpr_read_b32 v56, a216
    v_accvgpr_read_b32 v57, a217
    v_accvgpr_read_b32 v58, a218
    v_accvgpr_read_b32 v59, a219
    v_mfma_f32_16x16x32_bf16 a[228:231], v[212:215], v[188:191], a[228:231]
    ds_read_b128 v[96:99], v124 offset:0
    v_accvgpr_read_b32 v60, a220
    v_accvgpr_read_b32 v61, a221
    v_accvgpr_read_b32 v62, a222
    v_accvgpr_read_b32 v63, a223
    v_mfma_f32_16x16x32_bf16 a[228:231], v[208:211], v[152:155], a[228:231]
    ds_read_b128 v[100:103], v124 offset:1024
    v_mul_f32 v48, v48, v118
    v_mul_f32 v49, v49, v118
    v_mul_f32 v50, v50, v118
    v_mul_f32 v51, v51, v118
    v_mfma_f32_16x16x32_bf16 a[228:231], v[204:207], v[184:187], a[228:231]
    ds_read_b64_tr_b16 v[204:205], v133 offset:320
    v_mul_f32 v52, v52, v118
    v_mul_f32 v53, v53, v118
    v_mul_f32 v54, v54, v118
    v_mul_f32 v55, v55, v118
    v_mfma_f32_16x16x32_bf16 a[232:235], v[216:219], v[184:187], a[232:235]
    ds_read_b64_tr_b16 v[206:207], v133 offset:9024
    v_mul_f32 v56, v56, v118
    v_mul_f32 v57, v57, v118
    v_mul_f32 v58, v58, v118
    v_mul_f32 v59, v59, v118
    v_mfma_f32_16x16x32_bf16 a[232:235], v[220:223], v[152:155], a[232:235]
    s_waitcnt lgkmcnt(12)
    ds_read_b64_tr_b16 v[208:209], v225 offset:17792
    s_waitcnt lgkmcnt(4)
    buffer_store_dwordx4 v[96:99], v125, s[16:19], s27 offen offset:128 nt
    v_mul_f32 v60, v60, v118
    v_mul_f32 v61, v61, v118
    v_mfma_f32_16x16x32_bf16 a[232:235], v[192:195], v[188:191], a[232:235]
    ds_read_b64_tr_b16 v[210:211], v225 offset:26496
    v_mul_f32 v62, v62, v118
    v_mul_f32 v63, v63, v118
    v_cvt_pk_bf16_f32 v48, v48, v49
    v_cvt_pk_bf16_f32 v49, v50, v51
    v_mfma_f32_16x16x32_bf16 a[168:171], v[192:195], v[180:183], a[168:171]
    ds_read_b64_tr_b16 v[212:213], v225 offset:35200
    s_waitcnt lgkmcnt(5)
    buffer_store_dwordx4 v[100:103], v125, s[16:19], s88 offen offset:128 nt
    v_cvt_pk_bf16_f32 v50, v52, v53
    v_cvt_pk_bf16_f32 v51, v54, v55
    v_mfma_f32_16x16x32_bf16 a[168:171], v[220:223], v[144:147], a[168:171]
    ds_read_b64_tr_b16 v[214:215], v225 offset:43904
    v_cvt_pk_bf16_f32 v52, v56, v57
    v_cvt_pk_bf16_f32 v53, v58, v59
    v_cvt_pk_bf16_f32 v54, v60, v61
    v_cvt_pk_bf16_f32 v55, v62, v63
    v_mfma_f32_16x16x32_bf16 a[168:171], v[216:219], v[176:179], a[168:171]
    ds_read_b128 v[104:107], v124 offset:2048
    v_accvgpr_read_b32 v0, a32
    v_accvgpr_read_b32 v1, a33
    v_accvgpr_read_b32 v2, a34
    v_accvgpr_read_b32 v3, a35
    v_mfma_f32_16x16x32_bf16 a[104:107], v[216:219], v[168:171], a[104:107]
    ds_read_b128 v[108:111], v124 offset:3072
    v_accvgpr_read_b32 v4, a36
    v_accvgpr_read_b32 v5, a37
    v_accvgpr_read_b32 v6, a38
    v_accvgpr_read_b32 v7, a39
    v_mfma_f32_16x16x32_bf16 a[104:107], v[220:223], v[136:139], a[104:107]
    ds_write_b64 v123, v[32:33] offset:17408
    v_mul_f32 v0, v0, v112
    v_mul_f32 v1, v1, v112
    v_mul_f32 v2, v2, v112
    v_mul_f32 v3, v3, v112
    v_mfma_f32_16x16x32_bf16 a[104:107], v[192:195], v[172:175], a[104:107]
    ds_write_b64 v120, v[34:35] offset:17408
    v_mul_f32 v4, v4, v112
    v_mul_f32 v5, v5, v112
    v_mul_f32 v6, v6, v112
    v_mul_f32 v7, v7, v112
    v_mfma_f32_16x16x32_bf16 a[40:43], v[192:195], v[164:167], a[40:43]
    ds_write_b64 v121, v[36:37] offset:17408
    s_waitcnt lgkmcnt(4)
    buffer_store_dwordx4 v[104:107], v125, s[16:19], s89 offen offset:128 nt
    v_cvt_pk_bf16_f32 v0, v0, v1
    v_cvt_pk_bf16_f32 v1, v2, v3
    v_mfma_f32_16x16x32_bf16 a[40:43], v[220:223], v[128:131], a[40:43]
    ds_write_b64 v122, v[38:39] offset:17408
    v_cvt_pk_bf16_f32 v2, v4, v5
    v_cvt_pk_bf16_f32 v3, v6, v7
    v_accvgpr_read_b32 v16, a96
    v_accvgpr_read_b32 v17, a97
    v_mfma_f32_16x16x32_bf16 a[40:43], v[216:219], v[160:163], a[40:43]
    ds_read_b64_tr_b16 v[216:217], v132 offset:384
    s_waitcnt lgkmcnt(5)
    buffer_store_dwordx4 v[108:111], v125, s[16:19], s90 offen offset:128 nt
    v_accvgpr_read_b32 v18, a98
    v_accvgpr_read_b32 v19, a99
    v_mfma_f32_16x16x32_bf16 a[44:47], v[196:199], v[160:163], a[44:47]
    ds_read_b64_tr_b16 v[218:219], v132 offset:9088
    v_accvgpr_read_b32 v20, a100
    v_accvgpr_read_b32 v21, a101
    v_accvgpr_read_b32 v8, a40
    v_accvgpr_read_b32 v9, a41
    v_mfma_f32_16x16x32_bf16 a[44:47], v[200:203], v[128:131], a[44:47]
    ds_read_b64_tr_b16 v[220:221], v226 offset:17792
    v_accvgpr_read_b32 v10, a42
    v_accvgpr_read_b32 v11, a43
    v_mul_f32 v8, v8, v112
    v_mul_f32 v9, v9, v112
    v_mfma_f32_16x16x32_bf16 a[44:47], v[204:207], v[164:167], a[44:47]
    ds_read_b64_tr_b16 v[222:223], v226 offset:26496
    v_mul_f32 v10, v10, v112
    v_mul_f32 v11, v11, v112
    v_cvt_pk_bf16_f32 v4, v8, v9
    v_cvt_pk_bf16_f32 v5, v10, v11
    v_mfma_f32_16x16x32_bf16 a[108:111], v[204:207], v[172:175], a[108:111]
    ds_read_b64_tr_b16 v[192:193], v226 offset:35200
    v_accvgpr_read_b32 v22, a102
    v_accvgpr_read_b32 v12, a44
    v_accvgpr_read_b32 v13, a45
    v_accvgpr_read_b32 v14, a46
    v_mfma_f32_16x16x32_bf16 a[108:111], v[200:203], v[136:139], a[108:111]
    ds_read_b64_tr_b16 v[194:195], v226 offset:43904
    v_accvgpr_read_b32 v15, a47
    v_mul_f32 v12, v12, v112
    v_mul_f32 v13, v13, v112
    v_mul_f32 v14, v14, v112
    v_mfma_f32_16x16x32_bf16 a[108:111], v[196:199], v[168:171], a[108:111]
    ds_write_b64 v123, v[48:49] offset:19456
    v_mul_f32 v15, v15, v112
    v_cvt_pk_bf16_f32 v6, v12, v13
    v_cvt_pk_bf16_f32 v7, v14, v15
    v_accvgpr_read_b32 v23, a103
    v_mfma_f32_16x16x32_bf16 a[172:175], v[196:199], v[176:179], a[172:175]
    ds_write_b64 v120, v[50:51] offset:19456
    v_accvgpr_read_b32 v24, a104
    v_accvgpr_read_b32 v25, a105
    v_accvgpr_read_b32 v26, a106
    v_accvgpr_read_b32 v27, a107
    v_mfma_f32_16x16x32_bf16 a[172:175], v[200:203], v[144:147], a[172:175]
    ds_write_b64 v121, v[52:53] offset:19456
    v_accvgpr_read_b32 v28, a108
    v_accvgpr_read_b32 v29, a109
    v_accvgpr_read_b32 v30, a110
    v_accvgpr_read_b32 v31, a111
    v_mfma_f32_16x16x32_bf16 a[172:175], v[204:207], v[180:183], a[172:175]
    ds_write_b64 v122, v[54:55] offset:19456
    v_mul_f32 v16, v16, v114
    v_mul_f32 v17, v17, v114
    v_mul_f32 v18, v18, v114
    v_mul_f32 v19, v19, v114
    v_mfma_f32_16x16x32_bf16 a[236:239], v[204:207], v[188:191], a[236:239]
    ds_read_b128 v[64:67], v124 offset:17408
    v_mul_f32 v20, v20, v114
    v_mul_f32 v21, v21, v114
    v_mul_f32 v22, v22, v114
    v_mul_f32 v23, v23, v114
    v_mfma_f32_16x16x32_bf16 a[236:239], v[200:203], v[152:155], a[236:239]
    ds_read_b128 v[68:71], v124 offset:18432
    v_mul_f32 v24, v24, v114
    v_mul_f32 v25, v25, v114
    v_mul_f32 v26, v26, v114
    v_mul_f32 v27, v27, v114
    v_mfma_f32_16x16x32_bf16 a[236:239], v[196:199], v[184:187], a[236:239]
    ds_read_b64_tr_b16 v[196:197], v133 offset:384
    v_mul_f32 v28, v28, v114
    v_mul_f32 v29, v29, v114
    v_mul_f32 v30, v30, v114
    v_mul_f32 v31, v31, v114
    v_mfma_f32_16x16x32_bf16 a[240:243], v[208:211], v[184:187], a[240:243]
    ds_read_b64_tr_b16 v[198:199], v133 offset:9088
    v_cvt_pk_bf16_f32 v16, v16, v17
    v_cvt_pk_bf16_f32 v17, v18, v19
    v_cvt_pk_bf16_f32 v18, v20, v21
    v_cvt_pk_bf16_f32 v19, v22, v23
    v_mfma_f32_16x16x32_bf16 a[240:243], v[212:215], v[152:155], a[240:243]
    s_waitcnt lgkmcnt(12)
    ds_read_b64_tr_b16 v[200:201], v225 offset:17856
    s_waitcnt lgkmcnt(4)
    buffer_store_dwordx4 v[64:67], v125, s[16:19], s91 offen offset:128 nt
    v_cvt_pk_bf16_f32 v20, v24, v25
    v_cvt_pk_bf16_f32 v21, v26, v27
    v_mfma_f32_16x16x32_bf16 a[240:243], v[216:219], v[188:191], a[240:243]
    ds_read_b64_tr_b16 v[202:203], v225 offset:26560
    v_cvt_pk_bf16_f32 v22, v28, v29
    v_cvt_pk_bf16_f32 v23, v30, v31
    v_accvgpr_read_b32 v32, a160
    v_accvgpr_read_b32 v33, a161
    v_mfma_f32_16x16x32_bf16 a[176:179], v[216:219], v[180:183], a[176:179]
    ds_read_b64_tr_b16 v[204:205], v225 offset:35264
    s_waitcnt lgkmcnt(5)
    buffer_store_dwordx4 v[68:71], v125, s[16:19], s92 offen offset:128 nt
    v_accvgpr_read_b32 v34, a162
    v_accvgpr_read_b32 v35, a163
    v_mfma_f32_16x16x32_bf16 a[176:179], v[212:215], v[144:147], a[176:179]
    ds_read_b64_tr_b16 v[206:207], v225 offset:43968
    v_accvgpr_read_b32 v36, a164
    v_accvgpr_read_b32 v37, a165
    v_accvgpr_read_b32 v38, a166
    v_accvgpr_read_b32 v39, a167
    v_mfma_f32_16x16x32_bf16 a[176:179], v[208:211], v[176:179], a[176:179]
    ds_read_b128 v[72:75], v124 offset:19456
    v_accvgpr_read_b32 v40, a168
    v_accvgpr_read_b32 v41, a169
    v_accvgpr_read_b32 v42, a170
    v_accvgpr_read_b32 v43, a171
    v_mfma_f32_16x16x32_bf16 a[112:115], v[208:211], v[168:171], a[112:115]
    ds_read_b128 v[76:79], v124 offset:20480
    v_accvgpr_read_b32 v44, a172
    v_accvgpr_read_b32 v45, a173
    v_accvgpr_read_b32 v46, a174
    v_accvgpr_read_b32 v47, a175
    v_mfma_f32_16x16x32_bf16 a[112:115], v[212:215], v[136:139], a[112:115]
    ds_write_b64 v123, v[0:1] offset:0
    v_mul_f32 v32, v32, v116
    v_mul_f32 v33, v33, v116
    v_mul_f32 v34, v34, v116
    v_mul_f32 v35, v35, v116
    v_mfma_f32_16x16x32_bf16 a[112:115], v[216:219], v[172:175], a[112:115]
    ds_write_b64 v120, v[2:3] offset:0
    v_mul_f32 v36, v36, v116
    v_mul_f32 v37, v37, v116
    v_mul_f32 v38, v38, v116
    v_mul_f32 v39, v39, v116
    v_mfma_f32_16x16x32_bf16 a[48:51], v[216:219], v[164:167], a[48:51]
    ds_write_b64 v121, v[4:5] offset:0
    s_waitcnt lgkmcnt(4)
    buffer_store_dwordx4 v[72:75], v125, s[16:19], s93 offen offset:128 nt
    v_mul_f32 v40, v40, v116
    v_mul_f32 v41, v41, v116
    v_mfma_f32_16x16x32_bf16 a[48:51], v[212:215], v[128:131], a[48:51]
    ds_write_b64 v122, v[6:7] offset:0
    v_mul_f32 v42, v42, v116
    v_mul_f32 v43, v43, v116
    v_mul_f32 v44, v44, v116
    v_mul_f32 v45, v45, v116
    v_mfma_f32_16x16x32_bf16 a[48:51], v[208:211], v[160:163], a[48:51]
    ds_read_b64_tr_b16 v[208:209], v132 offset:448
    s_waitcnt lgkmcnt(5)
    buffer_store_dwordx4 v[76:79], v125, s[16:19], s94 offen offset:128 nt
    v_mul_f32 v46, v46, v116
    v_mul_f32 v47, v47, v116
    v_mfma_f32_16x16x32_bf16 a[52:55], v[220:223], v[160:163], a[52:55]
    ds_read_b64_tr_b16 v[210:211], v132 offset:9152
    v_cvt_pk_bf16_f32 v32, v32, v33
    v_cvt_pk_bf16_f32 v33, v34, v35
    v_cvt_pk_bf16_f32 v34, v36, v37
    v_cvt_pk_bf16_f32 v35, v38, v39
    v_mfma_f32_16x16x32_bf16 a[52:55], v[192:195], v[128:131], a[52:55]
    ds_read_b64_tr_b16 v[212:213], v226 offset:17856
    v_cvt_pk_bf16_f32 v36, v40, v41
    v_cvt_pk_bf16_f32 v37, v42, v43
    v_cvt_pk_bf16_f32 v38, v44, v45
    v_cvt_pk_bf16_f32 v39, v46, v47
    v_mfma_f32_16x16x32_bf16 a[52:55], v[196:199], v[164:167], a[52:55]
    ds_read_b64_tr_b16 v[214:215], v226 offset:26560
    v_accvgpr_read_b32 v48, a224
    v_accvgpr_read_b32 v49, a225
    v_accvgpr_read_b32 v50, a226
    v_accvgpr_read_b32 v51, a227
    v_mfma_f32_16x16x32_bf16 a[116:119], v[196:199], v[172:175], a[116:119]
    ds_read_b64_tr_b16 v[216:217], v226 offset:35264
    v_accvgpr_read_b32 v52, a228
    v_accvgpr_read_b32 v53, a229
    v_accvgpr_read_b32 v54, a230
    v_accvgpr_read_b32 v55, a231
    v_mfma_f32_16x16x32_bf16 a[116:119], v[192:195], v[136:139], a[116:119]
    ds_read_b64_tr_b16 v[218:219], v226 offset:43968
    v_accvgpr_read_b32 v56, a232
    v_accvgpr_read_b32 v57, a233
    v_accvgpr_read_b32 v58, a234
    v_accvgpr_read_b32 v59, a235
    v_mfma_f32_16x16x32_bf16 a[116:119], v[220:223], v[168:171], a[116:119]
    ds_write_b64 v123, v[16:17] offset:2048
    v_accvgpr_read_b32 v60, a236
    v_accvgpr_read_b32 v61, a237
    v_accvgpr_read_b32 v62, a238
    v_accvgpr_read_b32 v63, a239
    v_mfma_f32_16x16x32_bf16 a[180:183], v[220:223], v[176:179], a[180:183]
    ds_write_b64 v120, v[18:19] offset:2048
    v_mul_f32 v48, v48, v118
    v_mul_f32 v49, v49, v118
    v_mul_f32 v50, v50, v118
    v_mul_f32 v51, v51, v118
    v_mfma_f32_16x16x32_bf16 a[180:183], v[192:195], v[144:147], a[180:183]
    ds_write_b64 v121, v[20:21] offset:2048
    v_mul_f32 v52, v52, v118
    v_mul_f32 v53, v53, v118
    v_mul_f32 v54, v54, v118
    v_mul_f32 v55, v55, v118
    v_mfma_f32_16x16x32_bf16 a[180:183], v[196:199], v[180:183], a[180:183]
    ds_write_b64 v122, v[22:23] offset:2048
    v_mul_f32 v56, v56, v118
    v_mul_f32 v57, v57, v118
    v_mul_f32 v58, v58, v118
    v_mul_f32 v59, v59, v118
    v_mfma_f32_16x16x32_bf16 a[244:247], v[196:199], v[188:191], a[244:247]
    ds_read_b128 v[80:83], v124 offset:0
    v_mul_f32 v60, v60, v118
    v_mul_f32 v61, v61, v118
    v_mul_f32 v62, v62, v118
    v_mul_f32 v63, v63, v118
    v_mfma_f32_16x16x32_bf16 a[244:247], v[192:195], v[152:155], a[244:247]
    ds_read_b128 v[84:87], v124 offset:1024
    v_cvt_pk_bf16_f32 v48, v48, v49
    v_cvt_pk_bf16_f32 v49, v50, v51
    v_cvt_pk_bf16_f32 v50, v52, v53
    v_cvt_pk_bf16_f32 v51, v54, v55
    v_mfma_f32_16x16x32_bf16 a[244:247], v[220:223], v[184:187], a[244:247]
    ds_read_b64_tr_b16 v[220:221], v133 offset:448
    v_cvt_pk_bf16_f32 v52, v56, v57
    v_cvt_pk_bf16_f32 v53, v58, v59
    v_cvt_pk_bf16_f32 v54, v60, v61
    v_cvt_pk_bf16_f32 v55, v62, v63
    v_mfma_f32_16x16x32_bf16 a[248:251], v[200:203], v[184:187], a[248:251]
    ds_read_b64_tr_b16 v[222:223], v133 offset:9152
    v_accvgpr_read_b32 v0, a48
    v_accvgpr_read_b32 v1, a49
    v_accvgpr_read_b32 v2, a50
    v_accvgpr_read_b32 v3, a51
    v_mfma_f32_16x16x32_bf16 a[248:251], v[204:207], v[152:155], a[248:251]
    s_waitcnt lgkmcnt(12)
    ds_read_b128 v[88:91], v124 offset:2048
    s_waitcnt lgkmcnt(4)
    buffer_store_dwordx4 v[80:83], v125, s[16:19], s27 offen offset:256 nt
    v_accvgpr_read_b32 v4, a52
    v_accvgpr_read_b32 v5, a53
    v_mfma_f32_16x16x32_bf16 a[248:251], v[208:211], v[188:191], a[248:251]
    ds_read_b128 v[92:95], v124 offset:3072
    v_accvgpr_read_b32 v6, a54
    v_accvgpr_read_b32 v7, a55
    v_accvgpr_read_b32 v16, a112
    v_accvgpr_read_b32 v17, a113
    v_mfma_f32_16x16x32_bf16 a[184:187], v[208:211], v[180:183], a[184:187]
    ds_write_b64 v123, v[32:33] offset:17408
    s_waitcnt lgkmcnt(5)
    buffer_store_dwordx4 v[84:87], v125, s[16:19], s88 offen offset:256 nt
    v_accvgpr_read_b32 v18, a114
    v_accvgpr_read_b32 v19, a115
    v_mfma_f32_16x16x32_bf16 a[184:187], v[204:207], v[144:147], a[184:187]
    ds_write_b64 v120, v[34:35] offset:17408
    v_accvgpr_read_b32 v20, a116
    v_accvgpr_read_b32 v21, a117
    v_accvgpr_read_b32 v22, a118
    v_accvgpr_read_b32 v23, a119
    v_mfma_f32_16x16x32_bf16 a[184:187], v[200:203], v[176:179], a[184:187]
    ds_write_b64 v121, v[36:37] offset:17408
    v_mfma_f32_16x16x32_bf16 a[120:123], v[200:203], v[168:171], a[120:123]
    ds_write_b64 v122, v[38:39] offset:17408
    s_waitcnt lgkmcnt(5)
    buffer_store_dwordx4 v[88:91], v125, s[16:19], s89 offen offset:256 nt
    v_accvgpr_read_b32 v32, a176
    v_accvgpr_read_b32 v33, a177
    v_mfma_f32_16x16x32_bf16 a[120:123], v[204:207], v[136:139], a[120:123]
    ds_write_b64 v123, v[48:49] offset:19456
    s_waitcnt lgkmcnt(5)
    buffer_store_dwordx4 v[92:95], v125, s[16:19], s90 offen offset:256 nt
    v_accvgpr_read_b32 v34, a178
    v_accvgpr_read_b32 v35, a179
    v_mfma_f32_16x16x32_bf16 a[120:123], v[208:211], v[172:175], a[120:123]
    ds_write_b64 v120, v[50:51] offset:19456
    v_accvgpr_read_b32 v36, a180
    v_accvgpr_read_b32 v37, a181
    v_accvgpr_read_b32 v38, a182
    v_accvgpr_read_b32 v39, a183
    v_mfma_f32_16x16x32_bf16 a[56:59], v[208:211], v[164:167], a[56:59]
    ds_write_b64 v121, v[52:53] offset:19456
    v_accvgpr_read_b32 v40, a184
    v_accvgpr_read_b32 v24, a120
    v_accvgpr_read_b32 v25, a121
    v_accvgpr_read_b32 v26, a122
    v_mfma_f32_16x16x32_bf16 a[56:59], v[204:207], v[128:131], a[56:59]
    ds_write_b64 v122, v[54:55] offset:19456
    v_accvgpr_read_b32 v27, a123
    v_accvgpr_read_b32 v41, a185
    v_accvgpr_read_b32 v42, a186
    v_accvgpr_read_b32 v43, a187
    v_mfma_f32_16x16x32_bf16 a[56:59], v[200:203], v[160:163], a[56:59]
    ds_read_b128 v[96:99], v124 offset:17408
    v_accvgpr_read_b32 v48, a240
    v_accvgpr_read_b32 v49, a241
    v_accvgpr_read_b32 v50, a242
    v_accvgpr_read_b32 v51, a243
    v_mfma_f32_16x16x32_bf16 a[60:63], v[212:215], v[160:163], a[60:63]
    ds_read_b128 v[100:103], v124 offset:18432
    v_accvgpr_read_b32 v52, a244
    v_accvgpr_read_b32 v8, a56
    v_accvgpr_read_b32 v9, a57
    v_accvgpr_read_b32 v10, a58
    v_mfma_f32_16x16x32_bf16 a[60:63], v[216:219], v[128:131], a[60:63]
    ds_read_b128 v[104:107], v124 offset:19456
    v_accvgpr_read_b32 v11, a59
    v_accvgpr_read_b32 v53, a245
    v_accvgpr_read_b32 v54, a246
    v_accvgpr_read_b32 v55, a247
    v_mfma_f32_16x16x32_bf16 a[60:63], v[220:223], v[164:167], a[60:63]
    ds_read_b128 v[108:111], v124 offset:20480
    v_accvgpr_read_b32 v56, a248
    v_accvgpr_read_b32 v57, a249
    v_accvgpr_read_b32 v58, a250
    v_accvgpr_read_b32 v59, a251
    v_mfma_f32_16x16x32_bf16 a[124:127], v[220:223], v[172:175], a[124:127]
    v_mfma_f32_16x16x32_bf16 a[124:127], v[216:219], v[136:139], a[124:127]
    s_waitcnt lgkmcnt(3)
    buffer_store_dwordx4 v[96:99], v125, s[16:19], s91 offen offset:256 nt
    v_accvgpr_read_b32 v12, a60
    v_accvgpr_read_b32 v13, a61
    v_accvgpr_read_b32 v14, a62
    v_mfma_f32_16x16x32_bf16 a[124:127], v[212:215], v[168:171], a[124:127]
    v_accvgpr_read_b32 v15, a63
    v_mfma_f32_16x16x32_bf16 a[188:191], v[212:215], v[176:179], a[188:191]
    s_waitcnt lgkmcnt(2)
    buffer_store_dwordx4 v[100:103], v125, s[16:19], s92 offen offset:256 nt
    v_mfma_f32_16x16x32_bf16 a[188:191], v[216:219], v[144:147], a[188:191]
    v_mfma_f32_16x16x32_bf16 a[188:191], v[220:223], v[180:183], a[188:191]
    v_mfma_f32_16x16x32_bf16 a[252:255], v[220:223], v[188:191], a[252:255]
    v_mfma_f32_16x16x32_bf16 a[252:255], v[216:219], v[152:155], a[252:255]
    s_waitcnt lgkmcnt(1)
    buffer_store_dwordx4 v[104:107], v125, s[16:19], s93 offen offset:256 nt
    v_accvgpr_read_b32 v28, a124
    v_accvgpr_read_b32 v29, a125
    v_accvgpr_read_b32 v30, a126
    v_mfma_f32_16x16x32_bf16 a[252:255], v[212:215], v[184:187], a[252:255]
    v_accvgpr_read_b32 v31, a127
    v_accvgpr_read_b32 v44, a188
    v_accvgpr_read_b32 v45, a189
    v_accvgpr_read_b32 v46, a190
    v_accvgpr_read_b32 v47, a191
    s_waitcnt lgkmcnt(0)
    buffer_store_dwordx4 v[108:111], v125, s[16:19], s94 offen offset:256 nt
    v_pk_mul_f32 v[0:1], v[0:1], v[112:113] op_sel_hi:[1,0]
    v_pk_mul_f32 v[2:3], v[2:3], v[112:113] op_sel_hi:[1,0]
    v_pk_mul_f32 v[4:5], v[4:5], v[112:113] op_sel_hi:[1,0]
    v_pk_mul_f32 v[6:7], v[6:7], v[112:113] op_sel_hi:[1,0]
    v_pk_mul_f32 v[8:9], v[8:9], v[112:113] op_sel_hi:[1,0]
    v_pk_mul_f32 v[10:11], v[10:11], v[112:113] op_sel_hi:[1,0]
    v_pk_mul_f32 v[12:13], v[12:13], v[112:113] op_sel_hi:[1,0]
    v_pk_mul_f32 v[14:15], v[14:15], v[112:113] op_sel_hi:[1,0]
    v_cvt_pk_bf16_f32 v0, v0, v1
    v_cvt_pk_bf16_f32 v1, v2, v3
    ds_write_b64 v123, v[0:1] offset:0
    v_cvt_pk_bf16_f32 v2, v4, v5
    v_cvt_pk_bf16_f32 v3, v6, v7
    ds_write_b64 v120, v[2:3] offset:0
    v_cvt_pk_bf16_f32 v4, v8, v9
    v_cvt_pk_bf16_f32 v5, v10, v11
    ds_write_b64 v121, v[4:5] offset:0
    v_cvt_pk_bf16_f32 v6, v12, v13
    v_cvt_pk_bf16_f32 v7, v14, v15
    ds_write_b64 v122, v[6:7] offset:0
    v_pk_mul_f32 v[16:17], v[16:17], v[114:115] op_sel_hi:[1,0]
    v_pk_mul_f32 v[18:19], v[18:19], v[114:115] op_sel_hi:[1,0]
    v_pk_mul_f32 v[20:21], v[20:21], v[114:115] op_sel_hi:[1,0]
    v_pk_mul_f32 v[22:23], v[22:23], v[114:115] op_sel_hi:[1,0]
    v_pk_mul_f32 v[24:25], v[24:25], v[114:115] op_sel_hi:[1,0]
    v_pk_mul_f32 v[26:27], v[26:27], v[114:115] op_sel_hi:[1,0]
    v_pk_mul_f32 v[28:29], v[28:29], v[114:115] op_sel_hi:[1,0]
    v_pk_mul_f32 v[30:31], v[30:31], v[114:115] op_sel_hi:[1,0]
    v_cvt_pk_bf16_f32 v16, v16, v17
    v_cvt_pk_bf16_f32 v17, v18, v19
    ds_write_b64 v123, v[16:17] offset:2048
    v_cvt_pk_bf16_f32 v18, v20, v21
    v_cvt_pk_bf16_f32 v19, v22, v23
    ds_write_b64 v120, v[18:19] offset:2048
    v_cvt_pk_bf16_f32 v20, v24, v25
    v_cvt_pk_bf16_f32 v21, v26, v27
    ds_write_b64 v121, v[20:21] offset:2048
    v_cvt_pk_bf16_f32 v22, v28, v29
    v_cvt_pk_bf16_f32 v23, v30, v31
    ds_write_b64 v122, v[22:23] offset:2048
    ds_read_b128 v[64:67], v124 offset:0
    ds_read_b128 v[68:71], v124 offset:1024
    ds_read_b128 v[72:75], v124 offset:2048
    ds_read_b128 v[76:79], v124 offset:3072
    v_pk_mul_f32 v[32:33], v[32:33], v[116:117] op_sel_hi:[1,0]
    v_pk_mul_f32 v[34:35], v[34:35], v[116:117] op_sel_hi:[1,0]
    v_pk_mul_f32 v[36:37], v[36:37], v[116:117] op_sel_hi:[1,0]
    v_pk_mul_f32 v[38:39], v[38:39], v[116:117] op_sel_hi:[1,0]
    v_pk_mul_f32 v[40:41], v[40:41], v[116:117] op_sel_hi:[1,0]
    v_pk_mul_f32 v[42:43], v[42:43], v[116:117] op_sel_hi:[1,0]
    v_pk_mul_f32 v[44:45], v[44:45], v[116:117] op_sel_hi:[1,0]
    v_pk_mul_f32 v[46:47], v[46:47], v[116:117] op_sel_hi:[1,0]
    v_cvt_pk_bf16_f32 v32, v32, v33
    v_cvt_pk_bf16_f32 v33, v34, v35
    ds_write_b64 v123, v[32:33] offset:17408
    v_cvt_pk_bf16_f32 v34, v36, v37
    v_cvt_pk_bf16_f32 v35, v38, v39
    ds_write_b64 v120, v[34:35] offset:17408
    v_cvt_pk_bf16_f32 v36, v40, v41
    v_cvt_pk_bf16_f32 v37, v42, v43
    ds_write_b64 v121, v[36:37] offset:17408
    v_cvt_pk_bf16_f32 v38, v44, v45
    v_cvt_pk_bf16_f32 v39, v46, v47
    ds_write_b64 v122, v[38:39] offset:17408
    v_accvgpr_read_b32 v60, a252
    s_waitcnt lgkmcnt(7)
    buffer_store_dwordx4 v[64:67], v125, s[16:19], s27 offen offset:384 nt
    s_waitcnt lgkmcnt(6)
    buffer_store_dwordx4 v[68:71], v125, s[16:19], s88 offen offset:384 nt
    s_waitcnt lgkmcnt(5)
    buffer_store_dwordx4 v[72:75], v125, s[16:19], s89 offen offset:384 nt
    s_waitcnt lgkmcnt(4)
    buffer_store_dwordx4 v[76:79], v125, s[16:19], s90 offen offset:384 nt
    v_accvgpr_read_b32 v61, a253
    v_accvgpr_read_b32 v62, a254
    v_accvgpr_read_b32 v63, a255
    v_pk_mul_f32 v[48:49], v[48:49], v[118:119] op_sel_hi:[1,0]
    v_pk_mul_f32 v[50:51], v[50:51], v[118:119] op_sel_hi:[1,0]
    v_pk_mul_f32 v[52:53], v[52:53], v[118:119] op_sel_hi:[1,0]
    v_pk_mul_f32 v[54:55], v[54:55], v[118:119] op_sel_hi:[1,0]
    v_pk_mul_f32 v[56:57], v[56:57], v[118:119] op_sel_hi:[1,0]
    v_pk_mul_f32 v[58:59], v[58:59], v[118:119] op_sel_hi:[1,0]
    v_pk_mul_f32 v[60:61], v[60:61], v[118:119] op_sel_hi:[1,0]
    v_pk_mul_f32 v[62:63], v[62:63], v[118:119] op_sel_hi:[1,0]
    v_cvt_pk_bf16_f32 v48, v48, v49
    v_cvt_pk_bf16_f32 v49, v50, v51
    ds_write_b64 v123, v[48:49] offset:19456
    v_cvt_pk_bf16_f32 v50, v52, v53
    v_cvt_pk_bf16_f32 v51, v54, v55
    ds_write_b64 v120, v[50:51] offset:19456
    v_cvt_pk_bf16_f32 v52, v56, v57
    v_cvt_pk_bf16_f32 v53, v58, v59
    ds_write_b64 v121, v[52:53] offset:19456
    v_cvt_pk_bf16_f32 v54, v60, v61
    v_cvt_pk_bf16_f32 v55, v62, v63
    ds_write_b64 v122, v[54:55] offset:19456
    ds_read_b128 v[80:83], v124 offset:17408
    ds_read_b128 v[84:87], v124 offset:18432
    ds_read_b128 v[88:91], v124 offset:19456
    ds_read_b128 v[92:95], v124 offset:20480
    s_waitcnt lgkmcnt(3)
    buffer_store_dwordx4 v[80:83], v125, s[16:19], s91 offen offset:384 nt
    s_waitcnt lgkmcnt(2)
    buffer_store_dwordx4 v[84:87], v125, s[16:19], s92 offen offset:384 nt
    s_waitcnt lgkmcnt(1)
    buffer_store_dwordx4 v[88:91], v125, s[16:19], s93 offen offset:384 nt
    s_waitcnt lgkmcnt(0)
    buffer_store_dwordx4 v[92:95], v125, s[16:19], s94 offen offset:384 nt
L_end:
    s_endpgm
L_rare0:
    s_waitcnt vmcnt(0)
    s_nop 7
    ds_read_b128 v[232:235], v224 offset:17408
    s_waitcnt lgkmcnt(0)
    v_mfma_f32_16x16x32_bf16 v[160:163], v[232:235], v[0:3], v[240:243]
    s_nop 7
    ds_read_b128 v[232:235], v224 offset:17472
    s_waitcnt lgkmcnt(0)
    v_mfma_f32_16x16x32_bf16 v[160:163], v[232:235], v[4:7], v[160:163]
    s_nop 7
    ds_read_b128 v[232:235], v224 offset:17536
    s_waitcnt lgkmcnt(0)
    v_mfma_f32_16x16x32_bf16 v[160:163], v[232:235], v[8:11], v[160:163]
    s_nop 7
    ds_read_b128 v[232:235], v224 offset:17600
    s_waitcnt lgkmcnt(0)
    v_mfma_f32_16x16x32_bf16 v[160:163], v[232:235], v[12:15], v[160:163]
    s_nop 7
    ds_read_b128 v[232:235], v224 offset:17664
    s_waitcnt lgkmcnt(0)
    v_mfma_f32_16x16x32_bf16 v[160:163], v[232:235], v[16:19], v[160:163]
    s_nop 7
    ds_read_b128 v[232:235], v224 offset:17728
    s_waitcnt lgkmcnt(0)
    v_mfma_f32_16x16x32_bf16 v[160:163], v[232:235], v[20:23], v[160:163]
    s_nop 7
    ds_read_b128 v[232:235], v224 offset:17792
    s_waitcnt lgkmcnt(0)
    v_mfma_f32_16x16x32_bf16 v[160:163], v[232:235], v[24:27], v[160:163]
    s_nop 7
    ds_read_b128 v[232:235], v224 offset:17856
    s_waitcnt lgkmcnt(0)
    v_mfma_f32_16x16x32_bf16 v[160:163], v[232:235], v[28:31], v[160:163]
    s_nop 7
    ds_read_b128 v[232:235], v224 offset:26112
    s_waitcnt lgkmcnt(0)
    v_mfma_f32_16x16x32_bf16 v[236:239], v[232:235], v[0:3], v[240:243]
    s_nop 7
    ds_read_b128 v[232:235], v224 offset:26176
    s_waitcnt lgkmcnt(0)
    v_mfma_f32_16x16x32_bf16 v[236:239], v[232:235], v[4:7], v[236:239]
    s_nop 7
    ds_read_b128 v[232:235], v224 offset:26240
    s_waitcnt lgkmcnt(0)
    v_mfma_f32_16x16x32_bf16 v[236:239], v[232:235], v[8:11], v[236:239]
    s_nop 7
    ds_read_b128 v[232:235], v224 offset:26304
    s_waitcnt lgkmcnt(0)
    v_mfma_f32_16x16x32_bf16 v[236:239], v[232:235], v[12:15], v[236:239]
    s_nop 7
    ds_read_b128 v[232:235], v224 offset:26368
    s_waitcnt lgkmcnt(0)
    v_mfma_f32_16x16x32_bf16 v[236:239], v[232:235], v[16:19], v[236:239]
    s_nop 7
    ds_read_b128 v[232:235], v224 offset:26432
    s_waitcnt lgkmcnt(0)
    v_mfma_f32_16x16x32_bf16 v[236:239], v[232:235], v[20:23], v[236:239]
    s_nop 7
    ds_read_b128 v[232:235], v224 offset:26496
    s_waitcnt lgkmcnt(0)
    v_mfma_f32_16x16x32_bf16 v[236:239], v[232:235], v[24:27], v[236:239]
    s_nop 7
    ds_read_b128 v[232:235], v224 offset:26560
    s_waitcnt lgkmcnt(0)
    v_mfma_f32_16x16x32_bf16 v[236:239], v[232:235], v[28:31], v[236:239]
    s_nop 7
    s_nop 3
    v_max3_f32 v232, v160, v161, v162
    v_max3_f32 v232, v232, v163, v236
    v_max3_f32 v232, v232, v237, v238
    v_max_f32 v232, v232, v239
    v_mov_b32 v233, v232
    s_nop 1
    v_permlane16_swap_b32 v232, v233
    s_nop 1
    v_max_f32 v232, v232, v233
    v_mov_b32 v233, v232
    s_nop 1
    v_permlane32_swap_b32 v232, v233
    s_nop 1
    v_max_f32 v232, v232, v233
    v_ceil_f32 v232, v232
    v_max_f32 v232, 0, v232
    v_sub_f32 v240, v240, v232
    v_sub_f32 v241, v241, v232
    v_sub_f32 v242, v242, v232
    v_sub_f32 v243, v243, v232
    v_sub_f32 v160, v160, v232
    v_sub_f32 v161, v161, v232
    v_sub_f32 v162, v162, v232
    v_sub_f32 v163, v163, v232
    v_sub_f32 v236, v236, v232
    v_sub_f32 v237, v237, v232
    v_sub_f32 v238, v238, v232
    v_sub_f32 v239, v239, v232
    v_sub_f32 v128, v128, v232
    v_sub_f32 v129, v129, v232
    v_sub_f32 v130, v130, v232
    v_sub_f32 v131, v131, v232
    v_sub_f32 v164, v164, v232
    v_sub_f32 v165, v165, v232
    v_sub_f32 v166, v166, v232
    v_sub_f32 v167, v167, v232
    v_min_f32 v233, 0x43480000, v232
    v_cvt_i32_f32 v233, v233
    v_sub_u32 v233, 0, v233
    v_ldexp_f32 v234, 1.0, v233
    v_mul_f32 v228, v228, v234
    v_accvgpr_read_b32 v232, a0
    v_accvgpr_read_b32 v233, a1
    v_mul_f32 v232, v232, v234
    v_mul_f32 v233, v233, v234
    v_accvgpr_write_b32 a0, v232
    v_accvgpr_write_b32 a1, v233
    v_accvgpr_read_b32 v232, a2
    v_accvgpr_read_b32 v233, a3
    v_mul_f32 v232, v232, v234
    v_mul_f32 v233, v233, v234
    v_accvgpr_write_b32 a2, v232
    v_accvgpr_write_b32 a3, v233
    v_accvgpr_read_b32 v232, a4
    v_accvgpr_read_b32 v233, a5
    v_mul_f32 v232, v232, v234
    v_mul_f32 v233, v233, v234
    v_accvgpr_write_b32 a4, v232
    v_accvgpr_write_b32 a5, v233
    v_accvgpr_read_b32 v232, a6
    v_accvgpr_read_b32 v233, a7
    v_mul_f32 v232, v232, v234
    v_mul_f32 v233, v233, v234
    v_accvgpr_write_b32 a6, v232
    v_accvgpr_write_b32 a7, v233
    v_accvgpr_read_b32 v232, a8
    v_accvgpr_read_b32 v233, a9
    v_mul_f32 v232, v232, v234
    v_mul_f32 v233, v233, v234
    v_accvgpr_write_b32 a8, v232
    v_accvgpr_write_b32 a9, v233
    v_accvgpr_read_b32 v232, a10
    v_accvgpr_read_b32 v233, a11
    v_mul_f32 v232, v232, v234
    v_mul_f32 v233, v233, v234
    v_accvgpr_write_b32 a10, v232
    v_accvgpr_write_b32 a11, v233
    v_accvgpr_read_b32 v232, a12
    v_accvgpr_read_b32 v233, a13
    v_mul_f32 v232, v232, v234
    v_mul_f32 v233, v233, v234
    v_accvgpr_write_b32 a12, v232
    v_accvgpr_write_b32 a13, v233
    v_accvgpr_read_b32 v232, a14
    v_accvgpr_read_b32 v233, a15
    v_mul_f32 v232, v232, v234
    v_mul_f32 v233, v233, v234
    v_accvgpr_write_b32 a14, v232
    v_accvgpr_write_b32 a15, v233
    v_accvgpr_read_b32 v232, a16
    v_accvgpr_read_b32 v233, a17
    v_mul_f32 v232, v232, v234
    v_mul_f32 v233, v233, v234
    v_accvgpr_write_b32 a16, v232
    v_accvgpr_write_b32 a17, v233
    v_accvgpr_read_b32 v232, a18
    v_accvgpr_read_b32 v233, a19
    v_mul_f32 v232, v232, v234
    v_mul_f32 v233, v233, v234
    v_accvgpr_write_b32 a18, v232
    v_accvgpr_write_b32 a19, v233
    v_accvgpr_read_b32 v232, a20
    v_accvgpr_read_b32 v233, a21
    v_mul_f32 v232, v232, v234
    v_mul_f32 v233, v233, v234
    v_accvgpr_write_b32 a20, v232
    v_accvgpr_write_b32 a21, v233
    v_accvgpr_read_b32 v232, a22
    v_accvgpr_read_b32 v233, a23
    v_mul_f32 v232, v232, v234
    v_mul_f32 v233, v233, v234
    v_accvgpr_write_b32 a22, v232
    v_accvgpr_write_b32 a23, v233
    v_accvgpr_read_b32 v232, a24
    v_accvgpr_read_b32 v233, a25
    v_mul_f32 v232, v232, v234
    v_mul_f32 v233, v233, v234
    v_accvgpr_write_b32 a24, v232
    v_accvgpr_write_b32 a25, v233
    v_accvgpr_read_b32 v232, a26
    v_accvgpr_read_b32 v233, a27
    v_mul_f32 v232, v232, v234
    v_mul_f32 v233, v233, v234
    v_accvgpr_write_b32 a26, v232
    v_accvgpr_write_b32 a27, v233
    v_accvgpr_read_b32 v232, a28
    v_accvgpr_read_b32 v233, a29
    v_mul_f32 v232, v232, v234
    v_mul_f32 v233, v233, v234
    v_accvgpr_write_b32 a28, v232
    v_accvgpr_write_b32 a29, v233
    v_accvgpr_read_b32 v232, a30
    v_accvgpr_read_b32 v233, a31
    v_mul_f32 v232, v232, v234
    v_mul_f32 v233, v233, v234
    v_accvgpr_write_b32 a30, v232
    v_accvgpr_write_b32 a31, v233
    v_accvgpr_read_b32 v232, a32
    v_accvgpr_read_b32 v233, a33
    v_mul_f32 v232, v232, v234
    v_mul_f32 v233, v233, v234
    v_accvgpr_write_b32 a32, v232
    v_accvgpr_write_b32 a33, v233
    v_accvgpr_read_b32 v232, a34
    v_accvgpr_read_b32 v233, a35
    v_mul_f32 v232, v232, v234
    v_mul_f32 v233, v233, v234
    v_accvgpr_write_b32 a34, v232
    v_accvgpr_write_b32 a35, v233
    v_accvgpr_read_b32 v232, a36
    v_accvgpr_read_b32 v233, a37
    v_mul_f32 v232, v232, v234
    v_mul_f32 v233, v233, v234
    v_accvgpr_write_b32 a36, v232
    v_accvgpr_write_b32 a37, v233
    v_accvgpr_read_b32 v232, a38
    v_accvgpr_read_b32 v233, a39
    v_mul_f32 v232, v232, v234
    v_mul_f32 v233, v233, v234
    v_accvgpr_write_b32 a38, v232
    v_accvgpr_write_b32 a39, v233
    v_accvgpr_read_b32 v232, a40
    v_accvgpr_read_b32 v233, a41
    v_mul_f32 v232, v232, v234
    v_mul_f32 v233, v233, v234
    v_accvgpr_write_b32 a40, v232
    v_accvgpr_write_b32 a41, v233
    v_accvgpr_read_b32 v232, a42
    v_accvgpr_read_b32 v233, a43
    v_mul_f32 v232, v232, v234
    v_mul_f32 v233, v233, v234
    v_accvgpr_write_b32 a42, v232
    v_accvgpr_write_b32 a43, v233
    v_accvgpr_read_b32 v232, a44
    v_accvgpr_read_b32 v233, a45
    v_mul_f32 v232, v232, v234
    v_mul_f32 v233, v233, v234
    v_accvgpr_write_b32 a44, v232
    v_accvgpr_write_b32 a45, v233
    v_accvgpr_read_b32 v232, a46
    v_accvgpr_read_b32 v233, a47
    v_mul_f32 v232, v232, v234
    v_mul_f32 v233, v233, v234
    v_accvgpr_write_b32 a46, v232
    v_accvgpr_write_b32 a47, v233
    v_accvgpr_read_b32 v232, a48
    v_accvgpr_read_b32 v233, a49
    v_mul_f32 v232, v232, v234
    v_mul_f32 v233, v233, v234
    v_accvgpr_write_b32 a48, v232
    v_accvgpr_write_b32 a49, v233
    v_accvgpr_read_b32 v232, a50
    v_accvgpr_read_b32 v233, a51
    v_mul_f32 v232, v232, v234
    v_mul_f32 v233, v233, v234
    v_accvgpr_write_b32 a50, v232
    v_accvgpr_write_b32 a51, v233
    v_accvgpr_read_b32 v232, a52
    v_accvgpr_read_b32 v233, a53
    v_mul_f32 v232, v232, v234
    v_mul_f32 v233, v233, v234
    v_accvgpr_write_b32 a52, v232
    v_accvgpr_write_b32 a53, v233
    v_accvgpr_read_b32 v232, a54
    v_accvgpr_read_b32 v233, a55
    v_mul_f32 v232, v232, v234
    v_mul_f32 v233, v233, v234
    v_accvgpr_write_b32 a54, v232
    v_accvgpr_write_b32 a55, v233
    v_accvgpr_read_b32 v232, a56
    v_accvgpr_read_b32 v233, a57
    v_mul_f32 v232, v232, v234
    v_mul_f32 v233, v233, v234
    v_accvgpr_write_b32 a56, v232
    v_accvgpr_write_b32 a57, v233
    v_accvgpr_read_b32 v232, a58
    v_accvgpr_read_b32 v233, a59
    v_mul_f32 v232, v232, v234
    v_mul_f32 v233, v233, v234
    v_accvgpr_write_b32 a58, v232
    v_accvgpr_write_b32 a59, v233
    v_accvgpr_read_b32 v232, a60
    v_accvgpr_read_b32 v233, a61
    v_mul_f32 v232, v232, v234
    v_mul_f32 v233, v233, v234
    v_accvgpr_write_b32 a60, v232
    v_accvgpr_write_b32 a61, v233
    v_accvgpr_read_b32 v232, a62
    v_accvgpr_read_b32 v233, a63
    v_mul_f32 v232, v232, v234
    v_mul_f32 v233, v233, v234
    v_accvgpr_write_b32 a62, v232
    v_accvgpr_write_b32 a63, v233
    v_exp_f32 v160, v160
    v_exp_f32 v161, v161
    v_exp_f32 v162, v162
    v_exp_f32 v163, v163
    v_exp_f32 v236, v236
    v_exp_f32 v237, v237
    v_exp_f32 v238, v238
    v_exp_f32 v239, v239
    s_nop 0
    v_add_f32 v228, v228, v160
    v_add_f32 v228, v228, v161
    v_add_f32 v228, v228, v162
    v_add_f32 v228, v228, v163
    v_add_f32 v228, v228, v236
    v_add_f32 v228, v228, v237
    v_add_f32 v228, v228, v238
    v_add_f32 v228, v228, v239
    v_cvt_pk_bf16_f32 v160, v160, v161
    v_cvt_pk_bf16_f32 v161, v162, v163
    v_cvt_pk_bf16_f32 v162, v236, v237
    v_cvt_pk_bf16_f32 v163, v238, v239
    ds_read_b128 v[232:235], v224 offset:17408
    s_waitcnt lgkmcnt(0)
    v_mfma_f32_16x16x32_bf16 v[168:171], v[232:235], v[32:35], v[244:247]
    s_nop 7
    ds_read_b128 v[232:235], v224 offset:17472
    s_waitcnt lgkmcnt(0)
    v_mfma_f32_16x16x32_bf16 v[168:171], v[232:235], v[36:39], v[168:171]
    s_nop 7
    ds_read_b128 v[232:235], v224 offset:17536
    s_waitcnt lgkmcnt(0)
    v_mfma_f32_16x16x32_bf16 v[168:171], v[232:235], v[40:43], v[168:171]
    s_nop 7
    ds_read_b128 v[232:235], v224 offset:17600
    s_waitcnt lgkmcnt(0)
    v_mfma_f32_16x16x32_bf16 v[168:171], v[232:235], v[44:47], v[168:171]
    s_nop 7
    ds_read_b128 v[232:235], v224 offset:17664
    s_waitcnt lgkmcnt(0)
    v_mfma_f32_16x16x32_bf16 v[168:171], v[232:235], v[48:51], v[168:171]
    s_nop 7
    ds_read_b128 v[232:235], v224 offset:17728
    s_waitcnt lgkmcnt(0)
    v_mfma_f32_16x16x32_bf16 v[168:171], v[232:235], v[52:55], v[168:171]
    s_nop 7
    ds_read_b128 v[232:235], v224 offset:17792
    s_waitcnt lgkmcnt(0)
    v_mfma_f32_16x16x32_bf16 v[168:171], v[232:235], v[56:59], v[168:171]
    s_nop 7
    ds_read_b128 v[232:235], v224 offset:17856
    s_waitcnt lgkmcnt(0)
    v_mfma_f32_16x16x32_bf16 v[168:171], v[232:235], v[60:63], v[168:171]
    s_nop 7
    ds_read_b128 v[232:235], v224 offset:26112
    s_waitcnt lgkmcnt(0)
    v_mfma_f32_16x16x32_bf16 v[236:239], v[232:235], v[32:35], v[244:247]
    s_nop 7
    ds_read_b128 v[232:235], v224 offset:26176
    s_waitcnt lgkmcnt(0)
    v_mfma_f32_16x16x32_bf16 v[236:239], v[232:235], v[36:39], v[236:239]
    s_nop 7
    ds_read_b128 v[232:235], v224 offset:26240
    s_waitcnt lgkmcnt(0)
    v_mfma_f32_16x16x32_bf16 v[236:239], v[232:235], v[40:43], v[236:239]
    s_nop 7
    ds_read_b128 v[232:235], v224 offset:26304
    s_waitcnt lgkmcnt(0)
    v_mfma_f32_16x16x32_bf16 v[236:239], v[232:235], v[44:47], v[236:239]
    s_nop 7
    ds_read_b128 v[232:235], v224 offset:26368
    s_waitcnt lgkmcnt(0)
    v_mfma_f32_16x16x32_bf16 v[236:239], v[232:235], v[48:51], v[236:239]
    s_nop 7
    ds_read_b128 v[232:235], v224 offset:26432
    s_waitcnt lgkmcnt(0)
    v_mfma_f32_16x16x32_bf16 v[236:239], v[232:235], v[52:55], v[236:239]
    s_nop 7
    ds_read_b128 v[232:235], v224 offset:26496
    s_waitcnt lgkmcnt(0)
    v_mfma_f32_16x16x32_bf16 v[236:239], v[232:235], v[56:59], v[236:239]
    s_nop 7
    ds_read_b128 v[232:235], v224 offset:26560
    s_waitcnt lgkmcnt(0)
    v_mfma_f32_16x16x32_bf16 v[236:239], v[232:235], v[60:63], v[236:239]
    s_nop 7
    s_nop 3
    v_max3_f32 v232, v168, v169, v170
    v_max3_f32 v232, v232, v171, v236
    v_max3_f32 v232, v232, v237, v238
    v_max_f32 v232, v232, v239
    v_mov_b32 v233, v232
    s_nop 1
    v_permlane16_swap_b32 v232, v233
    s_nop 1
    v_max_f32 v232, v232, v233
    v_mov_b32 v233, v232
    s_nop 1
    v_permlane32_swap_b32 v232, v233
    s_nop 1
    v_max_f32 v232, v232, v233
    v_ceil_f32 v232, v232
    v_max_f32 v232, 0, v232
    v_sub_f32 v244, v244, v232
    v_sub_f32 v245, v245, v232
    v_sub_f32 v246, v246, v232
    v_sub_f32 v247, v247, v232
    v_sub_f32 v168, v168, v232
    v_sub_f32 v169, v169, v232
    v_sub_f32 v170, v170, v232
    v_sub_f32 v171, v171, v232
    v_sub_f32 v236, v236, v232
    v_sub_f32 v237, v237, v232
    v_sub_f32 v238, v238, v232
    v_sub_f32 v239, v239, v232
    v_sub_f32 v136, v136, v232
    v_sub_f32 v137, v137, v232
    v_sub_f32 v138, v138, v232
    v_sub_f32 v139, v139, v232
    v_sub_f32 v172, v172, v232
    v_sub_f32 v173, v173, v232
    v_sub_f32 v174, v174, v232
    v_sub_f32 v175, v175, v232
    v_min_f32 v233, 0x43480000, v232
    v_cvt_i32_f32 v233, v233
    v_sub_u32 v233, 0, v233
    v_ldexp_f32 v234, 1.0, v233
    v_mul_f32 v229, v229, v234
    v_accvgpr_read_b32 v232, a64
    v_accvgpr_read_b32 v233, a65
    v_mul_f32 v232, v232, v234
    v_mul_f32 v233, v233, v234
    v_accvgpr_write_b32 a64, v232
    v_accvgpr_write_b32 a65, v233
    v_accvgpr_read_b32 v232, a66
    v_accvgpr_read_b32 v233, a67
    v_mul_f32 v232, v232, v234
    v_mul_f32 v233, v233, v234
    v_accvgpr_write_b32 a66, v232
    v_accvgpr_write_b32 a67, v233
    v_accvgpr_read_b32 v232, a68
    v_accvgpr_read_b32 v233, a69
    v_mul_f32 v232, v232, v234
    v_mul_f32 v233, v233, v234
    v_accvgpr_write_b32 a68, v232
    v_accvgpr_write_b32 a69, v233
    v_accvgpr_read_b32 v232, a70
    v_accvgpr_read_b32 v233, a71
    v_mul_f32 v232, v232, v234
    v_mul_f32 v233, v233, v234
    v_accvgpr_write_b32 a70, v232
    v_accvgpr_write_b32 a71, v233
    v_accvgpr_read_b32 v232, a72
    v_accvgpr_read_b32 v233, a73
    v_mul_f32 v232, v232, v234
    v_mul_f32 v233, v233, v234
    v_accvgpr_write_b32 a72, v232
    v_accvgpr_write_b32 a73, v233
    v_accvgpr_read_b32 v232, a74
    v_accvgpr_read_b32 v233, a75
    v_mul_f32 v232, v232, v234
    v_mul_f32 v233, v233, v234
    v_accvgpr_write_b32 a74, v232
    v_accvgpr_write_b32 a75, v233
    v_accvgpr_read_b32 v232, a76
    v_accvgpr_read_b32 v233, a77
    v_mul_f32 v232, v232, v234
    v_mul_f32 v233, v233, v234
    v_accvgpr_write_b32 a76, v232
    v_accvgpr_write_b32 a77, v233
    v_accvgpr_read_b32 v232, a78
    v_accvgpr_read_b32 v233, a79
    v_mul_f32 v232, v232, v234
    v_mul_f32 v233, v233, v234
    v_accvgpr_write_b32 a78, v232
    v_accvgpr_write_b32 a79, v233
    v_accvgpr_read_b32 v232, a80
    v_accvgpr_read_b32 v233, a81
    v_mul_f32 v232, v232, v234
    v_mul_f32 v233, v233, v234
    v_accvgpr_write_b32 a80, v232
    v_accvgpr_write_b32 a81, v233
    v_accvgpr_read_b32 v232, a82
    v_accvgpr_read_b32 v233, a83
    v_mul_f32 v232, v232, v234
    v_mul_f32 v233, v233, v234
    v_accvgpr_write_b32 a82, v232
    v_accvgpr_write_b32 a83, v233
    v_accvgpr_read_b32 v232, a84
    v_accvgpr_read_b32 v233, a85
    v_mul_f32 v232, v232, v234
    v_mul_f32 v233, v233, v234
    v_accvgpr_write_b32 a84, v232
    v_accvgpr_write_b32 a85, v233
    v_accvgpr_read_b32 v232, a86
    v_accvgpr_read_b32 v233, a87
    v_mul_f32 v232, v232, v234
    v_mul_f32 v233, v233, v234
    v_accvgpr_write_b32 a86, v232
    v_accvgpr_write_b32 a87, v233
    v_accvgpr_read_b32 v232, a88
    v_accvgpr_read_b32 v233, a89
    v_mul_f32 v232, v232, v234
    v_mul_f32 v233, v233, v234
    v_accvgpr_write_b32 a88, v232
    v_accvgpr_write_b32 a89, v233
    v_accvgpr_read_b32 v232, a90
    v_accvgpr_read_b32 v233, a91
    v_mul_f32 v232, v232, v234
    v_mul_f32 v233, v233, v234
    v_accvgpr_write_b32 a90, v232
    v_accvgpr_write_b32 a91, v233
    v_accvgpr_read_b32 v232, a92
    v_accvgpr_read_b32 v233, a93
    v_mul_f32 v232, v232, v234
    v_mul_f32 v233, v233, v234
    v_accvgpr_write_b32 a92, v232
    v_accvgpr_write_b32 a93, v233
    v_accvgpr_read_b32 v232, a94
    v_accvgpr_read_b32 v233, a95
    v_mul_f32 v232, v232, v234
    v_mul_f32 v233, v233, v234
    v_accvgpr_write_b32 a94, v232
    v_accvgpr_write_b32 a95, v233
    v_accvgpr_read_b32 v232, a96
    v_accvgpr_read_b32 v233, a97
    v_mul_f32 v232, v232, v234
    v_mul_f32 v233, v233, v234
    v_accvgpr_write_b32 a96, v232
    v_accvgpr_write_b32 a97, v233
    v_accvgpr_read_b32 v232, a98
    v_accvgpr_read_b32 v233, a99
    v_mul_f32 v232, v232, v234
    v_mul_f32 v233, v233, v234
    v_accvgpr_write_b32 a98, v232
    v_accvgpr_write_b32 a99, v233
    v_accvgpr_read_b32 v232, a100
    v_accvgpr_read_b32 v233, a101
    v_mul_f32 v232, v232, v234
    v_mul_f32 v233, v233, v234
    v_accvgpr_write_b32 a100, v232
    v_accvgpr_write_b32 a101, v233
    v_accvgpr_read_b32 v232, a102
    v_accvgpr_read_b32 v233, a103
    v_mul_f32 v232, v232, v234
    v_mul_f32 v233, v233, v234
    v_accvgpr_write_b32 a102, v232
    v_accvgpr_write_b32 a103, v233
    v_accvgpr_read_b32 v232, a104
    v_accvgpr_read_b32 v233, a105
    v_mul_f32 v232, v232, v234
    v_mul_f32 v233, v233, v234
    v_accvgpr_write_b32 a104, v232
    v_accvgpr_write_b32 a105, v233
    v_accvgpr_read_b32 v232, a106
    v_accvgpr_read_b32 v233, a107
    v_mul_f32 v232, v232, v234
    v_mul_f32 v233, v233, v234
    v_accvgpr_write_b32 a106, v232
    v_accvgpr_write_b32 a107, v233
    v_accvgpr_read_b32 v232, a108
    v_accvgpr_read_b32 v233, a109
    v_mul_f32 v232, v232, v234
    v_mul_f32 v233, v233, v234
    v_accvgpr_write_b32 a108, v232
    v_accvgpr_write_b32 a109, v233
    v_accvgpr_read_b32 v232, a110
    v_accvgpr_read_b32 v233, a111
    v_mul_f32 v232, v232, v234
    v_mul_f32 v233, v233, v234
    v_accvgpr_write_b32 a110, v232
    v_accvgpr_write_b32 a111, v233
    v_accvgpr_read_b32 v232, a112
    v_accvgpr_read_b32 v233, a113
    v_mul_f32 v232, v232, v234
    v_mul_f32 v233, v233, v234
    v_accvgpr_write_b32 a112, v232
    v_accvgpr_write_b32 a113, v233
    v_accvgpr_read_b32 v232, a114
    v_accvgpr_read_b32 v233, a115
    v_mul_f32 v232, v232, v234
    v_mul_f32 v233, v233, v234
    v_accvgpr_write_b32 a114, v232
    v_accvgpr_write_b32 a115, v233
    v_accvgpr_read_b32 v232, a116
    v_accvgpr_read_b32 v233, a117
    v_mul_f32 v232, v232, v234
    v_mul_f32 v233, v233, v234
    v_accvgpr_write_b32 a116, v232
    v_accvgpr_write_b32 a117, v233
    v_accvgpr_read_b32 v232, a118
    v_accvgpr_read_b32 v233, a119
    v_mul_f32 v232, v232, v234
    v_mul_f32 v233, v233, v234
    v_accvgpr_write_b32 a118, v232
    v_accvgpr_write_b32 a119, v233
    v_accvgpr_read_b32 v232, a120
    v_accvgpr_read_b32 v233, a121
    v_mul_f32 v232, v232, v234
    v_mul_f32 v233, v233, v234
    v_accvgpr_write_b32 a120, v232
    v_accvgpr_write_b32 a121, v233
    v_accvgpr_read_b32 v232, a122
    v_accvgpr_read_b32 v233, a123
    v_mul_f32 v232, v232, v234
    v_mul_f32 v233, v233, v234
    v_accvgpr_write_b32 a122, v232
    v_accvgpr_write_b32 a123, v233
    v_accvgpr_read_b32 v232, a124
    v_accvgpr_read_b32 v233, a125
    v_mul_f32 v232, v232, v234
    v_mul_f32 v233, v233, v234
    v_accvgpr_write_b32 a124, v232
    v_accvgpr_write_b32 a125, v233
    v_accvgpr_read_b32 v232, a126
    v_accvgpr_read_b32 v233, a127
    v_mul_f32 v232, v232, v234
    v_mul_f32 v233, v233, v234
    v_accvgpr_write_b32 a126, v232
    v_accvgpr_write_b32 a127, v233
    v_exp_f32 v168, v168
    v_exp_f32 v169, v169
    v_exp_f32 v170, v170
    v_exp_f32 v171, v171
    v_exp_f32 v236, v236
    v_exp_f32 v237, v237
    v_exp_f32 v238, v238
    v_exp_f32 v239, v239
    s_nop 0
    v_add_f32 v229, v229, v168
    v_add_f32 v229, v229, v169
    v_add_f32 v229, v229, v170
    v_add_f32 v229, v229, v171
    v_add_f32 v229, v229, v236
    v_add_f32 v229, v229, v237
    v_add_f32 v229, v229, v238
    v_add_f32 v229, v229, v239
    v_cvt_pk_bf16_f32 v168, v168, v169
    v_cvt_pk_bf16_f32 v169, v170, v171
    v_cvt_pk_bf16_f32 v170, v236, v237
    v_cvt_pk_bf16_f32 v171, v238, v239
    ds_read_b128 v[232:235], v224 offset:17408
    s_waitcnt lgkmcnt(0)
    v_mfma_f32_16x16x32_bf16 v[176:179], v[232:235], v[64:67], v[248:251]
    s_nop 7
    ds_read_b128 v[232:235], v224 offset:17472
    s_waitcnt lgkmcnt(0)
    v_mfma_f32_16x16x32_bf16 v[176:179], v[232:235], v[68:71], v[176:179]
    s_nop 7
    ds_read_b128 v[232:235], v224 offset:17536
    s_waitcnt lgkmcnt(0)
    v_mfma_f32_16x16x32_bf16 v[176:179], v[232:235], v[72:75], v[176:179]
    s_nop 7
    ds_read_b128 v[232:235], v224 offset:17600
    s_waitcnt lgkmcnt(0)
    v_mfma_f32_16x16x32_bf16 v[176:179], v[232:235], v[76:79], v[176:179]
    s_nop 7
    ds_read_b128 v[232:235], v224 offset:17664
    s_waitcnt lgkmcnt(0)
    v_mfma_f32_16x16x32_bf16 v[176:179], v[232:235], v[80:83], v[176:179]
    s_nop 7
    ds_read_b128 v[232:235], v224 offset:17728
    s_waitcnt lgkmcnt(0)
    v_mfma_f32_16x16x32_bf16 v[176:179], v[232:235], v[84:87], v[176:179]
    s_nop 7
    ds_read_b128 v[232:235], v224 offset:17792
    s_waitcnt lgkmcnt(0)
    v_mfma_f32_16x16x32_bf16 v[176:179], v[232:235], v[88:91], v[176:179]
    s_nop 7
    ds_read_b128 v[232:235], v224 offset:17856
    s_waitcnt lgkmcnt(0)
    v_mfma_f32_16x16x32_bf16 v[176:179], v[232:235], v[92:95], v[176:179]
    s_nop 7
    ds_read_b128 v[232:235], v224 offset:26112
    s_waitcnt lgkmcnt(0)
    v_mfma_f32_16x16x32_bf16 v[236:239], v[232:235], v[64:67], v[248:251]
    s_nop 7
    ds_read_b128 v[232:235], v224 offset:26176
    s_waitcnt lgkmcnt(0)
    v_mfma_f32_16x16x32_bf16 v[236:239], v[232:235], v[68:71], v[236:239]
    s_nop 7
    ds_read_b128 v[232:235], v224 offset:26240
    s_waitcnt lgkmcnt(0)
    v_mfma_f32_16x16x32_bf16 v[236:239], v[232:235], v[72:75], v[236:239]
    s_nop 7
    ds_read_b128 v[232:235], v224 offset:26304
    s_waitcnt lgkmcnt(0)
    v_mfma_f32_16x16x32_bf16 v[236:239], v[232:235], v[76:79], v[236:239]
    s_nop 7
    ds_read_b128 v[232:235], v224 offset:26368
    s_waitcnt lgkmcnt(0)
    v_mfma_f32_16x16x32_bf16 v[236:239], v[232:235], v[80:83], v[236:239]
    s_nop 7
    ds_read_b128 v[232:235], v224 offset:26432
    s_waitcnt lgkmcnt(0)
    v_mfma_f32_16x16x32_bf16 v[236:239], v[232:235], v[84:87], v[236:239]
    s_nop 7
    ds_read_b128 v[232:235], v224 offset:26496
    s_waitcnt lgkmcnt(0)
    v_mfma_f32_16x16x32_bf16 v[236:239], v[232:235], v[88:91], v[236:239]
    s_nop 7
    ds_read_b128 v[232:235], v224 offset:26560
    s_waitcnt lgkmcnt(0)
    v_mfma_f32_16x16x32_bf16 v[236:239], v[232:235], v[92:95], v[236:239]
    s_nop 7
    s_nop 3
    v_max3_f32 v232, v176, v177, v178
    v_max3_f32 v232, v232, v179, v236
    v_max3_f32 v232, v232, v237, v238
    v_max_f32 v232, v232, v239
    v_mov_b32 v233, v232
    s_nop 1
    v_permlane16_swap_b32 v232, v233
    s_nop 1
    v_max_f32 v232, v232, v233
    v_mov_b32 v233, v232
    s_nop 1
    v_permlane32_swap_b32 v232, v233
    s_nop 1
    v_max_f32 v232, v232, v233
    v_ceil_f32 v232, v232
    v_max_f32 v232, 0, v232
    v_sub_f32 v248, v248, v232
    v_sub_f32 v249, v249, v232
    v_sub_f32 v250, v250, v232
    v_sub_f32 v251, v251, v232
    v_sub_f32 v176, v176, v232
    v_sub_f32 v177, v177, v232
    v_sub_f32 v178, v178, v232
    v_sub_f32 v179, v179, v232
    v_sub_f32 v236, v236, v232
    v_sub_f32 v237, v237, v232
    v_sub_f32 v238, v238, v232
    v_sub_f32 v239, v239, v232
    v_sub_f32 v144, v144, v232
    v_sub_f32 v145, v145, v232
    v_sub_f32 v146, v146, v232
    v_sub_f32 v147, v147, v232
    v_sub_f32 v180, v180, v232
    v_sub_f32 v181, v181, v232
    v_sub_f32 v182, v182, v232
    v_sub_f32 v183, v183, v232
    v_min_f32 v233, 0x43480000, v232
    v_cvt_i32_f32 v233, v233
    v_sub_u32 v233, 0, v233
    v_ldexp_f32 v234, 1.0, v233
    v_mul_f32 v230, v230, v234
    v_accvgpr_read_b32 v232, a128
    v_accvgpr_read_b32 v233, a129
    v_mul_f32 v232, v232, v234
    v_mul_f32 v233, v233, v234
    v_accvgpr_write_b32 a128, v232
    v_accvgpr_write_b32 a129, v233
    v_accvgpr_read_b32 v232, a130
    v_accvgpr_read_b32 v233, a131
    v_mul_f32 v232, v232, v234
    v_mul_f32 v233, v233, v234
    v_accvgpr_write_b32 a130, v232
    v_accvgpr_write_b32 a131, v233
    v_accvgpr_read_b32 v232, a132
    v_accvgpr_read_b32 v233, a133
    v_mul_f32 v232, v232, v234
    v_mul_f32 v233, v233, v234
    v_accvgpr_write_b32 a132, v232
    v_accvgpr_write_b32 a133, v233
    v_accvgpr_read_b32 v232, a134
    v_accvgpr_read_b32 v233, a135
    v_mul_f32 v232, v232, v234
    v_mul_f32 v233, v233, v234
    v_accvgpr_write_b32 a134, v232
    v_accvgpr_write_b32 a135, v233
    v_accvgpr_read_b32 v232, a136
    v_accvgpr_read_b32 v233, a137
    v_mul_f32 v232, v232, v234
    v_mul_f32 v233, v233, v234
    v_accvgpr_write_b32 a136, v232
    v_accvgpr_write_b32 a137, v233
    v_accvgpr_read_b32 v232, a138
    v_accvgpr_read_b32 v233, a139
    v_mul_f32 v232, v232, v234
    v_mul_f32 v233, v233, v234
    v_accvgpr_write_b32 a138, v232
    v_accvgpr_write_b32 a139, v233
    v_accvgpr_read_b32 v232, a140
    v_accvgpr_read_b32 v233, a141
    v_mul_f32 v232, v232, v234
    v_mul_f32 v233, v233, v234
    v_accvgpr_write_b32 a140, v232
    v_accvgpr_write_b32 a141, v233
    v_accvgpr_read_b32 v232, a142
    v_accvgpr_read_b32 v233, a143
    v_mul_f32 v232, v232, v234
    v_mul_f32 v233, v233, v234
    v_accvgpr_write_b32 a142, v232
    v_accvgpr_write_b32 a143, v233
    v_accvgpr_read_b32 v232, a144
    v_accvgpr_read_b32 v233, a145
    v_mul_f32 v232, v232, v234
    v_mul_f32 v233, v233, v234
    v_accvgpr_write_b32 a144, v232
    v_accvgpr_write_b32 a145, v233
    v_accvgpr_read_b32 v232, a146
    v_accvgpr_read_b32 v233, a147
    v_mul_f32 v232, v232, v234
    v_mul_f32 v233, v233, v234
    v_accvgpr_write_b32 a146, v232
    v_accvgpr_write_b32 a147, v233
    v_accvgpr_read_b32 v232, a148
    v_accvgpr_read_b32 v233, a149
    v_mul_f32 v232, v232, v234
    v_mul_f32 v233, v233, v234
    v_accvgpr_write_b32 a148, v232
    v_accvgpr_write_b32 a149, v233
    v_accvgpr_read_b32 v232, a150
    v_accvgpr_read_b32 v233, a151
    v_mul_f32 v232, v232, v234
    v_mul_f32 v233, v233, v234
    v_accvgpr_write_b32 a150, v232
    v_accvgpr_write_b32 a151, v233
    v_accvgpr_read_b32 v232, a152
    v_accvgpr_read_b32 v233, a153
    v_mul_f32 v232, v232, v234
    v_mul_f32 v233, v233, v234
    v_accvgpr_write_b32 a152, v232
    v_accvgpr_write_b32 a153, v233
    v_accvgpr_read_b32 v232, a154
    v_accvgpr_read_b32 v233, a155
    v_mul_f32 v232, v232, v234
    v_mul_f32 v233, v233, v234
    v_accvgpr_write_b32 a154, v232
    v_accvgpr_write_b32 a155, v233
    v_accvgpr_read_b32 v232, a156
    v_accvgpr_read_b32 v233, a157
    v_mul_f32 v232, v232, v234
    v_mul_f32 v233, v233, v234
    v_accvgpr_write_b32 a156, v232
    v_accvgpr_write_b32 a157, v233
    v_accvgpr_read_b32 v232, a158
    v_accvgpr_read_b32 v233, a159
    v_mul_f32 v232, v232, v234
    v_mul_f32 v233, v233, v234
    v_accvgpr_write_b32 a158, v232
    v_accvgpr_write_b32 a159, v233
    v_accvgpr_read_b32 v232, a160
    v_accvgpr_read_b32 v233, a161
    v_mul_f32 v232, v232, v234
    v_mul_f32 v233, v233, v234
    v_accvgpr_write_b32 a160, v232
    v_accvgpr_write_b32 a161, v233
    v_accvgpr_read_b32 v232, a162
    v_accvgpr_read_b32 v233, a163
    v_mul_f32 v232, v232, v234
    v_mul_f32 v233, v233, v234
    v_accvgpr_write_b32 a162, v232
    v_accvgpr_write_b32 a163, v233
    v_accvgpr_read_b32 v232, a164
    v_accvgpr_read_b32 v233, a165
    v_mul_f32 v232, v232, v234
    v_mul_f32 v233, v233, v234
    v_accvgpr_write_b32 a164, v232
    v_accvgpr_write_b32 a165, v233
    v_accvgpr_read_b32 v232, a166
    v_accvgpr_read_b32 v233, a167
    v_mul_f32 v232, v232, v234
    v_mul_f32 v233, v233, v234
    v_accvgpr_write_b32 a166, v232
    v_accvgpr_write_b32 a167, v233
    v_accvgpr_read_b32 v232, a168
    v_accvgpr_read_b32 v233, a169
    v_mul_f32 v232, v232, v234
    v_mul_f32 v233, v233, v234
    v_accvgpr_write_b32 a168, v232
    v_accvgpr_write_b32 a169, v233
    v_accvgpr_read_b32 v232, a170
    v_accvgpr_read_b32 v233, a171
    v_mul_f32 v232, v232, v234
    v_mul_f32 v233, v233, v234
    v_accvgpr_write_b32 a170, v232
    v_accvgpr_write_b32 a171, v233
    v_accvgpr_read_b32 v232, a172
    v_accvgpr_read_b32 v233, a173
    v_mul_f32 v232, v232, v234
    v_mul_f32 v233, v233, v234
    v_accvgpr_write_b32 a172, v232
    v_accvgpr_write_b32 a173, v233
    v_accvgpr_read_b32 v232, a174
    v_accvgpr_read_b32 v233, a175
    v_mul_f32 v232, v232, v234
    v_mul_f32 v233, v233, v234
    v_accvgpr_write_b32 a174, v232
    v_accvgpr_write_b32 a175, v233
    v_accvgpr_read_b32 v232, a176
    v_accvgpr_read_b32 v233, a177
    v_mul_f32 v232, v232, v234
    v_mul_f32 v233, v233, v234
    v_accvgpr_write_b32 a176, v232
    v_accvgpr_write_b32 a177, v233
    v_accvgpr_read_b32 v232, a178
    v_accvgpr_read_b32 v233, a179
    v_mul_f32 v232, v232, v234
    v_mul_f32 v233, v233, v234
    v_accvgpr_write_b32 a178, v232
    v_accvgpr_write_b32 a179, v233
    v_accvgpr_read_b32 v232, a180
    v_accvgpr_read_b32 v233, a181
    v_mul_f32 v232, v232, v234
    v_mul_f32 v233, v233, v234
    v_accvgpr_write_b32 a180, v232
    v_accvgpr_write_b32 a181, v233
    v_accvgpr_read_b32 v232, a182
    v_accvgpr_read_b32 v233, a183
    v_mul_f32 v232, v232, v234
    v_mul_f32 v233, v233, v234
    v_accvgpr_write_b32 a182, v232
    v_accvgpr_write_b32 a183, v233
    v_accvgpr_read_b32 v232, a184
    v_accvgpr_read_b32 v233, a185
    v_mul_f32 v232, v232, v234
    v_mul_f32 v233, v233, v234
    v_accvgpr_write_b32 a184, v232
    v_accvgpr_write_b32 a185, v233
    v_accvgpr_read_b32 v232, a186
    v_accvgpr_read_b32 v233, a187
    v_mul_f32 v232, v232, v234
    v_mul_f32 v233, v233, v234
    v_accvgpr_write_b32 a186, v232
    v_accvgpr_write_b32 a187, v233
    v_accvgpr_read_b32 v232, a188
    v_accvgpr_read_b32 v233, a189
    v_mul_f32 v232, v232, v234
    v_mul_f32 v233, v233, v234
    v_accvgpr_write_b32 a188, v232
    v_accvgpr_write_b32 a189, v233
    v_accvgpr_read_b32 v232, a190
    v_accvgpr_read_b32 v233, a191
    v_mul_f32 v232, v232, v234
    v_mul_f32 v233, v233, v234
    v_accvgpr_write_b32 a190, v232
    v_accvgpr_write_b32 a191, v233
    v_exp_f32 v176, v176
    v_exp_f32 v177, v177
    v_exp_f32 v178, v178
    v_exp_f32 v179, v179
    v_exp_f32 v236, v236
    v_exp_f32 v237, v237
    v_exp_f32 v238, v238
    v_exp_f32 v239, v239
    s_nop 0
    v_add_f32 v230, v230, v176
    v_add_f32 v230, v230, v177
    v_add_f32 v230, v230, v178
    v_add_f32 v230, v230, v179
    v_add_f32 v230, v230, v236
    v_add_f32 v230, v230, v237
    v_add_f32 v230, v230, v238
    v_add_f32 v230, v230, v239
    v_cvt_pk_bf16_f32 v176, v176, v177
    v_cvt_pk_bf16_f32 v177, v178, v179
    v_cvt_pk_bf16_f32 v178, v236, v237
    v_cvt_pk_bf16_f32 v179, v238, v239
    ds_read_b128 v[232:235], v224 offset:17408
    s_waitcnt lgkmcnt(0)
    v_mfma_f32_16x16x32_bf16 v[184:187], v[232:235], v[96:99], v[252:255]
    s_nop 7
    ds_read_b128 v[232:235], v224 offset:17472
    s_waitcnt lgkmcnt(0)
    v_mfma_f32_16x16x32_bf16 v[184:187], v[232:235], v[100:103], v[184:187]
    s_nop 7
    ds_read_b128 v[232:235], v224 offset:17536
    s_waitcnt lgkmcnt(0)
    v_mfma_f32_16x16x32_bf16 v[184:187], v[232:235], v[104:107], v[184:187]
    s_nop 7
    ds_read_b128 v[232:235], v224 offset:17600
    s_waitcnt lgkmcnt(0)
    v_mfma_f32_16x16x32_bf16 v[184:187], v[232:235], v[108:111], v[184:187]
    s_nop 7
    ds_read_b128 v[232:235], v224 offset:17664
    s_waitcnt lgkmcnt(0)
    v_mfma_f32_16x16x32_bf16 v[184:187], v[232:235], v[112:115], v[184:187]
    s_nop 7
    ds_read_b128 v[232:235], v224 offset:17728
    s_waitcnt lgkmcnt(0)
    v_mfma_f32_16x16x32_bf16 v[184:187], v[232:235], v[116:119], v[184:187]
    s_nop 7
    ds_read_b128 v[232:235], v224 offset:17792
    s_waitcnt lgkmcnt(0)
    v_mfma_f32_16x16x32_bf16 v[184:187], v[232:235], v[120:123], v[184:187]
    s_nop 7
    ds_read_b128 v[232:235], v224 offset:17856
    s_waitcnt lgkmcnt(0)
    v_mfma_f32_16x16x32_bf16 v[184:187], v[232:235], v[124:127], v[184:187]
    s_nop 7
    ds_read_b128 v[232:235], v224 offset:26112
    s_waitcnt lgkmcnt(0)
    v_mfma_f32_16x16x32_bf16 v[236:239], v[232:235], v[96:99], v[252:255]
    s_nop 7
    ds_read_b128 v[232:235], v224 offset:26176
    s_waitcnt lgkmcnt(0)
    v_mfma_f32_16x16x32_bf16 v[236:239], v[232:235], v[100:103], v[236:239]
    s_nop 7
    ds_read_b128 v[232:235], v224 offset:26240
    s_waitcnt lgkmcnt(0)
    v_mfma_f32_16x16x32_bf16 v[236:239], v[232:235], v[104:107], v[236:239]
    s_nop 7
    ds_read_b128 v[232:235], v224 offset:26304
    s_waitcnt lgkmcnt(0)
    v_mfma_f32_16x16x32_bf16 v[236:239], v[232:235], v[108:111], v[236:239]
    s_nop 7
    ds_read_b128 v[232:235], v224 offset:26368
    s_waitcnt lgkmcnt(0)
    v_mfma_f32_16x16x32_bf16 v[236:239], v[232:235], v[112:115], v[236:239]
    s_nop 7
    ds_read_b128 v[232:235], v224 offset:26432
    s_waitcnt lgkmcnt(0)
    v_mfma_f32_16x16x32_bf16 v[236:239], v[232:235], v[116:119], v[236:239]
    s_nop 7
    ds_read_b128 v[232:235], v224 offset:26496
    s_waitcnt lgkmcnt(0)
    v_mfma_f32_16x16x32_bf16 v[236:239], v[232:235], v[120:123], v[236:239]
    s_nop 7
    ds_read_b128 v[232:235], v224 offset:26560
    s_waitcnt lgkmcnt(0)
    v_mfma_f32_16x16x32_bf16 v[236:239], v[232:235], v[124:127], v[236:239]
    s_nop 7
    s_nop 3
    v_max3_f32 v232, v184, v185, v186
    v_max3_f32 v232, v232, v187, v236
    v_max3_f32 v232, v232, v237, v238
    v_max_f32 v232, v232, v239
    v_mov_b32 v233, v232
    s_nop 1
    v_permlane16_swap_b32 v232, v233
    s_nop 1
    v_max_f32 v232, v232, v233
    v_mov_b32 v233, v232
    s_nop 1
    v_permlane32_swap_b32 v232, v233
    s_nop 1
    v_max_f32 v232, v232, v233
    v_ceil_f32 v232, v232
    v_max_f32 v232, 0, v232
    v_sub_f32 v252, v252, v232
    v_sub_f32 v253, v253, v232
    v_sub_f32 v254, v254, v232
    v_sub_f32 v255, v255, v232
    v_sub_f32 v184, v184, v232
    v_sub_f32 v185, v185, v232
    v_sub_f32 v186, v186, v232
    v_sub_f32 v187, v187, v232
    v_sub_f32 v236, v236, v232
    v_sub_f32 v237, v237, v232
    v_sub_f32 v238, v238, v232
    v_sub_f32 v239, v239, v232
    v_sub_f32 v152, v152, v232
    v_sub_f32 v153, v153, v232
    v_sub_f32 v154, v154, v232
    v_sub_f32 v155, v155, v232
    v_sub_f32 v188, v188, v232
    v_sub_f32 v189, v189, v232
    v_sub_f32 v190, v190, v232
    v_sub_f32 v191, v191, v232
    v_min_f32 v233, 0x43480000, v232
    v_cvt_i32_f32 v233, v233
    v_sub_u32 v233, 0, v233
    v_ldexp_f32 v234, 1.0, v233
    v_mul_f32 v231, v231, v234
    v_accvgpr_read_b32 v232, a192
    v_accvgpr_read_b32 v233, a193
    v_mul_f32 v232, v232, v234
    v_mul_f32 v233, v233, v234
    v_accvgpr_write_b32 a192, v232
    v_accvgpr_write_b32 a193, v233
    v_accvgpr_read_b32 v232, a194
    v_accvgpr_read_b32 v233, a195
    v_mul_f32 v232, v232, v234
    v_mul_f32 v233, v233, v234
    v_accvgpr_write_b32 a194, v232
    v_accvgpr_write_b32 a195, v233
    v_accvgpr_read_b32 v232, a196
    v_accvgpr_read_b32 v233, a197
    v_mul_f32 v232, v232, v234
    v_mul_f32 v233, v233, v234
    v_accvgpr_write_b32 a196, v232
    v_accvgpr_write_b32 a197, v233
    v_accvgpr_read_b32 v232, a198
    v_accvgpr_read_b32 v233, a199
    v_mul_f32 v232, v232, v234
    v_mul_f32 v233, v233, v234
    v_accvgpr_write_b32 a198, v232
    v_accvgpr_write_b32 a199, v233
    v_accvgpr_read_b32 v232, a200
    v_accvgpr_read_b32 v233, a201
    v_mul_f32 v232, v232, v234
    v_mul_f32 v233, v233, v234
    v_accvgpr_write_b32 a200, v232
    v_accvgpr_write_b32 a201, v233
    v_accvgpr_read_b32 v232, a202
    v_accvgpr_read_b32 v233, a203
    v_mul_f32 v232, v232, v234
    v_mul_f32 v233, v233, v234
    v_accvgpr_write_b32 a202, v232
    v_accvgpr_write_b32 a203, v233
    v_accvgpr_read_b32 v232, a204
    v_accvgpr_read_b32 v233, a205
    v_mul_f32 v232, v232, v234
    v_mul_f32 v233, v233, v234
    v_accvgpr_write_b32 a204, v232
    v_accvgpr_write_b32 a205, v233
    v_accvgpr_read_b32 v232, a206
    v_accvgpr_read_b32 v233, a207
    v_mul_f32 v232, v232, v234
    v_mul_f32 v233, v233, v234
    v_accvgpr_write_b32 a206, v232
    v_accvgpr_write_b32 a207, v233
    v_accvgpr_read_b32 v232, a208
    v_accvgpr_read_b32 v233, a209
    v_mul_f32 v232, v232, v234
    v_mul_f32 v233, v233, v234
    v_accvgpr_write_b32 a208, v232
    v_accvgpr_write_b32 a209, v233
    v_accvgpr_read_b32 v232, a210
    v_accvgpr_read_b32 v233, a211
    v_mul_f32 v232, v232, v234
    v_mul_f32 v233, v233, v234
    v_accvgpr_write_b32 a210, v232
    v_accvgpr_write_b32 a211, v233
    v_accvgpr_read_b32 v232, a212
    v_accvgpr_read_b32 v233, a213
    v_mul_f32 v232, v232, v234
    v_mul_f32 v233, v233, v234
    v_accvgpr_write_b32 a212, v232
    v_accvgpr_write_b32 a213, v233
    v_accvgpr_read_b32 v232, a214
    v_accvgpr_read_b32 v233, a215
    v_mul_f32 v232, v232, v234
    v_mul_f32 v233, v233, v234
    v_accvgpr_write_b32 a214, v232
    v_accvgpr_write_b32 a215, v233
    v_accvgpr_read_b32 v232, a216
    v_accvgpr_read_b32 v233, a217
    v_mul_f32 v232, v232, v234
    v_mul_f32 v233, v233, v234
    v_accvgpr_write_b32 a216, v232
    v_accvgpr_write_b32 a217, v233
    v_accvgpr_read_b32 v232, a218
    v_accvgpr_read_b32 v233, a219
    v_mul_f32 v232, v232, v234
    v_mul_f32 v233, v233, v234
    v_accvgpr_write_b32 a218, v232
    v_accvgpr_write_b32 a219, v233
    v_accvgpr_read_b32 v232, a220
    v_accvgpr_read_b32 v233, a221
    v_mul_f32 v232, v232, v234
    v_mul_f32 v233, v233, v234
    v_accvgpr_write_b32 a220, v232
    v_accvgpr_write_b32 a221, v233
    v_accvgpr_read_b32 v232, a222
    v_accvgpr_read_b32 v233, a223
    v_mul_f32 v232, v232, v234
    v_mul_f32 v233, v233, v234
    v_accvgpr_write_b32 a222, v232
    v_accvgpr_write_b32 a223, v233
    v_accvgpr_read_b32 v232, a224
    v_accvgpr_read_b32 v233, a225
    v_mul_f32 v232, v232, v234
    v_mul_f32 v233, v233, v234
    v_accvgpr_write_b32 a224, v232
    v_accvgpr_write_b32 a225, v233
    v_accvgpr_read_b32 v232, a226
    v_accvgpr_read_b32 v233, a227
    v_mul_f32 v232, v232, v234
    v_mul_f32 v233, v233, v234
    v_accvgpr_write_b32 a226, v232
    v_accvgpr_write_b32 a227, v233
    v_accvgpr_read_b32 v232, a228
    v_accvgpr_read_b32 v233, a229
    v_mul_f32 v232, v232, v234
    v_mul_f32 v233, v233, v234
    v_accvgpr_write_b32 a228, v232
    v_accvgpr_write_b32 a229, v233
    v_accvgpr_read_b32 v232, a230
    v_accvgpr_read_b32 v233, a231
    v_mul_f32 v232, v232, v234
    v_mul_f32 v233, v233, v234
    v_accvgpr_write_b32 a230, v232
    v_accvgpr_write_b32 a231, v233
    v_accvgpr_read_b32 v232, a232
    v_accvgpr_read_b32 v233, a233
    v_mul_f32 v232, v232, v234
    v_mul_f32 v233, v233, v234
    v_accvgpr_write_b32 a232, v232
    v_accvgpr_write_b32 a233, v233
    v_accvgpr_read_b32 v232, a234
    v_accvgpr_read_b32 v233, a235
    v_mul_f32 v232, v232, v234
    v_mul_f32 v233, v233, v234
    v_accvgpr_write_b32 a234, v232
    v_accvgpr_write_b32 a235, v233
    v_accvgpr_read_b32 v232, a236
    v_accvgpr_read_b32 v233, a237
    v_mul_f32 v232, v232, v234
    v_mul_f32 v233, v233, v234
    v_accvgpr_write_b32 a236, v232
    v_accvgpr_write_b32 a237, v233
    v_accvgpr_read_b32 v232, a238
    v_accvgpr_read_b32 v233, a239
    v_mul_f32 v232, v232, v234
    v_mul_f32 v233, v233, v234
    v_accvgpr_write_b32 a238, v232
    v_accvgpr_write_b32 a239, v233
    v_accvgpr_read_b32 v232, a240
    v_accvgpr_read_b32 v233, a241
    v_mul_f32 v232, v232, v234
    v_mul_f32 v233, v233, v234
    v_accvgpr_write_b32 a240, v232
    v_accvgpr_write_b32 a241, v233
    v_accvgpr_read_b32 v232, a242
    v_accvgpr_read_b32 v233, a243
    v_mul_f32 v232, v232, v234
    v_mul_f32 v233, v233, v234
    v_accvgpr_write_b32 a242, v232
    v_accvgpr_write_b32 a243, v233
    v_accvgpr_read_b32 v232, a244
    v_accvgpr_read_b32 v233, a245
    v_mul_f32 v232, v232, v234
    v_mul_f32 v233, v233, v234
    v_accvgpr_write_b32 a244, v232
    v_accvgpr_write_b32 a245, v233
    v_accvgpr_read_b32 v232, a246
    v_accvgpr_read_b32 v233, a247
    v_mul_f32 v232, v232, v234
    v_mul_f32 v233, v233, v234
    v_accvgpr_write_b32 a246, v232
    v_accvgpr_write_b32 a247, v233
    v_accvgpr_read_b32 v232, a248
    v_accvgpr_read_b32 v233, a249
    v_mul_f32 v232, v232, v234
    v_mul_f32 v233, v233, v234
    v_accvgpr_write_b32 a248, v232
    v_accvgpr_write_b32 a249, v233
    v_accvgpr_read_b32 v232, a250
    v_accvgpr_read_b32 v233, a251
    v_mul_f32 v232, v232, v234
    v_mul_f32 v233, v233, v234
    v_accvgpr_write_b32 a250, v232
    v_accvgpr_write_b32 a251, v233
    v_accvgpr_read_b32 v232, a252
    v_accvgpr_read_b32 v233, a253
    v_mul_f32 v232, v232, v234
    v_mul_f32 v233, v233, v234
    v_accvgpr_write_b32 a252, v232
    v_accvgpr_write_b32 a253, v233
    v_accvgpr_read_b32 v232, a254
    v_accvgpr_read_b32 v233, a255
    v_mul_f32 v232, v232, v234
    v_mul_f32 v233, v233, v234
    v_accvgpr_write_b32 a254, v232
    v_accvgpr_write_b32 a255, v233
    v_exp_f32 v184, v184
    v_exp_f32 v185, v185
    v_exp_f32 v186, v186
    v_exp_f32 v187, v187
    v_exp_f32 v236, v236
    v_exp_f32 v237, v237
    v_exp_f32 v238, v238
    v_exp_f32 v239, v239
    s_nop 0
    v_add_f32 v231, v231, v184
    v_add_f32 v231, v231, v185
    v_add_f32 v231, v231, v186
    v_add_f32 v231, v231, v187
    v_add_f32 v231, v231, v236
    v_add_f32 v231, v231, v237
    v_add_f32 v231, v231, v238
    v_add_f32 v231, v231, v239
    v_cvt_pk_bf16_f32 v184, v184, v185
    v_cvt_pk_bf16_f32 v185, v186, v187
    v_cvt_pk_bf16_f32 v186, v236, v237
    v_cvt_pk_bf16_f32 v187, v238, v239
    v_mov_b32 v232, 0
    v_mov_b32 v233, 0
    v_mov_b32 v234, 0
    v_mov_b32 v235, 0
    s_nop 1
    s_branch L_back0
L_rare1:
    s_waitcnt vmcnt(0)
    s_nop 7
    ds_read_b128 v[232:235], v224 offset:34816
    s_waitcnt lgkmcnt(0)
    v_mfma_f32_16x16x32_bf16 v[128:131], v[232:235], v[0:3], v[240:243]
    s_nop 7
    ds_read_b128 v[232:235], v224 offset:34880
    s_waitcnt lgkmcnt(0)
    v_mfma_f32_16x16x32_bf16 v[128:131], v[232:235], v[4:7], v[128:131]
    s_nop 7
    ds_read_b128 v[232:235], v224 offset:34944
    s_waitcnt lgkmcnt(0)
    v_mfma_f32_16x16x32_bf16 v[128:131], v[232:235], v[8:11], v[128:131]
    s_nop 7
    ds_read_b128 v[232:235], v224 offset:35008
    s_waitcnt lgkmcnt(0)
    v_mfma_f32_16x16x32_bf16 v[128:131], v[232:235], v[12:15], v[128:131]
    s_nop 7
    ds_read_b128 v[232:235], v224 offset:35072
    s_waitcnt lgkmcnt(0)
    v_mfma_f32_16x16x32_bf16 v[128:131], v[232:235], v[16:19], v[128:131]
    s_nop 7
    ds_read_b128 v[232:235], v224 offset:35136
    s_waitcnt lgkmcnt(0)
    v_mfma_f32_16x16x32_bf16 v[128:131], v[232:235], v[20:23], v[128:131]
    s_nop 7
    ds_read_b128 v[232:235], v224 offset:35200
    s_waitcnt lgkmcnt(0)
    v_mfma_f32_16x16x32_bf16 v[128:131], v[232:235], v[24:27], v[128:131]
    s_nop 7
    ds_read_b128 v[232:235], v224 offset:35264
    s_waitcnt lgkmcnt(0)
    v_mfma_f32_16x16x32_bf16 v[128:131], v[232:235], v[28:31], v[128:131]
    s_nop 7
    ds_read_b128 v[232:235], v224 offset:43520
    s_waitcnt lgkmcnt(0)
    v_mfma_f32_16x16x32_bf16 v[236:239], v[232:235], v[0:3], v[240:243]
    s_nop 7
    ds_read_b128 v[232:235], v224 offset:43584
    s_waitcnt lgkmcnt(0)
    v_mfma_f32_16x16x32_bf16 v[236:239], v[232:235], v[4:7], v[236:239]
    s_nop 7
    ds_read_b128 v[232:235], v224 offset:43648
    s_waitcnt lgkmcnt(0)
    v_mfma_f32_16x16x32_bf16 v[236:239], v[232:235], v[8:11], v[236:239]
    s_nop 7
    ds_read_b128 v[232:235], v224 offset:43712
    s_waitcnt lgkmcnt(0)
    v_mfma_f32_16x16x32_bf16 v[236:239], v[232:235], v[12:15], v[236:239]
    s_nop 7
    ds_read_b128 v[232:235], v224 offset:43776
    s_waitcnt lgkmcnt(0)
    v_mfma_f32_16x16x32_bf16 v[236:239], v[232:235], v[16:19], v[236:239]
    s_nop 7
    ds_read_b128 v[232:235], v224 offset:43840
    s_waitcnt lgkmcnt(0)
    v_mfma_f32_16x16x32_bf16 v[236:239], v[232:235], v[20:23], v[236:239]
    s_nop 7
    ds_read_b128 v[232:235], v224 offset:43904
    s_waitcnt lgkmcnt(0)
    v_mfma_f32_16x16x32_bf16 v[236:239], v[232:235], v[24:27], v[236:239]
    s_nop 7
    ds_read_b128 v[232:235], v224 offset:43968
    s_waitcnt lgkmcnt(0)
    v_mfma_f32_16x16x32_bf16 v[236:239], v[232:235], v[28:31], v[236:239]
    s_nop 7
    s_nop 3
    v_max3_f32 v232, v128, v129, v130
    v_max3_f32 v232, v232, v131, v236
    v_max3_f32 v232, v232, v237, v238
    v_max_f32 v232, v232, v239
    v_mov_b32 v233, v232
    s_nop 1
    v_permlane16_swap_b32 v232, v233
    s_nop 1
    v_max_f32 v232, v232, v233
    v_mov_b32 v233, v232
    s_nop 1
    v_permlane32_swap_b32 v232, v233
    s_nop 1
    v_max_f32 v232, v232, v233
    v_ceil_f32 v232, v232
    v_max_f32 v232, 0, v232
    v_sub_f32 v240, v240, v232
    v_sub_f32 v241, v241, v232
    v_sub_f32 v242, v242, v232
    v_sub_f32 v243, v243, v232
    v_sub_f32 v128, v128, v232
    v_sub_f32 v129, v129, v232
    v_sub_f32 v130, v130, v232
    v_sub_f32 v131, v131, v232
    v_sub_f32 v236, v236, v232
    v_sub_f32 v237, v237, v232
    v_sub_f32 v238, v238, v232
    v_sub_f32 v239, v239, v232
    v_sub_f32 v132, v132, v232
    v_sub_f32 v133, v133, v232
    v_sub_f32 v134, v134, v232
    v_sub_f32 v135, v135, v232
    v_sub_f32 v164, v164, v232
    v_sub_f32 v165, v165, v232
    v_sub_f32 v166, v166, v232
    v_sub_f32 v167, v167, v232
    v_min_f32 v233, 0x43480000, v232
    v_cvt_i32_f32 v233, v233
    v_sub_u32 v233, 0, v233
    v_ldexp_f32 v234, 1.0, v233
    v_mul_f32 v228, v228, v234
    v_lshlrev_b32 v232, 16, v160
    v_and_b32 v233, 0xffff0000, v160
    v_mul_f32 v232, v232, v234
    v_mul_f32 v233, v233, v234
    v_cvt_pk_bf16_f32 v160, v232, v233
    v_lshlrev_b32 v232, 16, v161
    v_and_b32 v233, 0xffff0000, v161
    v_mul_f32 v232, v232, v234
    v_mul_f32 v233, v233, v234
    v_cvt_pk_bf16_f32 v161, v232, v233
    v_lshlrev_b32 v232, 16, v162
    v_and_b32 v233, 0xffff0000, v162
    v_mul_f32 v232, v232, v234
    v_mul_f32 v233, v233, v234
    v_cvt_pk_bf16_f32 v162, v232, v233
    v_lshlrev_b32 v232, 16, v163
    v_and_b32 v233, 0xffff0000, v163
    v_mul_f32 v232, v232, v234
    v_mul_f32 v233, v233, v234
    v_cvt_pk_bf16_f32 v163, v232, v233
    v_accvgpr_read_b32 v232, a0
    v_accvgpr_read_b32 v233, a1
    v_mul_f32 v232, v232, v234
    v_mul_f32 v233, v233, v234
    v_accvgpr_write_b32 a0, v232
    v_accvgpr_write_b32 a1, v233
    v_accvgpr_read_b32 v232, a2
    v_accvgpr_read_b32 v233, a3
    v_mul_f32 v232, v232, v234
    v_mul_f32 v233, v233, v234
    v_accvgpr_write_b32 a2, v232
    v_accvgpr_write_b32 a3, v233
    v_accvgpr_read_b32 v232, a4
    v_accvgpr_read_b32 v233, a5
    v_mul_f32 v232, v232, v234
    v_mul_f32 v233, v233, v234
    v_accvgpr_write_b32 a4, v232
    v_accvgpr_write_b32 a5, v233
    v_accvgpr_read_b32 v232, a6
    v_accvgpr_read_b32 v233, a7
    v_mul_f32 v232, v232, v234
    v_mul_f32 v233, v233, v234
    v_accvgpr_write_b32 a6, v232
    v_accvgpr_write_b32 a7, v233
    v_accvgpr_read_b32 v232, a8
    v_accvgpr_read_b32 v233, a9
    v_mul_f32 v232, v232, v234
    v_mul_f32 v233, v233, v234
    v_accvgpr_write_b32 a8, v232
    v_accvgpr_write_b32 a9, v233
    v_accvgpr_read_b32 v232, a10
    v_accvgpr_read_b32 v233, a11
    v_mul_f32 v232, v232, v234
    v_mul_f32 v233, v233, v234
    v_accvgpr_write_b32 a10, v232
    v_accvgpr_write_b32 a11, v233
    v_accvgpr_read_b32 v232, a12
    v_accvgpr_read_b32 v233, a13
    v_mul_f32 v232, v232, v234
    v_mul_f32 v233, v233, v234
    v_accvgpr_write_b32 a12, v232
    v_accvgpr_write_b32 a13, v233
    v_accvgpr_read_b32 v232, a14
    v_accvgpr_read_b32 v233, a15
    v_mul_f32 v232, v232, v234
    v_mul_f32 v233, v233, v234
    v_accvgpr_write_b32 a14, v232
    v_accvgpr_write_b32 a15, v233
    v_accvgpr_read_b32 v232, a16
    v_accvgpr_read_b32 v233, a17
    v_mul_f32 v232, v232, v234
    v_mul_f32 v233, v233, v234
    v_accvgpr_write_b32 a16, v232
    v_accvgpr_write_b32 a17, v233
    v_accvgpr_read_b32 v232, a18
    v_accvgpr_read_b32 v233, a19
    v_mul_f32 v232, v232, v234
    v_mul_f32 v233, v233, v234
    v_accvgpr_write_b32 a18, v232
    v_accvgpr_write_b32 a19, v233
    v_accvgpr_read_b32 v232, a20
    v_accvgpr_read_b32 v233, a21
    v_mul_f32 v232, v232, v234
    v_mul_f32 v233, v233, v234
    v_accvgpr_write_b32 a20, v232
    v_accvgpr_write_b32 a21, v233
    v_accvgpr_read_b32 v232, a22
    v_accvgpr_read_b32 v233, a23
    v_mul_f32 v232, v232, v234
    v_mul_f32 v233, v233, v234
    v_accvgpr_write_b32 a22, v232
    v_accvgpr_write_b32 a23, v233
    v_accvgpr_read_b32 v232, a24
    v_accvgpr_read_b32 v233, a25
    v_mul_f32 v232, v232, v234
    v_mul_f32 v233, v233, v234
    v_accvgpr_write_b32 a24, v232
    v_accvgpr_write_b32 a25, v233
    v_accvgpr_read_b32 v232, a26
    v_accvgpr_read_b32 v233, a27
    v_mul_f32 v232, v232, v234
    v_mul_f32 v233, v233, v234
    v_accvgpr_write_b32 a26, v232
    v_accvgpr_write_b32 a27, v233
    v_accvgpr_read_b32 v232, a28
    v_accvgpr_read_b32 v233, a29
    v_mul_f32 v232, v232, v234
    v_mul_f32 v233, v233, v234
    v_accvgpr_write_b32 a28, v232
    v_accvgpr_write_b32 a29, v233
    v_accvgpr_read_b32 v232, a30
    v_accvgpr_read_b32 v233, a31
    v_mul_f32 v232, v232, v234
    v_mul_f32 v233, v233, v234
    v_accvgpr_write_b32 a30, v232
    v_accvgpr_write_b32 a31, v233
    v_accvgpr_read_b32 v232, a32
    v_accvgpr_read_b32 v233, a33
    v_mul_f32 v232, v232, v234
    v_mul_f32 v233, v233, v234
    v_accvgpr_write_b32 a32, v232
    v_accvgpr_write_b32 a33, v233
    v_accvgpr_read_b32 v232, a34
    v_accvgpr_read_b32 v233, a35
    v_mul_f32 v232, v232, v234
    v_mul_f32 v233, v233, v234
    v_accvgpr_write_b32 a34, v232
    v_accvgpr_write_b32 a35, v233
    v_accvgpr_read_b32 v232, a36
    v_accvgpr_read_b32 v233, a37
    v_mul_f32 v232, v232, v234
    v_mul_f32 v233, v233, v234
    v_accvgpr_write_b32 a36, v232
    v_accvgpr_write_b32 a37, v233
    v_accvgpr_read_b32 v232, a38
    v_accvgpr_read_b32 v233, a39
    v_mul_f32 v232, v232, v234
    v_mul_f32 v233, v233, v234
    v_accvgpr_write_b32 a38, v232
    v_accvgpr_write_b32 a39, v233
    v_accvgpr_read_b32 v232, a40
    v_accvgpr_read_b32 v233, a41
    v_mul_f32 v232, v232, v234
    v_mul_f32 v233, v233, v234
    v_accvgpr_write_b32 a40, v232
    v_accvgpr_write_b32 a41, v233
    v_accvgpr_read_b32 v232, a42
    v_accvgpr_read_b32 v233, a43
    v_mul_f32 v232, v232, v234
    v_mul_f32 v233, v233, v234
    v_accvgpr_write_b32 a42, v232
    v_accvgpr_write_b32 a43, v233
    v_accvgpr_read_b32 v232, a44
    v_accvgpr_read_b32 v233, a45
    v_mul_f32 v232, v232, v234
    v_mul_f32 v233, v233, v234
    v_accvgpr_write_b32 a44, v232
    v_accvgpr_write_b32 a45, v233
    v_accvgpr_read_b32 v232, a46
    v_accvgpr_read_b32 v233, a47
    v_mul_f32 v232, v232, v234
    v_mul_f32 v233, v233, v234
    v_accvgpr_write_b32 a46, v232
    v_accvgpr_write_b32 a47, v233
    v_accvgpr_read_b32 v232, a48
    v_accvgpr_read_b32 v233, a49
    v_mul_f32 v232, v232, v234
    v_mul_f32 v233, v233, v234
    v_accvgpr_write_b32 a48, v232
    v_accvgpr_write_b32 a49, v233
    v_accvgpr_read_b32 v232, a50
    v_accvgpr_read_b32 v233, a51
    v_mul_f32 v232, v232, v234
    v_mul_f32 v233, v233, v234
    v_accvgpr_write_b32 a50, v232
    v_accvgpr_write_b32 a51, v233
    v_accvgpr_read_b32 v232, a52
    v_accvgpr_read_b32 v233, a53
    v_mul_f32 v232, v232, v234
    v_mul_f32 v233, v233, v234
    v_accvgpr_write_b32 a52, v232
    v_accvgpr_write_b32 a53, v233
    v_accvgpr_read_b32 v232, a54
    v_accvgpr_read_b32 v233, a55
    v_mul_f32 v232, v232, v234
    v_mul_f32 v233, v233, v234
    v_accvgpr_write_b32 a54, v232
    v_accvgpr_write_b32 a55, v233
    v_accvgpr_read_b32 v232, a56
    v_accvgpr_read_b32 v233, a57
    v_mul_f32 v232, v232, v234
    v_mul_f32 v233, v233, v234
    v_accvgpr_write_b32 a56, v232
    v_accvgpr_write_b32 a57, v233
    v_accvgpr_read_b32 v232, a58
    v_accvgpr_read_b32 v233, a59
    v_mul_f32 v232, v232, v234
    v_mul_f32 v233, v233, v234
    v_accvgpr_write_b32 a58, v232
    v_accvgpr_write_b32 a59, v233
    v_accvgpr_read_b32 v232, a60
    v_accvgpr_read_b32 v233, a61
    v_mul_f32 v232, v232, v234
    v_mul_f32 v233, v233, v234
    v_accvgpr_write_b32 a60, v232
    v_accvgpr_write_b32 a61, v233
    v_accvgpr_read_b32 v232, a62
    v_accvgpr_read_b32 v233, a63
    v_mul_f32 v232, v232, v234
    v_mul_f32 v233, v233, v234
    v_accvgpr_write_b32 a62, v232
    v_accvgpr_write_b32 a63, v233
    v_exp_f32 v128, v128
    v_exp_f32 v129, v129
    v_exp_f32 v130, v130
    v_exp_f32 v131, v131
    v_exp_f32 v236, v236
    v_exp_f32 v237, v237
    v_exp_f32 v238, v238
    v_exp_f32 v239, v239
    s_nop 0
    v_add_f32 v228, v228, v128
    v_add_f32 v228, v228, v129
    v_add_f32 v228, v228, v130
    v_add_f32 v228, v228, v131
    v_add_f32 v228, v228, v236
    v_add_f32 v228, v228, v237
    v_add_f32 v228, v228, v238
    v_add_f32 v228, v228, v239
    v_cvt_pk_bf16_f32 v128, v128, v129
    v_cvt_pk_bf16_f32 v129, v130, v131
    v_cvt_pk_bf16_f32 v130, v236, v237
    v_cvt_pk_bf16_f32 v131, v238, v239
    ds_read_b128 v[232:235], v224 offset:34816
    s_waitcnt lgkmcnt(0)
    v_mfma_f32_16x16x32_bf16 v[136:139], v[232:235], v[32:35], v[244:247]
    s_nop 7
    ds_read_b128 v[232:235], v224 offset:34880
    s_waitcnt lgkmcnt(0)
    v_mfma_f32_16x16x32_bf16 v[136:139], v[232:235], v[36:39], v[136:139]
    s_nop 7
    ds_read_b128 v[232:235], v224 offset:34944
    s_waitcnt lgkmcnt(0)
    v_mfma_f32_16x16x32_bf16 v[136:139], v[232:235], v[40:43], v[136:139]
    s_nop 7
    ds_read_b128 v[232:235], v224 offset:35008
    s_waitcnt lgkmcnt(0)
    v_mfma_f32_16x16x32_bf16 v[136:139], v[232:235], v[44:47], v[136:139]
    s_nop 7
    ds_read_b128 v[232:235], v224 offset:35072
    s_waitcnt lgkmcnt(0)
    v_mfma_f32_16x16x32_bf16 v[136:139], v[232:235], v[48:51], v[136:139]
    s_nop 7
    ds_read_b128 v[232:235], v224 offset:35136
    s_waitcnt lgkmcnt(0)
    v_mfma_f32_16x16x32_bf16 v[136:139], v[232:235], v[52:55], v[136:139]
    s_nop 7
    ds_read_b128 v[232:235], v224 offset:35200
    s_waitcnt lgkmcnt(0)
    v_mfma_f32_16x16x32_bf16 v[136:139], v[232:235], v[56:59], v[136:139]
    s_nop 7
    ds_read_b128 v[232:235], v224 offset:35264
    s_waitcnt lgkmcnt(0)
    v_mfma_f32_16x16x32_bf16 v[136:139], v[232:235], v[60:63], v[136:139]
    s_nop 7
    ds_read_b128 v[232:235], v224 offset:43520
    s_waitcnt lgkmcnt(0)
    v_mfma_f32_16x16x32_bf16 v[236:239], v[232:235], v[32:35], v[244:247]
    s_nop 7
    ds_read_b128 v[232:235], v224 offset:43584
    s_waitcnt lgkmcnt(0)
    v_mfma_f32_16x16x32_bf16 v[236:239], v[232:235], v[36:39], v[236:239]
    s_nop 7
    ds_read_b128 v[232:235], v224 offset:43648
    s_waitcnt lgkmcnt(0)
    v_mfma_f32_16x16x32_bf16 v[236:239], v[232:235], v[40:43], v[236:239]
    s_nop 7
    ds_read_b128 v[232:235], v224 offset:43712
    s_waitcnt lgkmcnt(0)
    v_mfma_f32_16x16x32_bf16 v[236:239], v[232:235], v[44:47], v[236:239]
    s_nop 7
    ds_read_b128 v[232:235], v224 offset:43776
    s_waitcnt lgkmcnt(0)
    v_mfma_f32_16x16x32_bf16 v[236:239], v[232:235], v[48:51], v[236:239]
    s_nop 7
    ds_read_b128 v[232:235], v224 offset:43840
    s_waitcnt lgkmcnt(0)
    v_mfma_f32_16x16x32_bf16 v[236:239], v[232:235], v[52:55], v[236:239]
    s_nop 7
    ds_read_b128 v[232:235], v224 offset:43904
    s_waitcnt lgkmcnt(0)
    v_mfma_f32_16x16x32_bf16 v[236:239], v[232:235], v[56:59], v[236:239]
    s_nop 7
    ds_read_b128 v[232:235], v224 offset:43968
    s_waitcnt lgkmcnt(0)
    v_mfma_f32_16x16x32_bf16 v[236:239], v[232:235], v[60:63], v[236:239]
    s_nop 7
    s_nop 3
    v_max3_f32 v232, v136, v137, v138
    v_max3_f32 v232, v232, v139, v236
    v_max3_f32 v232, v232, v237, v238
    v_max_f32 v232, v232, v239
    v_mov_b32 v233, v232
    s_nop 1
    v_permlane16_swap_b32 v232, v233
    s_nop 1
    v_max_f32 v232, v232, v233
    v_mov_b32 v233, v232
    s_nop 1
    v_permlane32_swap_b32 v232, v233
    s_nop 1
    v_max_f32 v232, v232, v233
    v_ceil_f32 v232, v232
    v_max_f32 v232, 0, v232
    v_sub_f32 v244, v244, v232
    v_sub_f32 v245, v245, v232
    v_sub_f32 v246, v246, v232
    v_sub_f32 v247, v247, v232
    v_sub_f32 v136, v136, v232
    v_sub_f32 v137, v137, v232
    v_sub_f32 v138, v138, v232
    v_sub_f32 v139, v139, v232
    v_sub_f32 v236, v236, v232
    v_sub_f32 v237, v237, v232
    v_sub_f32 v238, v238, v232
    v_sub_f32 v239, v239, v232
    v_sub_f32 v140, v140, v232
    v_sub_f32 v141, v141, v232
    v_sub_f32 v142, v142, v232
    v_sub_f32 v143, v143, v232
    v_sub_f32 v172, v172, v232
    v_sub_f32 v173, v173, v232
    v_sub_f32 v174, v174, v232
    v_sub_f32 v175, v175, v232
    v_min_f32 v233, 0x43480000, v232
    v_cvt_i32_f32 v233, v233
    v_sub_u32 v233, 0, v233
    v_ldexp_f32 v234, 1.0, v233
    v_mul_f32 v229, v229, v234
    v_lshlrev_b32 v232, 16, v168
    v_and_b32 v233, 0xffff0000, v168
    v_mul_f32 v232, v232, v234
    v_mul_f32 v233, v233, v234
    v_cvt_pk_bf16_f32 v168, v232, v233
    v_lshlrev_b32 v232, 16, v169
    v_and_b32 v233, 0xffff0000, v169
    v_mul_f32 v232, v232, v234
    v_mul_f32 v233, v233, v234
    v_cvt_pk_bf16_f32 v169, v232, v233
    v_lshlrev_b32 v232, 16, v170
    v_and_b32 v233, 0xffff0000, v170
    v_mul_f32 v232, v232, v234
    v_mul_f32 v233, v233, v234
    v_cvt_pk_bf16_f32 v170, v232, v233
    v_lshlrev_b32 v232, 16, v171
    v_and_b32 v233, 0xffff0000, v171
    v_mul_f32 v232, v232, v234
    v_mul_f32 v233, v233, v234
    v_cvt_pk_bf16_f32 v171, v232, v233
    v_accvgpr_read_b32 v232, a64
    v_accvgpr_read_b32 v233, a65
    v_mul_f32 v232, v232, v234
    v_mul_f32 v233, v233, v234
    v_accvgpr_write_b32 a64, v232
    v_accvgpr_write_b32 a65, v233
    v_accvgpr_read_b32 v232, a66
    v_accvgpr_read_b32 v233, a67
    v_mul_f32 v232, v232, v234
    v_mul_f32 v233, v233, v234
    v_accvgpr_write_b32 a66, v232
    v_accvgpr_write_b32 a67, v233
    v_accvgpr_read_b32 v232, a68
    v_accvgpr_read_b32 v233, a69
    v_mul_f32 v232, v232, v234
    v_mul_f32 v233, v233, v234
    v_accvgpr_write_b32 a68, v232
    v_accvgpr_write_b32 a69, v233
    v_accvgpr_read_b32 v232, a70
    v_accvgpr_read_b32 v233, a71
    v_mul_f32 v232, v232, v234
    v_mul_f32 v233, v233, v234
    v_accvgpr_write_b32 a70, v232
    v_accvgpr_write_b32 a71, v233
    v_accvgpr_read_b32 v232, a72
    v_accvgpr_read_b32 v233, a73
    v_mul_f32 v232, v232, v234
    v_mul_f32 v233, v233, v234
    v_accvgpr_write_b32 a72, v232
    v_accvgpr_write_b32 a73, v233
    v_accvgpr_read_b32 v232, a74
    v_accvgpr_read_b32 v233, a75
    v_mul_f32 v232, v232, v234
    v_mul_f32 v233, v233, v234
    v_accvgpr_write_b32 a74, v232
    v_accvgpr_write_b32 a75, v233
    v_accvgpr_read_b32 v232, a76
    v_accvgpr_read_b32 v233, a77
    v_mul_f32 v232, v232, v234
    v_mul_f32 v233, v233, v234
    v_accvgpr_write_b32 a76, v232
    v_accvgpr_write_b32 a77, v233
    v_accvgpr_read_b32 v232, a78
    v_accvgpr_read_b32 v233, a79
    v_mul_f32 v232, v232, v234
    v_mul_f32 v233, v233, v234
    v_accvgpr_write_b32 a78, v232
    v_accvgpr_write_b32 a79, v233
    v_accvgpr_read_b32 v232, a80
    v_accvgpr_read_b32 v233, a81
    v_mul_f32 v232, v232, v234
    v_mul_f32 v233, v233, v234
    v_accvgpr_write_b32 a80, v232
    v_accvgpr_write_b32 a81, v233
    v_accvgpr_read_b32 v232, a82
    v_accvgpr_read_b32 v233, a83
    v_mul_f32 v232, v232, v234
    v_mul_f32 v233, v233, v234
    v_accvgpr_write_b32 a82, v232
    v_accvgpr_write_b32 a83, v233
    v_accvgpr_read_b32 v232, a84
    v_accvgpr_read_b32 v233, a85
    v_mul_f32 v232, v232, v234
    v_mul_f32 v233, v233, v234
    v_accvgpr_write_b32 a84, v232
    v_accvgpr_write_b32 a85, v233
    v_accvgpr_read_b32 v232, a86
    v_accvgpr_read_b32 v233, a87
    v_mul_f32 v232, v232, v234
    v_mul_f32 v233, v233, v234
    v_accvgpr_write_b32 a86, v232
    v_accvgpr_write_b32 a87, v233
    v_accvgpr_read_b32 v232, a88
    v_accvgpr_read_b32 v233, a89
    v_mul_f32 v232, v232, v234
    v_mul_f32 v233, v233, v234
    v_accvgpr_write_b32 a88, v232
    v_accvgpr_write_b32 a89, v233
    v_accvgpr_read_b32 v232, a90
    v_accvgpr_read_b32 v233, a91
    v_mul_f32 v232, v232, v234
    v_mul_f32 v233, v233, v234
    v_accvgpr_write_b32 a90, v232
    v_accvgpr_write_b32 a91, v233
    v_accvgpr_read_b32 v232, a92
    v_accvgpr_read_b32 v233, a93
    v_mul_f32 v232, v232, v234
    v_mul_f32 v233, v233, v234
    v_accvgpr_write_b32 a92, v232
    v_accvgpr_write_b32 a93, v233
    v_accvgpr_read_b32 v232, a94
    v_accvgpr_read_b32 v233, a95
    v_mul_f32 v232, v232, v234
    v_mul_f32 v233, v233, v234
    v_accvgpr_write_b32 a94, v232
    v_accvgpr_write_b32 a95, v233
    v_accvgpr_read_b32 v232, a96
    v_accvgpr_read_b32 v233, a97
    v_mul_f32 v232, v232, v234
    v_mul_f32 v233, v233, v234
    v_accvgpr_write_b32 a96, v232
    v_accvgpr_write_b32 a97, v233
    v_accvgpr_read_b32 v232, a98
    v_accvgpr_read_b32 v233, a99
    v_mul_f32 v232, v232, v234
    v_mul_f32 v233, v233, v234
    v_accvgpr_write_b32 a98, v232
    v_accvgpr_write_b32 a99, v233
    v_accvgpr_read_b32 v232, a100
    v_accvgpr_read_b32 v233, a101
    v_mul_f32 v232, v232, v234
    v_mul_f32 v233, v233, v234
    v_accvgpr_write_b32 a100, v232
    v_accvgpr_write_b32 a101, v233
    v_accvgpr_read_b32 v232, a102
    v_accvgpr_read_b32 v233, a103
    v_mul_f32 v232, v232, v234
    v_mul_f32 v233, v233, v234
    v_accvgpr_write_b32 a102, v232
    v_accvgpr_write_b32 a103, v233
    v_accvgpr_read_b32 v232, a104
    v_accvgpr_read_b32 v233, a105
    v_mul_f32 v232, v232, v234
    v_mul_f32 v233, v233, v234
    v_accvgpr_write_b32 a104, v232
    v_accvgpr_write_b32 a105, v233
    v_accvgpr_read_b32 v232, a106
    v_accvgpr_read_b32 v233, a107
    v_mul_f32 v232, v232, v234
    v_mul_f32 v233, v233, v234
    v_accvgpr_write_b32 a106, v232
    v_accvgpr_write_b32 a107, v233
    v_accvgpr_read_b32 v232, a108
    v_accvgpr_read_b32 v233, a109
    v_mul_f32 v232, v232, v234
    v_mul_f32 v233, v233, v234
    v_accvgpr_write_b32 a108, v232
    v_accvgpr_write_b32 a109, v233
    v_accvgpr_read_b32 v232, a110
    v_accvgpr_read_b32 v233, a111
    v_mul_f32 v232, v232, v234
    v_mul_f32 v233, v233, v234
    v_accvgpr_write_b32 a110, v232
    v_accvgpr_write_b32 a111, v233
    v_accvgpr_read_b32 v232, a112
    v_accvgpr_read_b32 v233, a113
    v_mul_f32 v232, v232, v234
    v_mul_f32 v233, v233, v234
    v_accvgpr_write_b32 a112, v232
    v_accvgpr_write_b32 a113, v233
    v_accvgpr_read_b32 v232, a114
    v_accvgpr_read_b32 v233, a115
    v_mul_f32 v232, v232, v234
    v_mul_f32 v233, v233, v234
    v_accvgpr_write_b32 a114, v232
    v_accvgpr_write_b32 a115, v233
    v_accvgpr_read_b32 v232, a116
    v_accvgpr_read_b32 v233, a117
    v_mul_f32 v232, v232, v234
    v_mul_f32 v233, v233, v234
    v_accvgpr_write_b32 a116, v232
    v_accvgpr_write_b32 a117, v233
    v_accvgpr_read_b32 v232, a118
    v_accvgpr_read_b32 v233, a119
    v_mul_f32 v232, v232, v234
    v_mul_f32 v233, v233, v234
    v_accvgpr_write_b32 a118, v232
    v_accvgpr_write_b32 a119, v233
    v_accvgpr_read_b32 v232, a120
    v_accvgpr_read_b32 v233, a121
    v_mul_f32 v232, v232, v234
    v_mul_f32 v233, v233, v234
    v_accvgpr_write_b32 a120, v232
    v_accvgpr_write_b32 a121, v233
    v_accvgpr_read_b32 v232, a122
    v_accvgpr_read_b32 v233, a123
    v_mul_f32 v232, v232, v234
    v_mul_f32 v233, v233, v234
    v_accvgpr_write_b32 a122, v232
    v_accvgpr_write_b32 a123, v233
    v_accvgpr_read_b32 v232, a124
    v_accvgpr_read_b32 v233, a125
    v_mul_f32 v232, v232, v234
    v_mul_f32 v233, v233, v234
    v_accvgpr_write_b32 a124, v232
    v_accvgpr_write_b32 a125, v233
    v_accvgpr_read_b32 v232, a126
    v_accvgpr_read_b32 v233, a127
    v_mul_f32 v232, v232, v234
    v_mul_f32 v233, v233, v234
    v_accvgpr_write_b32 a126, v232
    v_accvgpr_write_b32 a127, v233
    v_exp_f32 v136, v136
    v_exp_f32 v137, v137
    v_exp_f32 v138, v138
    v_exp_f32 v139, v139
    v_exp_f32 v236, v236
    v_exp_f32 v237, v237
    v_exp_f32 v238, v238
    v_exp_f32 v239, v239
    s_nop 0
    v_add_f32 v229, v229, v136
    v_add_f32 v229, v229, v137
    v_add_f32 v229, v229, v138
    v_add_f32 v229, v229, v139
    v_add_f32 v229, v229, v236
    v_add_f32 v229, v229, v237
    v_add_f32 v229, v229, v238
    v_add_f32 v229, v229, v239
    v_cvt_pk_bf16_f32 v136, v136, v137
    v_cvt_pk_bf16_f32 v137, v138, v139
    v_cvt_pk_bf16_f32 v138, v236, v237
    v_cvt_pk_bf16_f32 v139, v238, v239
    ds_read_b128 v[232:235], v224 offset:34816
    s_waitcnt lgkmcnt(0)
    v_mfma_f32_16x16x32_bf16 v[144:147], v[232:235], v[64:67], v[248:251]
    s_nop 7
    ds_read_b128 v[232:235], v224 offset:34880
    s_waitcnt lgkmcnt(0)
    v_mfma_f32_16x16x32_bf16 v[144:147], v[232:235], v[68:71], v[144:147]
    s_nop 7
    ds_read_b128 v[232:235], v224 offset:34944
    s_waitcnt lgkmcnt(0)
    v_mfma_f32_16x16x32_bf16 v[144:147], v[232:235], v[72:75], v[144:147]
    s_nop 7
    ds_read_b128 v[232:235], v224 offset:35008
    s_waitcnt lgkmcnt(0)
    v_mfma_f32_16x16x32_bf16 v[144:147], v[232:235], v[76:79], v[144:147]
    s_nop 7
    ds_read_b128 v[232:235], v224 offset:35072
    s_waitcnt lgkmcnt(0)
    v_mfma_f32_16x16x32_bf16 v[144:147], v[232:235], v[80:83], v[144:147]
    s_nop 7
    ds_read_b128 v[232:235], v224 offset:35136
    s_waitcnt lgkmcnt(0)
    v_mfma_f32_16x16x32_bf16 v[144:147], v[232:235], v[84:87], v[144:147]
    s_nop 7
    ds_read_b128 v[232:235], v224 offset:35200
    s_waitcnt lgkmcnt(0)
    v_mfma_f32_16x16x32_bf16 v[144:147], v[232:235], v[88:91], v[144:147]
    s_nop 7
    ds_read_b128 v[232:235], v224 offset:35264
    s_waitcnt lgkmcnt(0)
    v_mfma_f32_16x16x32_bf16 v[144:147], v[232:235], v[92:95], v[144:147]
    s_nop 7
    ds_read_b128 v[232:235], v224 offset:43520
    s_waitcnt lgkmcnt(0)
    v_mfma_f32_16x16x32_bf16 v[236:239], v[232:235], v[64:67], v[248:251]
    s_nop 7
    ds_read_b128 v[232:235], v224 offset:43584
    s_waitcnt lgkmcnt(0)
    v_mfma_f32_16x16x32_bf16 v[236:239], v[232:235], v[68:71], v[236:239]
    s_nop 7
    ds_read_b128 v[232:235], v224 offset:43648
    s_waitcnt lgkmcnt(0)
    v_mfma_f32_16x16x32_bf16 v[236:239], v[232:235], v[72:75], v[236:239]
    s_nop 7
    ds_read_b128 v[232:235], v224 offset:43712
    s_waitcnt lgkmcnt(0)
    v_mfma_f32_16x16x32_bf16 v[236:239], v[232:235], v[76:79], v[236:239]
    s_nop 7
    ds_read_b128 v[232:235], v224 offset:43776
    s_waitcnt lgkmcnt(0)
    v_mfma_f32_16x16x32_bf16 v[236:239], v[232:235], v[80:83], v[236:239]
    s_nop 7
    ds_read_b128 v[232:235], v224 offset:43840
    s_waitcnt lgkmcnt(0)
    v_mfma_f32_16x16x32_bf16 v[236:239], v[232:235], v[84:87], v[236:239]
    s_nop 7
    ds_read_b128 v[232:235], v224 offset:43904
    s_waitcnt lgkmcnt(0)
    v_mfma_f32_16x16x32_bf16 v[236:239], v[232:235], v[88:91], v[236:239]
    s_nop 7
    ds_read_b128 v[232:235], v224 offset:43968
    s_waitcnt lgkmcnt(0)
    v_mfma_f32_16x16x32_bf16 v[236:239], v[232:235], v[92:95], v[236:239]
    s_nop 7
    s_nop 3
    v_max3_f32 v232, v144, v145, v146
    v_max3_f32 v232, v232, v147, v236
    v_max3_f32 v232, v232, v237, v238
    v_max_f32 v232, v232, v239
    v_mov_b32 v233, v232
    s_nop 1
    v_permlane16_swap_b32 v232, v233
    s_nop 1
    v_max_f32 v232, v232, v233
    v_mov_b32 v233, v232
    s_nop 1
    v_permlane32_swap_b32 v232, v233
    s_nop 1
    v_max_f32 v232, v232, v233
    v_ceil_f32 v232, v232
    v_max_f32 v232, 0, v232
    v_sub_f32 v248, v248, v232
    v_sub_f32 v249, v249, v232
    v_sub_f32 v250, v250, v232
    v_sub_f32 v251, v251, v232
    v_sub_f32 v144, v144, v232
    v_sub_f32 v145, v145, v232
    v_sub_f32 v146, v146, v232
    v_sub_f32 v147, v147, v232
    v_sub_f32 v236, v236, v232
    v_sub_f32 v237, v237, v232
    v_sub_f32 v238, v238, v232
    v_sub_f32 v239, v239, v232
    v_sub_f32 v148, v148, v232
    v_sub_f32 v149, v149, v232
    v_sub_f32 v150, v150, v232
    v_sub_f32 v151, v151, v232
    v_sub_f32 v180, v180, v232
    v_sub_f32 v181, v181, v232
    v_sub_f32 v182, v182, v232
    v_sub_f32 v183, v183, v232
    v_min_f32 v233, 0x43480000, v232
    v_cvt_i32_f32 v233, v233
    v_sub_u32 v233, 0, v233
    v_ldexp_f32 v234, 1.0, v233
    v_mul_f32 v230, v230, v234
    v_lshlrev_b32 v232, 16, v176
    v_and_b32 v233, 0xffff0000, v176
    v_mul_f32 v232, v232, v234
    v_mul_f32 v233, v233, v234
    v_cvt_pk_bf16_f32 v176, v232, v233
    v_lshlrev_b32 v232, 16, v177
    v_and_b32 v233, 0xffff0000, v177
    v_mul_f32 v232, v232, v234
    v_mul_f32 v233, v233, v234
    v_cvt_pk_bf16_f32 v177, v232, v233
    v_lshlrev_b32 v232, 16, v178
    v_and_b32 v233, 0xffff0000, v178
    v_mul_f32 v232, v232, v234
    v_mul_f32 v233, v233, v234
    v_cvt_pk_bf16_f32 v178, v232, v233
    v_lshlrev_b32 v232, 16, v179
    v_and_b32 v233, 0xffff0000, v179
    v_mul_f32 v232, v232, v234
    v_mul_f32 v233, v233, v234
    v_cvt_pk_bf16_f32 v179, v232, v233
    v_accvgpr_read_b32 v232, a128
    v_accvgpr_read_b32 v233, a129
    v_mul_f32 v232, v232, v234
    v_mul_f32 v233, v233, v234
    v_accvgpr_write_b32 a128, v232
    v_accvgpr_write_b32 a129, v233
    v_accvgpr_read_b32 v232, a130
    v_accvgpr_read_b32 v233, a131
    v_mul_f32 v232, v232, v234
    v_mul_f32 v233, v233, v234
    v_accvgpr_write_b32 a130, v232
    v_accvgpr_write_b32 a131, v233
    v_accvgpr_read_b32 v232, a132
    v_accvgpr_read_b32 v233, a133
    v_mul_f32 v232, v232, v234
    v_mul_f32 v233, v233, v234
    v_accvgpr_write_b32 a132, v232
    v_accvgpr_write_b32 a133, v233
    v_accvgpr_read_b32 v232, a134
    v_accvgpr_read_b32 v233, a135
    v_mul_f32 v232, v232, v234
    v_mul_f32 v233, v233, v234
    v_accvgpr_write_b32 a134, v232
    v_accvgpr_write_b32 a135, v233
    v_accvgpr_read_b32 v232, a136
    v_accvgpr_read_b32 v233, a137
    v_mul_f32 v232, v232, v234
    v_mul_f32 v233, v233, v234
    v_accvgpr_write_b32 a136, v232
    v_accvgpr_write_b32 a137, v233
    v_accvgpr_read_b32 v232, a138
    v_accvgpr_read_b32 v233, a139
    v_mul_f32 v232, v232, v234
    v_mul_f32 v233, v233, v234
    v_accvgpr_write_b32 a138, v232
    v_accvgpr_write_b32 a139, v233
    v_accvgpr_read_b32 v232, a140
    v_accvgpr_read_b32 v233, a141
    v_mul_f32 v232, v232, v234
    v_mul_f32 v233, v233, v234
    v_accvgpr_write_b32 a140, v232
    v_accvgpr_write_b32 a141, v233
    v_accvgpr_read_b32 v232, a142
    v_accvgpr_read_b32 v233, a143
    v_mul_f32 v232, v232, v234
    v_mul_f32 v233, v233, v234
    v_accvgpr_write_b32 a142, v232
    v_accvgpr_write_b32 a143, v233
    v_accvgpr_read_b32 v232, a144
    v_accvgpr_read_b32 v233, a145
    v_mul_f32 v232, v232, v234
    v_mul_f32 v233, v233, v234
    v_accvgpr_write_b32 a144, v232
    v_accvgpr_write_b32 a145, v233
    v_accvgpr_read_b32 v232, a146
    v_accvgpr_read_b32 v233, a147
    v_mul_f32 v232, v232, v234
    v_mul_f32 v233, v233, v234
    v_accvgpr_write_b32 a146, v232
    v_accvgpr_write_b32 a147, v233
    v_accvgpr_read_b32 v232, a148
    v_accvgpr_read_b32 v233, a149
    v_mul_f32 v232, v232, v234
    v_mul_f32 v233, v233, v234
    v_accvgpr_write_b32 a148, v232
    v_accvgpr_write_b32 a149, v233
    v_accvgpr_read_b32 v232, a150
    v_accvgpr_read_b32 v233, a151
    v_mul_f32 v232, v232, v234
    v_mul_f32 v233, v233, v234
    v_accvgpr_write_b32 a150, v232
    v_accvgpr_write_b32 a151, v233
    v_accvgpr_read_b32 v232, a152
    v_accvgpr_read_b32 v233, a153
    v_mul_f32 v232, v232, v234
    v_mul_f32 v233, v233, v234
    v_accvgpr_write_b32 a152, v232
    v_accvgpr_write_b32 a153, v233
    v_accvgpr_read_b32 v232, a154
    v_accvgpr_read_b32 v233, a155
    v_mul_f32 v232, v232, v234
    v_mul_f32 v233, v233, v234
    v_accvgpr_write_b32 a154, v232
    v_accvgpr_write_b32 a155, v233
    v_accvgpr_read_b32 v232, a156
    v_accvgpr_read_b32 v233, a157
    v_mul_f32 v232, v232, v234
    v_mul_f32 v233, v233, v234
    v_accvgpr_write_b32 a156, v232
    v_accvgpr_write_b32 a157, v233
    v_accvgpr_read_b32 v232, a158
    v_accvgpr_read_b32 v233, a159
    v_mul_f32 v232, v232, v234
    v_mul_f32 v233, v233, v234
    v_accvgpr_write_b32 a158, v232
    v_accvgpr_write_b32 a159, v233
    v_accvgpr_read_b32 v232, a160
    v_accvgpr_read_b32 v233, a161
    v_mul_f32 v232, v232, v234
    v_mul_f32 v233, v233, v234
    v_accvgpr_write_b32 a160, v232
    v_accvgpr_write_b32 a161, v233
    v_accvgpr_read_b32 v232, a162
    v_accvgpr_read_b32 v233, a163
    v_mul_f32 v232, v232, v234
    v_mul_f32 v233, v233, v234
    v_accvgpr_write_b32 a162, v232
    v_accvgpr_write_b32 a163, v233
    v_accvgpr_read_b32 v232, a164
    v_accvgpr_read_b32 v233, a165
    v_mul_f32 v232, v232, v234
    v_mul_f32 v233, v233, v234
    v_accvgpr_write_b32 a164, v232
    v_accvgpr_write_b32 a165, v233
    v_accvgpr_read_b32 v232, a166
    v_accvgpr_read_b32 v233, a167
    v_mul_f32 v232, v232, v234
    v_mul_f32 v233, v233, v234
    v_accvgpr_write_b32 a166, v232
    v_accvgpr_write_b32 a167, v233
    v_accvgpr_read_b32 v232, a168
    v_accvgpr_read_b32 v233, a169
    v_mul_f32 v232, v232, v234
    v_mul_f32 v233, v233, v234
    v_accvgpr_write_b32 a168, v232
    v_accvgpr_write_b32 a169, v233
    v_accvgpr_read_b32 v232, a170
    v_accvgpr_read_b32 v233, a171
    v_mul_f32 v232, v232, v234
    v_mul_f32 v233, v233, v234
    v_accvgpr_write_b32 a170, v232
    v_accvgpr_write_b32 a171, v233
    v_accvgpr_read_b32 v232, a172
    v_accvgpr_read_b32 v233, a173
    v_mul_f32 v232, v232, v234
    v_mul_f32 v233, v233, v234
    v_accvgpr_write_b32 a172, v232
    v_accvgpr_write_b32 a173, v233
    v_accvgpr_read_b32 v232, a174
    v_accvgpr_read_b32 v233, a175
    v_mul_f32 v232, v232, v234
    v_mul_f32 v233, v233, v234
    v_accvgpr_write_b32 a174, v232
    v_accvgpr_write_b32 a175, v233
    v_accvgpr_read_b32 v232, a176
    v_accvgpr_read_b32 v233, a177
    v_mul_f32 v232, v232, v234
    v_mul_f32 v233, v233, v234
    v_accvgpr_write_b32 a176, v232
    v_accvgpr_write_b32 a177, v233
    v_accvgpr_read_b32 v232, a178
    v_accvgpr_read_b32 v233, a179
    v_mul_f32 v232, v232, v234
    v_mul_f32 v233, v233, v234
    v_accvgpr_write_b32 a178, v232
    v_accvgpr_write_b32 a179, v233
    v_accvgpr_read_b32 v232, a180
    v_accvgpr_read_b32 v233, a181
    v_mul_f32 v232, v232, v234
    v_mul_f32 v233, v233, v234
    v_accvgpr_write_b32 a180, v232
    v_accvgpr_write_b32 a181, v233
    v_accvgpr_read_b32 v232, a182
    v_accvgpr_read_b32 v233, a183
    v_mul_f32 v232, v232, v234
    v_mul_f32 v233, v233, v234
    v_accvgpr_write_b32 a182, v232
    v_accvgpr_write_b32 a183, v233
    v_accvgpr_read_b32 v232, a184
    v_accvgpr_read_b32 v233, a185
    v_mul_f32 v232, v232, v234
    v_mul_f32 v233, v233, v234
    v_accvgpr_write_b32 a184, v232
    v_accvgpr_write_b32 a185, v233
    v_accvgpr_read_b32 v232, a186
    v_accvgpr_read_b32 v233, a187
    v_mul_f32 v232, v232, v234
    v_mul_f32 v233, v233, v234
    v_accvgpr_write_b32 a186, v232
    v_accvgpr_write_b32 a187, v233
    v_accvgpr_read_b32 v232, a188
    v_accvgpr_read_b32 v233, a189
    v_mul_f32 v232, v232, v234
    v_mul_f32 v233, v233, v234
    v_accvgpr_write_b32 a188, v232
    v_accvgpr_write_b32 a189, v233
    v_accvgpr_read_b32 v232, a190
    v_accvgpr_read_b32 v233, a191
    v_mul_f32 v232, v232, v234
    v_mul_f32 v233, v233, v234
    v_accvgpr_write_b32 a190, v232
    v_accvgpr_write_b32 a191, v233
    v_exp_f32 v144, v144
    v_exp_f32 v145, v145
    v_exp_f32 v146, v146
    v_exp_f32 v147, v147
    v_exp_f32 v236, v236
    v_exp_f32 v237, v237
    v_exp_f32 v238, v238
    v_exp_f32 v239, v239
    s_nop 0
    v_add_f32 v230, v230, v144
    v_add_f32 v230, v230, v145
    v_add_f32 v230, v230, v146
    v_add_f32 v230, v230, v147
    v_add_f32 v230, v230, v236
    v_add_f32 v230, v230, v237
    v_add_f32 v230, v230, v238
    v_add_f32 v230, v230, v239
    v_cvt_pk_bf16_f32 v144, v144, v145
    v_cvt_pk_bf16_f32 v145, v146, v147
    v_cvt_pk_bf16_f32 v146, v236, v237
    v_cvt_pk_bf16_f32 v147, v238, v239
    ds_read_b128 v[232:235], v224 offset:34816
    s_waitcnt lgkmcnt(0)
    v_mfma_f32_16x16x32_bf16 v[152:155], v[232:235], v[96:99], v[252:255]
    s_nop 7
    ds_read_b128 v[232:235], v224 offset:34880
    s_waitcnt lgkmcnt(0)
    v_mfma_f32_16x16x32_bf16 v[152:155], v[232:235], v[100:103], v[152:155]
    s_nop 7
    ds_read_b128 v[232:235], v224 offset:34944
    s_waitcnt lgkmcnt(0)
    v_mfma_f32_16x16x32_bf16 v[152:155], v[232:235], v[104:107], v[152:155]
    s_nop 7
    ds_read_b128 v[232:235], v224 offset:35008
    s_waitcnt lgkmcnt(0)
    v_mfma_f32_16x16x32_bf16 v[152:155], v[232:235], v[108:111], v[152:155]
    s_nop 7
    ds_read_b128 v[232:235], v224 offset:35072
    s_waitcnt lgkmcnt(0)
    v_mfma_f32_16x16x32_bf16 v[152:155], v[232:235], v[112:115], v[152:155]
    s_nop 7
    ds_read_b128 v[232:235], v224 offset:35136
    s_waitcnt lgkmcnt(0)
    v_mfma_f32_16x16x32_bf16 v[152:155], v[232:235], v[116:119], v[152:155]
    s_nop 7
    ds_read_b128 v[232:235], v224 offset:35200
    s_waitcnt lgkmcnt(0)
    v_mfma_f32_16x16x32_bf16 v[152:155], v[232:235], v[120:123], v[152:155]
    s_nop 7
    ds_read_b128 v[232:235], v224 offset:35264
    s_waitcnt lgkmcnt(0)
    v_mfma_f32_16x16x32_bf16 v[152:155], v[232:235], v[124:127], v[152:155]
    s_nop 7
    ds_read_b128 v[232:235], v224 offset:43520
    s_waitcnt lgkmcnt(0)
    v_mfma_f32_16x16x32_bf16 v[236:239], v[232:235], v[96:99], v[252:255]
    s_nop 7
    ds_read_b128 v[232:235], v224 offset:43584
    s_waitcnt lgkmcnt(0)
    v_mfma_f32_16x16x32_bf16 v[236:239], v[232:235], v[100:103], v[236:239]
    s_nop 7
    ds_read_b128 v[232:235], v224 offset:43648
    s_waitcnt lgkmcnt(0)
    v_mfma_f32_16x16x32_bf16 v[236:239], v[232:235], v[104:107], v[236:239]
    s_nop 7
    ds_read_b128 v[232:235], v224 offset:43712
    s_waitcnt lgkmcnt(0)
    v_mfma_f32_16x16x32_bf16 v[236:239], v[232:235], v[108:111], v[236:239]
    s_nop 7
    ds_read_b128 v[232:235], v224 offset:43776
    s_waitcnt lgkmcnt(0)
    v_mfma_f32_16x16x32_bf16 v[236:239], v[232:235], v[112:115], v[236:239]
    s_nop 7
    ds_read_b128 v[232:235], v224 offset:43840
    s_waitcnt lgkmcnt(0)
    v_mfma_f32_16x16x32_bf16 v[236:239], v[232:235], v[116:119], v[236:239]
    s_nop 7
    ds_read_b128 v[232:235], v224 offset:43904
    s_waitcnt lgkmcnt(0)
    v_mfma_f32_16x16x32_bf16 v[236:239], v[232:235], v[120:123], v[236:239]
    s_nop 7
    ds_read_b128 v[232:235], v224 offset:43968
    s_waitcnt lgkmcnt(0)
    v_mfma_f32_16x16x32_bf16 v[236:239], v[232:235], v[124:127], v[236:239]
    s_nop 7
    s_nop 3
    v_max3_f32 v232, v152, v153, v154
    v_max3_f32 v232, v232, v155, v236
    v_max3_f32 v232, v232, v237, v238
    v_max_f32 v232, v232, v239
    v_mov_b32 v233, v232
    s_nop 1
    v_permlane16_swap_b32 v232, v233
    s_nop 1
    v_max_f32 v232, v232, v233
    v_mov_b32 v233, v232
    s_nop 1
    v_permlane32_swap_b32 v232, v233
    s_nop 1
    v_max_f32 v232, v232, v233
    v_ceil_f32 v232, v232
    v_max_f32 v232, 0, v232
    v_sub_f32 v252, v252, v232
    v_sub_f32 v253, v253, v232
    v_sub_f32 v254, v254, v232
    v_sub_f32 v255, v255, v232
    v_sub_f32 v152, v152, v232
    v_sub_f32 v153, v153, v232
    v_sub_f32 v154, v154, v232
    v_sub_f32 v155, v155, v232
    v_sub_f32 v236, v236, v232
    v_sub_f32 v237, v237, v232
    v_sub_f32 v238, v238, v232
    v_sub_f32 v239, v239, v232
    v_sub_f32 v156, v156, v232
    v_sub_f32 v157, v157, v232
    v_sub_f32 v158, v158, v232
    v_sub_f32 v159, v159, v232
    v_sub_f32 v188, v188, v232
    v_sub_f32 v189, v189, v232
    v_sub_f32 v190, v190, v232
    v_sub_f32 v191, v191, v232
    v_min_f32 v233, 0x43480000, v232
    v_cvt_i32_f32 v233, v233
    v_sub_u32 v233, 0, v233
    v_ldexp_f32 v234, 1.0, v233
    v_mul_f32 v231, v231, v234
    v_lshlrev_b32 v232, 16, v184
    v_and_b32 v233, 0xffff0000, v184
    v_mul_f32 v232, v232, v234
    v_mul_f32 v233, v233, v234
    v_cvt_pk_bf16_f32 v184, v232, v233
    v_lshlrev_b32 v232, 16, v185
    v_and_b32 v233, 0xffff0000, v185
    v_mul_f32 v232, v232, v234
    v_mul_f32 v233, v233, v234
    v_cvt_pk_bf16_f32 v185, v232, v233
    v_lshlrev_b32 v232, 16, v186
    v_and_b32 v233, 0xffff0000, v186
    v_mul_f32 v232, v232, v234
    v_mul_f32 v233, v233, v234
    v_cvt_pk_bf16_f32 v186, v232, v233
    v_lshlrev_b32 v232, 16, v187
    v_and_b32 v233, 0xffff0000, v187
    v_mul_f32 v232, v232, v234
    v_mul_f32 v233, v233, v234
    v_cvt_pk_bf16_f32 v187, v232, v233
    v_accvgpr_read_b32 v232, a192
    v_accvgpr_read_b32 v233, a193
    v_mul_f32 v232, v232, v234
    v_mul_f32 v233, v233, v234
    v_accvgpr_write_b32 a192, v232
    v_accvgpr_write_b32 a193, v233
    v_accvgpr_read_b32 v232, a194
    v_accvgpr_read_b32 v233, a195
    v_mul_f32 v232, v232, v234
    v_mul_f32 v233, v233, v234
    v_accvgpr_write_b32 a194, v232
    v_accvgpr_write_b32 a195, v233
    v_accvgpr_read_b32 v232, a196
    v_accvgpr_read_b32 v233, a197
    v_mul_f32 v232, v232, v234
    v_mul_f32 v233, v233, v234
    v_accvgpr_write_b32 a196, v232
    v_accvgpr_write_b32 a197, v233
    v_accvgpr_read_b32 v232, a198
    v_accvgpr_read_b32 v233, a199
    v_mul_f32 v232, v232, v234
    v_mul_f32 v233, v233, v234
    v_accvgpr_write_b32 a198, v232
    v_accvgpr_write_b32 a199, v233
    v_accvgpr_read_b32 v232, a200
    v_accvgpr_read_b32 v233, a201
    v_mul_f32 v232, v232, v234
    v_mul_f32 v233, v233, v234
    v_accvgpr_write_b32 a200, v232
    v_accvgpr_write_b32 a201, v233
    v_accvgpr_read_b32 v232, a202
    v_accvgpr_read_b32 v233, a203
    v_mul_f32 v232, v232, v234
    v_mul_f32 v233, v233, v234
    v_accvgpr_write_b32 a202, v232
    v_accvgpr_write_b32 a203, v233
    v_accvgpr_read_b32 v232, a204
    v_accvgpr_read_b32 v233, a205
    v_mul_f32 v232, v232, v234
    v_mul_f32 v233, v233, v234
    v_accvgpr_write_b32 a204, v232
    v_accvgpr_write_b32 a205, v233
    v_accvgpr_read_b32 v232, a206
    v_accvgpr_read_b32 v233, a207
    v_mul_f32 v232, v232, v234
    v_mul_f32 v233, v233, v234
    v_accvgpr_write_b32 a206, v232
    v_accvgpr_write_b32 a207, v233
    v_accvgpr_read_b32 v232, a208
    v_accvgpr_read_b32 v233, a209
    v_mul_f32 v232, v232, v234
    v_mul_f32 v233, v233, v234
    v_accvgpr_write_b32 a208, v232
    v_accvgpr_write_b32 a209, v233
    v_accvgpr_read_b32 v232, a210
    v_accvgpr_read_b32 v233, a211
    v_mul_f32 v232, v232, v234
    v_mul_f32 v233, v233, v234
    v_accvgpr_write_b32 a210, v232
    v_accvgpr_write_b32 a211, v233
    v_accvgpr_read_b32 v232, a212
    v_accvgpr_read_b32 v233, a213
    v_mul_f32 v232, v232, v234
    v_mul_f32 v233, v233, v234
    v_accvgpr_write_b32 a212, v232
    v_accvgpr_write_b32 a213, v233
    v_accvgpr_read_b32 v232, a214
    v_accvgpr_read_b32 v233, a215
    v_mul_f32 v232, v232, v234
    v_mul_f32 v233, v233, v234
    v_accvgpr_write_b32 a214, v232
    v_accvgpr_write_b32 a215, v233
    v_accvgpr_read_b32 v232, a216
    v_accvgpr_read_b32 v233, a217
    v_mul_f32 v232, v232, v234
    v_mul_f32 v233, v233, v234
    v_accvgpr_write_b32 a216, v232
    v_accvgpr_write_b32 a217, v233
    v_accvgpr_read_b32 v232, a218
    v_accvgpr_read_b32 v233, a219
    v_mul_f32 v232, v232, v234
    v_mul_f32 v233, v233, v234
    v_accvgpr_write_b32 a218, v232
    v_accvgpr_write_b32 a219, v233
    v_accvgpr_read_b32 v232, a220
    v_accvgpr_read_b32 v233, a221
    v_mul_f32 v232, v232, v234
    v_mul_f32 v233, v233, v234
    v_accvgpr_write_b32 a220, v232
    v_accvgpr_write_b32 a221, v233
    v_accvgpr_read_b32 v232, a222
    v_accvgpr_read_b32 v233, a223
    v_mul_f32 v232, v232, v234
    v_mul_f32 v233, v233, v234
    v_accvgpr_write_b32 a222, v232
    v_accvgpr_write_b32 a223, v233
    v_accvgpr_read_b32 v232, a224
    v_accvgpr_read_b32 v233, a225
    v_mul_f32 v232, v232, v234
    v_mul_f32 v233, v233, v234
    v_accvgpr_write_b32 a224, v232
    v_accvgpr_write_b32 a225, v233
    v_accvgpr_read_b32 v232, a226
    v_accvgpr_read_b32 v233, a227
    v_mul_f32 v232, v232, v234
    v_mul_f32 v233, v233, v234
    v_accvgpr_write_b32 a226, v232
    v_accvgpr_write_b32 a227, v233
    v_accvgpr_read_b32 v232, a228
    v_accvgpr_read_b32 v233, a229
    v_mul_f32 v232, v232, v234
    v_mul_f32 v233, v233, v234
    v_accvgpr_write_b32 a228, v232
    v_accvgpr_write_b32 a229, v233
    v_accvgpr_read_b32 v232, a230
    v_accvgpr_read_b32 v233, a231
    v_mul_f32 v232, v232, v234
    v_mul_f32 v233, v233, v234
    v_accvgpr_write_b32 a230, v232
    v_accvgpr_write_b32 a231, v233
    v_accvgpr_read_b32 v232, a232
    v_accvgpr_read_b32 v233, a233
    v_mul_f32 v232, v232, v234
    v_mul_f32 v233, v233, v234
    v_accvgpr_write_b32 a232, v232
    v_accvgpr_write_b32 a233, v233
    v_accvgpr_read_b32 v232, a234
    v_accvgpr_read_b32 v233, a235
    v_mul_f32 v232, v232, v234
    v_mul_f32 v233, v233, v234
    v_accvgpr_write_b32 a234, v232
    v_accvgpr_write_b32 a235, v233
    v_accvgpr_read_b32 v232, a236
    v_accvgpr_read_b32 v233, a237
    v_mul_f32 v232, v232, v234
    v_mul_f32 v233, v233, v234
    v_accvgpr_write_b32 a236, v232
    v_accvgpr_write_b32 a237, v233
    v_accvgpr_read_b32 v232, a238
    v_accvgpr_read_b32 v233, a239
    v_mul_f32 v232, v232, v234
    v_mul_f32 v233, v233, v234
    v_accvgpr_write_b32 a238, v232
    v_accvgpr_write_b32 a239, v233
    v_accvgpr_read_b32 v232, a240
    v_accvgpr_read_b32 v233, a241
    v_mul_f32 v232, v232, v234
    v_mul_f32 v233, v233, v234
    v_accvgpr_write_b32 a240, v232
    v_accvgpr_write_b32 a241, v233
    v_accvgpr_read_b32 v232, a242
    v_accvgpr_read_b32 v233, a243
    v_mul_f32 v232, v232, v234
    v_mul_f32 v233, v233, v234
    v_accvgpr_write_b32 a242, v232
    v_accvgpr_write_b32 a243, v233
    v_accvgpr_read_b32 v232, a244
    v_accvgpr_read_b32 v233, a245
    v_mul_f32 v232, v232, v234
    v_mul_f32 v233, v233, v234
    v_accvgpr_write_b32 a244, v232
    v_accvgpr_write_b32 a245, v233
    v_accvgpr_read_b32 v232, a246
    v_accvgpr_read_b32 v233, a247
    v_mul_f32 v232, v232, v234
    v_mul_f32 v233, v233, v234
    v_accvgpr_write_b32 a246, v232
    v_accvgpr_write_b32 a247, v233
    v_accvgpr_read_b32 v232, a248
    v_accvgpr_read_b32 v233, a249
    v_mul_f32 v232, v232, v234
    v_mul_f32 v233, v233, v234
    v_accvgpr_write_b32 a248, v232
    v_accvgpr_write_b32 a249, v233
    v_accvgpr_read_b32 v232, a250
    v_accvgpr_read_b32 v233, a251
    v_mul_f32 v232, v232, v234
    v_mul_f32 v233, v233, v234
    v_accvgpr_write_b32 a250, v232
    v_accvgpr_write_b32 a251, v233
    v_accvgpr_read_b32 v232, a252
    v_accvgpr_read_b32 v233, a253
    v_mul_f32 v232, v232, v234
    v_mul_f32 v233, v233, v234
    v_accvgpr_write_b32 a252, v232
    v_accvgpr_write_b32 a253, v233
    v_accvgpr_read_b32 v232, a254
    v_accvgpr_read_b32 v233, a255
    v_mul_f32 v232, v232, v234
    v_mul_f32 v233, v233, v234
    v_accvgpr_write_b32 a254, v232
    v_accvgpr_write_b32 a255, v233
    v_exp_f32 v152, v152
    v_exp_f32 v153, v153
    v_exp_f32 v154, v154
    v_exp_f32 v155, v155
    v_exp_f32 v236, v236
    v_exp_f32 v237, v237
    v_exp_f32 v238, v238
    v_exp_f32 v239, v239
    s_nop 0
    v_add_f32 v231, v231, v152
    v_add_f32 v231, v231, v153
    v_add_f32 v231, v231, v154
    v_add_f32 v231, v231, v155
    v_add_f32 v231, v231, v236
    v_add_f32 v231, v231, v237
    v_add_f32 v231, v231, v238
    v_add_f32 v231, v231, v239
    v_cvt_pk_bf16_f32 v152, v152, v153
    v_cvt_pk_bf16_f32 v153, v154, v155
    v_cvt_pk_bf16_f32 v154, v236, v237
    v_cvt_pk_bf16_f32 v155, v238, v239
    v_mov_b32 v232, 0
    v_mov_b32 v233, 0
    v_mov_b32 v234, 0
    v_mov_b32 v235, 0
    s_nop 1
    s_branch L_back1
L_rare2:
    s_waitcnt vmcnt(0)
    s_nop 7
    ds_read_b128 v[232:235], v224 offset:52224
    s_waitcnt lgkmcnt(0)
    v_mfma_f32_16x16x32_bf16 v[132:135], v[232:235], v[0:3], v[240:243]
    s_nop 7
    ds_read_b128 v[232:235], v224 offset:52288
    s_waitcnt lgkmcnt(0)
    v_mfma_f32_16x16x32_bf16 v[132:135], v[232:235], v[4:7], v[132:135]
    s_nop 7
    ds_read_b128 v[232:235], v224 offset:52352
    s_waitcnt lgkmcnt(0)
    v_mfma_f32_16x16x32_bf16 v[132:135], v[232:235], v[8:11], v[132:135]
    s_nop 7
    ds_read_b128 v[232:235], v224 offset:52416
    s_waitcnt lgkmcnt(0)
    v_mfma_f32_16x16x32_bf16 v[132:135], v[232:235], v[12:15], v[132:135]
    s_nop 7
    ds_read_b128 v[232:235], v224 offset:52480
    s_waitcnt lgkmcnt(0)
    v_mfma_f32_16x16x32_bf16 v[132:135], v[232:235], v[16:19], v[132:135]
    s_nop 7
    ds_read_b128 v[232:235], v224 offset:52544
    s_waitcnt lgkmcnt(0)
    v_mfma_f32_16x16x32_bf16 v[132:135], v[232:235], v[20:23], v[132:135]
    s_nop 7
    ds_read_b128 v[232:235], v224 offset:52608
    s_waitcnt lgkmcnt(0)
    v_mfma_f32_16x16x32_bf16 v[132:135], v[232:235], v[24:27], v[132:135]
    s_nop 7
    ds_read_b128 v[232:235], v224 offset:52672
    s_waitcnt lgkmcnt(0)
    v_mfma_f32_16x16x32_bf16 v[132:135], v[232:235], v[28:31], v[132:135]
    s_nop 7
    ds_read_b128 v[232:235], v224 offset:60928
    s_waitcnt lgkmcnt(0)
    v_mfma_f32_16x16x32_bf16 v[236:239], v[232:235], v[0:3], v[240:243]
    s_nop 7
    ds_read_b128 v[232:235], v224 offset:60992
    s_waitcnt lgkmcnt(0)
    v_mfma_f32_16x16x32_bf16 v[236:239], v[232:235], v[4:7], v[236:239]
    s_nop 7
    ds_read_b128 v[232:235], v224 offset:61056
    s_waitcnt lgkmcnt(0)
    v_mfma_f32_16x16x32_bf16 v[236:239], v[232:235], v[8:11], v[236:239]
    s_nop 7
    ds_read_b128 v[232:235], v224 offset:61120
    s_waitcnt lgkmcnt(0)
    v_mfma_f32_16x16x32_bf16 v[236:239], v[232:235], v[12:15], v[236:239]
    s_nop 7
    ds_read_b128 v[232:235], v224 offset:61184
    s_waitcnt lgkmcnt(0)
    v_mfma_f32_16x16x32_bf16 v[236:239], v[232:235], v[16:19], v[236:239]
    s_nop 7
    ds_read_b128 v[232:235], v224 offset:61248
    s_waitcnt lgkmcnt(0)
    v_mfma_f32_16x16x32_bf16 v[236:239], v[232:235], v[20:23], v[236:239]
    s_nop 7
    ds_read_b128 v[232:235], v224 offset:61312
    s_waitcnt lgkmcnt(0)
    v_mfma_f32_16x16x32_bf16 v[236:239], v[232:235], v[24:27], v[236:239]
    s_nop 7
    ds_read_b128 v[232:235], v224 offset:61376
    s_waitcnt lgkmcnt(0)
    v_mfma_f32_16x16x32_bf16 v[236:239], v[232:235], v[28:31], v[236:239]
    s_nop 7
    s_nop 3
    v_max3_f32 v232, v132, v133, v134
    v_max3_f32 v232, v232, v135, v236
    v_max3_f32 v232, v232, v237, v238
    v_max_f32 v232, v232, v239
    v_mov_b32 v233, v232
    s_nop 1
    v_permlane16_swap_b32 v232, v233
    s_nop 1
    v_max_f32 v232, v232, v233
    v_mov_b32 v233, v232
    s_nop 1
    v_permlane32_swap_b32 v232, v233
    s_nop 1
    v_max_f32 v232, v232, v233
    v_ceil_f32 v232, v232
    v_max_f32 v232, 0, v232
    v_sub_f32 v240, v240, v232
    v_sub_f32 v241, v241, v232
    v_sub_f32 v242, v242, v232
    v_sub_f32 v243, v243, v232
    v_sub_f32 v132, v132, v232
    v_sub_f32 v133, v133, v232
    v_sub_f32 v134, v134, v232
    v_sub_f32 v135, v135, v232
    v_sub_f32 v236, v236, v232
    v_sub_f32 v237, v237, v232
    v_sub_f32 v238, v238, v232
    v_sub_f32 v239, v239, v232
    v_sub_f32 v128, v128, v232
    v_sub_f32 v129, v129, v232
    v_sub_f32 v130, v130, v232
    v_sub_f32 v131, v131, v232
    v_sub_f32 v164, v164, v232
    v_sub_f32 v165, v165, v232
    v_sub_f32 v166, v166, v232
    v_sub_f32 v167, v167, v232
    v_min_f32 v233, 0x43480000, v232
    v_cvt_i32_f32 v233, v233
    v_sub_u32 v233, 0, v233
    v_ldexp_f32 v234, 1.0, v233
    v_mul_f32 v228, v228, v234
    v_accvgpr_read_b32 v232, a0
    v_accvgpr_read_b32 v233, a1
    v_mul_f32 v232, v232, v234
    v_mul_f32 v233, v233, v234
    v_accvgpr_write_b32 a0, v232
    v_accvgpr_write_b32 a1, v233
    v_accvgpr_read_b32 v232, a2
    v_accvgpr_read_b32 v233, a3
    v_mul_f32 v232, v232, v234
    v_mul_f32 v233, v233, v234
    v_accvgpr_write_b32 a2, v232
    v_accvgpr_write_b32 a3, v233
    v_accvgpr_read_b32 v232, a4
    v_accvgpr_read_b32 v233, a5
    v_mul_f32 v232, v232, v234
    v_mul_f32 v233, v233, v234
    v_accvgpr_write_b32 a4, v232
    v_accvgpr_write_b32 a5, v233
    v_accvgpr_read_b32 v232, a6
    v_accvgpr_read_b32 v233, a7
    v_mul_f32 v232, v232, v234
    v_mul_f32 v233, v233, v234
    v_accvgpr_write_b32 a6, v232
    v_accvgpr_write_b32 a7, v233
    v_accvgpr_read_b32 v232, a8
    v_accvgpr_read_b32 v233, a9
    v_mul_f32 v232, v232, v234
    v_mul_f32 v233, v233, v234
    v_accvgpr_write_b32 a8, v232
    v_accvgpr_write_b32 a9, v233
    v_accvgpr_read_b32 v232, a10
    v_accvgpr_read_b32 v233, a11
    v_mul_f32 v232, v232, v234
    v_mul_f32 v233, v233, v234
    v_accvgpr_write_b32 a10, v232
    v_accvgpr_write_b32 a11, v233
    v_accvgpr_read_b32 v232, a12
    v_accvgpr_read_b32 v233, a13
    v_mul_f32 v232, v232, v234
    v_mul_f32 v233, v233, v234
    v_accvgpr_write_b32 a12, v232
    v_accvgpr_write_b32 a13, v233
    v_accvgpr_read_b32 v232, a14
    v_accvgpr_read_b32 v233, a15
    v_mul_f32 v232, v232, v234
    v_mul_f32 v233, v233, v234
    v_accvgpr_write_b32 a14, v232
    v_accvgpr_write_b32 a15, v233
    v_accvgpr_read_b32 v232, a16
    v_accvgpr_read_b32 v233, a17
    v_mul_f32 v232, v232, v234
    v_mul_f32 v233, v233, v234
    v_accvgpr_write_b32 a16, v232
    v_accvgpr_write_b32 a17, v233
    v_accvgpr_read_b32 v232, a18
    v_accvgpr_read_b32 v233, a19
    v_mul_f32 v232, v232, v234
    v_mul_f32 v233, v233, v234
    v_accvgpr_write_b32 a18, v232
    v_accvgpr_write_b32 a19, v233
    v_accvgpr_read_b32 v232, a20
    v_accvgpr_read_b32 v233, a21
    v_mul_f32 v232, v232, v234
    v_mul_f32 v233, v233, v234
    v_accvgpr_write_b32 a20, v232
    v_accvgpr_write_b32 a21, v233
    v_accvgpr_read_b32 v232, a22
    v_accvgpr_read_b32 v233, a23
    v_mul_f32 v232, v232, v234
    v_mul_f32 v233, v233, v234
    v_accvgpr_write_b32 a22, v232
    v_accvgpr_write_b32 a23, v233
    v_accvgpr_read_b32 v232, a24
    v_accvgpr_read_b32 v233, a25
    v_mul_f32 v232, v232, v234
    v_mul_f32 v233, v233, v234
    v_accvgpr_write_b32 a24, v232
    v_accvgpr_write_b32 a25, v233
    v_accvgpr_read_b32 v232, a26
    v_accvgpr_read_b32 v233, a27
    v_mul_f32 v232, v232, v234
    v_mul_f32 v233, v233, v234
    v_accvgpr_write_b32 a26, v232
    v_accvgpr_write_b32 a27, v233
    v_accvgpr_read_b32 v232, a28
    v_accvgpr_read_b32 v233, a29
    v_mul_f32 v232, v232, v234
    v_mul_f32 v233, v233, v234
    v_accvgpr_write_b32 a28, v232
    v_accvgpr_write_b32 a29, v233
    v_accvgpr_read_b32 v232, a30
    v_accvgpr_read_b32 v233, a31
    v_mul_f32 v232, v232, v234
    v_mul_f32 v233, v233, v234
    v_accvgpr_write_b32 a30, v232
    v_accvgpr_write_b32 a31, v233
    v_accvgpr_read_b32 v232, a32
    v_accvgpr_read_b32 v233, a33
    v_mul_f32 v232, v232, v234
    v_mul_f32 v233, v233, v234
    v_accvgpr_write_b32 a32, v232
    v_accvgpr_write_b32 a33, v233
    v_accvgpr_read_b32 v232, a34
    v_accvgpr_read_b32 v233, a35
    v_mul_f32 v232, v232, v234
    v_mul_f32 v233, v233, v234
    v_accvgpr_write_b32 a34, v232
    v_accvgpr_write_b32 a35, v233
    v_accvgpr_read_b32 v232, a36
    v_accvgpr_read_b32 v233, a37
    v_mul_f32 v232, v232, v234
    v_mul_f32 v233, v233, v234
    v_accvgpr_write_b32 a36, v232
    v_accvgpr_write_b32 a37, v233
    v_accvgpr_read_b32 v232, a38
    v_accvgpr_read_b32 v233, a39
    v_mul_f32 v232, v232, v234
    v_mul_f32 v233, v233, v234
    v_accvgpr_write_b32 a38, v232
    v_accvgpr_write_b32 a39, v233
    v_accvgpr_read_b32 v232, a40
    v_accvgpr_read_b32 v233, a41
    v_mul_f32 v232, v232, v234
    v_mul_f32 v233, v233, v234
    v_accvgpr_write_b32 a40, v232
    v_accvgpr_write_b32 a41, v233
    v_accvgpr_read_b32 v232, a42
    v_accvgpr_read_b32 v233, a43
    v_mul_f32 v232, v232, v234
    v_mul_f32 v233, v233, v234
    v_accvgpr_write_b32 a42, v232
    v_accvgpr_write_b32 a43, v233
    v_accvgpr_read_b32 v232, a44
    v_accvgpr_read_b32 v233, a45
    v_mul_f32 v232, v232, v234
    v_mul_f32 v233, v233, v234
    v_accvgpr_write_b32 a44, v232
    v_accvgpr_write_b32 a45, v233
    v_accvgpr_read_b32 v232, a46
    v_accvgpr_read_b32 v233, a47
    v_mul_f32 v232, v232, v234
    v_mul_f32 v233, v233, v234
    v_accvgpr_write_b32 a46, v232
    v_accvgpr_write_b32 a47, v233
    v_accvgpr_read_b32 v232, a48
    v_accvgpr_read_b32 v233, a49
    v_mul_f32 v232, v232, v234
    v_mul_f32 v233, v233, v234
    v_accvgpr_write_b32 a48, v232
    v_accvgpr_write_b32 a49, v233
    v_accvgpr_read_b32 v232, a50
    v_accvgpr_read_b32 v233, a51
    v_mul_f32 v232, v232, v234
    v_mul_f32 v233, v233, v234
    v_accvgpr_write_b32 a50, v232
    v_accvgpr_write_b32 a51, v233
    v_accvgpr_read_b32 v232, a52
    v_accvgpr_read_b32 v233, a53
    v_mul_f32 v232, v232, v234
    v_mul_f32 v233, v233, v234
    v_accvgpr_write_b32 a52, v232
    v_accvgpr_write_b32 a53, v233
    v_accvgpr_read_b32 v232, a54
    v_accvgpr_read_b32 v233, a55
    v_mul_f32 v232, v232, v234
    v_mul_f32 v233, v233, v234
    v_accvgpr_write_b32 a54, v232
    v_accvgpr_write_b32 a55, v233
    v_accvgpr_read_b32 v232, a56
    v_accvgpr_read_b32 v233, a57
    v_mul_f32 v232, v232, v234
    v_mul_f32 v233, v233, v234
    v_accvgpr_write_b32 a56, v232
    v_accvgpr_write_b32 a57, v233
    v_accvgpr_read_b32 v232, a58
    v_accvgpr_read_b32 v233, a59
    v_mul_f32 v232, v232, v234
    v_mul_f32 v233, v233, v234
    v_accvgpr_write_b32 a58, v232
    v_accvgpr_write_b32 a59, v233
    v_accvgpr_read_b32 v232, a60
    v_accvgpr_read_b32 v233, a61
    v_mul_f32 v232, v232, v234
    v_mul_f32 v233, v233, v234
    v_accvgpr_write_b32 a60, v232
    v_accvgpr_write_b32 a61, v233
    v_accvgpr_read_b32 v232, a62
    v_accvgpr_read_b32 v233, a63
    v_mul_f32 v232, v232, v234
    v_mul_f32 v233, v233, v234
    v_accvgpr_write_b32 a62, v232
    v_accvgpr_write_b32 a63, v233
    v_exp_f32 v132, v132
    v_exp_f32 v133, v133
    v_exp_f32 v134, v134
    v_exp_f32 v135, v135
    v_exp_f32 v236, v236
    v_exp_f32 v237, v237
    v_exp_f32 v238, v238
    v_exp_f32 v239, v239
    s_nop 0
    v_add_f32 v228, v228, v132
    v_add_f32 v228, v228, v133
    v_add_f32 v228, v228, v134
    v_add_f32 v228, v228, v135
    v_add_f32 v228, v228, v236
    v_add_f32 v228, v228, v237
    v_add_f32 v228, v228, v238
    v_add_f32 v228, v228, v239
    v_cvt_pk_bf16_f32 v132, v132, v133
    v_cvt_pk_bf16_f32 v133, v134, v135
    v_cvt_pk_bf16_f32 v134, v236, v237
    v_cvt_pk_bf16_f32 v135, v238, v239
    ds_read_b128 v[232:235], v224 offset:52224
    s_waitcnt lgkmcnt(0)
    v_mfma_f32_16x16x32_bf16 v[140:143], v[232:235], v[32:35], v[244:247]
    s_nop 7
    ds_read_b128 v[232:235], v224 offset:52288
    s_waitcnt lgkmcnt(0)
    v_mfma_f32_16x16x32_bf16 v[140:143], v[232:235], v[36:39], v[140:143]
    s_nop 7
    ds_read_b128 v[232:235], v224 offset:52352
    s_waitcnt lgkmcnt(0)
    v_mfma_f32_16x16x32_bf16 v[140:143], v[232:235], v[40:43], v[140:143]
    s_nop 7
    ds_read_b128 v[232:235], v224 offset:52416
    s_waitcnt lgkmcnt(0)
    v_mfma_f32_16x16x32_bf16 v[140:143], v[232:235], v[44:47], v[140:143]
    s_nop 7
    ds_read_b128 v[232:235], v224 offset:52480
    s_waitcnt lgkmcnt(0)
    v_mfma_f32_16x16x32_bf16 v[140:143], v[232:235], v[48:51], v[140:143]
    s_nop 7
    ds_read_b128 v[232:235], v224 offset:52544
    s_waitcnt lgkmcnt(0)
    v_mfma_f32_16x16x32_bf16 v[140:143], v[232:235], v[52:55], v[140:143]
    s_nop 7
    ds_read_b128 v[232:235], v224 offset:52608
    s_waitcnt lgkmcnt(0)
    v_mfma_f32_16x16x32_bf16 v[140:143], v[232:235], v[56:59], v[140:143]
    s_nop 7
    ds_read_b128 v[232:235], v224 offset:52672
    s_waitcnt lgkmcnt(0)
    v_mfma_f32_16x16x32_bf16 v[140:143], v[232:235], v[60:63], v[140:143]
    s_nop 7
    ds_read_b128 v[232:235], v224 offset:60928
    s_waitcnt lgkmcnt(0)
    v_mfma_f32_16x16x32_bf16 v[236:239], v[232:235], v[32:35], v[244:247]
    s_nop 7
    ds_read_b128 v[232:235], v224 offset:60992
    s_waitcnt lgkmcnt(0)
    v_mfma_f32_16x16x32_bf16 v[236:239], v[232:235], v[36:39], v[236:239]
    s_nop 7
    ds_read_b128 v[232:235], v224 offset:61056
    s_waitcnt lgkmcnt(0)
    v_mfma_f32_16x16x32_bf16 v[236:239], v[232:235], v[40:43], v[236:239]
    s_nop 7
    ds_read_b128 v[232:235], v224 offset:61120
    s_waitcnt lgkmcnt(0)
    v_mfma_f32_16x16x32_bf16 v[236:239], v[232:235], v[44:47], v[236:239]
    s_nop 7
    ds_read_b128 v[232:235], v224 offset:61184
    s_waitcnt lgkmcnt(0)
    v_mfma_f32_16x16x32_bf16 v[236:239], v[232:235], v[48:51], v[236:239]
    s_nop 7
    ds_read_b128 v[232:235], v224 offset:61248
    s_waitcnt lgkmcnt(0)
    v_mfma_f32_16x16x32_bf16 v[236:239], v[232:235], v[52:55], v[236:239]
    s_nop 7
    ds_read_b128 v[232:235], v224 offset:61312
    s_waitcnt lgkmcnt(0)
    v_mfma_f32_16x16x32_bf16 v[236:239], v[232:235], v[56:59], v[236:239]
    s_nop 7
    ds_read_b128 v[232:235], v224 offset:61376
    s_waitcnt lgkmcnt(0)
    v_mfma_f32_16x16x32_bf16 v[236:239], v[232:235], v[60:63], v[236:239]
    s_nop 7
    s_nop 3
    v_max3_f32 v232, v140, v141, v142
    v_max3_f32 v232, v232, v143, v236
    v_max3_f32 v232, v232, v237, v238
    v_max_f32 v232, v232, v239
    v_mov_b32 v233, v232
    s_nop 1
    v_permlane16_swap_b32 v232, v233
    s_nop 1
    v_max_f32 v232, v232, v233
    v_mov_b32 v233, v232
    s_nop 1
    v_permlane32_swap_b32 v232, v233
    s_nop 1
    v_max_f32 v232, v232, v233
    v_ceil_f32 v232, v232
    v_max_f32 v232, 0, v232
    v_sub_f32 v244, v244, v232
    v_sub_f32 v245, v245, v232
    v_sub_f32 v246, v246, v232
    v_sub_f32 v247, v247, v232
    v_sub_f32 v140, v140, v232
    v_sub_f32 v141, v141, v232
    v_sub_f32 v142, v142, v232
    v_sub_f32 v143, v143, v232
    v_sub_f32 v236, v236, v232
    v_sub_f32 v237, v237, v232
    v_sub_f32 v238, v238, v232
    v_sub_f32 v239, v239, v232
    v_sub_f32 v136, v136, v232
    v_sub_f32 v137, v137, v232
    v_sub_f32 v138, v138, v232
    v_sub_f32 v139, v139, v232
    v_sub_f32 v172, v172, v232
    v_sub_f32 v173, v173, v232
    v_sub_f32 v174, v174, v232
    v_sub_f32 v175, v175, v232
    v_min_f32 v233, 0x43480000, v232
    v_cvt_i32_f32 v233, v233
    v_sub_u32 v233, 0, v233
    v_ldexp_f32 v234, 1.0, v233
    v_mul_f32 v229, v229, v234
    v_accvgpr_read_b32 v232, a64
    v_accvgpr_read_b32 v233, a65
    v_mul_f32 v232, v232, v234
    v_mul_f32 v233, v233, v234
    v_accvgpr_write_b32 a64, v232
    v_accvgpr_write_b32 a65, v233
    v_accvgpr_read_b32 v232, a66
    v_accvgpr_read_b32 v233, a67
    v_mul_f32 v232, v232, v234
    v_mul_f32 v233, v233, v234
    v_accvgpr_write_b32 a66, v232
    v_accvgpr_write_b32 a67, v233
    v_accvgpr_read_b32 v232, a68
    v_accvgpr_read_b32 v233, a69
    v_mul_f32 v232, v232, v234
    v_mul_f32 v233, v233, v234
    v_accvgpr_write_b32 a68, v232
    v_accvgpr_write_b32 a69, v233
    v_accvgpr_read_b32 v232, a70
    v_accvgpr_read_b32 v233, a71
    v_mul_f32 v232, v232, v234
    v_mul_f32 v233, v233, v234
    v_accvgpr_write_b32 a70, v232
    v_accvgpr_write_b32 a71, v233
    v_accvgpr_read_b32 v232, a72
    v_accvgpr_read_b32 v233, a73
    v_mul_f32 v232, v232, v234
    v_mul_f32 v233, v233, v234
    v_accvgpr_write_b32 a72, v232
    v_accvgpr_write_b32 a73, v233
    v_accvgpr_read_b32 v232, a74
    v_accvgpr_read_b32 v233, a75
    v_mul_f32 v232, v232, v234
    v_mul_f32 v233, v233, v234
    v_accvgpr_write_b32 a74, v232
    v_accvgpr_write_b32 a75, v233
    v_accvgpr_read_b32 v232, a76
    v_accvgpr_read_b32 v233, a77
    v_mul_f32 v232, v232, v234
    v_mul_f32 v233, v233, v234
    v_accvgpr_write_b32 a76, v232
    v_accvgpr_write_b32 a77, v233
    v_accvgpr_read_b32 v232, a78
    v_accvgpr_read_b32 v233, a79
    v_mul_f32 v232, v232, v234
    v_mul_f32 v233, v233, v234
    v_accvgpr_write_b32 a78, v232
    v_accvgpr_write_b32 a79, v233
    v_accvgpr_read_b32 v232, a80
    v_accvgpr_read_b32 v233, a81
    v_mul_f32 v232, v232, v234
    v_mul_f32 v233, v233, v234
    v_accvgpr_write_b32 a80, v232
    v_accvgpr_write_b32 a81, v233
    v_accvgpr_read_b32 v232, a82
    v_accvgpr_read_b32 v233, a83
    v_mul_f32 v232, v232, v234
    v_mul_f32 v233, v233, v234
    v_accvgpr_write_b32 a82, v232
    v_accvgpr_write_b32 a83, v233
    v_accvgpr_read_b32 v232, a84
    v_accvgpr_read_b32 v233, a85
    v_mul_f32 v232, v232, v234
    v_mul_f32 v233, v233, v234
    v_accvgpr_write_b32 a84, v232
    v_accvgpr_write_b32 a85, v233
    v_accvgpr_read_b32 v232, a86
    v_accvgpr_read_b32 v233, a87
    v_mul_f32 v232, v232, v234
    v_mul_f32 v233, v233, v234
    v_accvgpr_write_b32 a86, v232
    v_accvgpr_write_b32 a87, v233
    v_accvgpr_read_b32 v232, a88
    v_accvgpr_read_b32 v233, a89
    v_mul_f32 v232, v232, v234
    v_mul_f32 v233, v233, v234
    v_accvgpr_write_b32 a88, v232
    v_accvgpr_write_b32 a89, v233
    v_accvgpr_read_b32 v232, a90
    v_accvgpr_read_b32 v233, a91
    v_mul_f32 v232, v232, v234
    v_mul_f32 v233, v233, v234
    v_accvgpr_write_b32 a90, v232
    v_accvgpr_write_b32 a91, v233
    v_accvgpr_read_b32 v232, a92
    v_accvgpr_read_b32 v233, a93
    v_mul_f32 v232, v232, v234
    v_mul_f32 v233, v233, v234
    v_accvgpr_write_b32 a92, v232
    v_accvgpr_write_b32 a93, v233
    v_accvgpr_read_b32 v232, a94
    v_accvgpr_read_b32 v233, a95
    v_mul_f32 v232, v232, v234
    v_mul_f32 v233, v233, v234
    v_accvgpr_write_b32 a94, v232
    v_accvgpr_write_b32 a95, v233
    v_accvgpr_read_b32 v232, a96
    v_accvgpr_read_b32 v233, a97
    v_mul_f32 v232, v232, v234
    v_mul_f32 v233, v233, v234
    v_accvgpr_write_b32 a96, v232
    v_accvgpr_write_b32 a97, v233
    v_accvgpr_read_b32 v232, a98
    v_accvgpr_read_b32 v233, a99
    v_mul_f32 v232, v232, v234
    v_mul_f32 v233, v233, v234
    v_accvgpr_write_b32 a98, v232
    v_accvgpr_write_b32 a99, v233
    v_accvgpr_read_b32 v232, a100
    v_accvgpr_read_b32 v233, a101
    v_mul_f32 v232, v232, v234
    v_mul_f32 v233, v233, v234
    v_accvgpr_write_b32 a100, v232
    v_accvgpr_write_b32 a101, v233
    v_accvgpr_read_b32 v232, a102
    v_accvgpr_read_b32 v233, a103
    v_mul_f32 v232, v232, v234
    v_mul_f32 v233, v233, v234
    v_accvgpr_write_b32 a102, v232
    v_accvgpr_write_b32 a103, v233
    v_accvgpr_read_b32 v232, a104
    v_accvgpr_read_b32 v233, a105
    v_mul_f32 v232, v232, v234
    v_mul_f32 v233, v233, v234
    v_accvgpr_write_b32 a104, v232
    v_accvgpr_write_b32 a105, v233
    v_accvgpr_read_b32 v232, a106
    v_accvgpr_read_b32 v233, a107
    v_mul_f32 v232, v232, v234
    v_mul_f32 v233, v233, v234
    v_accvgpr_write_b32 a106, v232
    v_accvgpr_write_b32 a107, v233
    v_accvgpr_read_b32 v232, a108
    v_accvgpr_read_b32 v233, a109
    v_mul_f32 v232, v232, v234
    v_mul_f32 v233, v233, v234
    v_accvgpr_write_b32 a108, v232
    v_accvgpr_write_b32 a109, v233
    v_accvgpr_read_b32 v232, a110
    v_accvgpr_read_b32 v233, a111
    v_mul_f32 v232, v232, v234
    v_mul_f32 v233, v233, v234
    v_accvgpr_write_b32 a110, v232
    v_accvgpr_write_b32 a111, v233
    v_accvgpr_read_b32 v232, a112
    v_accvgpr_read_b32 v233, a113
    v_mul_f32 v232, v232, v234
    v_mul_f32 v233, v233, v234
    v_accvgpr_write_b32 a112, v232
    v_accvgpr_write_b32 a113, v233
    v_accvgpr_read_b32 v232, a114
    v_accvgpr_read_b32 v233, a115
    v_mul_f32 v232, v232, v234
    v_mul_f32 v233, v233, v234
    v_accvgpr_write_b32 a114, v232
    v_accvgpr_write_b32 a115, v233
    v_accvgpr_read_b32 v232, a116
    v_accvgpr_read_b32 v233, a117
    v_mul_f32 v232, v232, v234
    v_mul_f32 v233, v233, v234
    v_accvgpr_write_b32 a116, v232
    v_accvgpr_write_b32 a117, v233
    v_accvgpr_read_b32 v232, a118
    v_accvgpr_read_b32 v233, a119
    v_mul_f32 v232, v232, v234
    v_mul_f32 v233, v233, v234
    v_accvgpr_write_b32 a118, v232
    v_accvgpr_write_b32 a119, v233
    v_accvgpr_read_b32 v232, a120
    v_accvgpr_read_b32 v233, a121
    v_mul_f32 v232, v232, v234
    v_mul_f32 v233, v233, v234
    v_accvgpr_write_b32 a120, v232
    v_accvgpr_write_b32 a121, v233
    v_accvgpr_read_b32 v232, a122
    v_accvgpr_read_b32 v233, a123
    v_mul_f32 v232, v232, v234
    v_mul_f32 v233, v233, v234
    v_accvgpr_write_b32 a122, v232
    v_accvgpr_write_b32 a123, v233
    v_accvgpr_read_b32 v232, a124
    v_accvgpr_read_b32 v233, a125
    v_mul_f32 v232, v232, v234
    v_mul_f32 v233, v233, v234
    v_accvgpr_write_b32 a124, v232
    v_accvgpr_write_b32 a125, v233
    v_accvgpr_read_b32 v232, a126
    v_accvgpr_read_b32 v233, a127
    v_mul_f32 v232, v232, v234
    v_mul_f32 v233, v233, v234
    v_accvgpr_write_b32 a126, v232
    v_accvgpr_write_b32 a127, v233
    v_exp_f32 v140, v140
    v_exp_f32 v141, v141
    v_exp_f32 v142, v142
    v_exp_f32 v143, v143
    v_exp_f32 v236, v236
    v_exp_f32 v237, v237
    v_exp_f32 v238, v238
    v_exp_f32 v239, v239
    s_nop 0
    v_add_f32 v229, v229, v140
    v_add_f32 v229, v229, v141
    v_add_f32 v229, v229, v142
    v_add_f32 v229, v229, v143
    v_add_f32 v229, v229, v236
    v_add_f32 v229, v229, v237
    v_add_f32 v229, v229, v238
    v_add_f32 v229, v229, v239
    v_cvt_pk_bf16_f32 v140, v140, v141
    v_cvt_pk_bf16_f32 v141, v142, v143
    v_cvt_pk_bf16_f32 v142, v236, v237
    v_cvt_pk_bf16_f32 v143, v238, v239
    ds_read_b128 v[232:235], v224 offset:52224
    s_waitcnt lgkmcnt(0)
    v_mfma_f32_16x16x32_bf16 v[148:151], v[232:235], v[64:67], v[248:251]
    s_nop 7
    ds_read_b128 v[232:235], v224 offset:52288
    s_waitcnt lgkmcnt(0)
    v_mfma_f32_16x16x32_bf16 v[148:151], v[232:235], v[68:71], v[148:151]
    s_nop 7
    ds_read_b128 v[232:235], v224 offset:52352
    s_waitcnt lgkmcnt(0)
    v_mfma_f32_16x16x32_bf16 v[148:151], v[232:235], v[72:75], v[148:151]
    s_nop 7
    ds_read_b128 v[232:235], v224 offset:52416
    s_waitcnt lgkmcnt(0)
    v_mfma_f32_16x16x32_bf16 v[148:151], v[232:235], v[76:79], v[148:151]
    s_nop 7
    ds_read_b128 v[232:235], v224 offset:52480
    s_waitcnt lgkmcnt(0)
    v_mfma_f32_16x16x32_bf16 v[148:151], v[232:235], v[80:83], v[148:151]
    s_nop 7
    ds_read_b128 v[232:235], v224 offset:52544
    s_waitcnt lgkmcnt(0)
    v_mfma_f32_16x16x32_bf16 v[148:151], v[232:235], v[84:87], v[148:151]
    s_nop 7
    ds_read_b128 v[232:235], v224 offset:52608
    s_waitcnt lgkmcnt(0)
    v_mfma_f32_16x16x32_bf16 v[148:151], v[232:235], v[88:91], v[148:151]
    s_nop 7
    ds_read_b128 v[232:235], v224 offset:52672
    s_waitcnt lgkmcnt(0)
    v_mfma_f32_16x16x32_bf16 v[148:151], v[232:235], v[92:95], v[148:151]
    s_nop 7
    ds_read_b128 v[232:235], v224 offset:60928
    s_waitcnt lgkmcnt(0)
    v_mfma_f32_16x16x32_bf16 v[236:239], v[232:235], v[64:67], v[248:251]
    s_nop 7
    ds_read_b128 v[232:235], v224 offset:60992
    s_waitcnt lgkmcnt(0)
    v_mfma_f32_16x16x32_bf16 v[236:239], v[232:235], v[68:71], v[236:239]
    s_nop 7
    ds_read_b128 v[232:235], v224 offset:61056
    s_waitcnt lgkmcnt(0)
    v_mfma_f32_16x16x32_bf16 v[236:239], v[232:235], v[72:75], v[236:239]
    s_nop 7
    ds_read_b128 v[232:235], v224 offset:61120
    s_waitcnt lgkmcnt(0)
    v_mfma_f32_16x16x32_bf16 v[236:239], v[232:235], v[76:79], v[236:239]
    s_nop 7
    ds_read_b128 v[232:235], v224 offset:61184
    s_waitcnt lgkmcnt(0)
    v_mfma_f32_16x16x32_bf16 v[236:239], v[232:235], v[80:83], v[236:239]
    s_nop 7
    ds_read_b128 v[232:235], v224 offset:61248
    s_waitcnt lgkmcnt(0)
    v_mfma_f32_16x16x32_bf16 v[236:239], v[232:235], v[84:87], v[236:239]
    s_nop 7
    ds_read_b128 v[232:235], v224 offset:61312
    s_waitcnt lgkmcnt(0)
    v_mfma_f32_16x16x32_bf16 v[236:239], v[232:235], v[88:91], v[236:239]
    s_nop 7
    ds_read_b128 v[232:235], v224 offset:61376
    s_waitcnt lgkmcnt(0)
    v_mfma_f32_16x16x32_bf16 v[236:239], v[232:235], v[92:95], v[236:239]
    s_nop 7
    s_nop 3
    v_max3_f32 v232, v148, v149, v150
    v_max3_f32 v232, v232, v151, v236
    v_max3_f32 v232, v232, v237, v238
    v_max_f32 v232, v232, v239
    v_mov_b32 v233, v232
    s_nop 1
    v_permlane16_swap_b32 v232, v233
    s_nop 1
    v_max_f32 v232, v232, v233
    v_mov_b32 v233, v232
    s_nop 1
    v_permlane32_swap_b32 v232, v233
    s_nop 1
    v_max_f32 v232, v232, v233
    v_ceil_f32 v232, v232
    v_max_f32 v232, 0, v232
    v_sub_f32 v248, v248, v232
    v_sub_f32 v249, v249, v232
    v_sub_f32 v250, v250, v232
    v_sub_f32 v251, v251, v232
    v_sub_f32 v148, v148, v232
    v_sub_f32 v149, v149, v232
    v_sub_f32 v150, v150, v232
    v_sub_f32 v151, v151, v232
    v_sub_f32 v236, v236, v232
    v_sub_f32 v237, v237, v232
    v_sub_f32 v238, v238, v232
    v_sub_f32 v239, v239, v232
    v_sub_f32 v144, v144, v232
    v_sub_f32 v145, v145, v232
    v_sub_f32 v146, v146, v232
    v_sub_f32 v147, v147, v232
    v_sub_f32 v180, v180, v232
    v_sub_f32 v181, v181, v232
    v_sub_f32 v182, v182, v232
    v_sub_f32 v183, v183, v232
    v_min_f32 v233, 0x43480000, v232
    v_cvt_i32_f32 v233, v233
    v_sub_u32 v233, 0, v233
    v_ldexp_f32 v234, 1.0, v233
    v_mul_f32 v230, v230, v234
    v_accvgpr_read_b32 v232, a128
    v_accvgpr_read_b32 v233, a129
    v_mul_f32 v232, v232, v234
    v_mul_f32 v233, v233, v234
    v_accvgpr_write_b32 a128, v232
    v_accvgpr_write_b32 a129, v233
    v_accvgpr_read_b32 v232, a130
    v_accvgpr_read_b32 v233, a131
    v_mul_f32 v232, v232, v234
    v_mul_f32 v233, v233, v234
    v_accvgpr_write_b32 a130, v232
    v_accvgpr_write_b32 a131, v233
    v_accvgpr_read_b32 v232, a132
    v_accvgpr_read_b32 v233, a133
    v_mul_f32 v232, v232, v234
    v_mul_f32 v233, v233, v234
    v_accvgpr_write_b32 a132, v232
    v_accvgpr_write_b32 a133, v233
    v_accvgpr_read_b32 v232, a134
    v_accvgpr_read_b32 v233, a135
    v_mul_f32 v232, v232, v234
    v_mul_f32 v233, v233, v234
    v_accvgpr_write_b32 a134, v232
    v_accvgpr_write_b32 a135, v233
    v_accvgpr_read_b32 v232, a136
    v_accvgpr_read_b32 v233, a137
    v_mul_f32 v232, v232, v234
    v_mul_f32 v233, v233, v234
    v_accvgpr_write_b32 a136, v232
    v_accvgpr_write_b32 a137, v233
    v_accvgpr_read_b32 v232, a138
    v_accvgpr_read_b32 v233, a139
    v_mul_f32 v232, v232, v234
    v_mul_f32 v233, v233, v234
    v_accvgpr_write_b32 a138, v232
    v_accvgpr_write_b32 a139, v233
    v_accvgpr_read_b32 v232, a140
    v_accvgpr_read_b32 v233, a141
    v_mul_f32 v232, v232, v234
    v_mul_f32 v233, v233, v234
    v_accvgpr_write_b32 a140, v232
    v_accvgpr_write_b32 a141, v233
    v_accvgpr_read_b32 v232, a142
    v_accvgpr_read_b32 v233, a143
    v_mul_f32 v232, v232, v234
    v_mul_f32 v233, v233, v234
    v_accvgpr_write_b32 a142, v232
    v_accvgpr_write_b32 a143, v233
    v_accvgpr_read_b32 v232, a144
    v_accvgpr_read_b32 v233, a145
    v_mul_f32 v232, v232, v234
    v_mul_f32 v233, v233, v234
    v_accvgpr_write_b32 a144, v232
    v_accvgpr_write_b32 a145, v233
    v_accvgpr_read_b32 v232, a146
    v_accvgpr_read_b32 v233, a147
    v_mul_f32 v232, v232, v234
    v_mul_f32 v233, v233, v234
    v_accvgpr_write_b32 a146, v232
    v_accvgpr_write_b32 a147, v233
    v_accvgpr_read_b32 v232, a148
    v_accvgpr_read_b32 v233, a149
    v_mul_f32 v232, v232, v234
    v_mul_f32 v233, v233, v234
    v_accvgpr_write_b32 a148, v232
    v_accvgpr_write_b32 a149, v233
    v_accvgpr_read_b32 v232, a150
    v_accvgpr_read_b32 v233, a151
    v_mul_f32 v232, v232, v234
    v_mul_f32 v233, v233, v234
    v_accvgpr_write_b32 a150, v232
    v_accvgpr_write_b32 a151, v233
    v_accvgpr_read_b32 v232, a152
    v_accvgpr_read_b32 v233, a153
    v_mul_f32 v232, v232, v234
    v_mul_f32 v233, v233, v234
    v_accvgpr_write_b32 a152, v232
    v_accvgpr_write_b32 a153, v233
    v_accvgpr_read_b32 v232, a154
    v_accvgpr_read_b32 v233, a155
    v_mul_f32 v232, v232, v234
    v_mul_f32 v233, v233, v234
    v_accvgpr_write_b32 a154, v232
    v_accvgpr_write_b32 a155, v233
    v_accvgpr_read_b32 v232, a156
    v_accvgpr_read_b32 v233, a157
    v_mul_f32 v232, v232, v234
    v_mul_f32 v233, v233, v234
    v_accvgpr_write_b32 a156, v232
    v_accvgpr_write_b32 a157, v233
    v_accvgpr_read_b32 v232, a158
    v_accvgpr_read_b32 v233, a159
    v_mul_f32 v232, v232, v234
    v_mul_f32 v233, v233, v234
    v_accvgpr_write_b32 a158, v232
    v_accvgpr_write_b32 a159, v233
    v_accvgpr_read_b32 v232, a160
    v_accvgpr_read_b32 v233, a161
    v_mul_f32 v232, v232, v234
    v_mul_f32 v233, v233, v234
    v_accvgpr_write_b32 a160, v232
    v_accvgpr_write_b32 a161, v233
    v_accvgpr_read_b32 v232, a162
    v_accvgpr_read_b32 v233, a163
    v_mul_f32 v232, v232, v234
    v_mul_f32 v233, v233, v234
    v_accvgpr_write_b32 a162, v232
    v_accvgpr_write_b32 a163, v233
    v_accvgpr_read_b32 v232, a164
    v_accvgpr_read_b32 v233, a165
    v_mul_f32 v232, v232, v234
    v_mul_f32 v233, v233, v234
    v_accvgpr_write_b32 a164, v232
    v_accvgpr_write_b32 a165, v233
    v_accvgpr_read_b32 v232, a166
    v_accvgpr_read_b32 v233, a167
    v_mul_f32 v232, v232, v234
    v_mul_f32 v233, v233, v234
    v_accvgpr_write_b32 a166, v232
    v_accvgpr_write_b32 a167, v233
    v_accvgpr_read_b32 v232, a168
    v_accvgpr_read_b32 v233, a169
    v_mul_f32 v232, v232, v234
    v_mul_f32 v233, v233, v234
    v_accvgpr_write_b32 a168, v232
    v_accvgpr_write_b32 a169, v233
    v_accvgpr_read_b32 v232, a170
    v_accvgpr_read_b32 v233, a171
    v_mul_f32 v232, v232, v234
    v_mul_f32 v233, v233, v234
    v_accvgpr_write_b32 a170, v232
    v_accvgpr_write_b32 a171, v233
    v_accvgpr_read_b32 v232, a172
    v_accvgpr_read_b32 v233, a173
    v_mul_f32 v232, v232, v234
    v_mul_f32 v233, v233, v234
    v_accvgpr_write_b32 a172, v232
    v_accvgpr_write_b32 a173, v233
    v_accvgpr_read_b32 v232, a174
    v_accvgpr_read_b32 v233, a175
    v_mul_f32 v232, v232, v234
    v_mul_f32 v233, v233, v234
    v_accvgpr_write_b32 a174, v232
    v_accvgpr_write_b32 a175, v233
    v_accvgpr_read_b32 v232, a176
    v_accvgpr_read_b32 v233, a177
    v_mul_f32 v232, v232, v234
    v_mul_f32 v233, v233, v234
    v_accvgpr_write_b32 a176, v232
    v_accvgpr_write_b32 a177, v233
    v_accvgpr_read_b32 v232, a178
    v_accvgpr_read_b32 v233, a179
    v_mul_f32 v232, v232, v234
    v_mul_f32 v233, v233, v234
    v_accvgpr_write_b32 a178, v232
    v_accvgpr_write_b32 a179, v233
    v_accvgpr_read_b32 v232, a180
    v_accvgpr_read_b32 v233, a181
    v_mul_f32 v232, v232, v234
    v_mul_f32 v233, v233, v234
    v_accvgpr_write_b32 a180, v232
    v_accvgpr_write_b32 a181, v233
    v_accvgpr_read_b32 v232, a182
    v_accvgpr_read_b32 v233, a183
    v_mul_f32 v232, v232, v234
    v_mul_f32 v233, v233, v234
    v_accvgpr_write_b32 a182, v232
    v_accvgpr_write_b32 a183, v233
    v_accvgpr_read_b32 v232, a184
    v_accvgpr_read_b32 v233, a185
    v_mul_f32 v232, v232, v234
    v_mul_f32 v233, v233, v234
    v_accvgpr_write_b32 a184, v232
    v_accvgpr_write_b32 a185, v233
    v_accvgpr_read_b32 v232, a186
    v_accvgpr_read_b32 v233, a187
    v_mul_f32 v232, v232, v234
    v_mul_f32 v233, v233, v234
    v_accvgpr_write_b32 a186, v232
    v_accvgpr_write_b32 a187, v233
    v_accvgpr_read_b32 v232, a188
    v_accvgpr_read_b32 v233, a189
    v_mul_f32 v232, v232, v234
    v_mul_f32 v233, v233, v234
    v_accvgpr_write_b32 a188, v232
    v_accvgpr_write_b32 a189, v233
    v_accvgpr_read_b32 v232, a190
    v_accvgpr_read_b32 v233, a191
    v_mul_f32 v232, v232, v234
    v_mul_f32 v233, v233, v234
    v_accvgpr_write_b32 a190, v232
    v_accvgpr_write_b32 a191, v233
    v_exp_f32 v148, v148
    v_exp_f32 v149, v149
    v_exp_f32 v150, v150
    v_exp_f32 v151, v151
    v_exp_f32 v236, v236
    v_exp_f32 v237, v237
    v_exp_f32 v238, v238
    v_exp_f32 v239, v239
    s_nop 0
    v_add_f32 v230, v230, v148
    v_add_f32 v230, v230, v149
    v_add_f32 v230, v230, v150
    v_add_f32 v230, v230, v151
    v_add_f32 v230, v230, v236
    v_add_f32 v230, v230, v237
    v_add_f32 v230, v230, v238
    v_add_f32 v230, v230, v239
    v_cvt_pk_bf16_f32 v148, v148, v149
    v_cvt_pk_bf16_f32 v149, v150, v151
    v_cvt_pk_bf16_f32 v150, v236, v237
    v_cvt_pk_bf16_f32 v151, v238, v239
    ds_read_b128 v[232:235], v224 offset:52224
    s_waitcnt lgkmcnt(0)
    v_mfma_f32_16x16x32_bf16 v[156:159], v[232:235], v[96:99], v[252:255]
    s_nop 7
    ds_read_b128 v[232:235], v224 offset:52288
    s_waitcnt lgkmcnt(0)
    v_mfma_f32_16x16x32_bf16 v[156:159], v[232:235], v[100:103], v[156:159]
    s_nop 7
    ds_read_b128 v[232:235], v224 offset:52352
    s_waitcnt lgkmcnt(0)
    v_mfma_f32_16x16x32_bf16 v[156:159], v[232:235], v[104:107], v[156:159]
    s_nop 7
    ds_read_b128 v[232:235], v224 offset:52416
    s_waitcnt lgkmcnt(0)
    v_mfma_f32_16x16x32_bf16 v[156:159], v[232:235], v[108:111], v[156:159]
    s_nop 7
    ds_read_b128 v[232:235], v224 offset:52480
    s_waitcnt lgkmcnt(0)
    v_mfma_f32_16x16x32_bf16 v[156:159], v[232:235], v[112:115], v[156:159]
    s_nop 7
    ds_read_b128 v[232:235], v224 offset:52544
    s_waitcnt lgkmcnt(0)
    v_mfma_f32_16x16x32_bf16 v[156:159], v[232:235], v[116:119], v[156:159]
    s_nop 7
    ds_read_b128 v[232:235], v224 offset:52608
    s_waitcnt lgkmcnt(0)
    v_mfma_f32_16x16x32_bf16 v[156:159], v[232:235], v[120:123], v[156:159]
    s_nop 7
    ds_read_b128 v[232:235], v224 offset:52672
    s_waitcnt lgkmcnt(0)
    v_mfma_f32_16x16x32_bf16 v[156:159], v[232:235], v[124:127], v[156:159]
    s_nop 7
    ds_read_b128 v[232:235], v224 offset:60928
    s_waitcnt lgkmcnt(0)
    v_mfma_f32_16x16x32_bf16 v[236:239], v[232:235], v[96:99], v[252:255]
    s_nop 7
    ds_read_b128 v[232:235], v224 offset:60992
    s_waitcnt lgkmcnt(0)
    v_mfma_f32_16x16x32_bf16 v[236:239], v[232:235], v[100:103], v[236:239]
    s_nop 7
    ds_read_b128 v[232:235], v224 offset:61056
    s_waitcnt lgkmcnt(0)
    v_mfma_f32_16x16x32_bf16 v[236:239], v[232:235], v[104:107], v[236:239]
    s_nop 7
    ds_read_b128 v[232:235], v224 offset:61120
    s_waitcnt lgkmcnt(0)
    v_mfma_f32_16x16x32_bf16 v[236:239], v[232:235], v[108:111], v[236:239]
    s_nop 7
    ds_read_b128 v[232:235], v224 offset:61184
    s_waitcnt lgkmcnt(0)
    v_mfma_f32_16x16x32_bf16 v[236:239], v[232:235], v[112:115], v[236:239]
    s_nop 7
    ds_read_b128 v[232:235], v224 offset:61248
    s_waitcnt lgkmcnt(0)
    v_mfma_f32_16x16x32_bf16 v[236:239], v[232:235], v[116:119], v[236:239]
    s_nop 7
    ds_read_b128 v[232:235], v224 offset:61312
    s_waitcnt lgkmcnt(0)
    v_mfma_f32_16x16x32_bf16 v[236:239], v[232:235], v[120:123], v[236:239]
    s_nop 7
    ds_read_b128 v[232:235], v224 offset:61376
    s_waitcnt lgkmcnt(0)
    v_mfma_f32_16x16x32_bf16 v[236:239], v[232:235], v[124:127], v[236:239]
    s_nop 7
    s_nop 3
    v_max3_f32 v232, v156, v157, v158
    v_max3_f32 v232, v232, v159, v236
    v_max3_f32 v232, v232, v237, v238
    v_max_f32 v232, v232, v239
    v_mov_b32 v233, v232
    s_nop 1
    v_permlane16_swap_b32 v232, v233
    s_nop 1
    v_max_f32 v232, v232, v233
    v_mov_b32 v233, v232
    s_nop 1
    v_permlane32_swap_b32 v232, v233
    s_nop 1
    v_max_f32 v232, v232, v233
    v_ceil_f32 v232, v232
    v_max_f32 v232, 0, v232
    v_sub_f32 v252, v252, v232
    v_sub_f32 v253, v253, v232
    v_sub_f32 v254, v254, v232
    v_sub_f32 v255, v255, v232
    v_sub_f32 v156, v156, v232
    v_sub_f32 v157, v157, v232
    v_sub_f32 v158, v158, v232
    v_sub_f32 v159, v159, v232
    v_sub_f32 v236, v236, v232
    v_sub_f32 v237, v237, v232
    v_sub_f32 v238, v238, v232
    v_sub_f32 v239, v239, v232
    v_sub_f32 v152, v152, v232
    v_sub_f32 v153, v153, v232
    v_sub_f32 v154, v154, v232
    v_sub_f32 v155, v155, v232
    v_sub_f32 v188, v188, v232
    v_sub_f32 v189, v189, v232
    v_sub_f32 v190, v190, v232
    v_sub_f32 v191, v191, v232
    v_min_f32 v233, 0x43480000, v232
    v_cvt_i32_f32 v233, v233
    v_sub_u32 v233, 0, v233
    v_ldexp_f32 v234, 1.0, v233
    v_mul_f32 v231, v231, v234
    v_accvgpr_read_b32 v232, a192
    v_accvgpr_read_b32 v233, a193
    v_mul_f32 v232, v232, v234
    v_mul_f32 v233, v233, v234
    v_accvgpr_write_b32 a192, v232
    v_accvgpr_write_b32 a193, v233
    v_accvgpr_read_b32 v232, a194
    v_accvgpr_read_b32 v233, a195
    v_mul_f32 v232, v232, v234
    v_mul_f32 v233, v233, v234
    v_accvgpr_write_b32 a194, v232
    v_accvgpr_write_b32 a195, v233
    v_accvgpr_read_b32 v232, a196
    v_accvgpr_read_b32 v233, a197
    v_mul_f32 v232, v232, v234
    v_mul_f32 v233, v233, v234
    v_accvgpr_write_b32 a196, v232
    v_accvgpr_write_b32 a197, v233
    v_accvgpr_read_b32 v232, a198
    v_accvgpr_read_b32 v233, a199
    v_mul_f32 v232, v232, v234
    v_mul_f32 v233, v233, v234
    v_accvgpr_write_b32 a198, v232
    v_accvgpr_write_b32 a199, v233
    v_accvgpr_read_b32 v232, a200
    v_accvgpr_read_b32 v233, a201
    v_mul_f32 v232, v232, v234
    v_mul_f32 v233, v233, v234
    v_accvgpr_write_b32 a200, v232
    v_accvgpr_write_b32 a201, v233
    v_accvgpr_read_b32 v232, a202
    v_accvgpr_read_b32 v233, a203
    v_mul_f32 v232, v232, v234
    v_mul_f32 v233, v233, v234
    v_accvgpr_write_b32 a202, v232
    v_accvgpr_write_b32 a203, v233
    v_accvgpr_read_b32 v232, a204
    v_accvgpr_read_b32 v233, a205
    v_mul_f32 v232, v232, v234
    v_mul_f32 v233, v233, v234
    v_accvgpr_write_b32 a204, v232
    v_accvgpr_write_b32 a205, v233
    v_accvgpr_read_b32 v232, a206
    v_accvgpr_read_b32 v233, a207
    v_mul_f32 v232, v232, v234
    v_mul_f32 v233, v233, v234
    v_accvgpr_write_b32 a206, v232
    v_accvgpr_write_b32 a207, v233
    v_accvgpr_read_b32 v232, a208
    v_accvgpr_read_b32 v233, a209
    v_mul_f32 v232, v232, v234
    v_mul_f32 v233, v233, v234
    v_accvgpr_write_b32 a208, v232
    v_accvgpr_write_b32 a209, v233
    v_accvgpr_read_b32 v232, a210
    v_accvgpr_read_b32 v233, a211
    v_mul_f32 v232, v232, v234
    v_mul_f32 v233, v233, v234
    v_accvgpr_write_b32 a210, v232
    v_accvgpr_write_b32 a211, v233
    v_accvgpr_read_b32 v232, a212
    v_accvgpr_read_b32 v233, a213
    v_mul_f32 v232, v232, v234
    v_mul_f32 v233, v233, v234
    v_accvgpr_write_b32 a212, v232
    v_accvgpr_write_b32 a213, v233
    v_accvgpr_read_b32 v232, a214
    v_accvgpr_read_b32 v233, a215
    v_mul_f32 v232, v232, v234
    v_mul_f32 v233, v233, v234
    v_accvgpr_write_b32 a214, v232
    v_accvgpr_write_b32 a215, v233
    v_accvgpr_read_b32 v232, a216
    v_accvgpr_read_b32 v233, a217
    v_mul_f32 v232, v232, v234
    v_mul_f32 v233, v233, v234
    v_accvgpr_write_b32 a216, v232
    v_accvgpr_write_b32 a217, v233
    v_accvgpr_read_b32 v232, a218
    v_accvgpr_read_b32 v233, a219
    v_mul_f32 v232, v232, v234
    v_mul_f32 v233, v233, v234
    v_accvgpr_write_b32 a218, v232
    v_accvgpr_write_b32 a219, v233
    v_accvgpr_read_b32 v232, a220
    v_accvgpr_read_b32 v233, a221
    v_mul_f32 v232, v232, v234
    v_mul_f32 v233, v233, v234
    v_accvgpr_write_b32 a220, v232
    v_accvgpr_write_b32 a221, v233
    v_accvgpr_read_b32 v232, a222
    v_accvgpr_read_b32 v233, a223
    v_mul_f32 v232, v232, v234
    v_mul_f32 v233, v233, v234
    v_accvgpr_write_b32 a222, v232
    v_accvgpr_write_b32 a223, v233
    v_accvgpr_read_b32 v232, a224
    v_accvgpr_read_b32 v233, a225
    v_mul_f32 v232, v232, v234
    v_mul_f32 v233, v233, v234
    v_accvgpr_write_b32 a224, v232
    v_accvgpr_write_b32 a225, v233
    v_accvgpr_read_b32 v232, a226
    v_accvgpr_read_b32 v233, a227
    v_mul_f32 v232, v232, v234
    v_mul_f32 v233, v233, v234
    v_accvgpr_write_b32 a226, v232
    v_accvgpr_write_b32 a227, v233
    v_accvgpr_read_b32 v232, a228
    v_accvgpr_read_b32 v233, a229
    v_mul_f32 v232, v232, v234
    v_mul_f32 v233, v233, v234
    v_accvgpr_write_b32 a228, v232
    v_accvgpr_write_b32 a229, v233
    v_accvgpr_read_b32 v232, a230
    v_accvgpr_read_b32 v233, a231
    v_mul_f32 v232, v232, v234
    v_mul_f32 v233, v233, v234
    v_accvgpr_write_b32 a230, v232
    v_accvgpr_write_b32 a231, v233
    v_accvgpr_read_b32 v232, a232
    v_accvgpr_read_b32 v233, a233
    v_mul_f32 v232, v232, v234
    v_mul_f32 v233, v233, v234
    v_accvgpr_write_b32 a232, v232
    v_accvgpr_write_b32 a233, v233
    v_accvgpr_read_b32 v232, a234
    v_accvgpr_read_b32 v233, a235
    v_mul_f32 v232, v232, v234
    v_mul_f32 v233, v233, v234
    v_accvgpr_write_b32 a234, v232
    v_accvgpr_write_b32 a235, v233
    v_accvgpr_read_b32 v232, a236
    v_accvgpr_read_b32 v233, a237
    v_mul_f32 v232, v232, v234
    v_mul_f32 v233, v233, v234
    v_accvgpr_write_b32 a236, v232
    v_accvgpr_write_b32 a237, v233
    v_accvgpr_read_b32 v232, a238
    v_accvgpr_read_b32 v233, a239
    v_mul_f32 v232, v232, v234
    v_mul_f32 v233, v233, v234
    v_accvgpr_write_b32 a238, v232
    v_accvgpr_write_b32 a239, v233
    v_accvgpr_read_b32 v232, a240
    v_accvgpr_read_b32 v233, a241
    v_mul_f32 v232, v232, v234
    v_mul_f32 v233, v233, v234
    v_accvgpr_write_b32 a240, v232
    v_accvgpr_write_b32 a241, v233
    v_accvgpr_read_b32 v232, a242
    v_accvgpr_read_b32 v233, a243
    v_mul_f32 v232, v232, v234
    v_mul_f32 v233, v233, v234
    v_accvgpr_write_b32 a242, v232
    v_accvgpr_write_b32 a243, v233
    v_accvgpr_read_b32 v232, a244
    v_accvgpr_read_b32 v233, a245
    v_mul_f32 v232, v232, v234
    v_mul_f32 v233, v233, v234
    v_accvgpr_write_b32 a244, v232
    v_accvgpr_write_b32 a245, v233
    v_accvgpr_read_b32 v232, a246
    v_accvgpr_read_b32 v233, a247
    v_mul_f32 v232, v232, v234
    v_mul_f32 v233, v233, v234
    v_accvgpr_write_b32 a246, v232
    v_accvgpr_write_b32 a247, v233
    v_accvgpr_read_b32 v232, a248
    v_accvgpr_read_b32 v233, a249
    v_mul_f32 v232, v232, v234
    v_mul_f32 v233, v233, v234
    v_accvgpr_write_b32 a248, v232
    v_accvgpr_write_b32 a249, v233
    v_accvgpr_read_b32 v232, a250
    v_accvgpr_read_b32 v233, a251
    v_mul_f32 v232, v232, v234
    v_mul_f32 v233, v233, v234
    v_accvgpr_write_b32 a250, v232
    v_accvgpr_write_b32 a251, v233
    v_accvgpr_read_b32 v232, a252
    v_accvgpr_read_b32 v233, a253
    v_mul_f32 v232, v232, v234
    v_mul_f32 v233, v233, v234
    v_accvgpr_write_b32 a252, v232
    v_accvgpr_write_b32 a253, v233
    v_accvgpr_read_b32 v232, a254
    v_accvgpr_read_b32 v233, a255
    v_mul_f32 v232, v232, v234
    v_mul_f32 v233, v233, v234
    v_accvgpr_write_b32 a254, v232
    v_accvgpr_write_b32 a255, v233
    v_exp_f32 v156, v156
    v_exp_f32 v157, v157
    v_exp_f32 v158, v158
    v_exp_f32 v159, v159
    v_exp_f32 v236, v236
    v_exp_f32 v237, v237
    v_exp_f32 v238, v238
    v_exp_f32 v239, v239
    s_nop 0
    v_add_f32 v231, v231, v156
    v_add_f32 v231, v231, v157
    v_add_f32 v231, v231, v158
    v_add_f32 v231, v231, v159
    v_add_f32 v231, v231, v236
    v_add_f32 v231, v231, v237
    v_add_f32 v231, v231, v238
    v_add_f32 v231, v231, v239
    v_cvt_pk_bf16_f32 v156, v156, v157
    v_cvt_pk_bf16_f32 v157, v158, v159
    v_cvt_pk_bf16_f32 v158, v236, v237
    v_cvt_pk_bf16_f32 v159, v238, v239
    v_mov_b32 v232, 0
    v_mov_b32 v233, 0
    v_mov_b32 v234, 0
    v_mov_b32 v235, 0
    s_nop 1
    s_branch L_back2
L_rare3:
    s_waitcnt vmcnt(0)
    s_nop 7
    ds_read_b128 v[232:235], v224 offset:0
    s_waitcnt lgkmcnt(0)
    v_mfma_f32_16x16x32_bf16 v[128:131], v[232:235], v[0:3], v[240:243]
    s_nop 7
    ds_read_b128 v[232:235], v224 offset:64
    s_waitcnt lgkmcnt(0)
    v_mfma_f32_16x16x32_bf16 v[128:131], v[232:235], v[4:7], v[128:131]
    s_nop 7
    ds_read_b128 v[232:235], v224 offset:128
    s_waitcnt lgkmcnt(0)
    v_mfma_f32_16x16x32_bf16 v[128:131], v[232:235], v[8:11], v[128:131]
    s_nop 7
    ds_read_b128 v[232:235], v224 offset:192
    s_waitcnt lgkmcnt(0)
    v_mfma_f32_16x16x32_bf16 v[128:131], v[232:235], v[12:15], v[128:131]
    s_nop 7
    ds_read_b128 v[232:235], v224 offset:256
    s_waitcnt lgkmcnt(0)
    v_mfma_f32_16x16x32_bf16 v[128:131], v[232:235], v[16:19], v[128:131]
    s_nop 7
    ds_read_b128 v[232:235], v224 offset:320
    s_waitcnt lgkmcnt(0)
    v_mfma_f32_16x16x32_bf16 v[128:131], v[232:235], v[20:23], v[128:131]
    s_nop 7
    ds_read_b128 v[232:235], v224 offset:384
    s_waitcnt lgkmcnt(0)
    v_mfma_f32_16x16x32_bf16 v[128:131], v[232:235], v[24:27], v[128:131]
    s_nop 7
    ds_read_b128 v[232:235], v224 offset:448
    s_waitcnt lgkmcnt(0)
    v_mfma_f32_16x16x32_bf16 v[128:131], v[232:235], v[28:31], v[128:131]
    s_nop 7
    ds_read_b128 v[232:235], v224 offset:8704
    s_waitcnt lgkmcnt(0)
    v_mfma_f32_16x16x32_bf16 v[236:239], v[232:235], v[0:3], v[240:243]
    s_nop 7
    ds_read_b128 v[232:235], v224 offset:8768
    s_waitcnt lgkmcnt(0)
    v_mfma_f32_16x16x32_bf16 v[236:239], v[232:235], v[4:7], v[236:239]
    s_nop 7
    ds_read_b128 v[232:235], v224 offset:8832
    s_waitcnt lgkmcnt(0)
    v_mfma_f32_16x16x32_bf16 v[236:239], v[232:235], v[8:11], v[236:239]
    s_nop 7
    ds_read_b128 v[232:235], v224 offset:8896
    s_waitcnt lgkmcnt(0)
    v_mfma_f32_16x16x32_bf16 v[236:239], v[232:235], v[12:15], v[236:239]
    s_nop 7
    ds_read_b128 v[232:235], v224 offset:8960
    s_waitcnt lgkmcnt(0)
    v_mfma_f32_16x16x32_bf16 v[236:239], v[232:235], v[16:19], v[236:239]
    s_nop 7
    ds_read_b128 v[232:235], v224 offset:9024
    s_waitcnt lgkmcnt(0)
    v_mfma_f32_16x16x32_bf16 v[236:239], v[232:235], v[20:23], v[236:239]
    s_nop 7
    ds_read_b128 v[232:235], v224 offset:9088
    s_waitcnt lgkmcnt(0)
    v_mfma_f32_16x16x32_bf16 v[236:239], v[232:235], v[24:27], v[236:239]
    s_nop 7
    ds_read_b128 v[232:235], v224 offset:9152
    s_waitcnt lgkmcnt(0)
    v_mfma_f32_16x16x32_bf16 v[236:239], v[232:235], v[28:31], v[236:239]
    s_nop 7
    s_nop 3
    v_max3_f32 v232, v128, v129, v130
    v_max3_f32 v232, v232, v131, v236
    v_max3_f32 v232, v232, v237, v238
    v_max_f32 v232, v232, v239
    v_mov_b32 v233, v232
    s_nop 1
    v_permlane16_swap_b32 v232, v233
    s_nop 1
    v_max_f32 v232, v232, v233
    v_mov_b32 v233, v232
    s_nop 1
    v_permlane32_swap_b32 v232, v233
    s_nop 1
    v_max_f32 v232, v232, v233
    v_ceil_f32 v232, v232
    v_max_f32 v232, 0, v232
    v_sub_f32 v240, v240, v232
    v_sub_f32 v241, v241, v232
    v_sub_f32 v242, v242, v232
    v_sub_f32 v243, v243, v232
    v_sub_f32 v128, v128, v232
    v_sub_f32 v129, v129, v232
    v_sub_f32 v130, v130, v232
    v_sub_f32 v131, v131, v232
    v_sub_f32 v236, v236, v232
    v_sub_f32 v237, v237, v232
    v_sub_f32 v238, v238, v232
    v_sub_f32 v239, v239, v232
    v_sub_f32 v160, v160, v232
    v_sub_f32 v161, v161, v232
    v_sub_f32 v162, v162, v232
    v_sub_f32 v163, v163, v232
    v_sub_f32 v164, v164, v232
    v_sub_f32 v165, v165, v232
    v_sub_f32 v166, v166, v232
    v_sub_f32 v167, v167, v232
    v_min_f32 v233, 0x43480000, v232
    v_cvt_i32_f32 v233, v233
    v_sub_u32 v233, 0, v233
    v_ldexp_f32 v234, 1.0, v233
    v_mul_f32 v228, v228, v234
    v_lshlrev_b32 v232, 16, v132
    v_and_b32 v233, 0xffff0000, v132
    v_mul_f32 v232, v232, v234
    v_mul_f32 v233, v233, v234
    v_cvt_pk_bf16_f32 v132, v232, v233
    v_lshlrev_b32 v232, 16, v133
    v_and_b32 v233, 0xffff0000, v133
    v_mul_f32 v232, v232, v234
    v_mul_f32 v233, v233, v234
    v_cvt_pk_bf16_f32 v133, v232, v233
    v_lshlrev_b32 v232, 16, v134
    v_and_b32 v233, 0xffff0000, v134
    v_mul_f32 v232, v232, v234
    v_mul_f32 v233, v233, v234
    v_cvt_pk_bf16_f32 v134, v232, v233
    v_lshlrev_b32 v232, 16, v135
    v_and_b32 v233, 0xffff0000, v135
    v_mul_f32 v232, v232, v234
    v_mul_f32 v233, v233, v234
    v_cvt_pk_bf16_f32 v135, v232, v233
    v_accvgpr_read_b32 v232, a0
    v_accvgpr_read_b32 v233, a1
    v_mul_f32 v232, v232, v234
    v_mul_f32 v233, v233, v234
    v_accvgpr_write_b32 a0, v232
    v_accvgpr_write_b32 a1, v233
    v_accvgpr_read_b32 v232, a2
    v_accvgpr_read_b32 v233, a3
    v_mul_f32 v232, v232, v234
    v_mul_f32 v233, v233, v234
    v_accvgpr_write_b32 a2, v232
    v_accvgpr_write_b32 a3, v233
    v_accvgpr_read_b32 v232, a4
    v_accvgpr_read_b32 v233, a5
    v_mul_f32 v232, v232, v234
    v_mul_f32 v233, v233, v234
    v_accvgpr_write_b32 a4, v232
    v_accvgpr_write_b32 a5, v233
    v_accvgpr_read_b32 v232, a6
    v_accvgpr_read_b32 v233, a7
    v_mul_f32 v232, v232, v234
    v_mul_f32 v233, v233, v234
    v_accvgpr_write_b32 a6, v232
    v_accvgpr_write_b32 a7, v233
    v_accvgpr_read_b32 v232, a8
    v_accvgpr_read_b32 v233, a9
    v_mul_f32 v232, v232, v234
    v_mul_f32 v233, v233, v234
    v_accvgpr_write_b32 a8, v232
    v_accvgpr_write_b32 a9, v233
    v_accvgpr_read_b32 v232, a10
    v_accvgpr_read_b32 v233, a11
    v_mul_f32 v232, v232, v234
    v_mul_f32 v233, v233, v234
    v_accvgpr_write_b32 a10, v232
    v_accvgpr_write_b32 a11, v233
    v_accvgpr_read_b32 v232, a12
    v_accvgpr_read_b32 v233, a13
    v_mul_f32 v232, v232, v234
    v_mul_f32 v233, v233, v234
    v_accvgpr_write_b32 a12, v232
    v_accvgpr_write_b32 a13, v233
    v_accvgpr_read_b32 v232, a14
    v_accvgpr_read_b32 v233, a15
    v_mul_f32 v232, v232, v234
    v_mul_f32 v233, v233, v234
    v_accvgpr_write_b32 a14, v232
    v_accvgpr_write_b32 a15, v233
    v_accvgpr_read_b32 v232, a16
    v_accvgpr_read_b32 v233, a17
    v_mul_f32 v232, v232, v234
    v_mul_f32 v233, v233, v234
    v_accvgpr_write_b32 a16, v232
    v_accvgpr_write_b32 a17, v233
    v_accvgpr_read_b32 v232, a18
    v_accvgpr_read_b32 v233, a19
    v_mul_f32 v232, v232, v234
    v_mul_f32 v233, v233, v234
    v_accvgpr_write_b32 a18, v232
    v_accvgpr_write_b32 a19, v233
    v_accvgpr_read_b32 v232, a20
    v_accvgpr_read_b32 v233, a21
    v_mul_f32 v232, v232, v234
    v_mul_f32 v233, v233, v234
    v_accvgpr_write_b32 a20, v232
    v_accvgpr_write_b32 a21, v233
    v_accvgpr_read_b32 v232, a22
    v_accvgpr_read_b32 v233, a23
    v_mul_f32 v232, v232, v234
    v_mul_f32 v233, v233, v234
    v_accvgpr_write_b32 a22, v232
    v_accvgpr_write_b32 a23, v233
    v_accvgpr_read_b32 v232, a24
    v_accvgpr_read_b32 v233, a25
    v_mul_f32 v232, v232, v234
    v_mul_f32 v233, v233, v234
    v_accvgpr_write_b32 a24, v232
    v_accvgpr_write_b32 a25, v233
    v_accvgpr_read_b32 v232, a26
    v_accvgpr_read_b32 v233, a27
    v_mul_f32 v232, v232, v234
    v_mul_f32 v233, v233, v234
    v_accvgpr_write_b32 a26, v232
    v_accvgpr_write_b32 a27, v233
    v_accvgpr_read_b32 v232, a28
    v_accvgpr_read_b32 v233, a29
    v_mul_f32 v232, v232, v234
    v_mul_f32 v233, v233, v234
    v_accvgpr_write_b32 a28, v232
    v_accvgpr_write_b32 a29, v233
    v_accvgpr_read_b32 v232, a30
    v_accvgpr_read_b32 v233, a31
    v_mul_f32 v232, v232, v234
    v_mul_f32 v233, v233, v234
    v_accvgpr_write_b32 a30, v232
    v_accvgpr_write_b32 a31, v233
    v_accvgpr_read_b32 v232, a32
    v_accvgpr_read_b32 v233, a33
    v_mul_f32 v232, v232, v234
    v_mul_f32 v233, v233, v234
    v_accvgpr_write_b32 a32, v232
    v_accvgpr_write_b32 a33, v233
    v_accvgpr_read_b32 v232, a34
    v_accvgpr_read_b32 v233, a35
    v_mul_f32 v232, v232, v234
    v_mul_f32 v233, v233, v234
    v_accvgpr_write_b32 a34, v232
    v_accvgpr_write_b32 a35, v233
    v_accvgpr_read_b32 v232, a36
    v_accvgpr_read_b32 v233, a37
    v_mul_f32 v232, v232, v234
    v_mul_f32 v233, v233, v234
    v_accvgpr_write_b32 a36, v232
    v_accvgpr_write_b32 a37, v233
    v_accvgpr_read_b32 v232, a38
    v_accvgpr_read_b32 v233, a39
    v_mul_f32 v232, v232, v234
    v_mul_f32 v233, v233, v234
    v_accvgpr_write_b32 a38, v232
    v_accvgpr_write_b32 a39, v233
    v_accvgpr_read_b32 v232, a40
    v_accvgpr_read_b32 v233, a41
    v_mul_f32 v232, v232, v234
    v_mul_f32 v233, v233, v234
    v_accvgpr_write_b32 a40, v232
    v_accvgpr_write_b32 a41, v233
    v_accvgpr_read_b32 v232, a42
    v_accvgpr_read_b32 v233, a43
    v_mul_f32 v232, v232, v234
    v_mul_f32 v233, v233, v234
    v_accvgpr_write_b32 a42, v232
    v_accvgpr_write_b32 a43, v233
    v_accvgpr_read_b32 v232, a44
    v_accvgpr_read_b32 v233, a45
    v_mul_f32 v232, v232, v234
    v_mul_f32 v233, v233, v234
    v_accvgpr_write_b32 a44, v232
    v_accvgpr_write_b32 a45, v233
    v_accvgpr_read_b32 v232, a46
    v_accvgpr_read_b32 v233, a47
    v_mul_f32 v232, v232, v234
    v_mul_f32 v233, v233, v234
    v_accvgpr_write_b32 a46, v232
    v_accvgpr_write_b32 a47, v233
    v_accvgpr_read_b32 v232, a48
    v_accvgpr_read_b32 v233, a49
    v_mul_f32 v232, v232, v234
    v_mul_f32 v233, v233, v234
    v_accvgpr_write_b32 a48, v232
    v_accvgpr_write_b32 a49, v233
    v_accvgpr_read_b32 v232, a50
    v_accvgpr_read_b32 v233, a51
    v_mul_f32 v232, v232, v234
    v_mul_f32 v233, v233, v234
    v_accvgpr_write_b32 a50, v232
    v_accvgpr_write_b32 a51, v233
    v_accvgpr_read_b32 v232, a52
    v_accvgpr_read_b32 v233, a53
    v_mul_f32 v232, v232, v234
    v_mul_f32 v233, v233, v234
    v_accvgpr_write_b32 a52, v232
    v_accvgpr_write_b32 a53, v233
    v_accvgpr_read_b32 v232, a54
    v_accvgpr_read_b32 v233, a55
    v_mul_f32 v232, v232, v234
    v_mul_f32 v233, v233, v234
    v_accvgpr_write_b32 a54, v232
    v_accvgpr_write_b32 a55, v233
    v_accvgpr_read_b32 v232, a56
    v_accvgpr_read_b32 v233, a57
    v_mul_f32 v232, v232, v234
    v_mul_f32 v233, v233, v234
    v_accvgpr_write_b32 a56, v232
    v_accvgpr_write_b32 a57, v233
    v_accvgpr_read_b32 v232, a58
    v_accvgpr_read_b32 v233, a59
    v_mul_f32 v232, v232, v234
    v_mul_f32 v233, v233, v234
    v_accvgpr_write_b32 a58, v232
    v_accvgpr_write_b32 a59, v233
    v_accvgpr_read_b32 v232, a60
    v_accvgpr_read_b32 v233, a61
    v_mul_f32 v232, v232, v234
    v_mul_f32 v233, v233, v234
    v_accvgpr_write_b32 a60, v232
    v_accvgpr_write_b32 a61, v233
    v_accvgpr_read_b32 v232, a62
    v_accvgpr_read_b32 v233, a63
    v_mul_f32 v232, v232, v234
    v_mul_f32 v233, v233, v234
    v_accvgpr_write_b32 a62, v232
    v_accvgpr_write_b32 a63, v233
    v_exp_f32 v128, v128
    v_exp_f32 v129, v129
    v_exp_f32 v130, v130
    v_exp_f32 v131, v131
    v_exp_f32 v236, v236
    v_exp_f32 v237, v237
    v_exp_f32 v238, v238
    v_exp_f32 v239, v239
    s_nop 0
    v_add_f32 v228, v228, v128
    v_add_f32 v228, v228, v129
    v_add_f32 v228, v228, v130
    v_add_f32 v228, v228, v131
    v_add_f32 v228, v228, v236
    v_add_f32 v228, v228, v237
    v_add_f32 v228, v228, v238
    v_add_f32 v228, v228, v239
    v_cvt_pk_bf16_f32 v128, v128, v129
    v_cvt_pk_bf16_f32 v129, v130, v131
    v_cvt_pk_bf16_f32 v130, v236, v237
    v_cvt_pk_bf16_f32 v131, v238, v239
    ds_read_b128 v[232:235], v224 offset:0
    s_waitcnt lgkmcnt(0)
    v_mfma_f32_16x16x32_bf16 v[136:139], v[232:235], v[32:35], v[244:247]
    s_nop 7
    ds_read_b128 v[232:235], v224 offset:64
    s_waitcnt lgkmcnt(0)
    v_mfma_f32_16x16x32_bf16 v[136:139], v[232:235], v[36:39], v[136:139]
    s_nop 7
    ds_read_b128 v[232:235], v224 offset:128
    s_waitcnt lgkmcnt(0)
    v_mfma_f32_16x16x32_bf16 v[136:139], v[232:235], v[40:43], v[136:139]
    s_nop 7
    ds_read_b128 v[232:235], v224 offset:192
    s_waitcnt lgkmcnt(0)
    v_mfma_f32_16x16x32_bf16 v[136:139], v[232:235], v[44:47], v[136:139]
    s_nop 7
    ds_read_b128 v[232:235], v224 offset:256
    s_waitcnt lgkmcnt(0)
    v_mfma_f32_16x16x32_bf16 v[136:139], v[232:235], v[48:51], v[136:139]
    s_nop 7
    ds_read_b128 v[232:235], v224 offset:320
    s_waitcnt lgkmcnt(0)
    v_mfma_f32_16x16x32_bf16 v[136:139], v[232:235], v[52:55], v[136:139]
    s_nop 7
    ds_read_b128 v[232:235], v224 offset:384
    s_waitcnt lgkmcnt(0)
    v_mfma_f32_16x16x32_bf16 v[136:139], v[232:235], v[56:59], v[136:139]
    s_nop 7
    ds_read_b128 v[232:235], v224 offset:448
    s_waitcnt lgkmcnt(0)
    v_mfma_f32_16x16x32_bf16 v[136:139], v[232:235], v[60:63], v[136:139]
    s_nop 7
    ds_read_b128 v[232:235], v224 offset:8704
    s_waitcnt lgkmcnt(0)
    v_mfma_f32_16x16x32_bf16 v[236:239], v[232:235], v[32:35], v[244:247]
    s_nop 7
    ds_read_b128 v[232:235], v224 offset:8768
    s_waitcnt lgkmcnt(0)
    v_mfma_f32_16x16x32_bf16 v[236:239], v[232:235], v[36:39], v[236:239]
    s_nop 7
    ds_read_b128 v[232:235], v224 offset:8832
    s_waitcnt lgkmcnt(0)
    v_mfma_f32_16x16x32_bf16 v[236:239], v[232:235], v[40:43], v[236:239]
    s_nop 7
    ds_read_b128 v[232:235], v224 offset:8896
    s_waitcnt lgkmcnt(0)
    v_mfma_f32_16x16x32_bf16 v[236:239], v[232:235], v[44:47], v[236:239]
    s_nop 7
    ds_read_b128 v[232:235], v224 offset:8960
    s_waitcnt lgkmcnt(0)
    v_mfma_f32_16x16x32_bf16 v[236:239], v[232:235], v[48:51], v[236:239]
    s_nop 7
    ds_read_b128 v[232:235], v224 offset:9024
    s_waitcnt lgkmcnt(0)
    v_mfma_f32_16x16x32_bf16 v[236:239], v[232:235], v[52:55], v[236:239]
    s_nop 7
    ds_read_b128 v[232:235], v224 offset:9088
    s_waitcnt lgkmcnt(0)
    v_mfma_f32_16x16x32_bf16 v[236:239], v[232:235], v[56:59], v[236:239]
    s_nop 7
    ds_read_b128 v[232:235], v224 offset:9152
    s_waitcnt lgkmcnt(0)
    v_mfma_f32_16x16x32_bf16 v[236:239], v[232:235], v[60:63], v[236:239]
    s_nop 7
    s_nop 3
    v_max3_f32 v232, v136, v137, v138
    v_max3_f32 v232, v232, v139, v236
    v_max3_f32 v232, v232, v237, v238
    v_max_f32 v232, v232, v239
    v_mov_b32 v233, v232
    s_nop 1
    v_permlane16_swap_b32 v232, v233
    s_nop 1
    v_max_f32 v232, v232, v233
    v_mov_b32 v233, v232
    s_nop 1
    v_permlane32_swap_b32 v232, v233
    s_nop 1
    v_max_f32 v232, v232, v233
    v_ceil_f32 v232, v232
    v_max_f32 v232, 0, v232
    v_sub_f32 v244, v244, v232
    v_sub_f32 v245, v245, v232
    v_sub_f32 v246, v246, v232
    v_sub_f32 v247, v247, v232
    v_sub_f32 v136, v136, v232
    v_sub_f32 v137, v137, v232
    v_sub_f32 v138, v138, v232
    v_sub_f32 v139, v139, v232
    v_sub_f32 v236, v236, v232
    v_sub_f32 v237, v237, v232
    v_sub_f32 v238, v238, v232
    v_sub_f32 v239, v239, v232
    v_sub_f32 v168, v168, v232
    v_sub_f32 v169, v169, v232
    v_sub_f32 v170, v170, v232
    v_sub_f32 v171, v171, v232
    v_sub_f32 v172, v172, v232
    v_sub_f32 v173, v173, v232
    v_sub_f32 v174, v174, v232
    v_sub_f32 v175, v175, v232
    v_min_f32 v233, 0x43480000, v232
    v_cvt_i32_f32 v233, v233
    v_sub_u32 v233, 0, v233
    v_ldexp_f32 v234, 1.0, v233
    v_mul_f32 v229, v229, v234
    v_lshlrev_b32 v232, 16, v140
    v_and_b32 v233, 0xffff0000, v140
    v_mul_f32 v232, v232, v234
    v_mul_f32 v233, v233, v234
    v_cvt_pk_bf16_f32 v140, v232, v233
    v_lshlrev_b32 v232, 16, v141
    v_and_b32 v233, 0xffff0000, v141
    v_mul_f32 v232, v232, v234
    v_mul_f32 v233, v233, v234
    v_cvt_pk_bf16_f32 v141, v232, v233
    v_lshlrev_b32 v232, 16, v142
    v_and_b32 v233, 0xffff0000, v142
    v_mul_f32 v232, v232, v234
    v_mul_f32 v233, v233, v234
    v_cvt_pk_bf16_f32 v142, v232, v233
    v_lshlrev_b32 v232, 16, v143
    v_and_b32 v233, 0xffff0000, v143
    v_mul_f32 v232, v232, v234
    v_mul_f32 v233, v233, v234
    v_cvt_pk_bf16_f32 v143, v232, v233
    v_accvgpr_read_b32 v232, a64
    v_accvgpr_read_b32 v233, a65
    v_mul_f32 v232, v232, v234
    v_mul_f32 v233, v233, v234
    v_accvgpr_write_b32 a64, v232
    v_accvgpr_write_b32 a65, v233
    v_accvgpr_read_b32 v232, a66
    v_accvgpr_read_b32 v233, a67
    v_mul_f32 v232, v232, v234
    v_mul_f32 v233, v233, v234
    v_accvgpr_write_b32 a66, v232
    v_accvgpr_write_b32 a67, v233
    v_accvgpr_read_b32 v232, a68
    v_accvgpr_read_b32 v233, a69
    v_mul_f32 v232, v232, v234
    v_mul_f32 v233, v233, v234
    v_accvgpr_write_b32 a68, v232
    v_accvgpr_write_b32 a69, v233
    v_accvgpr_read_b32 v232, a70
    v_accvgpr_read_b32 v233, a71
    v_mul_f32 v232, v232, v234
    v_mul_f32 v233, v233, v234
    v_accvgpr_write_b32 a70, v232
    v_accvgpr_write_b32 a71, v233
    v_accvgpr_read_b32 v232, a72
    v_accvgpr_read_b32 v233, a73
    v_mul_f32 v232, v232, v234
    v_mul_f32 v233, v233, v234
    v_accvgpr_write_b32 a72, v232
    v_accvgpr_write_b32 a73, v233
    v_accvgpr_read_b32 v232, a74
    v_accvgpr_read_b32 v233, a75
    v_mul_f32 v232, v232, v234
    v_mul_f32 v233, v233, v234
    v_accvgpr_write_b32 a74, v232
    v_accvgpr_write_b32 a75, v233
    v_accvgpr_read_b32 v232, a76
    v_accvgpr_read_b32 v233, a77
    v_mul_f32 v232, v232, v234
    v_mul_f32 v233, v233, v234
    v_accvgpr_write_b32 a76, v232
    v_accvgpr_write_b32 a77, v233
    v_accvgpr_read_b32 v232, a78
    v_accvgpr_read_b32 v233, a79
    v_mul_f32 v232, v232, v234
    v_mul_f32 v233, v233, v234
    v_accvgpr_write_b32 a78, v232
    v_accvgpr_write_b32 a79, v233
    v_accvgpr_read_b32 v232, a80
    v_accvgpr_read_b32 v233, a81
    v_mul_f32 v232, v232, v234
    v_mul_f32 v233, v233, v234
    v_accvgpr_write_b32 a80, v232
    v_accvgpr_write_b32 a81, v233
    v_accvgpr_read_b32 v232, a82
    v_accvgpr_read_b32 v233, a83
    v_mul_f32 v232, v232, v234
    v_mul_f32 v233, v233, v234
    v_accvgpr_write_b32 a82, v232
    v_accvgpr_write_b32 a83, v233
    v_accvgpr_read_b32 v232, a84
    v_accvgpr_read_b32 v233, a85
    v_mul_f32 v232, v232, v234
    v_mul_f32 v233, v233, v234
    v_accvgpr_write_b32 a84, v232
    v_accvgpr_write_b32 a85, v233
    v_accvgpr_read_b32 v232, a86
    v_accvgpr_read_b32 v233, a87
    v_mul_f32 v232, v232, v234
    v_mul_f32 v233, v233, v234
    v_accvgpr_write_b32 a86, v232
    v_accvgpr_write_b32 a87, v233
    v_accvgpr_read_b32 v232, a88
    v_accvgpr_read_b32 v233, a89
    v_mul_f32 v232, v232, v234
    v_mul_f32 v233, v233, v234
    v_accvgpr_write_b32 a88, v232
    v_accvgpr_write_b32 a89, v233
    v_accvgpr_read_b32 v232, a90
    v_accvgpr_read_b32 v233, a91
    v_mul_f32 v232, v232, v234
    v_mul_f32 v233, v233, v234
    v_accvgpr_write_b32 a90, v232
    v_accvgpr_write_b32 a91, v233
    v_accvgpr_read_b32 v232, a92
    v_accvgpr_read_b32 v233, a93
    v_mul_f32 v232, v232, v234
    v_mul_f32 v233, v233, v234
    v_accvgpr_write_b32 a92, v232
    v_accvgpr_write_b32 a93, v233
    v_accvgpr_read_b32 v232, a94
    v_accvgpr_read_b32 v233, a95
    v_mul_f32 v232, v232, v234
    v_mul_f32 v233, v233, v234
    v_accvgpr_write_b32 a94, v232
    v_accvgpr_write_b32 a95, v233
    v_accvgpr_read_b32 v232, a96
    v_accvgpr_read_b32 v233, a97
    v_mul_f32 v232, v232, v234
    v_mul_f32 v233, v233, v234
    v_accvgpr_write_b32 a96, v232
    v_accvgpr_write_b32 a97, v233
    v_accvgpr_read_b32 v232, a98
    v_accvgpr_read_b32 v233, a99
    v_mul_f32 v232, v232, v234
    v_mul_f32 v233, v233, v234
    v_accvgpr_write_b32 a98, v232
    v_accvgpr_write_b32 a99, v233
    v_accvgpr_read_b32 v232, a100
    v_accvgpr_read_b32 v233, a101
    v_mul_f32 v232, v232, v234
    v_mul_f32 v233, v233, v234
    v_accvgpr_write_b32 a100, v232
    v_accvgpr_write_b32 a101, v233
    v_accvgpr_read_b32 v232, a102
    v_accvgpr_read_b32 v233, a103
    v_mul_f32 v232, v232, v234
    v_mul_f32 v233, v233, v234
    v_accvgpr_write_b32 a102, v232
    v_accvgpr_write_b32 a103, v233
    v_accvgpr_read_b32 v232, a104
    v_accvgpr_read_b32 v233, a105
    v_mul_f32 v232, v232, v234
    v_mul_f32 v233, v233, v234
    v_accvgpr_write_b32 a104, v232
    v_accvgpr_write_b32 a105, v233
    v_accvgpr_read_b32 v232, a106
    v_accvgpr_read_b32 v233, a107
    v_mul_f32 v232, v232, v234
    v_mul_f32 v233, v233, v234
    v_accvgpr_write_b32 a106, v232
    v_accvgpr_write_b32 a107, v233
    v_accvgpr_read_b32 v232, a108
    v_accvgpr_read_b32 v233, a109
    v_mul_f32 v232, v232, v234
    v_mul_f32 v233, v233, v234
    v_accvgpr_write_b32 a108, v232
    v_accvgpr_write_b32 a109, v233
    v_accvgpr_read_b32 v232, a110
    v_accvgpr_read_b32 v233, a111
    v_mul_f32 v232, v232, v234
    v_mul_f32 v233, v233, v234
    v_accvgpr_write_b32 a110, v232
    v_accvgpr_write_b32 a111, v233
    v_accvgpr_read_b32 v232, a112
    v_accvgpr_read_b32 v233, a113
    v_mul_f32 v232, v232, v234
    v_mul_f32 v233, v233, v234
    v_accvgpr_write_b32 a112, v232
    v_accvgpr_write_b32 a113, v233
    v_accvgpr_read_b32 v232, a114
    v_accvgpr_read_b32 v233, a115
    v_mul_f32 v232, v232, v234
    v_mul_f32 v233, v233, v234
    v_accvgpr_write_b32 a114, v232
    v_accvgpr_write_b32 a115, v233
    v_accvgpr_read_b32 v232, a116
    v_accvgpr_read_b32 v233, a117
    v_mul_f32 v232, v232, v234
    v_mul_f32 v233, v233, v234
    v_accvgpr_write_b32 a116, v232
    v_accvgpr_write_b32 a117, v233
    v_accvgpr_read_b32 v232, a118
    v_accvgpr_read_b32 v233, a119
    v_mul_f32 v232, v232, v234
    v_mul_f32 v233, v233, v234
    v_accvgpr_write_b32 a118, v232
    v_accvgpr_write_b32 a119, v233
    v_accvgpr_read_b32 v232, a120
    v_accvgpr_read_b32 v233, a121
    v_mul_f32 v232, v232, v234
    v_mul_f32 v233, v233, v234
    v_accvgpr_write_b32 a120, v232
    v_accvgpr_write_b32 a121, v233
    v_accvgpr_read_b32 v232, a122
    v_accvgpr_read_b32 v233, a123
    v_mul_f32 v232, v232, v234
    v_mul_f32 v233, v233, v234
    v_accvgpr_write_b32 a122, v232
    v_accvgpr_write_b32 a123, v233
    v_accvgpr_read_b32 v232, a124
    v_accvgpr_read_b32 v233, a125
    v_mul_f32 v232, v232, v234
    v_mul_f32 v233, v233, v234
    v_accvgpr_write_b32 a124, v232
    v_accvgpr_write_b32 a125, v233
    v_accvgpr_read_b32 v232, a126
    v_accvgpr_read_b32 v233, a127
    v_mul_f32 v232, v232, v234
    v_mul_f32 v233, v233, v234
    v_accvgpr_write_b32 a126, v232
    v_accvgpr_write_b32 a127, v233
    v_exp_f32 v136, v136
    v_exp_f32 v137, v137
    v_exp_f32 v138, v138
    v_exp_f32 v139, v139
    v_exp_f32 v236, v236
    v_exp_f32 v237, v237
    v_exp_f32 v238, v238
    v_exp_f32 v239, v239
    s_nop 0
    v_add_f32 v229, v229, v136
    v_add_f32 v229, v229, v137
    v_add_f32 v229, v229, v138
    v_add_f32 v229, v229, v139
    v_add_f32 v229, v229, v236
    v_add_f32 v229, v229, v237
    v_add_f32 v229, v229, v238
    v_add_f32 v229, v229, v239
    v_cvt_pk_bf16_f32 v136, v136, v137
    v_cvt_pk_bf16_f32 v137, v138, v139
    v_cvt_pk_bf16_f32 v138, v236, v237
    v_cvt_pk_bf16_f32 v139, v238, v239
    ds_read_b128 v[232:235], v224 offset:0
    s_waitcnt lgkmcnt(0)
    v_mfma_f32_16x16x32_bf16 v[144:147], v[232:235], v[64:67], v[248:251]
    s_nop 7
    ds_read_b128 v[232:235], v224 offset:64
    s_waitcnt lgkmcnt(0)
    v_mfma_f32_16x16x32_bf16 v[144:147], v[232:235], v[68:71], v[144:147]
    s_nop 7
    ds_read_b128 v[232:235], v224 offset:128
    s_waitcnt lgkmcnt(0)
    v_mfma_f32_16x16x32_bf16 v[144:147], v[232:235], v[72:75], v[144:147]
    s_nop 7
    ds_read_b128 v[232:235], v224 offset:192
    s_waitcnt lgkmcnt(0)
    v_mfma_f32_16x16x32_bf16 v[144:147], v[232:235], v[76:79], v[144:147]
    s_nop 7
    ds_read_b128 v[232:235], v224 offset:256
    s_waitcnt lgkmcnt(0)
    v_mfma_f32_16x16x32_bf16 v[144:147], v[232:235], v[80:83], v[144:147]
    s_nop 7
    ds_read_b128 v[232:235], v224 offset:320
    s_waitcnt lgkmcnt(0)
    v_mfma_f32_16x16x32_bf16 v[144:147], v[232:235], v[84:87], v[144:147]
    s_nop 7
    ds_read_b128 v[232:235], v224 offset:384
    s_waitcnt lgkmcnt(0)
    v_mfma_f32_16x16x32_bf16 v[144:147], v[232:235], v[88:91], v[144:147]
    s_nop 7
    ds_read_b128 v[232:235], v224 offset:448
    s_waitcnt lgkmcnt(0)
    v_mfma_f32_16x16x32_bf16 v[144:147], v[232:235], v[92:95], v[144:147]
    s_nop 7
    ds_read_b128 v[232:235], v224 offset:8704
    s_waitcnt lgkmcnt(0)
    v_mfma_f32_16x16x32_bf16 v[236:239], v[232:235], v[64:67], v[248:251]
    s_nop 7
    ds_read_b128 v[232:235], v224 offset:8768
    s_waitcnt lgkmcnt(0)
    v_mfma_f32_16x16x32_bf16 v[236:239], v[232:235], v[68:71], v[236:239]
    s_nop 7
    ds_read_b128 v[232:235], v224 offset:8832
    s_waitcnt lgkmcnt(0)
    v_mfma_f32_16x16x32_bf16 v[236:239], v[232:235], v[72:75], v[236:239]
    s_nop 7
    ds_read_b128 v[232:235], v224 offset:8896
    s_waitcnt lgkmcnt(0)
    v_mfma_f32_16x16x32_bf16 v[236:239], v[232:235], v[76:79], v[236:239]
    s_nop 7
    ds_read_b128 v[232:235], v224 offset:8960
    s_waitcnt lgkmcnt(0)
    v_mfma_f32_16x16x32_bf16 v[236:239], v[232:235], v[80:83], v[236:239]
    s_nop 7
    ds_read_b128 v[232:235], v224 offset:9024
    s_waitcnt lgkmcnt(0)
    v_mfma_f32_16x16x32_bf16 v[236:239], v[232:235], v[84:87], v[236:239]
    s_nop 7
    ds_read_b128 v[232:235], v224 offset:9088
    s_waitcnt lgkmcnt(0)
    v_mfma_f32_16x16x32_bf16 v[236:239], v[232:235], v[88:91], v[236:239]
    s_nop 7
    ds_read_b128 v[232:235], v224 offset:9152
    s_waitcnt lgkmcnt(0)
    v_mfma_f32_16x16x32_bf16 v[236:239], v[232:235], v[92:95], v[236:239]
    s_nop 7
    s_nop 3
    v_max3_f32 v232, v144, v145, v146
    v_max3_f32 v232, v232, v147, v236
    v_max3_f32 v232, v232, v237, v238
    v_max_f32 v232, v232, v239
    v_mov_b32 v233, v232
    s_nop 1
    v_permlane16_swap_b32 v232, v233
    s_nop 1
    v_max_f32 v232, v232, v233
    v_mov_b32 v233, v232
    s_nop 1
    v_permlane32_swap_b32 v232, v233
    s_nop 1
    v_max_f32 v232, v232, v233
    v_ceil_f32 v232, v232
    v_max_f32 v232, 0, v232
    v_sub_f32 v248, v248, v232
    v_sub_f32 v249, v249, v232
    v_sub_f32 v250, v250, v232
    v_sub_f32 v251, v251, v232
    v_sub_f32 v144, v144, v232
    v_sub_f32 v145, v145, v232
    v_sub_f32 v146, v146, v232
    v_sub_f32 v147, v147, v232
    v_sub_f32 v236, v236, v232
    v_sub_f32 v237, v237, v232
    v_sub_f32 v238, v238, v232
    v_sub_f32 v239, v239, v232
    v_sub_f32 v176, v176, v232
    v_sub_f32 v177, v177, v232
    v_sub_f32 v178, v178, v232
    v_sub_f32 v179, v179, v232
    v_sub_f32 v180, v180, v232
    v_sub_f32 v181, v181, v232
    v_sub_f32 v182, v182, v232
    v_sub_f32 v183, v183, v232
    v_min_f32 v233, 0x43480000, v232
    v_cvt_i32_f32 v233, v233
    v_sub_u32 v233, 0, v233
    v_ldexp_f32 v234, 1.0, v233
    v_mul_f32 v230, v230, v234
    v_lshlrev_b32 v232, 16, v148
    v_and_b32 v233, 0xffff0000, v148
    v_mul_f32 v232, v232, v234
    v_mul_f32 v233, v233, v234
    v_cvt_pk_bf16_f32 v148, v232, v233
    v_lshlrev_b32 v232, 16, v149
    v_and_b32 v233, 0xffff0000, v149
    v_mul_f32 v232, v232, v234
    v_mul_f32 v233, v233, v234
    v_cvt_pk_bf16_f32 v149, v232, v233
    v_lshlrev_b32 v232, 16, v150
    v_and_b32 v233, 0xffff0000, v150
    v_mul_f32 v232, v232, v234
    v_mul_f32 v233, v233, v234
    v_cvt_pk_bf16_f32 v150, v232, v233
    v_lshlrev_b32 v232, 16, v151
    v_and_b32 v233, 0xffff0000, v151
    v_mul_f32 v232, v232, v234
    v_mul_f32 v233, v233, v234
    v_cvt_pk_bf16_f32 v151, v232, v233
    v_accvgpr_read_b32 v232, a128
    v_accvgpr_read_b32 v233, a129
    v_mul_f32 v232, v232, v234
    v_mul_f32 v233, v233, v234
    v_accvgpr_write_b32 a128, v232
    v_accvgpr_write_b32 a129, v233
    v_accvgpr_read_b32 v232, a130
    v_accvgpr_read_b32 v233, a131
    v_mul_f32 v232, v232, v234
    v_mul_f32 v233, v233, v234
    v_accvgpr_write_b32 a130, v232
    v_accvgpr_write_b32 a131, v233
    v_accvgpr_read_b32 v232, a132
    v_accvgpr_read_b32 v233, a133
    v_mul_f32 v232, v232, v234
    v_mul_f32 v233, v233, v234
    v_accvgpr_write_b32 a132, v232
    v_accvgpr_write_b32 a133, v233
    v_accvgpr_read_b32 v232, a134
    v_accvgpr_read_b32 v233, a135
    v_mul_f32 v232, v232, v234
    v_mul_f32 v233, v233, v234
    v_accvgpr_write_b32 a134, v232
    v_accvgpr_write_b32 a135, v233
    v_accvgpr_read_b32 v232, a136
    v_accvgpr_read_b32 v233, a137
    v_mul_f32 v232, v232, v234
    v_mul_f32 v233, v233, v234
    v_accvgpr_write_b32 a136, v232
    v_accvgpr_write_b32 a137, v233
    v_accvgpr_read_b32 v232, a138
    v_accvgpr_read_b32 v233, a139
    v_mul_f32 v232, v232, v234
    v_mul_f32 v233, v233, v234
    v_accvgpr_write_b32 a138, v232
    v_accvgpr_write_b32 a139, v233
    v_accvgpr_read_b32 v232, a140
    v_accvgpr_read_b32 v233, a141
    v_mul_f32 v232, v232, v234
    v_mul_f32 v233, v233, v234
    v_accvgpr_write_b32 a140, v232
    v_accvgpr_write_b32 a141, v233
    v_accvgpr_read_b32 v232, a142
    v_accvgpr_read_b32 v233, a143
    v_mul_f32 v232, v232, v234
    v_mul_f32 v233, v233, v234
    v_accvgpr_write_b32 a142, v232
    v_accvgpr_write_b32 a143, v233
    v_accvgpr_read_b32 v232, a144
    v_accvgpr_read_b32 v233, a145
    v_mul_f32 v232, v232, v234
    v_mul_f32 v233, v233, v234
    v_accvgpr_write_b32 a144, v232
    v_accvgpr_write_b32 a145, v233
    v_accvgpr_read_b32 v232, a146
    v_accvgpr_read_b32 v233, a147
    v_mul_f32 v232, v232, v234
    v_mul_f32 v233, v233, v234
    v_accvgpr_write_b32 a146, v232
    v_accvgpr_write_b32 a147, v233
    v_accvgpr_read_b32 v232, a148
    v_accvgpr_read_b32 v233, a149
    v_mul_f32 v232, v232, v234
    v_mul_f32 v233, v233, v234
    v_accvgpr_write_b32 a148, v232
    v_accvgpr_write_b32 a149, v233
    v_accvgpr_read_b32 v232, a150
    v_accvgpr_read_b32 v233, a151
    v_mul_f32 v232, v232, v234
    v_mul_f32 v233, v233, v234
    v_accvgpr_write_b32 a150, v232
    v_accvgpr_write_b32 a151, v233
    v_accvgpr_read_b32 v232, a152
    v_accvgpr_read_b32 v233, a153
    v_mul_f32 v232, v232, v234
    v_mul_f32 v233, v233, v234
    v_accvgpr_write_b32 a152, v232
    v_accvgpr_write_b32 a153, v233
    v_accvgpr_read_b32 v232, a154
    v_accvgpr_read_b32 v233, a155
    v_mul_f32 v232, v232, v234
    v_mul_f32 v233, v233, v234
    v_accvgpr_write_b32 a154, v232
    v_accvgpr_write_b32 a155, v233
    v_accvgpr_read_b32 v232, a156
    v_accvgpr_read_b32 v233, a157
    v_mul_f32 v232, v232, v234
    v_mul_f32 v233, v233, v234
    v_accvgpr_write_b32 a156, v232
    v_accvgpr_write_b32 a157, v233
    v_accvgpr_read_b32 v232, a158
    v_accvgpr_read_b32 v233, a159
    v_mul_f32 v232, v232, v234
    v_mul_f32 v233, v233, v234
    v_accvgpr_write_b32 a158, v232
    v_accvgpr_write_b32 a159, v233
    v_accvgpr_read_b32 v232, a160
    v_accvgpr_read_b32 v233, a161
    v_mul_f32 v232, v232, v234
    v_mul_f32 v233, v233, v234
    v_accvgpr_write_b32 a160, v232
    v_accvgpr_write_b32 a161, v233
    v_accvgpr_read_b32 v232, a162
    v_accvgpr_read_b32 v233, a163
    v_mul_f32 v232, v232, v234
    v_mul_f32 v233, v233, v234
    v_accvgpr_write_b32 a162, v232
    v_accvgpr_write_b32 a163, v233
    v_accvgpr_read_b32 v232, a164
    v_accvgpr_read_b32 v233, a165
    v_mul_f32 v232, v232, v234
    v_mul_f32 v233, v233, v234
    v_accvgpr_write_b32 a164, v232
    v_accvgpr_write_b32 a165, v233
    v_accvgpr_read_b32 v232, a166
    v_accvgpr_read_b32 v233, a167
    v_mul_f32 v232, v232, v234
    v_mul_f32 v233, v233, v234
    v_accvgpr_write_b32 a166, v232
    v_accvgpr_write_b32 a167, v233
    v_accvgpr_read_b32 v232, a168
    v_accvgpr_read_b32 v233, a169
    v_mul_f32 v232, v232, v234
    v_mul_f32 v233, v233, v234
    v_accvgpr_write_b32 a168, v232
    v_accvgpr_write_b32 a169, v233
    v_accvgpr_read_b32 v232, a170
    v_accvgpr_read_b32 v233, a171
    v_mul_f32 v232, v232, v234
    v_mul_f32 v233, v233, v234
    v_accvgpr_write_b32 a170, v232
    v_accvgpr_write_b32 a171, v233
    v_accvgpr_read_b32 v232, a172
    v_accvgpr_read_b32 v233, a173
    v_mul_f32 v232, v232, v234
    v_mul_f32 v233, v233, v234
    v_accvgpr_write_b32 a172, v232
    v_accvgpr_write_b32 a173, v233
    v_accvgpr_read_b32 v232, a174
    v_accvgpr_read_b32 v233, a175
    v_mul_f32 v232, v232, v234
    v_mul_f32 v233, v233, v234
    v_accvgpr_write_b32 a174, v232
    v_accvgpr_write_b32 a175, v233
    v_accvgpr_read_b32 v232, a176
    v_accvgpr_read_b32 v233, a177
    v_mul_f32 v232, v232, v234
    v_mul_f32 v233, v233, v234
    v_accvgpr_write_b32 a176, v232
    v_accvgpr_write_b32 a177, v233
    v_accvgpr_read_b32 v232, a178
    v_accvgpr_read_b32 v233, a179
    v_mul_f32 v232, v232, v234
    v_mul_f32 v233, v233, v234
    v_accvgpr_write_b32 a178, v232
    v_accvgpr_write_b32 a179, v233
    v_accvgpr_read_b32 v232, a180
    v_accvgpr_read_b32 v233, a181
    v_mul_f32 v232, v232, v234
    v_mul_f32 v233, v233, v234
    v_accvgpr_write_b32 a180, v232
    v_accvgpr_write_b32 a181, v233
    v_accvgpr_read_b32 v232, a182
    v_accvgpr_read_b32 v233, a183
    v_mul_f32 v232, v232, v234
    v_mul_f32 v233, v233, v234
    v_accvgpr_write_b32 a182, v232
    v_accvgpr_write_b32 a183, v233
    v_accvgpr_read_b32 v232, a184
    v_accvgpr_read_b32 v233, a185
    v_mul_f32 v232, v232, v234
    v_mul_f32 v233, v233, v234
    v_accvgpr_write_b32 a184, v232
    v_accvgpr_write_b32 a185, v233
    v_accvgpr_read_b32 v232, a186
    v_accvgpr_read_b32 v233, a187
    v_mul_f32 v232, v232, v234
    v_mul_f32 v233, v233, v234
    v_accvgpr_write_b32 a186, v232
    v_accvgpr_write_b32 a187, v233
    v_accvgpr_read_b32 v232, a188
    v_accvgpr_read_b32 v233, a189
    v_mul_f32 v232, v232, v234
    v_mul_f32 v233, v233, v234
    v_accvgpr_write_b32 a188, v232
    v_accvgpr_write_b32 a189, v233
    v_accvgpr_read_b32 v232, a190
    v_accvgpr_read_b32 v233, a191
    v_mul_f32 v232, v232, v234
    v_mul_f32 v233, v233, v234
    v_accvgpr_write_b32 a190, v232
    v_accvgpr_write_b32 a191, v233
    v_exp_f32 v144, v144
    v_exp_f32 v145, v145
    v_exp_f32 v146, v146
    v_exp_f32 v147, v147
    v_exp_f32 v236, v236
    v_exp_f32 v237, v237
    v_exp_f32 v238, v238
    v_exp_f32 v239, v239
    s_nop 0
    v_add_f32 v230, v230, v144
    v_add_f32 v230, v230, v145
    v_add_f32 v230, v230, v146
    v_add_f32 v230, v230, v147
    v_add_f32 v230, v230, v236
    v_add_f32 v230, v230, v237
    v_add_f32 v230, v230, v238
    v_add_f32 v230, v230, v239
    v_cvt_pk_bf16_f32 v144, v144, v145
    v_cvt_pk_bf16_f32 v145, v146, v147
    v_cvt_pk_bf16_f32 v146, v236, v237
    v_cvt_pk_bf16_f32 v147, v238, v239
    ds_read_b128 v[232:235], v224 offset:0
    s_waitcnt lgkmcnt(0)
    v_mfma_f32_16x16x32_bf16 v[152:155], v[232:235], v[96:99], v[252:255]
    s_nop 7
    ds_read_b128 v[232:235], v224 offset:64
    s_waitcnt lgkmcnt(0)
    v_mfma_f32_16x16x32_bf16 v[152:155], v[232:235], v[100:103], v[152:155]
    s_nop 7
    ds_read_b128 v[232:235], v224 offset:128
    s_waitcnt lgkmcnt(0)
    v_mfma_f32_16x16x32_bf16 v[152:155], v[232:235], v[104:107], v[152:155]
    s_nop 7
    ds_read_b128 v[232:235], v224 offset:192
    s_waitcnt lgkmcnt(0)
    v_mfma_f32_16x16x32_bf16 v[152:155], v[232:235], v[108:111], v[152:155]
    s_nop 7
    ds_read_b128 v[232:235], v224 offset:256
    s_waitcnt lgkmcnt(0)
    v_mfma_f32_16x16x32_bf16 v[152:155], v[232:235], v[112:115], v[152:155]
    s_nop 7
    ds_read_b128 v[232:235], v224 offset:320
    s_waitcnt lgkmcnt(0)
    v_mfma_f32_16x16x32_bf16 v[152:155], v[232:235], v[116:119], v[152:155]
    s_nop 7
    ds_read_b128 v[232:235], v224 offset:384
    s_waitcnt lgkmcnt(0)
    v_mfma_f32_16x16x32_bf16 v[152:155], v[232:235], v[120:123], v[152:155]
    s_nop 7
    ds_read_b128 v[232:235], v224 offset:448
    s_waitcnt lgkmcnt(0)
    v_mfma_f32_16x16x32_bf16 v[152:155], v[232:235], v[124:127], v[152:155]
    s_nop 7
    ds_read_b128 v[232:235], v224 offset:8704
    s_waitcnt lgkmcnt(0)
    v_mfma_f32_16x16x32_bf16 v[236:239], v[232:235], v[96:99], v[252:255]
    s_nop 7
    ds_read_b128 v[232:235], v224 offset:8768
    s_waitcnt lgkmcnt(0)
    v_mfma_f32_16x16x32_bf16 v[236:239], v[232:235], v[100:103], v[236:239]
    s_nop 7
    ds_read_b128 v[232:235], v224 offset:8832
    s_waitcnt lgkmcnt(0)
    v_mfma_f32_16x16x32_bf16 v[236:239], v[232:235], v[104:107], v[236:239]
    s_nop 7
    ds_read_b128 v[232:235], v224 offset:8896
    s_waitcnt lgkmcnt(0)
    v_mfma_f32_16x16x32_bf16 v[236:239], v[232:235], v[108:111], v[236:239]
    s_nop 7
    ds_read_b128 v[232:235], v224 offset:8960
    s_waitcnt lgkmcnt(0)
    v_mfma_f32_16x16x32_bf16 v[236:239], v[232:235], v[112:115], v[236:239]
    s_nop 7
    ds_read_b128 v[232:235], v224 offset:9024
    s_waitcnt lgkmcnt(0)
    v_mfma_f32_16x16x32_bf16 v[236:239], v[232:235], v[116:119], v[236:239]
    s_nop 7
    ds_read_b128 v[232:235], v224 offset:9088
    s_waitcnt lgkmcnt(0)
    v_mfma_f32_16x16x32_bf16 v[236:239], v[232:235], v[120:123], v[236:239]
    s_nop 7
    ds_read_b128 v[232:235], v224 offset:9152
    s_waitcnt lgkmcnt(0)
    v_mfma_f32_16x16x32_bf16 v[236:239], v[232:235], v[124:127], v[236:239]
    s_nop 7
    s_nop 3
    v_max3_f32 v232, v152, v153, v154
    v_max3_f32 v232, v232, v155, v236
    v_max3_f32 v232, v232, v237, v238
    v_max_f32 v232, v232, v239
    v_mov_b32 v233, v232
    s_nop 1
    v_permlane16_swap_b32 v232, v233
    s_nop 1
    v_max_f32 v232, v232, v233
    v_mov_b32 v233, v232
    s_nop 1
    v_permlane32_swap_b32 v232, v233
    s_nop 1
    v_max_f32 v232, v232, v233
    v_ceil_f32 v232, v232
    v_max_f32 v232, 0, v232
    v_sub_f32 v252, v252, v232
    v_sub_f32 v253, v253, v232
    v_sub_f32 v254, v254, v232
    v_sub_f32 v255, v255, v232
    v_sub_f32 v152, v152, v232
    v_sub_f32 v153, v153, v232
    v_sub_f32 v154, v154, v232
    v_sub_f32 v155, v155, v232
    v_sub_f32 v236, v236, v232
    v_sub_f32 v237, v237, v232
    v_sub_f32 v238, v238, v232
    v_sub_f32 v239, v239, v232
    v_sub_f32 v184, v184, v232
    v_sub_f32 v185, v185, v232
    v_sub_f32 v186, v186, v232
    v_sub_f32 v187, v187, v232
    v_sub_f32 v188, v188, v232
    v_sub_f32 v189, v189, v232
    v_sub_f32 v190, v190, v232
    v_sub_f32 v191, v191, v232
    v_min_f32 v233, 0x43480000, v232
    v_cvt_i32_f32 v233, v233
    v_sub_u32 v233, 0, v233
    v_ldexp_f32 v234, 1.0, v233
    v_mul_f32 v231, v231, v234
    v_lshlrev_b32 v232, 16, v156
    v_and_b32 v233, 0xffff0000, v156
    v_mul_f32 v232, v232, v234
    v_mul_f32 v233, v233, v234
    v_cvt_pk_bf16_f32 v156, v232, v233
    v_lshlrev_b32 v232, 16, v157
    v_and_b32 v233, 0xffff0000, v157
    v_mul_f32 v232, v232, v234
    v_mul_f32 v233, v233, v234
    v_cvt_pk_bf16_f32 v157, v232, v233
    v_lshlrev_b32 v232, 16, v158
    v_and_b32 v233, 0xffff0000, v158
    v_mul_f32 v232, v232, v234
    v_mul_f32 v233, v233, v234
    v_cvt_pk_bf16_f32 v158, v232, v233
    v_lshlrev_b32 v232, 16, v159
    v_and_b32 v233, 0xffff0000, v159
    v_mul_f32 v232, v232, v234
    v_mul_f32 v233, v233, v234
    v_cvt_pk_bf16_f32 v159, v232, v233
    v_accvgpr_read_b32 v232, a192
    v_accvgpr_read_b32 v233, a193
    v_mul_f32 v232, v232, v234
    v_mul_f32 v233, v233, v234
    v_accvgpr_write_b32 a192, v232
    v_accvgpr_write_b32 a193, v233
    v_accvgpr_read_b32 v232, a194
    v_accvgpr_read_b32 v233, a195
    v_mul_f32 v232, v232, v234
    v_mul_f32 v233, v233, v234
    v_accvgpr_write_b32 a194, v232
    v_accvgpr_write_b32 a195, v233
    v_accvgpr_read_b32 v232, a196
    v_accvgpr_read_b32 v233, a197
    v_mul_f32 v232, v232, v234
    v_mul_f32 v233, v233, v234
    v_accvgpr_write_b32 a196, v232
    v_accvgpr_write_b32 a197, v233
    v_accvgpr_read_b32 v232, a198
    v_accvgpr_read_b32 v233, a199
    v_mul_f32 v232, v232, v234
    v_mul_f32 v233, v233, v234
    v_accvgpr_write_b32 a198, v232
    v_accvgpr_write_b32 a199, v233
    v_accvgpr_read_b32 v232, a200
    v_accvgpr_read_b32 v233, a201
    v_mul_f32 v232, v232, v234
    v_mul_f32 v233, v233, v234
    v_accvgpr_write_b32 a200, v232
    v_accvgpr_write_b32 a201, v233
    v_accvgpr_read_b32 v232, a202
    v_accvgpr_read_b32 v233, a203
    v_mul_f32 v232, v232, v234
    v_mul_f32 v233, v233, v234
    v_accvgpr_write_b32 a202, v232
    v_accvgpr_write_b32 a203, v233
    v_accvgpr_read_b32 v232, a204
    v_accvgpr_read_b32 v233, a205
    v_mul_f32 v232, v232, v234
    v_mul_f32 v233, v233, v234
    v_accvgpr_write_b32 a204, v232
    v_accvgpr_write_b32 a205, v233
    v_accvgpr_read_b32 v232, a206
    v_accvgpr_read_b32 v233, a207
    v_mul_f32 v232, v232, v234
    v_mul_f32 v233, v233, v234
    v_accvgpr_write_b32 a206, v232
    v_accvgpr_write_b32 a207, v233
    v_accvgpr_read_b32 v232, a208
    v_accvgpr_read_b32 v233, a209
    v_mul_f32 v232, v232, v234
    v_mul_f32 v233, v233, v234
    v_accvgpr_write_b32 a208, v232
    v_accvgpr_write_b32 a209, v233
    v_accvgpr_read_b32 v232, a210
    v_accvgpr_read_b32 v233, a211
    v_mul_f32 v232, v232, v234
    v_mul_f32 v233, v233, v234
    v_accvgpr_write_b32 a210, v232
    v_accvgpr_write_b32 a211, v233
    v_accvgpr_read_b32 v232, a212
    v_accvgpr_read_b32 v233, a213
    v_mul_f32 v232, v232, v234
    v_mul_f32 v233, v233, v234
    v_accvgpr_write_b32 a212, v232
    v_accvgpr_write_b32 a213, v233
    v_accvgpr_read_b32 v232, a214
    v_accvgpr_read_b32 v233, a215
    v_mul_f32 v232, v232, v234
    v_mul_f32 v233, v233, v234
    v_accvgpr_write_b32 a214, v232
    v_accvgpr_write_b32 a215, v233
    v_accvgpr_read_b32 v232, a216
    v_accvgpr_read_b32 v233, a217
    v_mul_f32 v232, v232, v234
    v_mul_f32 v233, v233, v234
    v_accvgpr_write_b32 a216, v232
    v_accvgpr_write_b32 a217, v233
    v_accvgpr_read_b32 v232, a218
    v_accvgpr_read_b32 v233, a219
    v_mul_f32 v232, v232, v234
    v_mul_f32 v233, v233, v234
    v_accvgpr_write_b32 a218, v232
    v_accvgpr_write_b32 a219, v233
    v_accvgpr_read_b32 v232, a220
    v_accvgpr_read_b32 v233, a221
    v_mul_f32 v232, v232, v234
    v_mul_f32 v233, v233, v234
    v_accvgpr_write_b32 a220, v232
    v_accvgpr_write_b32 a221, v233
    v_accvgpr_read_b32 v232, a222
    v_accvgpr_read_b32 v233, a223
    v_mul_f32 v232, v232, v234
    v_mul_f32 v233, v233, v234
    v_accvgpr_write_b32 a222, v232
    v_accvgpr_write_b32 a223, v233
    v_accvgpr_read_b32 v232, a224
    v_accvgpr_read_b32 v233, a225
    v_mul_f32 v232, v232, v234
    v_mul_f32 v233, v233, v234
    v_accvgpr_write_b32 a224, v232
    v_accvgpr_write_b32 a225, v233
    v_accvgpr_read_b32 v232, a226
    v_accvgpr_read_b32 v233, a227
    v_mul_f32 v232, v232, v234
    v_mul_f32 v233, v233, v234
    v_accvgpr_write_b32 a226, v232
    v_accvgpr_write_b32 a227, v233
    v_accvgpr_read_b32 v232, a228
    v_accvgpr_read_b32 v233, a229
    v_mul_f32 v232, v232, v234
    v_mul_f32 v233, v233, v234
    v_accvgpr_write_b32 a228, v232
    v_accvgpr_write_b32 a229, v233
    v_accvgpr_read_b32 v232, a230
    v_accvgpr_read_b32 v233, a231
    v_mul_f32 v232, v232, v234
    v_mul_f32 v233, v233, v234
    v_accvgpr_write_b32 a230, v232
    v_accvgpr_write_b32 a231, v233
    v_accvgpr_read_b32 v232, a232
    v_accvgpr_read_b32 v233, a233
    v_mul_f32 v232, v232, v234
    v_mul_f32 v233, v233, v234
    v_accvgpr_write_b32 a232, v232
    v_accvgpr_write_b32 a233, v233
    v_accvgpr_read_b32 v232, a234
    v_accvgpr_read_b32 v233, a235
    v_mul_f32 v232, v232, v234
    v_mul_f32 v233, v233, v234
    v_accvgpr_write_b32 a234, v232
    v_accvgpr_write_b32 a235, v233
    v_accvgpr_read_b32 v232, a236
    v_accvgpr_read_b32 v233, a237
    v_mul_f32 v232, v232, v234
    v_mul_f32 v233, v233, v234
    v_accvgpr_write_b32 a236, v232
    v_accvgpr_write_b32 a237, v233
    v_accvgpr_read_b32 v232, a238
    v_accvgpr_read_b32 v233, a239
    v_mul_f32 v232, v232, v234
    v_mul_f32 v233, v233, v234
    v_accvgpr_write_b32 a238, v232
    v_accvgpr_write_b32 a239, v233
    v_accvgpr_read_b32 v232, a240
    v_accvgpr_read_b32 v233, a241
    v_mul_f32 v232, v232, v234
    v_mul_f32 v233, v233, v234
    v_accvgpr_write_b32 a240, v232
    v_accvgpr_write_b32 a241, v233
    v_accvgpr_read_b32 v232, a242
    v_accvgpr_read_b32 v233, a243
    v_mul_f32 v232, v232, v234
    v_mul_f32 v233, v233, v234
    v_accvgpr_write_b32 a242, v232
    v_accvgpr_write_b32 a243, v233
    v_accvgpr_read_b32 v232, a244
    v_accvgpr_read_b32 v233, a245
    v_mul_f32 v232, v232, v234
    v_mul_f32 v233, v233, v234
    v_accvgpr_write_b32 a244, v232
    v_accvgpr_write_b32 a245, v233
    v_accvgpr_read_b32 v232, a246
    v_accvgpr_read_b32 v233, a247
    v_mul_f32 v232, v232, v234
    v_mul_f32 v233, v233, v234
    v_accvgpr_write_b32 a246, v232
    v_accvgpr_write_b32 a247, v233
    v_accvgpr_read_b32 v232, a248
    v_accvgpr_read_b32 v233, a249
    v_mul_f32 v232, v232, v234
    v_mul_f32 v233, v233, v234
    v_accvgpr_write_b32 a248, v232
    v_accvgpr_write_b32 a249, v233
    v_accvgpr_read_b32 v232, a250
    v_accvgpr_read_b32 v233, a251
    v_mul_f32 v232, v232, v234
    v_mul_f32 v233, v233, v234
    v_accvgpr_write_b32 a250, v232
    v_accvgpr_write_b32 a251, v233
    v_accvgpr_read_b32 v232, a252
    v_accvgpr_read_b32 v233, a253
    v_mul_f32 v232, v232, v234
    v_mul_f32 v233, v233, v234
    v_accvgpr_write_b32 a252, v232
    v_accvgpr_write_b32 a253, v233
    v_accvgpr_read_b32 v232, a254
    v_accvgpr_read_b32 v233, a255
    v_mul_f32 v232, v232, v234
    v_mul_f32 v233, v233, v234
    v_accvgpr_write_b32 a254, v232
    v_accvgpr_write_b32 a255, v233
    v_exp_f32 v152, v152
    v_exp_f32 v153, v153
    v_exp_f32 v154, v154
    v_exp_f32 v155, v155
    v_exp_f32 v236, v236
    v_exp_f32 v237, v237
    v_exp_f32 v238, v238
    v_exp_f32 v239, v239
    s_nop 0
    v_add_f32 v231, v231, v152
    v_add_f32 v231, v231, v153
    v_add_f32 v231, v231, v154
    v_add_f32 v231, v231, v155
    v_add_f32 v231, v231, v236
    v_add_f32 v231, v231, v237
    v_add_f32 v231, v231, v238
    v_add_f32 v231, v231, v239
    v_cvt_pk_bf16_f32 v152, v152, v153
    v_cvt_pk_bf16_f32 v153, v154, v155
    v_cvt_pk_bf16_f32 v154, v236, v237
    v_cvt_pk_bf16_f32 v155, v238, v239
    v_mov_b32 v232, 0
    v_mov_b32 v233, 0
    v_mov_b32 v234, 0
    v_mov_b32 v235, 0
    s_nop 1
    s_branch L_back3
L_rare29:
    s_nop 7
    ds_read_b128 v[232:235], v224 offset:17408
    s_waitcnt lgkmcnt(0)
    v_mfma_f32_16x16x32_bf16 v[160:163], v[232:235], v[0:3], 0
    v_mfma_f32_16x16x32_bf16 v[168:171], v[232:235], v[32:35], 0
    v_mfma_f32_16x16x32_bf16 v[176:179], v[232:235], v[64:67], 0
    v_mfma_f32_16x16x32_bf16 v[184:187], v[232:235], v[96:99], 0
    s_nop 7
    ds_read_b128 v[232:235], v224 offset:17472
    s_waitcnt lgkmcnt(0)
    v_mfma_f32_16x16x32_bf16 v[160:163], v[232:235], v[4:7], v[160:163]
    v_mfma_f32_16x16x32_bf16 v[168:171], v[232:235], v[36:39], v[168:171]
    v_mfma_f32_16x16x32_bf16 v[176:179], v[232:235], v[68:71], v[176:179]
    v_mfma_f32_16x16x32_bf16 v[184:187], v[232:235], v[100:103], v[184:187]
    s_nop 7
    ds_read_b128 v[232:235], v224 offset:17536
    s_waitcnt lgkmcnt(0)
    v_mfma_f32_16x16x32_bf16 v[160:163], v[232:235], v[8:11], v[160:163]
    v_mfma_f32_16x16x32_bf16 v[168:171], v[232:235], v[40:43], v[168:171]
    v_mfma_f32_16x16x32_bf16 v[176:179], v[232:235], v[72:75], v[176:179]
    v_mfma_f32_16x16x32_bf16 v[184:187], v[232:235], v[104:107], v[184:187]
    s_nop 7
    ds_read_b128 v[232:235], v224 offset:17600
    s_waitcnt lgkmcnt(0)
    v_mfma_f32_16x16x32_bf16 v[160:163], v[232:235], v[12:15], v[160:163]
    v_mfma_f32_16x16x32_bf16 v[168:171], v[232:235], v[44:47], v[168:171]
    v_mfma_f32_16x16x32_bf16 v[176:179], v[232:235], v[76:79], v[176:179]
    v_mfma_f32_16x16x32_bf16 v[184:187], v[232:235], v[108:111], v[184:187]
    s_nop 7
    ds_read_b128 v[232:235], v224 offset:17664
    s_waitcnt lgkmcnt(0)
    v_mfma_f32_16x16x32_bf16 v[160:163], v[232:235], v[16:19], v[160:163]
    v_mfma_f32_16x16x32_bf16 v[168:171], v[232:235], v[48:51], v[168:171]
    v_mfma_f32_16x16x32_bf16 v[176:179], v[232:235], v[80:83], v[176:179]
    v_mfma_f32_16x16x32_bf16 v[184:187], v[232:235], v[112:115], v[184:187]
    s_nop 7
    ds_read_b128 v[232:235], v224 offset:17728
    s_waitcnt lgkmcnt(0)
    v_mfma_f32_16x16x32_bf16 v[160:163], v[232:235], v[20:23], v[160:163]
    v_mfma_f32_16x16x32_bf16 v[168:171], v[232:235], v[52:55], v[168:171]
    v_mfma_f32_16x16x32_bf16 v[176:179], v[232:235], v[84:87], v[176:179]
    v_mfma_f32_16x16x32_bf16 v[184:187], v[232:235], v[116:119], v[184:187]
    s_nop 7
    ds_read_b128 v[232:235], v224 offset:17792
    s_waitcnt lgkmcnt(0)
    v_mfma_f32_16x16x32_bf16 v[160:163], v[232:235], v[24:27], v[160:163]
    v_mfma_f32_16x16x32_bf16 v[168:171], v[232:235], v[56:59], v[168:171]
    v_mfma_f32_16x16x32_bf16 v[176:179], v[232:235], v[88:91], v[176:179]
    v_mfma_f32_16x16x32_bf16 v[184:187], v[232:235], v[120:123], v[184:187]
    s_nop 7
    ds_read_b128 v[232:235], v224 offset:17856
    s_waitcnt lgkmcnt(0)
    v_mfma_f32_16x16x32_bf16 v[160:163], v[232:235], v[28:31], v[160:163]
    v_mfma_f32_16x16x32_bf16 v[168:171], v[232:235], v[60:63], v[168:171]
    v_mfma_f32_16x16x32_bf16 v[176:179], v[232:235], v[92:95], v[176:179]
    v_mfma_f32_16x16x32_bf16 v[184:187], v[232:235], v[124:127], v[184:187]
    s_nop 7
    ds_read_b128 v[232:235], v224 offset:26112
    s_waitcnt lgkmcnt(0)
    v_mfma_f32_16x16x32_bf16 v[164:167], v[232:235], v[0:3], 0
    v_mfma_f32_16x16x32_bf16 v[172:175], v[232:235], v[32:35], 0
    v_mfma_f32_16x16x32_bf16 v[180:183], v[232:235], v[64:67], 0
    v_mfma_f32_16x16x32_bf16 v[188:191], v[232:235], v[96:99], 0
    s_nop 7
    ds_read_b128 v[232:235], v224 offset:26176
    s_waitcnt lgkmcnt(0)
    v_mfma_f32_16x16x32_bf16 v[164:167], v[232:235], v[4:7], v[164:167]
    v_mfma_f32_16x16x32_bf16 v[172:175], v[232:235], v[36:39], v[172:175]
    v_mfma_f32_16x16x32_bf16 v[180:183], v[232:235], v[68:71], v[180:183]
    v_mfma_f32_16x16x32_bf16 v[188:191], v[232:235], v[100:103], v[188:191]
    s_nop 7
    ds_read_b128 v[232:235], v224 offset:26240
    s_waitcnt lgkmcnt(0)
    v_mfma_f32_16x16x32_bf16 v[164:167], v[232:235], v[8:11], v[164:167]
    v_mfma_f32_16x16x32_bf16 v[172:175], v[232:235], v[40:43], v[172:175]
    v_mfma_f32_16x16x32_bf16 v[180:183], v[232:235], v[72:75], v[180:183]
    v_mfma_f32_16x16x32_bf16 v[188:191], v[232:235], v[104:107], v[188:191]
    s_nop 7
    ds_read_b128 v[232:235], v224 offset:26304
    s_waitcnt lgkmcnt(0)
    v_mfma_f32_16x16x32_bf16 v[164:167], v[232:235], v[12:15], v[164:167]
    v_mfma_f32_16x16x32_bf16 v[172:175], v[232:235], v[44:47], v[172:175]
    v_mfma_f32_16x16x32_bf16 v[180:183], v[232:235], v[76:79], v[180:183]
    v_mfma_f32_16x16x32_bf16 v[188:191], v[232:235], v[108:111], v[188:191]
    s_nop 7
    ds_read_b128 v[232:235], v224 offset:26368
    s_waitcnt lgkmcnt(0)
    v_mfma_f32_16x16x32_bf16 v[164:167], v[232:235], v[16:19], v[164:167]
    v_mfma_f32_16x16x32_bf16 v[172:175], v[232:235], v[48:51], v[172:175]
    v_mfma_f32_16x16x32_bf16 v[180:183], v[232:235], v[80:83], v[180:183]
    v_mfma_f32_16x16x32_bf16 v[188:191], v[232:235], v[112:115], v[188:191]
    s_nop 7
    ds_read_b128 v[232:235], v224 offset:26432
    s_waitcnt lgkmcnt(0)
    v_mfma_f32_16x16x32_bf16 v[164:167], v[232:235], v[20:23], v[164:167]
    v_mfma_f32_16x16x32_bf16 v[172:175], v[232:235], v[52:55], v[172:175]
    v_mfma_f32_16x16x32_bf16 v[180:183], v[232:235], v[84:87], v[180:183]
    v_mfma_f32_16x16x32_bf16 v[188:191], v[232:235], v[116:119], v[188:191]
    s_nop 7
    ds_read_b128 v[232:235], v224 offset:26496
    s_waitcnt lgkmcnt(0)
    v_mfma_f32_16x16x32_bf16 v[164:167], v[232:235], v[24:27], v[164:167]
    v_mfma_f32_16x16x32_bf16 v[172:175], v[232:235], v[56:59], v[172:175]
    v_mfma_f32_16x16x32_bf16 v[180:183], v[232:235], v[88:91], v[180:183]
    v_mfma_f32_16x16x32_bf16 v[188:191], v[232:235], v[120:123], v[188:191]
    s_nop 7
    ds_read_b128 v[232:235], v224 offset:26560
    s_waitcnt lgkmcnt(0)
    v_mfma_f32_16x16x32_bf16 v[164:167], v[232:235], v[28:31], v[164:167]
    v_mfma_f32_16x16x32_bf16 v[172:175], v[232:235], v[60:63], v[172:175]
    v_mfma_f32_16x16x32_bf16 v[180:183], v[232:235], v[92:95], v[180:183]
    v_mfma_f32_16x16x32_bf16 v[188:191], v[232:235], v[124:127], v[188:191]
    s_nop 7
    s_nop 7
    v_add_f32 v160, v160, v240
    v_add_f32 v161, v161, v240
    v_add_f32 v162, v162, v240
    v_add_f32 v163, v163, v240
    v_add_f32 v164, v164, v240
    v_add_f32 v165, v165, v240
    v_add_f32 v166, v166, v240
    v_add_f32 v167, v167, v240
    v_max3_f32 v236, v160, v161, v162
    v_max3_f32 v236, v236, v163, v164
    v_max3_f32 v236, v236, v165, v166
    v_max_f32 v236, v236, v167
    v_mov_b32 v232, v236
    s_nop 1
    v_permlane16_swap_b32 v236, v232
    s_nop 1
    v_max_f32 v236, v236, v232
    v_mov_b32 v232, v236
    s_nop 1
    v_permlane32_swap_b32 v236, v232
    s_nop 1
    v_max_f32 v236, v236, v232
    v_ceil_f32 v236, v236
    v_max_f32 v236, 0, v236
    v_sub_f32 v240, v240, v236
    v_sub_f32 v241, v241, v236
    v_sub_f32 v242, v242, v236
    v_sub_f32 v243, v243, v236
    v_sub_f32 v160, v160, v236
    v_sub_f32 v161, v161, v236
    v_sub_f32 v162, v162, v236
    v_sub_f32 v163, v163, v236
    v_sub_f32 v164, v164, v236
    v_sub_f32 v165, v165, v236
    v_sub_f32 v166, v166, v236
    v_sub_f32 v167, v167, v236
    v_sub_f32 v128, v128, v236
    v_sub_f32 v129, v129, v236
    v_sub_f32 v130, v130, v236
    v_sub_f32 v131, v131, v236
    v_sub_f32 v132, v132, v236
    v_sub_f32 v133, v133, v236
    v_sub_f32 v134, v134, v236
    v_sub_f32 v135, v135, v236
    v_min_f32 v232, 0x43480000, v236
    v_cvt_i32_f32 v232, v232
    v_sub_u32 v232, 0, v232
    v_ldexp_f32 v233, 1.0, v232
    v_mul_f32 v228, v228, v233
    v_accvgpr_read_b32 v236, a0
    v_accvgpr_read_b32 v232, a1
    v_mul_f32 v236, v236, v233
    v_mul_f32 v232, v232, v233
    v_accvgpr_write_b32 a0, v236
    v_accvgpr_write_b32 a1, v232
    v_accvgpr_read_b32 v236, a2
    v_accvgpr_read_b32 v232, a3
    v_mul_f32 v236, v236, v233
    v_mul_f32 v232, v232, v233
    v_accvgpr_write_b32 a2, v236
    v_accvgpr_write_b32 a3, v232
    v_accvgpr_read_b32 v236, a4
    v_accvgpr_read_b32 v232, a5
    v_mul_f32 v236, v236, v233
    v_mul_f32 v232, v232, v233
    v_accvgpr_write_b32 a4, v236
    v_accvgpr_write_b32 a5, v232
    v_accvgpr_read_b32 v236, a6
    v_accvgpr_read_b32 v232, a7
    v_mul_f32 v236, v236, v233
    v_mul_f32 v232, v232, v233
    v_accvgpr_write_b32 a6, v236
    v_accvgpr_write_b32 a7, v232
    v_accvgpr_read_b32 v236, a8
    v_accvgpr_read_b32 v232, a9
    v_mul_f32 v236, v236, v233
    v_mul_f32 v232, v232, v233
    v_accvgpr_write_b32 a8, v236
    v_accvgpr_write_b32 a9, v232
    v_accvgpr_read_b32 v236, a10
    v_accvgpr_read_b32 v232, a11
    v_mul_f32 v236, v236, v233
    v_mul_f32 v232, v232, v233
    v_accvgpr_write_b32 a10, v236
    v_accvgpr_write_b32 a11, v232
    v_accvgpr_read_b32 v236, a12
    v_accvgpr_read_b32 v232, a13
    v_mul_f32 v236, v236, v233
    v_mul_f32 v232, v232, v233
    v_accvgpr_write_b32 a12, v236
    v_accvgpr_write_b32 a13, v232
    v_accvgpr_read_b32 v236, a14
    v_accvgpr_read_b32 v232, a15
    v_mul_f32 v236, v236, v233
    v_mul_f32 v232, v232, v233
    v_accvgpr_write_b32 a14, v236
    v_accvgpr_write_b32 a15, v232
    v_accvgpr_read_b32 v236, a16
    v_accvgpr_read_b32 v232, a17
    v_mul_f32 v236, v236, v233
    v_mul_f32 v232, v232, v233
    v_accvgpr_write_b32 a16, v236
    v_accvgpr_write_b32 a17, v232
    v_accvgpr_read_b32 v236, a18
    v_accvgpr_read_b32 v232, a19
    v_mul_f32 v236, v236, v233
    v_mul_f32 v232, v232, v233
    v_accvgpr_write_b32 a18, v236
    v_accvgpr_write_b32 a19, v232
    v_accvgpr_read_b32 v236, a20
    v_accvgpr_read_b32 v232, a21
    v_mul_f32 v236, v236, v233
    v_mul_f32 v232, v232, v233
    v_accvgpr_write_b32 a20, v236
    v_accvgpr_write_b32 a21, v232
    v_accvgpr_read_b32 v236, a22
    v_accvgpr_read_b32 v232, a23
    v_mul_f32 v236, v236, v233
    v_mul_f32 v232, v232, v233
    v_accvgpr_write_b32 a22, v236
    v_accvgpr_write_b32 a23, v232
    v_accvgpr_read_b32 v236, a24
    v_accvgpr_read_b32 v232, a25
    v_mul_f32 v236, v236, v233
    v_mul_f32 v232, v232, v233
    v_accvgpr_write_b32 a24, v236
    v_accvgpr_write_b32 a25, v232
    v_accvgpr_read_b32 v236, a26
    v_accvgpr_read_b32 v232, a27
    v_mul_f32 v236, v236, v233
    v_mul_f32 v232, v232, v233
    v_accvgpr_write_b32 a26, v236
    v_accvgpr_write_b32 a27, v232
    v_accvgpr_read_b32 v236, a28
    v_accvgpr_read_b32 v232, a29
    v_mul_f32 v236, v236, v233
    v_mul_f32 v232, v232, v233
    v_accvgpr_write_b32 a28, v236
    v_accvgpr_write_b32 a29, v232
    v_accvgpr_read_b32 v236, a30
    v_accvgpr_read_b32 v232, a31
    v_mul_f32 v236, v236, v233
    v_mul_f32 v232, v232, v233
    v_accvgpr_write_b32 a30, v236
    v_accvgpr_write_b32 a31, v232
    v_accvgpr_read_b32 v236, a32
    v_accvgpr_read_b32 v232, a33
    v_mul_f32 v236, v236, v233
    v_mul_f32 v232, v232, v233
    v_accvgpr_write_b32 a32, v236
    v_accvgpr_write_b32 a33, v232
    v_accvgpr_read_b32 v236, a34
    v_accvgpr_read_b32 v232, a35
    v_mul_f32 v236, v236, v233
    v_mul_f32 v232, v232, v233
    v_accvgpr_write_b32 a34, v236
    v_accvgpr_write_b32 a35, v232
    v_accvgpr_read_b32 v236, a36
    v_accvgpr_read_b32 v232, a37
    v_mul_f32 v236, v236, v233
    v_mul_f32 v232, v232, v233
    v_accvgpr_write_b32 a36, v236
    v_accvgpr_write_b32 a37, v232
    v_accvgpr_read_b32 v236, a38
    v_accvgpr_read_b32 v232, a39
    v_mul_f32 v236, v236, v233
    v_mul_f32 v232, v232, v233
    v_accvgpr_write_b32 a38, v236
    v_accvgpr_write_b32 a39, v232
    v_accvgpr_read_b32 v236, a40
    v_accvgpr_read_b32 v232, a41
    v_mul_f32 v236, v236, v233
    v_mul_f32 v232, v232, v233
    v_accvgpr_write_b32 a40, v236
    v_accvgpr_write_b32 a41, v232
    v_accvgpr_read_b32 v236, a42
    v_accvgpr_read_b32 v232, a43
    v_mul_f32 v236, v236, v233
    v_mul_f32 v232, v232, v233
    v_accvgpr_write_b32 a42, v236
    v_accvgpr_write_b32 a43, v232
    v_accvgpr_read_b32 v236, a44
    v_accvgpr_read_b32 v232, a45
    v_mul_f32 v236, v236, v233
    v_mul_f32 v232, v232, v233
    v_accvgpr_write_b32 a44, v236
    v_accvgpr_write_b32 a45, v232
    v_accvgpr_read_b32 v236, a46
    v_accvgpr_read_b32 v232, a47
    v_mul_f32 v236, v236, v233
    v_mul_f32 v232, v232, v233
    v_accvgpr_write_b32 a46, v236
    v_accvgpr_write_b32 a47, v232
    v_accvgpr_read_b32 v236, a48
    v_accvgpr_read_b32 v232, a49
    v_mul_f32 v236, v236, v233
    v_mul_f32 v232, v232, v233
    v_accvgpr_write_b32 a48, v236
    v_accvgpr_write_b32 a49, v232
    v_accvgpr_read_b32 v236, a50
    v_accvgpr_read_b32 v232, a51
    v_mul_f32 v236, v236, v233
    v_mul_f32 v232, v232, v233
    v_accvgpr_write_b32 a50, v236
    v_accvgpr_write_b32 a51, v232
    v_accvgpr_read_b32 v236, a52
    v_accvgpr_read_b32 v232, a53
    v_mul_f32 v236, v236, v233
    v_mul_f32 v232, v232, v233
    v_accvgpr_write_b32 a52, v236
    v_accvgpr_write_b32 a53, v232
    v_accvgpr_read_b32 v236, a54
    v_accvgpr_read_b32 v232, a55
    v_mul_f32 v236, v236, v233
    v_mul_f32 v232, v232, v233
    v_accvgpr_write_b32 a54, v236
    v_accvgpr_write_b32 a55, v232
    v_accvgpr_read_b32 v236, a56
    v_accvgpr_read_b32 v232, a57
    v_mul_f32 v236, v236, v233
    v_mul_f32 v232, v232, v233
    v_accvgpr_write_b32 a56, v236
    v_accvgpr_write_b32 a57, v232
    v_accvgpr_read_b32 v236, a58
    v_accvgpr_read_b32 v232, a59
    v_mul_f32 v236, v236, v233
    v_mul_f32 v232, v232, v233
    v_accvgpr_write_b32 a58, v236
    v_accvgpr_write_b32 a59, v232
    v_accvgpr_read_b32 v236, a60
    v_accvgpr_read_b32 v232, a61
    v_mul_f32 v236, v236, v233
    v_mul_f32 v232, v232, v233
    v_accvgpr_write_b32 a60, v236
    v_accvgpr_write_b32 a61, v232
    v_accvgpr_read_b32 v236, a62
    v_accvgpr_read_b32 v232, a63
    v_mul_f32 v236, v236, v233
    v_mul_f32 v232, v232, v233
    v_accvgpr_write_b32 a62, v236
    v_accvgpr_write_b32 a63, v232
    v_add_f32 v168, v168, v244
    v_add_f32 v169, v169, v244
    v_add_f32 v170, v170, v244
    v_add_f32 v171, v171, v244
    v_add_f32 v172, v172, v244
    v_add_f32 v173, v173, v244
    v_add_f32 v174, v174, v244
    v_add_f32 v175, v175, v244
    v_max3_f32 v236, v168, v169, v170
    v_max3_f32 v236, v236, v171, v172
    v_max3_f32 v236, v236, v173, v174
    v_max_f32 v236, v236, v175
    v_mov_b32 v232, v236
    s_nop 1
    v_permlane16_swap_b32 v236, v232
    s_nop 1
    v_max_f32 v236, v236, v232
    v_mov_b32 v232, v236
    s_nop 1
    v_permlane32_swap_b32 v236, v232
    s_nop 1
    v_max_f32 v236, v236, v232
    v_ceil_f32 v236, v236
    v_max_f32 v236, 0, v236
    v_sub_f32 v244, v244, v236
    v_sub_f32 v245, v245, v236
    v_sub_f32 v246, v246, v236
    v_sub_f32 v247, v247, v236
    v_sub_f32 v168, v168, v236
    v_sub_f32 v169, v169, v236
    v_sub_f32 v170, v170, v236
    v_sub_f32 v171, v171, v236
    v_sub_f32 v172, v172, v236
    v_sub_f32 v173, v173, v236
    v_sub_f32 v174, v174, v236
    v_sub_f32 v175, v175, v236
    v_sub_f32 v136, v136, v236
    v_sub_f32 v137, v137, v236
    v_sub_f32 v138, v138, v236
    v_sub_f32 v139, v139, v236
    v_sub_f32 v140, v140, v236
    v_sub_f32 v141, v141, v236
    v_sub_f32 v142, v142, v236
    v_sub_f32 v143, v143, v236
    v_min_f32 v232, 0x43480000, v236
    v_cvt_i32_f32 v232, v232
    v_sub_u32 v232, 0, v232
    v_ldexp_f32 v233, 1.0, v232
    v_mul_f32 v229, v229, v233
    v_accvgpr_read_b32 v236, a64
    v_accvgpr_read_b32 v232, a65
    v_mul_f32 v236, v236, v233
    v_mul_f32 v232, v232, v233
    v_accvgpr_write_b32 a64, v236
    v_accvgpr_write_b32 a65, v232
    v_accvgpr_read_b32 v236, a66
    v_accvgpr_read_b32 v232, a67
    v_mul_f32 v236, v236, v233
    v_mul_f32 v232, v232, v233
    v_accvgpr_write_b32 a66, v236
    v_accvgpr_write_b32 a67, v232
    v_accvgpr_read_b32 v236, a68
    v_accvgpr_read_b32 v232, a69
    v_mul_f32 v236, v236, v233
    v_mul_f32 v232, v232, v233
    v_accvgpr_write_b32 a68, v236
    v_accvgpr_write_b32 a69, v232
    v_accvgpr_read_b32 v236, a70
    v_accvgpr_read_b32 v232, a71
    v_mul_f32 v236, v236, v233
    v_mul_f32 v232, v232, v233
    v_accvgpr_write_b32 a70, v236
    v_accvgpr_write_b32 a71, v232
    v_accvgpr_read_b32 v236, a72
    v_accvgpr_read_b32 v232, a73
    v_mul_f32 v236, v236, v233
    v_mul_f32 v232, v232, v233
    v_accvgpr_write_b32 a72, v236
    v_accvgpr_write_b32 a73, v232
    v_accvgpr_read_b32 v236, a74
    v_accvgpr_read_b32 v232, a75
    v_mul_f32 v236, v236, v233
    v_mul_f32 v232, v232, v233
    v_accvgpr_write_b32 a74, v236
    v_accvgpr_write_b32 a75, v232
    v_accvgpr_read_b32 v236, a76
    v_accvgpr_read_b32 v232, a77
    v_mul_f32 v236, v236, v233
    v_mul_f32 v232, v232, v233
    v_accvgpr_write_b32 a76, v236
    v_accvgpr_write_b32 a77, v232
    v_accvgpr_read_b32 v236, a78
    v_accvgpr_read_b32 v232, a79
    v_mul_f32 v236, v236, v233
    v_mul_f32 v232, v232, v233
    v_accvgpr_write_b32 a78, v236
    v_accvgpr_write_b32 a79, v232
    v_accvgpr_read_b32 v236, a80
    v_accvgpr_read_b32 v232, a81
    v_mul_f32 v236, v236, v233
    v_mul_f32 v232, v232, v233
    v_accvgpr_write_b32 a80, v236
    v_accvgpr_write_b32 a81, v232
    v_accvgpr_read_b32 v236, a82
    v_accvgpr_read_b32 v232, a83
    v_mul_f32 v236, v236, v233
    v_mul_f32 v232, v232, v233
    v_accvgpr_write_b32 a82, v236
    v_accvgpr_write_b32 a83, v232
    v_accvgpr_read_b32 v236, a84
    v_accvgpr_read_b32 v232, a85
    v_mul_f32 v236, v236, v233
    v_mul_f32 v232, v232, v233
    v_accvgpr_write_b32 a84, v236
    v_accvgpr_write_b32 a85, v232
    v_accvgpr_read_b32 v236, a86
    v_accvgpr_read_b32 v232, a87
    v_mul_f32 v236, v236, v233
    v_mul_f32 v232, v232, v233
    v_accvgpr_write_b32 a86, v236
    v_accvgpr_write_b32 a87, v232
    v_accvgpr_read_b32 v236, a88
    v_accvgpr_read_b32 v232, a89
    v_mul_f32 v236, v236, v233
    v_mul_f32 v232, v232, v233
    v_accvgpr_write_b32 a88, v236
    v_accvgpr_write_b32 a89, v232
    v_accvgpr_read_b32 v236, a90
    v_accvgpr_read_b32 v232, a91
    v_mul_f32 v236, v236, v233
    v_mul_f32 v232, v232, v233
    v_accvgpr_write_b32 a90, v236
    v_accvgpr_write_b32 a91, v232
    v_accvgpr_read_b32 v236, a92
    v_accvgpr_read_b32 v232, a93
    v_mul_f32 v236, v236, v233
    v_mul_f32 v232, v232, v233
    v_accvgpr_write_b32 a92, v236
    v_accvgpr_write_b32 a93, v232
    v_accvgpr_read_b32 v236, a94
    v_accvgpr_read_b32 v232, a95
    v_mul_f32 v236, v236, v233
    v_mul_f32 v232, v232, v233
    v_accvgpr_write_b32 a94, v236
    v_accvgpr_write_b32 a95, v232
    v_accvgpr_read_b32 v236, a96
    v_accvgpr_read_b32 v232, a97
    v_mul_f32 v236, v236, v233
    v_mul_f32 v232, v232, v233
    v_accvgpr_write_b32 a96, v236
    v_accvgpr_write_b32 a97, v232
    v_accvgpr_read_b32 v236, a98
    v_accvgpr_read_b32 v232, a99
    v_mul_f32 v236, v236, v233
    v_mul_f32 v232, v232, v233
    v_accvgpr_write_b32 a98, v236
    v_accvgpr_write_b32 a99, v232
    v_accvgpr_read_b32 v236, a100
    v_accvgpr_read_b32 v232, a101
    v_mul_f32 v236, v236, v233
    v_mul_f32 v232, v232, v233
    v_accvgpr_write_b32 a100, v236
    v_accvgpr_write_b32 a101, v232
    v_accvgpr_read_b32 v236, a102
    v_accvgpr_read_b32 v232, a103
    v_mul_f32 v236, v236, v233
    v_mul_f32 v232, v232, v233
    v_accvgpr_write_b32 a102, v236
    v_accvgpr_write_b32 a103, v232
    v_accvgpr_read_b32 v236, a104
    v_accvgpr_read_b32 v232, a105
    v_mul_f32 v236, v236, v233
    v_mul_f32 v232, v232, v233
    v_accvgpr_write_b32 a104, v236
    v_accvgpr_write_b32 a105, v232
    v_accvgpr_read_b32 v236, a106
    v_accvgpr_read_b32 v232, a107
    v_mul_f32 v236, v236, v233
    v_mul_f32 v232, v232, v233
    v_accvgpr_write_b32 a106, v236
    v_accvgpr_write_b32 a107, v232
    v_accvgpr_read_b32 v236, a108
    v_accvgpr_read_b32 v232, a109
    v_mul_f32 v236, v236, v233
    v_mul_f32 v232, v232, v233
    v_accvgpr_write_b32 a108, v236
    v_accvgpr_write_b32 a109, v232
    v_accvgpr_read_b32 v236, a110
    v_accvgpr_read_b32 v232, a111
    v_mul_f32 v236, v236, v233
    v_mul_f32 v232, v232, v233
    v_accvgpr_write_b32 a110, v236
    v_accvgpr_write_b32 a111, v232
    v_accvgpr_read_b32 v236, a112
    v_accvgpr_read_b32 v232, a113
    v_mul_f32 v236, v236, v233
    v_mul_f32 v232, v232, v233
    v_accvgpr_write_b32 a112, v236
    v_accvgpr_write_b32 a113, v232
    v_accvgpr_read_b32 v236, a114
    v_accvgpr_read_b32 v232, a115
    v_mul_f32 v236, v236, v233
    v_mul_f32 v232, v232, v233
    v_accvgpr_write_b32 a114, v236
    v_accvgpr_write_b32 a115, v232
    v_accvgpr_read_b32 v236, a116
    v_accvgpr_read_b32 v232, a117
    v_mul_f32 v236, v236, v233
    v_mul_f32 v232, v232, v233
    v_accvgpr_write_b32 a116, v236
    v_accvgpr_write_b32 a117, v232
    v_accvgpr_read_b32 v236, a118
    v_accvgpr_read_b32 v232, a119
    v_mul_f32 v236, v236, v233
    v_mul_f32 v232, v232, v233
    v_accvgpr_write_b32 a118, v236
    v_accvgpr_write_b32 a119, v232
    v_accvgpr_read_b32 v236, a120
    v_accvgpr_read_b32 v232, a121
    v_mul_f32 v236, v236, v233
    v_mul_f32 v232, v232, v233
    v_accvgpr_write_b32 a120, v236
    v_accvgpr_write_b32 a121, v232
    v_accvgpr_read_b32 v236, a122
    v_accvgpr_read_b32 v232, a123
    v_mul_f32 v236, v236, v233
    v_mul_f32 v232, v232, v233
    v_accvgpr_write_b32 a122, v236
    v_accvgpr_write_b32 a123, v232
    v_accvgpr_read_b32 v236, a124
    v_accvgpr_read_b32 v232, a125
    v_mul_f32 v236, v236, v233
    v_mul_f32 v232, v232, v233
    v_accvgpr_write_b32 a124, v236
    v_accvgpr_write_b32 a125, v232
    v_accvgpr_read_b32 v236, a126
    v_accvgpr_read_b32 v232, a127
    v_mul_f32 v236, v236, v233
    v_mul_f32 v232, v232, v233
    v_accvgpr_write_b32 a126, v236
    v_accvgpr_write_b32 a127, v232
    v_add_f32 v176, v176, v248
    v_add_f32 v177, v177, v248
    v_add_f32 v178, v178, v248
    v_add_f32 v179, v179, v248
    v_add_f32 v180, v180, v248
    v_add_f32 v181, v181, v248
    v_add_f32 v182, v182, v248
    v_add_f32 v183, v183, v248
    v_max3_f32 v236, v176, v177, v178
    v_max3_f32 v236, v236, v179, v180
    v_max3_f32 v236, v236, v181, v182
    v_max_f32 v236, v236, v183
    v_mov_b32 v232, v236
    s_nop 1
    v_permlane16_swap_b32 v236, v232
    s_nop 1
    v_max_f32 v236, v236, v232
    v_mov_b32 v232, v236
    s_nop 1
    v_permlane32_swap_b32 v236, v232
    s_nop 1
    v_max_f32 v236, v236, v232
    v_ceil_f32 v236, v236
    v_max_f32 v236, 0, v236
    v_sub_f32 v248, v248, v236
    v_sub_f32 v249, v249, v236
    v_sub_f32 v250, v250, v236
    v_sub_f32 v251, v251, v236
    v_sub_f32 v176, v176, v236
    v_sub_f32 v177, v177, v236
    v_sub_f32 v178, v178, v236
    v_sub_f32 v179, v179, v236
    v_sub_f32 v180, v180, v236
    v_sub_f32 v181, v181, v236
    v_sub_f32 v182, v182, v236
    v_sub_f32 v183, v183, v236
    v_sub_f32 v144, v144, v236
    v_sub_f32 v145, v145, v236
    v_sub_f32 v146, v146, v236
    v_sub_f32 v147, v147, v236
    v_sub_f32 v148, v148, v236
    v_sub_f32 v149, v149, v236
    v_sub_f32 v150, v150, v236
    v_sub_f32 v151, v151, v236
    v_min_f32 v232, 0x43480000, v236
    v_cvt_i32_f32 v232, v232
    v_sub_u32 v232, 0, v232
    v_ldexp_f32 v233, 1.0, v232
    v_mul_f32 v230, v230, v233
    v_accvgpr_read_b32 v236, a128
    v_accvgpr_read_b32 v232, a129
    v_mul_f32 v236, v236, v233
    v_mul_f32 v232, v232, v233
    v_accvgpr_write_b32 a128, v236
    v_accvgpr_write_b32 a129, v232
    v_accvgpr_read_b32 v236, a130
    v_accvgpr_read_b32 v232, a131
    v_mul_f32 v236, v236, v233
    v_mul_f32 v232, v232, v233
    v_accvgpr_write_b32 a130, v236
    v_accvgpr_write_b32 a131, v232
    v_accvgpr_read_b32 v236, a132
    v_accvgpr_read_b32 v232, a133
    v_mul_f32 v236, v236, v233
    v_mul_f32 v232, v232, v233
    v_accvgpr_write_b32 a132, v236
    v_accvgpr_write_b32 a133, v232
    v_accvgpr_read_b32 v236, a134
    v_accvgpr_read_b32 v232, a135
    v_mul_f32 v236, v236, v233
    v_mul_f32 v232, v232, v233
    v_accvgpr_write_b32 a134, v236
    v_accvgpr_write_b32 a135, v232
    v_accvgpr_read_b32 v236, a136
    v_accvgpr_read_b32 v232, a137
    v_mul_f32 v236, v236, v233
    v_mul_f32 v232, v232, v233
    v_accvgpr_write_b32 a136, v236
    v_accvgpr_write_b32 a137, v232
    v_accvgpr_read_b32 v236, a138
    v_accvgpr_read_b32 v232, a139
    v_mul_f32 v236, v236, v233
    v_mul_f32 v232, v232, v233
    v_accvgpr_write_b32 a138, v236
    v_accvgpr_write_b32 a139, v232
    v_accvgpr_read_b32 v236, a140
    v_accvgpr_read_b32 v232, a141
    v_mul_f32 v236, v236, v233
    v_mul_f32 v232, v232, v233
    v_accvgpr_write_b32 a140, v236
    v_accvgpr_write_b32 a141, v232
    v_accvgpr_read_b32 v236, a142
    v_accvgpr_read_b32 v232, a143
    v_mul_f32 v236, v236, v233
    v_mul_f32 v232, v232, v233
    v_accvgpr_write_b32 a142, v236
    v_accvgpr_write_b32 a143, v232
    v_accvgpr_read_b32 v236, a144
    v_accvgpr_read_b32 v232, a145
    v_mul_f32 v236, v236, v233
    v_mul_f32 v232, v232, v233
    v_accvgpr_write_b32 a144, v236
    v_accvgpr_write_b32 a145, v232
    v_accvgpr_read_b32 v236, a146
    v_accvgpr_read_b32 v232, a147
    v_mul_f32 v236, v236, v233
    v_mul_f32 v232, v232, v233
    v_accvgpr_write_b32 a146, v236
    v_accvgpr_write_b32 a147, v232
    v_accvgpr_read_b32 v236, a148
    v_accvgpr_read_b32 v232, a149
    v_mul_f32 v236, v236, v233
    v_mul_f32 v232, v232, v233
    v_accvgpr_write_b32 a148, v236
    v_accvgpr_write_b32 a149, v232
    v_accvgpr_read_b32 v236, a150
    v_accvgpr_read_b32 v232, a151
    v_mul_f32 v236, v236, v233
    v_mul_f32 v232, v232, v233
    v_accvgpr_write_b32 a150, v236
    v_accvgpr_write_b32 a151, v232
    v_accvgpr_read_b32 v236, a152
    v_accvgpr_read_b32 v232, a153
    v_mul_f32 v236, v236, v233
    v_mul_f32 v232, v232, v233
    v_accvgpr_write_b32 a152, v236
    v_accvgpr_write_b32 a153, v232
    v_accvgpr_read_b32 v236, a154
    v_accvgpr_read_b32 v232, a155
    v_mul_f32 v236, v236, v233
    v_mul_f32 v232, v232, v233
    v_accvgpr_write_b32 a154, v236
    v_accvgpr_write_b32 a155, v232
    v_accvgpr_read_b32 v236, a156
    v_accvgpr_read_b32 v232, a157
    v_mul_f32 v236, v236, v233
    v_mul_f32 v232, v232, v233
    v_accvgpr_write_b32 a156, v236
    v_accvgpr_write_b32 a157, v232
    v_accvgpr_read_b32 v236, a158
    v_accvgpr_read_b32 v232, a159
    v_mul_f32 v236, v236, v233
    v_mul_f32 v232, v232, v233
    v_accvgpr_write_b32 a158, v236
    v_accvgpr_write_b32 a159, v232
    v_accvgpr_read_b32 v236, a160
    v_accvgpr_read_b32 v232, a161
    v_mul_f32 v236, v236, v233
    v_mul_f32 v232, v232, v233
    v_accvgpr_write_b32 a160, v236
    v_accvgpr_write_b32 a161, v232
    v_accvgpr_read_b32 v236, a162
    v_accvgpr_read_b32 v232, a163
    v_mul_f32 v236, v236, v233
    v_mul_f32 v232, v232, v233
    v_accvgpr_write_b32 a162, v236
    v_accvgpr_write_b32 a163, v232
    v_accvgpr_read_b32 v236, a164
    v_accvgpr_read_b32 v232, a165
    v_mul_f32 v236, v236, v233
    v_mul_f32 v232, v232, v233
    v_accvgpr_write_b32 a164, v236
    v_accvgpr_write_b32 a165, v232
    v_accvgpr_read_b32 v236, a166
    v_accvgpr_read_b32 v232, a167
    v_mul_f32 v236, v236, v233
    v_mul_f32 v232, v232, v233
    v_accvgpr_write_b32 a166, v236
    v_accvgpr_write_b32 a167, v232
    v_accvgpr_read_b32 v236, a168
    v_accvgpr_read_b32 v232, a169
    v_mul_f32 v236, v236, v233
    v_mul_f32 v232, v232, v233
    v_accvgpr_write_b32 a168, v236
    v_accvgpr_write_b32 a169, v232
    v_accvgpr_read_b32 v236, a170
    v_accvgpr_read_b32 v232, a171
    v_mul_f32 v236, v236, v233
    v_mul_f32 v232, v232, v233
    v_accvgpr_write_b32 a170, v236
    v_accvgpr_write_b32 a171, v232
    v_accvgpr_read_b32 v236, a172
    v_accvgpr_read_b32 v232, a173
    v_mul_f32 v236, v236, v233
    v_mul_f32 v232, v232, v233
    v_accvgpr_write_b32 a172, v236
    v_accvgpr_write_b32 a173, v232
    v_accvgpr_read_b32 v236, a174
    v_accvgpr_read_b32 v232, a175
    v_mul_f32 v236, v236, v233
    v_mul_f32 v232, v232, v233
    v_accvgpr_write_b32 a174, v236
    v_accvgpr_write_b32 a175, v232
    v_accvgpr_read_b32 v236, a176
    v_accvgpr_read_b32 v232, a177
    v_mul_f32 v236, v236, v233
    v_mul_f32 v232, v232, v233
    v_accvgpr_write_b32 a176, v236
    v_accvgpr_write_b32 a177, v232
    v_accvgpr_read_b32 v236, a178
    v_accvgpr_read_b32 v232, a179
    v_mul_f32 v236, v236, v233
    v_mul_f32 v232, v232, v233
    v_accvgpr_write_b32 a178, v236
    v_accvgpr_write_b32 a179, v232
    v_accvgpr_read_b32 v236, a180
    v_accvgpr_read_b32 v232, a181
    v_mul_f32 v236, v236, v233
    v_mul_f32 v232, v232, v233
    v_accvgpr_write_b32 a180, v236
    v_accvgpr_write_b32 a181, v232
    v_accvgpr_read_b32 v236, a182
    v_accvgpr_read_b32 v232, a183
    v_mul_f32 v236, v236, v233
    v_mul_f32 v232, v232, v233
    v_accvgpr_write_b32 a182, v236
    v_accvgpr_write_b32 a183, v232
    v_accvgpr_read_b32 v236, a184
    v_accvgpr_read_b32 v232, a185
    v_mul_f32 v236, v236, v233
    v_mul_f32 v232, v232, v233
    v_accvgpr_write_b32 a184, v236
    v_accvgpr_write_b32 a185, v232
    v_accvgpr_read_b32 v236, a186
    v_accvgpr_read_b32 v232, a187
    v_mul_f32 v236, v236, v233
    v_mul_f32 v232, v232, v233
    v_accvgpr_write_b32 a186, v236
    v_accvgpr_write_b32 a187, v232
    v_accvgpr_read_b32 v236, a188
    v_accvgpr_read_b32 v232, a189
    v_mul_f32 v236, v236, v233
    v_mul_f32 v232, v232, v233
    v_accvgpr_write_b32 a188, v236
    v_accvgpr_write_b32 a189, v232
    v_accvgpr_read_b32 v236, a190
    v_accvgpr_read_b32 v232, a191
    v_mul_f32 v236, v236, v233
    v_mul_f32 v232, v232, v233
    v_accvgpr_write_b32 a190, v236
    v_accvgpr_write_b32 a191, v232
    v_add_f32 v184, v184, v252
    v_add_f32 v185, v185, v252
    v_add_f32 v186, v186, v252
    v_add_f32 v187, v187, v252
    v_add_f32 v188, v188, v252
    v_add_f32 v189, v189, v252
    v_add_f32 v190, v190, v252
    v_add_f32 v191, v191, v252
    v_max3_f32 v236, v184, v185, v186
    v_max3_f32 v236, v236, v187, v188
    v_max3_f32 v236, v236, v189, v190
    v_max_f32 v236, v236, v191
    v_mov_b32 v232, v236
    s_nop 1
    v_permlane16_swap_b32 v236, v232
    s_nop 1
    v_max_f32 v236, v236, v232
    v_mov_b32 v232, v236
    s_nop 1
    v_permlane32_swap_b32 v236, v232
    s_nop 1
    v_max_f32 v236, v236, v232
    v_ceil_f32 v236, v236
    v_max_f32 v236, 0, v236
    v_sub_f32 v252, v252, v236
    v_sub_f32 v253, v253, v236
    v_sub_f32 v254, v254, v236
    v_sub_f32 v255, v255, v236
    v_sub_f32 v184, v184, v236
    v_sub_f32 v185, v185, v236
    v_sub_f32 v186, v186, v236
    v_sub_f32 v187, v187, v236
    v_sub_f32 v188, v188, v236
    v_sub_f32 v189, v189, v236
    v_sub_f32 v190, v190, v236
    v_sub_f32 v191, v191, v236
    v_sub_f32 v152, v152, v236
    v_sub_f32 v153, v153, v236
    v_sub_f32 v154, v154, v236
    v_sub_f32 v155, v155, v236
    v_sub_f32 v156, v156, v236
    v_sub_f32 v157, v157, v236
    v_sub_f32 v158, v158, v236
    v_sub_f32 v159, v159, v236
    v_min_f32 v232, 0x43480000, v236
    v_cvt_i32_f32 v232, v232
    v_sub_u32 v232, 0, v232
    v_ldexp_f32 v233, 1.0, v232
    v_mul_f32 v231, v231, v233
    v_accvgpr_read_b32 v236, a192
    v_accvgpr_read_b32 v232, a193
    v_mul_f32 v236, v236, v233
    v_mul_f32 v232, v232, v233
    v_accvgpr_write_b32 a192, v236
    v_accvgpr_write_b32 a193, v232
    v_accvgpr_read_b32 v236, a194
    v_accvgpr_read_b32 v232, a195
    v_mul_f32 v236, v236, v233
    v_mul_f32 v232, v232, v233
    v_accvgpr_write_b32 a194, v236
    v_accvgpr_write_b32 a195, v232
    v_accvgpr_read_b32 v236, a196
    v_accvgpr_read_b32 v232, a197
    v_mul_f32 v236, v236, v233
    v_mul_f32 v232, v232, v233
    v_accvgpr_write_b32 a196, v236
    v_accvgpr_write_b32 a197, v232
    v_accvgpr_read_b32 v236, a198
    v_accvgpr_read_b32 v232, a199
    v_mul_f32 v236, v236, v233
    v_mul_f32 v232, v232, v233
    v_accvgpr_write_b32 a198, v236
    v_accvgpr_write_b32 a199, v232
    v_accvgpr_read_b32 v236, a200
    v_accvgpr_read_b32 v232, a201
    v_mul_f32 v236, v236, v233
    v_mul_f32 v232, v232, v233
    v_accvgpr_write_b32 a200, v236
    v_accvgpr_write_b32 a201, v232
    v_accvgpr_read_b32 v236, a202
    v_accvgpr_read_b32 v232, a203
    v_mul_f32 v236, v236, v233
    v_mul_f32 v232, v232, v233
    v_accvgpr_write_b32 a202, v236
    v_accvgpr_write_b32 a203, v232
    v_accvgpr_read_b32 v236, a204
    v_accvgpr_read_b32 v232, a205
    v_mul_f32 v236, v236, v233
    v_mul_f32 v232, v232, v233
    v_accvgpr_write_b32 a204, v236
    v_accvgpr_write_b32 a205, v232
    v_accvgpr_read_b32 v236, a206
    v_accvgpr_read_b32 v232, a207
    v_mul_f32 v236, v236, v233
    v_mul_f32 v232, v232, v233
    v_accvgpr_write_b32 a206, v236
    v_accvgpr_write_b32 a207, v232
    v_accvgpr_read_b32 v236, a208
    v_accvgpr_read_b32 v232, a209
    v_mul_f32 v236, v236, v233
    v_mul_f32 v232, v232, v233
    v_accvgpr_write_b32 a208, v236
    v_accvgpr_write_b32 a209, v232
    v_accvgpr_read_b32 v236, a210
    v_accvgpr_read_b32 v232, a211
    v_mul_f32 v236, v236, v233
    v_mul_f32 v232, v232, v233
    v_accvgpr_write_b32 a210, v236
    v_accvgpr_write_b32 a211, v232
    v_accvgpr_read_b32 v236, a212
    v_accvgpr_read_b32 v232, a213
    v_mul_f32 v236, v236, v233
    v_mul_f32 v232, v232, v233
    v_accvgpr_write_b32 a212, v236
    v_accvgpr_write_b32 a213, v232
    v_accvgpr_read_b32 v236, a214
    v_accvgpr_read_b32 v232, a215
    v_mul_f32 v236, v236, v233
    v_mul_f32 v232, v232, v233
    v_accvgpr_write_b32 a214, v236
    v_accvgpr_write_b32 a215, v232
    v_accvgpr_read_b32 v236, a216
    v_accvgpr_read_b32 v232, a217
    v_mul_f32 v236, v236, v233
    v_mul_f32 v232, v232, v233
    v_accvgpr_write_b32 a216, v236
    v_accvgpr_write_b32 a217, v232
    v_accvgpr_read_b32 v236, a218
    v_accvgpr_read_b32 v232, a219
    v_mul_f32 v236, v236, v233
    v_mul_f32 v232, v232, v233
    v_accvgpr_write_b32 a218, v236
    v_accvgpr_write_b32 a219, v232
    v_accvgpr_read_b32 v236, a220
    v_accvgpr_read_b32 v232, a221
    v_mul_f32 v236, v236, v233
    v_mul_f32 v232, v232, v233
    v_accvgpr_write_b32 a220, v236
    v_accvgpr_write_b32 a221, v232
    v_accvgpr_read_b32 v236, a222
    v_accvgpr_read_b32 v232, a223
    v_mul_f32 v236, v236, v233
    v_mul_f32 v232, v232, v233
    v_accvgpr_write_b32 a222, v236
    v_accvgpr_write_b32 a223, v232
    v_accvgpr_read_b32 v236, a224
    v_accvgpr_read_b32 v232, a225
    v_mul_f32 v236, v236, v233
    v_mul_f32 v232, v232, v233
    v_accvgpr_write_b32 a224, v236
    v_accvgpr_write_b32 a225, v232
    v_accvgpr_read_b32 v236, a226
    v_accvgpr_read_b32 v232, a227
    v_mul_f32 v236, v236, v233
    v_mul_f32 v232, v232, v233
    v_accvgpr_write_b32 a226, v236
    v_accvgpr_write_b32 a227, v232
    v_accvgpr_read_b32 v236, a228
    v_accvgpr_read_b32 v232, a229
    v_mul_f32 v236, v236, v233
    v_mul_f32 v232, v232, v233
    v_accvgpr_write_b32 a228, v236
    v_accvgpr_write_b32 a229, v232
    v_accvgpr_read_b32 v236, a230
    v_accvgpr_read_b32 v232, a231
    v_mul_f32 v236, v236, v233
    v_mul_f32 v232, v232, v233
    v_accvgpr_write_b32 a230, v236
    v_accvgpr_write_b32 a231, v232
    v_accvgpr_read_b32 v236, a232
    v_accvgpr_read_b32 v232, a233
    v_mul_f32 v236, v236, v233
    v_mul_f32 v232, v232, v233
    v_accvgpr_write_b32 a232, v236
    v_accvgpr_write_b32 a233, v232
    v_accvgpr_read_b32 v236, a234
    v_accvgpr_read_b32 v232, a235
    v_mul_f32 v236, v236, v233
    v_mul_f32 v232, v232, v233
    v_accvgpr_write_b32 a234, v236
    v_accvgpr_write_b32 a235, v232
    v_accvgpr_read_b32 v236, a236
    v_accvgpr_read_b32 v232, a237
    v_mul_f32 v236, v236, v233
    v_mul_f32 v232, v232, v233
    v_accvgpr_write_b32 a236, v236
    v_accvgpr_write_b32 a237, v232
    v_accvgpr_read_b32 v236, a238
    v_accvgpr_read_b32 v232, a239
    v_mul_f32 v236, v236, v233
    v_mul_f32 v232, v232, v233
    v_accvgpr_write_b32 a238, v236
    v_accvgpr_write_b32 a239, v232
    v_accvgpr_read_b32 v236, a240
    v_accvgpr_read_b32 v232, a241
    v_mul_f32 v236, v236, v233
    v_mul_f32 v232, v232, v233
    v_accvgpr_write_b32 a240, v236
    v_accvgpr_write_b32 a241, v232
    v_accvgpr_read_b32 v236, a242
    v_accvgpr_read_b32 v232, a243
    v_mul_f32 v236, v236, v233
    v_mul_f32 v232, v232, v233
    v_accvgpr_write_b32 a242, v236
    v_accvgpr_write_b32 a243, v232
    v_accvgpr_read_b32 v236, a244
    v_accvgpr_read_b32 v232, a245
    v_mul_f32 v236, v236, v233
    v_mul_f32 v232, v232, v233
    v_accvgpr_write_b32 a244, v236
    v_accvgpr_write_b32 a245, v232
    v_accvgpr_read_b32 v236, a246
    v_accvgpr_read_b32 v232, a247
    v_mul_f32 v236, v236, v233
    v_mul_f32 v232, v232, v233
    v_accvgpr_write_b32 a246, v236
    v_accvgpr_write_b32 a247, v232
    v_accvgpr_read_b32 v236, a248
    v_accvgpr_read_b32 v232, a249
    v_mul_f32 v236, v236, v233
    v_mul_f32 v232, v232, v233
    v_accvgpr_write_b32 a248, v236
    v_accvgpr_write_b32 a249, v232
    v_accvgpr_read_b32 v236, a250
    v_accvgpr_read_b32 v232, a251
    v_mul_f32 v236, v236, v233
    v_mul_f32 v232, v232, v233
    v_accvgpr_write_b32 a250, v236
    v_accvgpr_write_b32 a251, v232
    v_accvgpr_read_b32 v236, a252
    v_accvgpr_read_b32 v232, a253
    v_mul_f32 v236, v236, v233
    v_mul_f32 v232, v232, v233
    v_accvgpr_write_b32 a252, v236
    v_accvgpr_write_b32 a253, v232
    v_accvgpr_read_b32 v236, a254
    v_accvgpr_read_b32 v232, a255
    v_mul_f32 v236, v236, v233
    v_mul_f32 v232, v232, v233
    v_accvgpr_write_b32 a254, v236
    v_accvgpr_write_b32 a255, v232
    v_exp_f32 v160, v160
    v_exp_f32 v161, v161
    v_exp_f32 v162, v162
    v_exp_f32 v163, v163
    v_exp_f32 v164, v164
    v_exp_f32 v165, v165
    v_exp_f32 v166, v166
    v_exp_f32 v167, v167
    v_exp_f32 v168, v168
    v_exp_f32 v169, v169
    v_exp_f32 v170, v170
    v_exp_f32 v171, v171
    v_exp_f32 v172, v172
    v_exp_f32 v173, v173
    v_exp_f32 v174, v174
    v_exp_f32 v175, v175
    v_exp_f32 v176, v176
    v_exp_f32 v177, v177
    v_exp_f32 v178, v178
    v_exp_f32 v179, v179
    v_exp_f32 v180, v180
    v_exp_f32 v181, v181
    v_exp_f32 v182, v182
    v_exp_f32 v183, v183
    v_exp_f32 v184, v184
    v_exp_f32 v185, v185
    v_exp_f32 v186, v186
    v_exp_f32 v187, v187
    v_exp_f32 v188, v188
    v_exp_f32 v189, v189
    v_exp_f32 v190, v190
    v_exp_f32 v191, v191
    s_nop 0
    v_add_f32 v232, v160, v161
    v_add_f32 v232, v232, v162
    v_add_f32 v232, v232, v163
    v_add_f32 v232, v232, v164
    v_add_f32 v232, v232, v165
    v_add_f32 v232, v232, v166
    v_add_f32 v232, v232, v167
    v_add_f32 v233, v168, v169
    v_add_f32 v233, v233, v170
    v_add_f32 v233, v233, v171
    v_add_f32 v233, v233, v172
    v_add_f32 v233, v233, v173
    v_add_f32 v233, v233, v174
    v_add_f32 v233, v233, v175
    v_add_f32 v234, v176, v177
    v_add_f32 v234, v234, v178
    v_add_f32 v234, v234, v179
    v_add_f32 v234, v234, v180
    v_add_f32 v234, v234, v181
    v_add_f32 v234, v234, v182
    v_add_f32 v234, v234, v183
    v_add_f32 v235, v184, v185
    v_add_f32 v235, v235, v186
    v_add_f32 v235, v235, v187
    v_add_f32 v235, v235, v188
    v_add_f32 v235, v235, v189
    v_add_f32 v235, v235, v190
    v_add_f32 v235, v235, v191
    v_cvt_pk_bf16_f32 v160, v160, v161
    v_cvt_pk_bf16_f32 v161, v162, v163
    v_cvt_pk_bf16_f32 v162, v164, v165
    v_cvt_pk_bf16_f32 v163, v166, v167
    v_cvt_pk_bf16_f32 v168, v168, v169
    v_cvt_pk_bf16_f32 v169, v170, v171
    v_cvt_pk_bf16_f32 v170, v172, v173
    v_cvt_pk_bf16_f32 v171, v174, v175
    v_cvt_pk_bf16_f32 v176, v176, v177
    v_cvt_pk_bf16_f32 v177, v178, v179
    v_cvt_pk_bf16_f32 v178, v180, v181
    v_cvt_pk_bf16_f32 v179, v182, v183
    v_cvt_pk_bf16_f32 v184, v184, v185
    v_cvt_pk_bf16_f32 v185, v186, v187
    v_cvt_pk_bf16_f32 v186, v188, v189
    v_cvt_pk_bf16_f32 v187, v190, v191
    s_nop 1
    s_branch L_back29
L_rare30:
    s_nop 7
    ds_read_b128 v[232:235], v224 offset:34816
    s_waitcnt lgkmcnt(0)
    v_mfma_f32_16x16x32_bf16 v[128:131], v[232:235], v[0:3], 0
    v_mfma_f32_16x16x32_bf16 v[136:139], v[232:235], v[32:35], 0
    v_mfma_f32_16x16x32_bf16 v[144:147], v[232:235], v[64:67], 0
    v_mfma_f32_16x16x32_bf16 v[152:155], v[232:235], v[96:99], 0
    s_nop 7
    ds_read_b128 v[232:235], v224 offset:34880
    s_waitcnt lgkmcnt(0)
    v_mfma_f32_16x16x32_bf16 v[128:131], v[232:235], v[4:7], v[128:131]
    v_mfma_f32_16x16x32_bf16 v[136:139], v[232:235], v[36:39], v[136:139]
    v_mfma_f32_16x16x32_bf16 v[144:147], v[232:235], v[68:71], v[144:147]
    v_mfma_f32_16x16x32_bf16 v[152:155], v[232:235], v[100:103], v[152:155]
    s_nop 7
    ds_read_b128 v[232:235], v224 offset:34944
    s_waitcnt lgkmcnt(0)
    v_mfma_f32_16x16x32_bf16 v[128:131], v[232:235], v[8:11], v[128:131]
    v_mfma_f32_16x16x32_bf16 v[136:139], v[232:235], v[40:43], v[136:139]
    v_mfma_f32_16x16x32_bf16 v[144:147], v[232:235], v[72:75], v[144:147]
    v_mfma_f32_16x16x32_bf16 v[152:155], v[232:235], v[104:107], v[152:155]
    s_nop 7
    ds_read_b128 v[232:235], v224 offset:35008
    s_waitcnt lgkmcnt(0)
    v_mfma_f32_16x16x32_bf16 v[128:131], v[232:235], v[12:15], v[128:131]
    v_mfma_f32_16x16x32_bf16 v[136:139], v[232:235], v[44:47], v[136:139]
    v_mfma_f32_16x16x32_bf16 v[144:147], v[232:235], v[76:79], v[144:147]
    v_mfma_f32_16x16x32_bf16 v[152:155], v[232:235], v[108:111], v[152:155]
    s_nop 7
    ds_read_b128 v[232:235], v224 offset:35072
    s_waitcnt lgkmcnt(0)
    v_mfma_f32_16x16x32_bf16 v[128:131], v[232:235], v[16:19], v[128:131]
    v_mfma_f32_16x16x32_bf16 v[136:139], v[232:235], v[48:51], v[136:139]
    v_mfma_f32_16x16x32_bf16 v[144:147], v[232:235], v[80:83], v[144:147]
    v_mfma_f32_16x16x32_bf16 v[152:155], v[232:235], v[112:115], v[152:155]
    s_nop 7
    ds_read_b128 v[232:235], v224 offset:35136
    s_waitcnt lgkmcnt(0)
    v_mfma_f32_16x16x32_bf16 v[128:131], v[232:235], v[20:23], v[128:131]
    v_mfma_f32_16x16x32_bf16 v[136:139], v[232:235], v[52:55], v[136:139]
    v_mfma_f32_16x16x32_bf16 v[144:147], v[232:235], v[84:87], v[144:147]
    v_mfma_f32_16x16x32_bf16 v[152:155], v[232:235], v[116:119], v[152:155]
    s_nop 7
    ds_read_b128 v[232:235], v224 offset:35200
    s_waitcnt lgkmcnt(0)
    v_mfma_f32_16x16x32_bf16 v[128:131], v[232:235], v[24:27], v[128:131]
    v_mfma_f32_16x16x32_bf16 v[136:139], v[232:235], v[56:59], v[136:139]
    v_mfma_f32_16x16x32_bf16 v[144:147], v[232:235], v[88:91], v[144:147]
    v_mfma_f32_16x16x32_bf16 v[152:155], v[232:235], v[120:123], v[152:155]
    s_nop 7
    ds_read_b128 v[232:235], v224 offset:35264
    s_waitcnt lgkmcnt(0)
    v_mfma_f32_16x16x32_bf16 v[128:131], v[232:235], v[28:31], v[128:131]
    v_mfma_f32_16x16x32_bf16 v[136:139], v[232:235], v[60:63], v[136:139]
    v_mfma_f32_16x16x32_bf16 v[144:147], v[232:235], v[92:95], v[144:147]
    v_mfma_f32_16x16x32_bf16 v[152:155], v[232:235], v[124:127], v[152:155]
    s_nop 7
    ds_read_b128 v[232:235], v224 offset:43520
    s_waitcnt lgkmcnt(0)
    v_mfma_f32_16x16x32_bf16 v[132:135], v[232:235], v[0:3], 0
    v_mfma_f32_16x16x32_bf16 v[140:143], v[232:235], v[32:35], 0
    v_mfma_f32_16x16x32_bf16 v[148:151], v[232:235], v[64:67], 0
    v_mfma_f32_16x16x32_bf16 v[156:159], v[232:235], v[96:99], 0
    s_nop 7
    ds_read_b128 v[232:235], v224 offset:43584
    s_waitcnt lgkmcnt(0)
    v_mfma_f32_16x16x32_bf16 v[132:135], v[232:235], v[4:7], v[132:135]
    v_mfma_f32_16x16x32_bf16 v[140:143], v[232:235], v[36:39], v[140:143]
    v_mfma_f32_16x16x32_bf16 v[148:151], v[232:235], v[68:71], v[148:151]
    v_mfma_f32_16x16x32_bf16 v[156:159], v[232:235], v[100:103], v[156:159]
    s_nop 7
    ds_read_b128 v[232:235], v224 offset:43648
    s_waitcnt lgkmcnt(0)
    v_mfma_f32_16x16x32_bf16 v[132:135], v[232:235], v[8:11], v[132:135]
    v_mfma_f32_16x16x32_bf16 v[140:143], v[232:235], v[40:43], v[140:143]
    v_mfma_f32_16x16x32_bf16 v[148:151], v[232:235], v[72:75], v[148:151]
    v_mfma_f32_16x16x32_bf16 v[156:159], v[232:235], v[104:107], v[156:159]
    s_nop 7
    ds_read_b128 v[232:235], v224 offset:43712
    s_waitcnt lgkmcnt(0)
    v_mfma_f32_16x16x32_bf16 v[132:135], v[232:235], v[12:15], v[132:135]
    v_mfma_f32_16x16x32_bf16 v[140:143], v[232:235], v[44:47], v[140:143]
    v_mfma_f32_16x16x32_bf16 v[148:151], v[232:235], v[76:79], v[148:151]
    v_mfma_f32_16x16x32_bf16 v[156:159], v[232:235], v[108:111], v[156:159]
    s_nop 7
    ds_read_b128 v[232:235], v224 offset:43776
    s_waitcnt lgkmcnt(0)
    v_mfma_f32_16x16x32_bf16 v[132:135], v[232:235], v[16:19], v[132:135]
    v_mfma_f32_16x16x32_bf16 v[140:143], v[232:235], v[48:51], v[140:143]
    v_mfma_f32_16x16x32_bf16 v[148:151], v[232:235], v[80:83], v[148:151]
    v_mfma_f32_16x16x32_bf16 v[156:159], v[232:235], v[112:115], v[156:159]
    s_nop 7
    ds_read_b128 v[232:235], v224 offset:43840
    s_waitcnt lgkmcnt(0)
    v_mfma_f32_16x16x32_bf16 v[132:135], v[232:235], v[20:23], v[132:135]
    v_mfma_f32_16x16x32_bf16 v[140:143], v[232:235], v[52:55], v[140:143]
    v_mfma_f32_16x16x32_bf16 v[148:151], v[232:235], v[84:87], v[148:151]
    v_mfma_f32_16x16x32_bf16 v[156:159], v[232:235], v[116:119], v[156:159]
    s_nop 7
    ds_read_b128 v[232:235], v224 offset:43904
    s_waitcnt lgkmcnt(0)
    v_mfma_f32_16x16x32_bf16 v[132:135], v[232:235], v[24:27], v[132:135]
    v_mfma_f32_16x16x32_bf16 v[140:143], v[232:235], v[56:59], v[140:143]
    v_mfma_f32_16x16x32_bf16 v[148:151], v[232:235], v[88:91], v[148:151]
    v_mfma_f32_16x16x32_bf16 v[156:159], v[232:235], v[120:123], v[156:159]
    s_nop 7
    ds_read_b128 v[232:235], v224 offset:43968
    s_waitcnt lgkmcnt(0)
    v_mfma_f32_16x16x32_bf16 v[132:135], v[232:235], v[28:31], v[132:135]
    v_mfma_f32_16x16x32_bf16 v[140:143], v[232:235], v[60:63], v[140:143]
    v_mfma_f32_16x16x32_bf16 v[148:151], v[232:235], v[92:95], v[148:151]
    v_mfma_f32_16x16x32_bf16 v[156:159], v[232:235], v[124:127], v[156:159]
    s_nop 7
    s_nop 7
    v_add_f32 v128, v128, v237
    v_add_f32 v129, v129, v237
    v_add_f32 v130, v130, v237
    v_add_f32 v131, v131, v237
    v_add_f32 v132, v132, v237
    v_add_f32 v133, v133, v237
    v_add_f32 v134, v134, v237
    v_add_f32 v135, v135, v237
    v_max3_f32 v236, v128, v129, v130
    v_max3_f32 v236, v236, v131, v132
    v_max3_f32 v236, v236, v133, v134
    v_max_f32 v236, v236, v135
    v_mov_b32 v232, v236
    s_nop 1
    v_permlane16_swap_b32 v236, v232
    s_nop 1
    v_max_f32 v236, v236, v232
    v_mov_b32 v232, v236
    s_nop 1
    v_permlane32_swap_b32 v236, v232
    s_nop 1
    v_max_f32 v236, v236, v232
    v_ceil_f32 v236, v236
    v_max_f32 v236, 0, v236
    v_sub_f32 v237, v237, v236
    v_sub_f32 v128, v128, v236
    v_sub_f32 v129, v129, v236
    v_sub_f32 v130, v130, v236
    v_sub_f32 v131, v131, v236
    v_sub_f32 v132, v132, v236
    v_sub_f32 v133, v133, v236
    v_sub_f32 v134, v134, v236
    v_sub_f32 v135, v135, v236
    v_sub_f32 v164, v164, v236
    v_sub_f32 v165, v165, v236
    v_sub_f32 v166, v166, v236
    v_sub_f32 v167, v167, v236
    v_sub_f32 v240, v240, v236
    v_sub_f32 v241, v241, v236
    v_sub_f32 v242, v242, v236
    v_sub_f32 v243, v243, v236
    v_min_f32 v232, 0x43480000, v236
    v_cvt_i32_f32 v232, v232
    v_sub_u32 v232, 0, v232
    v_ldexp_f32 v233, 1.0, v232
    v_mul_f32 v228, v228, v233
    v_lshlrev_b32 v236, 16, v160
    v_and_b32 v232, 0xffff0000, v160
    v_mul_f32 v236, v236, v233
    v_mul_f32 v232, v232, v233
    v_cvt_pk_bf16_f32 v160, v236, v232
    v_lshlrev_b32 v236, 16, v161
    v_and_b32 v232, 0xffff0000, v161
    v_mul_f32 v236, v236, v233
    v_mul_f32 v232, v232, v233
    v_cvt_pk_bf16_f32 v161, v236, v232
    v_lshlrev_b32 v236, 16, v162
    v_and_b32 v232, 0xffff0000, v162
    v_mul_f32 v236, v236, v233
    v_mul_f32 v232, v232, v233
    v_cvt_pk_bf16_f32 v162, v236, v232
    v_lshlrev_b32 v236, 16, v163
    v_and_b32 v232, 0xffff0000, v163
    v_mul_f32 v236, v236, v233
    v_mul_f32 v232, v232, v233
    v_cvt_pk_bf16_f32 v163, v236, v232
    v_accvgpr_read_b32 v236, a0
    v_accvgpr_read_b32 v232, a1
    v_mul_f32 v236, v236, v233
    v_mul_f32 v232, v232, v233
    v_accvgpr_write_b32 a0, v236
    v_accvgpr_write_b32 a1, v232
    v_accvgpr_read_b32 v236, a2
    v_accvgpr_read_b32 v232, a3
    v_mul_f32 v236, v236, v233
    v_mul_f32 v232, v232, v233
    v_accvgpr_write_b32 a2, v236
    v_accvgpr_write_b32 a3, v232
    v_accvgpr_read_b32 v236, a4
    v_accvgpr_read_b32 v232, a5
    v_mul_f32 v236, v236, v233
    v_mul_f32 v232, v232, v233
    v_accvgpr_write_b32 a4, v236
    v_accvgpr_write_b32 a5, v232
    v_accvgpr_read_b32 v236, a6
    v_accvgpr_read_b32 v232, a7
    v_mul_f32 v236, v236, v233
    v_mul_f32 v232, v232, v233
    v_accvgpr_write_b32 a6, v236
    v_accvgpr_write_b32 a7, v232
    v_accvgpr_read_b32 v236, a8
    v_accvgpr_read_b32 v232, a9
    v_mul_f32 v236, v236, v233
    v_mul_f32 v232, v232, v233
    v_accvgpr_write_b32 a8, v236
    v_accvgpr_write_b32 a9, v232
    v_accvgpr_read_b32 v236, a10
    v_accvgpr_read_b32 v232, a11
    v_mul_f32 v236, v236, v233
    v_mul_f32 v232, v232, v233
    v_accvgpr_write_b32 a10, v236
    v_accvgpr_write_b32 a11, v232
    v_accvgpr_read_b32 v236, a12
    v_accvgpr_read_b32 v232, a13
    v_mul_f32 v236, v236, v233
    v_mul_f32 v232, v232, v233
    v_accvgpr_write_b32 a12, v236
    v_accvgpr_write_b32 a13, v232
    v_accvgpr_read_b32 v236, a14
    v_accvgpr_read_b32 v232, a15
    v_mul_f32 v236, v236, v233
    v_mul_f32 v232, v232, v233
    v_accvgpr_write_b32 a14, v236
    v_accvgpr_write_b32 a15, v232
    v_accvgpr_read_b32 v236, a16
    v_accvgpr_read_b32 v232, a17
    v_mul_f32 v236, v236, v233
    v_mul_f32 v232, v232, v233
    v_accvgpr_write_b32 a16, v236
    v_accvgpr_write_b32 a17, v232
    v_accvgpr_read_b32 v236, a18
    v_accvgpr_read_b32 v232, a19
    v_mul_f32 v236, v236, v233
    v_mul_f32 v232, v232, v233
    v_accvgpr_write_b32 a18, v236
    v_accvgpr_write_b32 a19, v232
    v_accvgpr_read_b32 v236, a20
    v_accvgpr_read_b32 v232, a21
    v_mul_f32 v236, v236, v233
    v_mul_f32 v232, v232, v233
    v_accvgpr_write_b32 a20, v236
    v_accvgpr_write_b32 a21, v232
    v_accvgpr_read_b32 v236, a22
    v_accvgpr_read_b32 v232, a23
    v_mul_f32 v236, v236, v233
    v_mul_f32 v232, v232, v233
    v_accvgpr_write_b32 a22, v236
    v_accvgpr_write_b32 a23, v232
    v_accvgpr_read_b32 v236, a24
    v_accvgpr_read_b32 v232, a25
    v_mul_f32 v236, v236, v233
    v_mul_f32 v232, v232, v233
    v_accvgpr_write_b32 a24, v236
    v_accvgpr_write_b32 a25, v232
    v_accvgpr_read_b32 v236, a26
    v_accvgpr_read_b32 v232, a27
    v_mul_f32 v236, v236, v233
    v_mul_f32 v232, v232, v233
    v_accvgpr_write_b32 a26, v236
    v_accvgpr_write_b32 a27, v232
    v_accvgpr_read_b32 v236, a28
    v_accvgpr_read_b32 v232, a29
    v_mul_f32 v236, v236, v233
    v_mul_f32 v232, v232, v233
    v_accvgpr_write_b32 a28, v236
    v_accvgpr_write_b32 a29, v232
    v_accvgpr_read_b32 v236, a30
    v_accvgpr_read_b32 v232, a31
    v_mul_f32 v236, v236, v233
    v_mul_f32 v232, v232, v233
    v_accvgpr_write_b32 a30, v236
    v_accvgpr_write_b32 a31, v232
    v_accvgpr_read_b32 v236, a32
    v_accvgpr_read_b32 v232, a33
    v_mul_f32 v236, v236, v233
    v_mul_f32 v232, v232, v233
    v_accvgpr_write_b32 a32, v236
    v_accvgpr_write_b32 a33, v232
    v_accvgpr_read_b32 v236, a34
    v_accvgpr_read_b32 v232, a35
    v_mul_f32 v236, v236, v233
    v_mul_f32 v232, v232, v233
    v_accvgpr_write_b32 a34, v236
    v_accvgpr_write_b32 a35, v232
    v_accvgpr_read_b32 v236, a36
    v_accvgpr_read_b32 v232, a37
    v_mul_f32 v236, v236, v233
    v_mul_f32 v232, v232, v233
    v_accvgpr_write_b32 a36, v236
    v_accvgpr_write_b32 a37, v232
    v_accvgpr_read_b32 v236, a38
    v_accvgpr_read_b32 v232, a39
    v_mul_f32 v236, v236, v233
    v_mul_f32 v232, v232, v233
    v_accvgpr_write_b32 a38, v236
    v_accvgpr_write_b32 a39, v232
    v_accvgpr_read_b32 v236, a40
    v_accvgpr_read_b32 v232, a41
    v_mul_f32 v236, v236, v233
    v_mul_f32 v232, v232, v233
    v_accvgpr_write_b32 a40, v236
    v_accvgpr_write_b32 a41, v232
    v_accvgpr_read_b32 v236, a42
    v_accvgpr_read_b32 v232, a43
    v_mul_f32 v236, v236, v233
    v_mul_f32 v232, v232, v233
    v_accvgpr_write_b32 a42, v236
    v_accvgpr_write_b32 a43, v232
    v_accvgpr_read_b32 v236, a44
    v_accvgpr_read_b32 v232, a45
    v_mul_f32 v236, v236, v233
    v_mul_f32 v232, v232, v233
    v_accvgpr_write_b32 a44, v236
    v_accvgpr_write_b32 a45, v232
    v_accvgpr_read_b32 v236, a46
    v_accvgpr_read_b32 v232, a47
    v_mul_f32 v236, v236, v233
    v_mul_f32 v232, v232, v233
    v_accvgpr_write_b32 a46, v236
    v_accvgpr_write_b32 a47, v232
    v_accvgpr_read_b32 v236, a48
    v_accvgpr_read_b32 v232, a49
    v_mul_f32 v236, v236, v233
    v_mul_f32 v232, v232, v233
    v_accvgpr_write_b32 a48, v236
    v_accvgpr_write_b32 a49, v232
    v_accvgpr_read_b32 v236, a50
    v_accvgpr_read_b32 v232, a51
    v_mul_f32 v236, v236, v233
    v_mul_f32 v232, v232, v233
    v_accvgpr_write_b32 a50, v236
    v_accvgpr_write_b32 a51, v232
    v_accvgpr_read_b32 v236, a52
    v_accvgpr_read_b32 v232, a53
    v_mul_f32 v236, v236, v233
    v_mul_f32 v232, v232, v233
    v_accvgpr_write_b32 a52, v236
    v_accvgpr_write_b32 a53, v232
    v_accvgpr_read_b32 v236, a54
    v_accvgpr_read_b32 v232, a55
    v_mul_f32 v236, v236, v233
    v_mul_f32 v232, v232, v233
    v_accvgpr_write_b32 a54, v236
    v_accvgpr_write_b32 a55, v232
    v_accvgpr_read_b32 v236, a56
    v_accvgpr_read_b32 v232, a57
    v_mul_f32 v236, v236, v233
    v_mul_f32 v232, v232, v233
    v_accvgpr_write_b32 a56, v236
    v_accvgpr_write_b32 a57, v232
    v_accvgpr_read_b32 v236, a58
    v_accvgpr_read_b32 v232, a59
    v_mul_f32 v236, v236, v233
    v_mul_f32 v232, v232, v233
    v_accvgpr_write_b32 a58, v236
    v_accvgpr_write_b32 a59, v232
    v_accvgpr_read_b32 v236, a60
    v_accvgpr_read_b32 v232, a61
    v_mul_f32 v236, v236, v233
    v_mul_f32 v232, v232, v233
    v_accvgpr_write_b32 a60, v236
    v_accvgpr_write_b32 a61, v232
    v_accvgpr_read_b32 v236, a62
    v_accvgpr_read_b32 v232, a63
    v_mul_f32 v236, v236, v233
    v_mul_f32 v232, v232, v233
    v_accvgpr_write_b32 a62, v236
    v_accvgpr_write_b32 a63, v232
    v_add_f32 v136, v136, v238
    v_add_f32 v137, v137, v238
    v_add_f32 v138, v138, v238
    v_add_f32 v139, v139, v238
    v_add_f32 v140, v140, v238
    v_add_f32 v141, v141, v238
    v_add_f32 v142, v142, v238
    v_add_f32 v143, v143, v238
    v_max3_f32 v236, v136, v137, v138
    v_max3_f32 v236, v236, v139, v140
    v_max3_f32 v236, v236, v141, v142
    v_max_f32 v236, v236, v143
    v_mov_b32 v232, v236
    s_nop 1
    v_permlane16_swap_b32 v236, v232
    s_nop 1
    v_max_f32 v236, v236, v232
    v_mov_b32 v232, v236
    s_nop 1
    v_permlane32_swap_b32 v236, v232
    s_nop 1
    v_max_f32 v236, v236, v232
    v_ceil_f32 v236, v236
    v_max_f32 v236, 0, v236
    v_sub_f32 v238, v238, v236
    v_sub_f32 v136, v136, v236
    v_sub_f32 v137, v137, v236
    v_sub_f32 v138, v138, v236
    v_sub_f32 v139, v139, v236
    v_sub_f32 v140, v140, v236
    v_sub_f32 v141, v141, v236
    v_sub_f32 v142, v142, v236
    v_sub_f32 v143, v143, v236
    v_sub_f32 v172, v172, v236
    v_sub_f32 v173, v173, v236
    v_sub_f32 v174, v174, v236
    v_sub_f32 v175, v175, v236
    v_sub_f32 v244, v244, v236
    v_sub_f32 v245, v245, v236
    v_sub_f32 v246, v246, v236
    v_sub_f32 v247, v247, v236
    v_min_f32 v232, 0x43480000, v236
    v_cvt_i32_f32 v232, v232
    v_sub_u32 v232, 0, v232
    v_ldexp_f32 v233, 1.0, v232
    v_mul_f32 v229, v229, v233
    v_lshlrev_b32 v236, 16, v168
    v_and_b32 v232, 0xffff0000, v168
    v_mul_f32 v236, v236, v233
    v_mul_f32 v232, v232, v233
    v_cvt_pk_bf16_f32 v168, v236, v232
    v_lshlrev_b32 v236, 16, v169
    v_and_b32 v232, 0xffff0000, v169
    v_mul_f32 v236, v236, v233
    v_mul_f32 v232, v232, v233
    v_cvt_pk_bf16_f32 v169, v236, v232
    v_lshlrev_b32 v236, 16, v170
    v_and_b32 v232, 0xffff0000, v170
    v_mul_f32 v236, v236, v233
    v_mul_f32 v232, v232, v233
    v_cvt_pk_bf16_f32 v170, v236, v232
    v_lshlrev_b32 v236, 16, v171
    v_and_b32 v232, 0xffff0000, v171
    v_mul_f32 v236, v236, v233
    v_mul_f32 v232, v232, v233
    v_cvt_pk_bf16_f32 v171, v236, v232
    v_accvgpr_read_b32 v236, a64
    v_accvgpr_read_b32 v232, a65
    v_mul_f32 v236, v236, v233
    v_mul_f32 v232, v232, v233
    v_accvgpr_write_b32 a64, v236
    v_accvgpr_write_b32 a65, v232
    v_accvgpr_read_b32 v236, a66
    v_accvgpr_read_b32 v232, a67
    v_mul_f32 v236, v236, v233
    v_mul_f32 v232, v232, v233
    v_accvgpr_write_b32 a66, v236
    v_accvgpr_write_b32 a67, v232
    v_accvgpr_read_b32 v236, a68
    v_accvgpr_read_b32 v232, a69
    v_mul_f32 v236, v236, v233
    v_mul_f32 v232, v232, v233
    v_accvgpr_write_b32 a68, v236
    v_accvgpr_write_b32 a69, v232
    v_accvgpr_read_b32 v236, a70
    v_accvgpr_read_b32 v232, a71
    v_mul_f32 v236, v236, v233
    v_mul_f32 v232, v232, v233
    v_accvgpr_write_b32 a70, v236
    v_accvgpr_write_b32 a71, v232
    v_accvgpr_read_b32 v236, a72
    v_accvgpr_read_b32 v232, a73
    v_mul_f32 v236, v236, v233
    v_mul_f32 v232, v232, v233
    v_accvgpr_write_b32 a72, v236
    v_accvgpr_write_b32 a73, v232
    v_accvgpr_read_b32 v236, a74
    v_accvgpr_read_b32 v232, a75
    v_mul_f32 v236, v236, v233
    v_mul_f32 v232, v232, v233
    v_accvgpr_write_b32 a74, v236
    v_accvgpr_write_b32 a75, v232
    v_accvgpr_read_b32 v236, a76
    v_accvgpr_read_b32 v232, a77
    v_mul_f32 v236, v236, v233
    v_mul_f32 v232, v232, v233
    v_accvgpr_write_b32 a76, v236
    v_accvgpr_write_b32 a77, v232
    v_accvgpr_read_b32 v236, a78
    v_accvgpr_read_b32 v232, a79
    v_mul_f32 v236, v236, v233
    v_mul_f32 v232, v232, v233
    v_accvgpr_write_b32 a78, v236
    v_accvgpr_write_b32 a79, v232
    v_accvgpr_read_b32 v236, a80
    v_accvgpr_read_b32 v232, a81
    v_mul_f32 v236, v236, v233
    v_mul_f32 v232, v232, v233
    v_accvgpr_write_b32 a80, v236
    v_accvgpr_write_b32 a81, v232
    v_accvgpr_read_b32 v236, a82
    v_accvgpr_read_b32 v232, a83
    v_mul_f32 v236, v236, v233
    v_mul_f32 v232, v232, v233
    v_accvgpr_write_b32 a82, v236
    v_accvgpr_write_b32 a83, v232
    v_accvgpr_read_b32 v236, a84
    v_accvgpr_read_b32 v232, a85
    v_mul_f32 v236, v236, v233
    v_mul_f32 v232, v232, v233
    v_accvgpr_write_b32 a84, v236
    v_accvgpr_write_b32 a85, v232
    v_accvgpr_read_b32 v236, a86
    v_accvgpr_read_b32 v232, a87
    v_mul_f32 v236, v236, v233
    v_mul_f32 v232, v232, v233
    v_accvgpr_write_b32 a86, v236
    v_accvgpr_write_b32 a87, v232
    v_accvgpr_read_b32 v236, a88
    v_accvgpr_read_b32 v232, a89
    v_mul_f32 v236, v236, v233
    v_mul_f32 v232, v232, v233
    v_accvgpr_write_b32 a88, v236
    v_accvgpr_write_b32 a89, v232
    v_accvgpr_read_b32 v236, a90
    v_accvgpr_read_b32 v232, a91
    v_mul_f32 v236, v236, v233
    v_mul_f32 v232, v232, v233
    v_accvgpr_write_b32 a90, v236
    v_accvgpr_write_b32 a91, v232
    v_accvgpr_read_b32 v236, a92
    v_accvgpr_read_b32 v232, a93
    v_mul_f32 v236, v236, v233
    v_mul_f32 v232, v232, v233
    v_accvgpr_write_b32 a92, v236
    v_accvgpr_write_b32 a93, v232
    v_accvgpr_read_b32 v236, a94
    v_accvgpr_read_b32 v232, a95
    v_mul_f32 v236, v236, v233
    v_mul_f32 v232, v232, v233
    v_accvgpr_write_b32 a94, v236
    v_accvgpr_write_b32 a95, v232
    v_accvgpr_read_b32 v236, a96
    v_accvgpr_read_b32 v232, a97
    v_mul_f32 v236, v236, v233
    v_mul_f32 v232, v232, v233
    v_accvgpr_write_b32 a96, v236
    v_accvgpr_write_b32 a97, v232
    v_accvgpr_read_b32 v236, a98
    v_accvgpr_read_b32 v232, a99
    v_mul_f32 v236, v236, v233
    v_mul_f32 v232, v232, v233
    v_accvgpr_write_b32 a98, v236
    v_accvgpr_write_b32 a99, v232
    v_accvgpr_read_b32 v236, a100
    v_accvgpr_read_b32 v232, a101
    v_mul_f32 v236, v236, v233
    v_mul_f32 v232, v232, v233
    v_accvgpr_write_b32 a100, v236
    v_accvgpr_write_b32 a101, v232
    v_accvgpr_read_b32 v236, a102
    v_accvgpr_read_b32 v232, a103
    v_mul_f32 v236, v236, v233
    v_mul_f32 v232, v232, v233
    v_accvgpr_write_b32 a102, v236
    v_accvgpr_write_b32 a103, v232
    v_accvgpr_read_b32 v236, a104
    v_accvgpr_read_b32 v232, a105
    v_mul_f32 v236, v236, v233
    v_mul_f32 v232, v232, v233
    v_accvgpr_write_b32 a104, v236
    v_accvgpr_write_b32 a105, v232
    v_accvgpr_read_b32 v236, a106
    v_accvgpr_read_b32 v232, a107
    v_mul_f32 v236, v236, v233
    v_mul_f32 v232, v232, v233
    v_accvgpr_write_b32 a106, v236
    v_accvgpr_write_b32 a107, v232
    v_accvgpr_read_b32 v236, a108
    v_accvgpr_read_b32 v232, a109
    v_mul_f32 v236, v236, v233
    v_mul_f32 v232, v232, v233
    v_accvgpr_write_b32 a108, v236
    v_accvgpr_write_b32 a109, v232
    v_accvgpr_read_b32 v236, a110
    v_accvgpr_read_b32 v232, a111
    v_mul_f32 v236, v236, v233
    v_mul_f32 v232, v232, v233
    v_accvgpr_write_b32 a110, v236
    v_accvgpr_write_b32 a111, v232
    v_accvgpr_read_b32 v236, a112
    v_accvgpr_read_b32 v232, a113
    v_mul_f32 v236, v236, v233
    v_mul_f32 v232, v232, v233
    v_accvgpr_write_b32 a112, v236
    v_accvgpr_write_b32 a113, v232
    v_accvgpr_read_b32 v236, a114
    v_accvgpr_read_b32 v232, a115
    v_mul_f32 v236, v236, v233
    v_mul_f32 v232, v232, v233
    v_accvgpr_write_b32 a114, v236
    v_accvgpr_write_b32 a115, v232
    v_accvgpr_read_b32 v236, a116
    v_accvgpr_read_b32 v232, a117
    v_mul_f32 v236, v236, v233
    v_mul_f32 v232, v232, v233
    v_accvgpr_write_b32 a116, v236
    v_accvgpr_write_b32 a117, v232
    v_accvgpr_read_b32 v236, a118
    v_accvgpr_read_b32 v232, a119
    v_mul_f32 v236, v236, v233
    v_mul_f32 v232, v232, v233
    v_accvgpr_write_b32 a118, v236
    v_accvgpr_write_b32 a119, v232
    v_accvgpr_read_b32 v236, a120
    v_accvgpr_read_b32 v232, a121
    v_mul_f32 v236, v236, v233
    v_mul_f32 v232, v232, v233
    v_accvgpr_write_b32 a120, v236
    v_accvgpr_write_b32 a121, v232
    v_accvgpr_read_b32 v236, a122
    v_accvgpr_read_b32 v232, a123
    v_mul_f32 v236, v236, v233
    v_mul_f32 v232, v232, v233
    v_accvgpr_write_b32 a122, v236
    v_accvgpr_write_b32 a123, v232
    v_accvgpr_read_b32 v236, a124
    v_accvgpr_read_b32 v232, a125
    v_mul_f32 v236, v236, v233
    v_mul_f32 v232, v232, v233
    v_accvgpr_write_b32 a124, v236
    v_accvgpr_write_b32 a125, v232
    v_accvgpr_read_b32 v236, a126
    v_accvgpr_read_b32 v232, a127
    v_mul_f32 v236, v236, v233
    v_mul_f32 v232, v232, v233
    v_accvgpr_write_b32 a126, v236
    v_accvgpr_write_b32 a127, v232
    v_add_f32 v144, v144, v239
    v_add_f32 v145, v145, v239
    v_add_f32 v146, v146, v239
    v_add_f32 v147, v147, v239
    v_add_f32 v148, v148, v239
    v_add_f32 v149, v149, v239
    v_add_f32 v150, v150, v239
    v_add_f32 v151, v151, v239
    v_max3_f32 v236, v144, v145, v146
    v_max3_f32 v236, v236, v147, v148
    v_max3_f32 v236, v236, v149, v150
    v_max_f32 v236, v236, v151
    v_mov_b32 v232, v236
    s_nop 1
    v_permlane16_swap_b32 v236, v232
    s_nop 1
    v_max_f32 v236, v236, v232
    v_mov_b32 v232, v236
    s_nop 1
    v_permlane32_swap_b32 v236, v232
    s_nop 1
    v_max_f32 v236, v236, v232
    v_ceil_f32 v236, v236
    v_max_f32 v236, 0, v236
    v_sub_f32 v239, v239, v236
    v_sub_f32 v144, v144, v236
    v_sub_f32 v145, v145, v236
    v_sub_f32 v146, v146, v236
    v_sub_f32 v147, v147, v236
    v_sub_f32 v148, v148, v236
    v_sub_f32 v149, v149, v236
    v_sub_f32 v150, v150, v236
    v_sub_f32 v151, v151, v236
    v_sub_f32 v180, v180, v236
    v_sub_f32 v181, v181, v236
    v_sub_f32 v182, v182, v236
    v_sub_f32 v183, v183, v236
    v_sub_f32 v248, v248, v236
    v_sub_f32 v249, v249, v236
    v_sub_f32 v250, v250, v236
    v_sub_f32 v251, v251, v236
    v_min_f32 v232, 0x43480000, v236
    v_cvt_i32_f32 v232, v232
    v_sub_u32 v232, 0, v232
    v_ldexp_f32 v233, 1.0, v232
    v_mul_f32 v230, v230, v233
    v_lshlrev_b32 v236, 16, v176
    v_and_b32 v232, 0xffff0000, v176
    v_mul_f32 v236, v236, v233
    v_mul_f32 v232, v232, v233
    v_cvt_pk_bf16_f32 v176, v236, v232
    v_lshlrev_b32 v236, 16, v177
    v_and_b32 v232, 0xffff0000, v177
    v_mul_f32 v236, v236, v233
    v_mul_f32 v232, v232, v233
    v_cvt_pk_bf16_f32 v177, v236, v232
    v_lshlrev_b32 v236, 16, v178
    v_and_b32 v232, 0xffff0000, v178
    v_mul_f32 v236, v236, v233
    v_mul_f32 v232, v232, v233
    v_cvt_pk_bf16_f32 v178, v236, v232
    v_lshlrev_b32 v236, 16, v179
    v_and_b32 v232, 0xffff0000, v179
    v_mul_f32 v236, v236, v233
    v_mul_f32 v232, v232, v233
    v_cvt_pk_bf16_f32 v179, v236, v232
    v_accvgpr_read_b32 v236, a128
    v_accvgpr_read_b32 v232, a129
    v_mul_f32 v236, v236, v233
    v_mul_f32 v232, v232, v233
    v_accvgpr_write_b32 a128, v236
    v_accvgpr_write_b32 a129, v232
    v_accvgpr_read_b32 v236, a130
    v_accvgpr_read_b32 v232, a131
    v_mul_f32 v236, v236, v233
    v_mul_f32 v232, v232, v233
    v_accvgpr_write_b32 a130, v236
    v_accvgpr_write_b32 a131, v232
    v_accvgpr_read_b32 v236, a132
    v_accvgpr_read_b32 v232, a133
    v_mul_f32 v236, v236, v233
    v_mul_f32 v232, v232, v233
    v_accvgpr_write_b32 a132, v236
    v_accvgpr_write_b32 a133, v232
    v_accvgpr_read_b32 v236, a134
    v_accvgpr_read_b32 v232, a135
    v_mul_f32 v236, v236, v233
    v_mul_f32 v232, v232, v233
    v_accvgpr_write_b32 a134, v236
    v_accvgpr_write_b32 a135, v232
    v_accvgpr_read_b32 v236, a136
    v_accvgpr_read_b32 v232, a137
    v_mul_f32 v236, v236, v233
    v_mul_f32 v232, v232, v233
    v_accvgpr_write_b32 a136, v236
    v_accvgpr_write_b32 a137, v232
    v_accvgpr_read_b32 v236, a138
    v_accvgpr_read_b32 v232, a139
    v_mul_f32 v236, v236, v233
    v_mul_f32 v232, v232, v233
    v_accvgpr_write_b32 a138, v236
    v_accvgpr_write_b32 a139, v232
    v_accvgpr_read_b32 v236, a140
    v_accvgpr_read_b32 v232, a141
    v_mul_f32 v236, v236, v233
    v_mul_f32 v232, v232, v233
    v_accvgpr_write_b32 a140, v236
    v_accvgpr_write_b32 a141, v232
    v_accvgpr_read_b32 v236, a142
    v_accvgpr_read_b32 v232, a143
    v_mul_f32 v236, v236, v233
    v_mul_f32 v232, v232, v233
    v_accvgpr_write_b32 a142, v236
    v_accvgpr_write_b32 a143, v232
    v_accvgpr_read_b32 v236, a144
    v_accvgpr_read_b32 v232, a145
    v_mul_f32 v236, v236, v233
    v_mul_f32 v232, v232, v233
    v_accvgpr_write_b32 a144, v236
    v_accvgpr_write_b32 a145, v232
    v_accvgpr_read_b32 v236, a146
    v_accvgpr_read_b32 v232, a147
    v_mul_f32 v236, v236, v233
    v_mul_f32 v232, v232, v233
    v_accvgpr_write_b32 a146, v236
    v_accvgpr_write_b32 a147, v232
    v_accvgpr_read_b32 v236, a148
    v_accvgpr_read_b32 v232, a149
    v_mul_f32 v236, v236, v233
    v_mul_f32 v232, v232, v233
    v_accvgpr_write_b32 a148, v236
    v_accvgpr_write_b32 a149, v232
    v_accvgpr_read_b32 v236, a150
    v_accvgpr_read_b32 v232, a151
    v_mul_f32 v236, v236, v233
    v_mul_f32 v232, v232, v233
    v_accvgpr_write_b32 a150, v236
    v_accvgpr_write_b32 a151, v232
    v_accvgpr_read_b32 v236, a152
    v_accvgpr_read_b32 v232, a153
    v_mul_f32 v236, v236, v233
    v_mul_f32 v232, v232, v233
    v_accvgpr_write_b32 a152, v236
    v_accvgpr_write_b32 a153, v232
    v_accvgpr_read_b32 v236, a154
    v_accvgpr_read_b32 v232, a155
    v_mul_f32 v236, v236, v233
    v_mul_f32 v232, v232, v233
    v_accvgpr_write_b32 a154, v236
    v_accvgpr_write_b32 a155, v232
    v_accvgpr_read_b32 v236, a156
    v_accvgpr_read_b32 v232, a157
    v_mul_f32 v236, v236, v233
    v_mul_f32 v232, v232, v233
    v_accvgpr_write_b32 a156, v236
    v_accvgpr_write_b32 a157, v232
    v_accvgpr_read_b32 v236, a158
    v_accvgpr_read_b32 v232, a159
    v_mul_f32 v236, v236, v233
    v_mul_f32 v232, v232, v233
    v_accvgpr_write_b32 a158, v236
    v_accvgpr_write_b32 a159, v232
    v_accvgpr_read_b32 v236, a160
    v_accvgpr_read_b32 v232, a161
    v_mul_f32 v236, v236, v233
    v_mul_f32 v232, v232, v233
    v_accvgpr_write_b32 a160, v236
    v_accvgpr_write_b32 a161, v232
    v_accvgpr_read_b32 v236, a162
    v_accvgpr_read_b32 v232, a163
    v_mul_f32 v236, v236, v233
    v_mul_f32 v232, v232, v233
    v_accvgpr_write_b32 a162, v236
    v_accvgpr_write_b32 a163, v232
    v_accvgpr_read_b32 v236, a164
    v_accvgpr_read_b32 v232, a165
    v_mul_f32 v236, v236, v233
    v_mul_f32 v232, v232, v233
    v_accvgpr_write_b32 a164, v236
    v_accvgpr_write_b32 a165, v232
    v_accvgpr_read_b32 v236, a166
    v_accvgpr_read_b32 v232, a167
    v_mul_f32 v236, v236, v233
    v_mul_f32 v232, v232, v233
    v_accvgpr_write_b32 a166, v236
    v_accvgpr_write_b32 a167, v232
    v_accvgpr_read_b32 v236, a168
    v_accvgpr_read_b32 v232, a169
    v_mul_f32 v236, v236, v233
    v_mul_f32 v232, v232, v233
    v_accvgpr_write_b32 a168, v236
    v_accvgpr_write_b32 a169, v232
    v_accvgpr_read_b32 v236, a170
    v_accvgpr_read_b32 v232, a171
    v_mul_f32 v236, v236, v233
    v_mul_f32 v232, v232, v233
    v_accvgpr_write_b32 a170, v236
    v_accvgpr_write_b32 a171, v232
    v_accvgpr_read_b32 v236, a172
    v_accvgpr_read_b32 v232, a173
    v_mul_f32 v236, v236, v233
    v_mul_f32 v232, v232, v233
    v_accvgpr_write_b32 a172, v236
    v_accvgpr_write_b32 a173, v232
    v_accvgpr_read_b32 v236, a174
    v_accvgpr_read_b32 v232, a175
    v_mul_f32 v236, v236, v233
    v_mul_f32 v232, v232, v233
    v_accvgpr_write_b32 a174, v236
    v_accvgpr_write_b32 a175, v232
    v_accvgpr_read_b32 v236, a176
    v_accvgpr_read_b32 v232, a177
    v_mul_f32 v236, v236, v233
    v_mul_f32 v232, v232, v233
    v_accvgpr_write_b32 a176, v236
    v_accvgpr_write_b32 a177, v232
    v_accvgpr_read_b32 v236, a178
    v_accvgpr_read_b32 v232, a179
    v_mul_f32 v236, v236, v233
    v_mul_f32 v232, v232, v233
    v_accvgpr_write_b32 a178, v236
    v_accvgpr_write_b32 a179, v232
    v_accvgpr_read_b32 v236, a180
    v_accvgpr_read_b32 v232, a181
    v_mul_f32 v236, v236, v233
    v_mul_f32 v232, v232, v233
    v_accvgpr_write_b32 a180, v236
    v_accvgpr_write_b32 a181, v232
    v_accvgpr_read_b32 v236, a182
    v_accvgpr_read_b32 v232, a183
    v_mul_f32 v236, v236, v233
    v_mul_f32 v232, v232, v233
    v_accvgpr_write_b32 a182, v236
    v_accvgpr_write_b32 a183, v232
    v_accvgpr_read_b32 v236, a184
    v_accvgpr_read_b32 v232, a185
    v_mul_f32 v236, v236, v233
    v_mul_f32 v232, v232, v233
    v_accvgpr_write_b32 a184, v236
    v_accvgpr_write_b32 a185, v232
    v_accvgpr_read_b32 v236, a186
    v_accvgpr_read_b32 v232, a187
    v_mul_f32 v236, v236, v233
    v_mul_f32 v232, v232, v233
    v_accvgpr_write_b32 a186, v236
    v_accvgpr_write_b32 a187, v232
    v_accvgpr_read_b32 v236, a188
    v_accvgpr_read_b32 v232, a189
    v_mul_f32 v236, v236, v233
    v_mul_f32 v232, v232, v233
    v_accvgpr_write_b32 a188, v236
    v_accvgpr_write_b32 a189, v232
    v_accvgpr_read_b32 v236, a190
    v_accvgpr_read_b32 v232, a191
    v_mul_f32 v236, v236, v233
    v_mul_f32 v232, v232, v233
    v_accvgpr_write_b32 a190, v236
    v_accvgpr_write_b32 a191, v232
    v_add_f32 v152, v152, v227
    v_add_f32 v153, v153, v227
    v_add_f32 v154, v154, v227
    v_add_f32 v155, v155, v227
    v_add_f32 v156, v156, v227
    v_add_f32 v157, v157, v227
    v_add_f32 v158, v158, v227
    v_add_f32 v159, v159, v227
    v_max3_f32 v236, v152, v153, v154
    v_max3_f32 v236, v236, v155, v156
    v_max3_f32 v236, v236, v157, v158
    v_max_f32 v236, v236, v159
    v_mov_b32 v232, v236
    s_nop 1
    v_permlane16_swap_b32 v236, v232
    s_nop 1
    v_max_f32 v236, v236, v232
    v_mov_b32 v232, v236
    s_nop 1
    v_permlane32_swap_b32 v236, v232
    s_nop 1
    v_max_f32 v236, v236, v232
    v_ceil_f32 v236, v236
    v_max_f32 v236, 0, v236
    v_sub_f32 v227, v227, v236
    v_sub_f32 v152, v152, v236
    v_sub_f32 v153, v153, v236
    v_sub_f32 v154, v154, v236
    v_sub_f32 v155, v155, v236
    v_sub_f32 v156, v156, v236
    v_sub_f32 v157, v157, v236
    v_sub_f32 v158, v158, v236
    v_sub_f32 v159, v159, v236
    v_sub_f32 v188, v188, v236
    v_sub_f32 v189, v189, v236
    v_sub_f32 v190, v190, v236
    v_sub_f32 v191, v191, v236
    v_sub_f32 v252, v252, v236
    v_sub_f32 v253, v253, v236
    v_sub_f32 v254, v254, v236
    v_sub_f32 v255, v255, v236
    v_min_f32 v232, 0x43480000, v236
    v_cvt_i32_f32 v232, v232
    v_sub_u32 v232, 0, v232
    v_ldexp_f32 v233, 1.0, v232
    v_mul_f32 v231, v231, v233
    v_lshlrev_b32 v236, 16, v184
    v_and_b32 v232, 0xffff0000, v184
    v_mul_f32 v236, v236, v233
    v_mul_f32 v232, v232, v233
    v_cvt_pk_bf16_f32 v184, v236, v232
    v_lshlrev_b32 v236, 16, v185
    v_and_b32 v232, 0xffff0000, v185
    v_mul_f32 v236, v236, v233
    v_mul_f32 v232, v232, v233
    v_cvt_pk_bf16_f32 v185, v236, v232
    v_lshlrev_b32 v236, 16, v186
    v_and_b32 v232, 0xffff0000, v186
    v_mul_f32 v236, v236, v233
    v_mul_f32 v232, v232, v233
    v_cvt_pk_bf16_f32 v186, v236, v232
    v_lshlrev_b32 v236, 16, v187
    v_and_b32 v232, 0xffff0000, v187
    v_mul_f32 v236, v236, v233
    v_mul_f32 v232, v232, v233
    v_cvt_pk_bf16_f32 v187, v236, v232
    v_accvgpr_read_b32 v236, a192
    v_accvgpr_read_b32 v232, a193
    v_mul_f32 v236, v236, v233
    v_mul_f32 v232, v232, v233
    v_accvgpr_write_b32 a192, v236
    v_accvgpr_write_b32 a193, v232
    v_accvgpr_read_b32 v236, a194
    v_accvgpr_read_b32 v232, a195
    v_mul_f32 v236, v236, v233
    v_mul_f32 v232, v232, v233
    v_accvgpr_write_b32 a194, v236
    v_accvgpr_write_b32 a195, v232
    v_accvgpr_read_b32 v236, a196
    v_accvgpr_read_b32 v232, a197
    v_mul_f32 v236, v236, v233
    v_mul_f32 v232, v232, v233
    v_accvgpr_write_b32 a196, v236
    v_accvgpr_write_b32 a197, v232
    v_accvgpr_read_b32 v236, a198
    v_accvgpr_read_b32 v232, a199
    v_mul_f32 v236, v236, v233
    v_mul_f32 v232, v232, v233
    v_accvgpr_write_b32 a198, v236
    v_accvgpr_write_b32 a199, v232
    v_accvgpr_read_b32 v236, a200
    v_accvgpr_read_b32 v232, a201
    v_mul_f32 v236, v236, v233
    v_mul_f32 v232, v232, v233
    v_accvgpr_write_b32 a200, v236
    v_accvgpr_write_b32 a201, v232
    v_accvgpr_read_b32 v236, a202
    v_accvgpr_read_b32 v232, a203
    v_mul_f32 v236, v236, v233
    v_mul_f32 v232, v232, v233
    v_accvgpr_write_b32 a202, v236
    v_accvgpr_write_b32 a203, v232
    v_accvgpr_read_b32 v236, a204
    v_accvgpr_read_b32 v232, a205
    v_mul_f32 v236, v236, v233
    v_mul_f32 v232, v232, v233
    v_accvgpr_write_b32 a204, v236
    v_accvgpr_write_b32 a205, v232
    v_accvgpr_read_b32 v236, a206
    v_accvgpr_read_b32 v232, a207
    v_mul_f32 v236, v236, v233
    v_mul_f32 v232, v232, v233
    v_accvgpr_write_b32 a206, v236
    v_accvgpr_write_b32 a207, v232
    v_accvgpr_read_b32 v236, a208
    v_accvgpr_read_b32 v232, a209
    v_mul_f32 v236, v236, v233
    v_mul_f32 v232, v232, v233
    v_accvgpr_write_b32 a208, v236
    v_accvgpr_write_b32 a209, v232
    v_accvgpr_read_b32 v236, a210
    v_accvgpr_read_b32 v232, a211
    v_mul_f32 v236, v236, v233
    v_mul_f32 v232, v232, v233
    v_accvgpr_write_b32 a210, v236
    v_accvgpr_write_b32 a211, v232
    v_accvgpr_read_b32 v236, a212
    v_accvgpr_read_b32 v232, a213
    v_mul_f32 v236, v236, v233
    v_mul_f32 v232, v232, v233
    v_accvgpr_write_b32 a212, v236
    v_accvgpr_write_b32 a213, v232
    v_accvgpr_read_b32 v236, a214
    v_accvgpr_read_b32 v232, a215
    v_mul_f32 v236, v236, v233
    v_mul_f32 v232, v232, v233
    v_accvgpr_write_b32 a214, v236
    v_accvgpr_write_b32 a215, v232
    v_accvgpr_read_b32 v236, a216
    v_accvgpr_read_b32 v232, a217
    v_mul_f32 v236, v236, v233
    v_mul_f32 v232, v232, v233
    v_accvgpr_write_b32 a216, v236
    v_accvgpr_write_b32 a217, v232
    v_accvgpr_read_b32 v236, a218
    v_accvgpr_read_b32 v232, a219
    v_mul_f32 v236, v236, v233
    v_mul_f32 v232, v232, v233
    v_accvgpr_write_b32 a218, v236
    v_accvgpr_write_b32 a219, v232
    v_accvgpr_read_b32 v236, a220
    v_accvgpr_read_b32 v232, a221
    v_mul_f32 v236, v236, v233
    v_mul_f32 v232, v232, v233
    v_accvgpr_write_b32 a220, v236
    v_accvgpr_write_b32 a221, v232
    v_accvgpr_read_b32 v236, a222
    v_accvgpr_read_b32 v232, a223
    v_mul_f32 v236, v236, v233
    v_mul_f32 v232, v232, v233
    v_accvgpr_write_b32 a222, v236
    v_accvgpr_write_b32 a223, v232
    v_accvgpr_read_b32 v236, a224
    v_accvgpr_read_b32 v232, a225
    v_mul_f32 v236, v236, v233
    v_mul_f32 v232, v232, v233
    v_accvgpr_write_b32 a224, v236
    v_accvgpr_write_b32 a225, v232
    v_accvgpr_read_b32 v236, a226
    v_accvgpr_read_b32 v232, a227
    v_mul_f32 v236, v236, v233
    v_mul_f32 v232, v232, v233
    v_accvgpr_write_b32 a226, v236
    v_accvgpr_write_b32 a227, v232
    v_accvgpr_read_b32 v236, a228
    v_accvgpr_read_b32 v232, a229
    v_mul_f32 v236, v236, v233
    v_mul_f32 v232, v232, v233
    v_accvgpr_write_b32 a228, v236
    v_accvgpr_write_b32 a229, v232
    v_accvgpr_read_b32 v236, a230
    v_accvgpr_read_b32 v232, a231
    v_mul_f32 v236, v236, v233
    v_mul_f32 v232, v232, v233
    v_accvgpr_write_b32 a230, v236
    v_accvgpr_write_b32 a231, v232
    v_accvgpr_read_b32 v236, a232
    v_accvgpr_read_b32 v232, a233
    v_mul_f32 v236, v236, v233
    v_mul_f32 v232, v232, v233
    v_accvgpr_write_b32 a232, v236
    v_accvgpr_write_b32 a233, v232
    v_accvgpr_read_b32 v236, a234
    v_accvgpr_read_b32 v232, a235
    v_mul_f32 v236, v236, v233
    v_mul_f32 v232, v232, v233
    v_accvgpr_write_b32 a234, v236
    v_accvgpr_write_b32 a235, v232
    v_accvgpr_read_b32 v236, a236
    v_accvgpr_read_b32 v232, a237
    v_mul_f32 v236, v236, v233
    v_mul_f32 v232, v232, v233
    v_accvgpr_write_b32 a236, v236
    v_accvgpr_write_b32 a237, v232
    v_accvgpr_read_b32 v236, a238
    v_accvgpr_read_b32 v232, a239
    v_mul_f32 v236, v236, v233
    v_mul_f32 v232, v232, v233
    v_accvgpr_write_b32 a238, v236
    v_accvgpr_write_b32 a239, v232
    v_accvgpr_read_b32 v236, a240
    v_accvgpr_read_b32 v232, a241
    v_mul_f32 v236, v236, v233
    v_mul_f32 v232, v232, v233
    v_accvgpr_write_b32 a240, v236
    v_accvgpr_write_b32 a241, v232
    v_accvgpr_read_b32 v236, a242
    v_accvgpr_read_b32 v232, a243
    v_mul_f32 v236, v236, v233
    v_mul_f32 v232, v232, v233
    v_accvgpr_write_b32 a242, v236
    v_accvgpr_write_b32 a243, v232
    v_accvgpr_read_b32 v236, a244
    v_accvgpr_read_b32 v232, a245
    v_mul_f32 v236, v236, v233
    v_mul_f32 v232, v232, v233
    v_accvgpr_write_b32 a244, v236
    v_accvgpr_write_b32 a245, v232
    v_accvgpr_read_b32 v236, a246
    v_accvgpr_read_b32 v232, a247
    v_mul_f32 v236, v236, v233
    v_mul_f32 v232, v232, v233
    v_accvgpr_write_b32 a246, v236
    v_accvgpr_write_b32 a247, v232
    v_accvgpr_read_b32 v236, a248
    v_accvgpr_read_b32 v232, a249
    v_mul_f32 v236, v236, v233
    v_mul_f32 v232, v232, v233
    v_accvgpr_write_b32 a248, v236
    v_accvgpr_write_b32 a249, v232
    v_accvgpr_read_b32 v236, a250
    v_accvgpr_read_b32 v232, a251
    v_mul_f32 v236, v236, v233
    v_mul_f32 v232, v232, v233
    v_accvgpr_write_b32 a250, v236
    v_accvgpr_write_b32 a251, v232
    v_accvgpr_read_b32 v236, a252
    v_accvgpr_read_b32 v232, a253
    v_mul_f32 v236, v236, v233
    v_mul_f32 v232, v232, v233
    v_accvgpr_write_b32 a252, v236
    v_accvgpr_write_b32 a253, v232
    v_accvgpr_read_b32 v236, a254
    v_accvgpr_read_b32 v232, a255
    v_mul_f32 v236, v236, v233
    v_mul_f32 v232, v232, v233
    v_accvgpr_write_b32 a254, v236
    v_accvgpr_write_b32 a255, v232
    v_exp_f32 v128, v128
    v_exp_f32 v129, v129
    v_exp_f32 v130, v130
    v_exp_f32 v131, v131
    v_exp_f32 v132, v132
    v_exp_f32 v133, v133
    v_exp_f32 v134, v134
    v_exp_f32 v135, v135
    v_exp_f32 v136, v136
    v_exp_f32 v137, v137
    v_exp_f32 v138, v138
    v_exp_f32 v139, v139
    v_exp_f32 v140, v140
    v_exp_f32 v141, v141
    v_exp_f32 v142, v142
    v_exp_f32 v143, v143
    v_exp_f32 v144, v144
    v_exp_f32 v145, v145
    v_exp_f32 v146, v146
    v_exp_f32 v147, v147
    v_exp_f32 v148, v148
    v_exp_f32 v149, v149
    v_exp_f32 v150, v150
    v_exp_f32 v151, v151
    v_exp_f32 v152, v152
    v_exp_f32 v153, v153
    v_exp_f32 v154, v154
    v_exp_f32 v155, v155
    v_exp_f32 v156, v156
    v_exp_f32 v157, v157
    v_exp_f32 v158, v158
    v_exp_f32 v159, v159
    s_nop 0
    v_add_f32 v232, v128, v129
    v_add_f32 v232, v232, v130
    v_add_f32 v232, v232, v131
    v_add_f32 v232, v232, v132
    v_add_f32 v232, v232, v133
    v_add_f32 v232, v232, v134
    v_add_f32 v232, v232, v135
    v_add_f32 v233, v136, v137
    v_add_f32 v233, v233, v138
    v_add_f32 v233, v233, v139
    v_add_f32 v233, v233, v140
    v_add_f32 v233, v233, v141
    v_add_f32 v233, v233, v142
    v_add_f32 v233, v233, v143
    v_add_f32 v234, v144, v145
    v_add_f32 v234, v234, v146
    v_add_f32 v234, v234, v147
    v_add_f32 v234, v234, v148
    v_add_f32 v234, v234, v149
    v_add_f32 v234, v234, v150
    v_add_f32 v234, v234, v151
    v_add_f32 v235, v152, v153
    v_add_f32 v235, v235, v154
    v_add_f32 v235, v235, v155
    v_add_f32 v235, v235, v156
    v_add_f32 v235, v235, v157
    v_add_f32 v235, v235, v158
    v_add_f32 v235, v235, v159
    v_cvt_pk_bf16_f32 v128, v128, v129
    v_cvt_pk_bf16_f32 v129, v130, v131
    v_cvt_pk_bf16_f32 v130, v132, v133
    v_cvt_pk_bf16_f32 v131, v134, v135
    v_cvt_pk_bf16_f32 v136, v136, v137
    v_cvt_pk_bf16_f32 v137, v138, v139
    v_cvt_pk_bf16_f32 v138, v140, v141
    v_cvt_pk_bf16_f32 v139, v142, v143
    v_cvt_pk_bf16_f32 v144, v144, v145
    v_cvt_pk_bf16_f32 v145, v146, v147
    v_cvt_pk_bf16_f32 v146, v148, v149
    v_cvt_pk_bf16_f32 v147, v150, v151
    v_cvt_pk_bf16_f32 v152, v152, v153
    v_cvt_pk_bf16_f32 v153, v154, v155
    v_cvt_pk_bf16_f32 v154, v156, v157
    v_cvt_pk_bf16_f32 v155, v158, v159
    s_nop 1
    s_branch L_back30
L_rare31:
    s_nop 7
    ds_read_b128 v[232:235], v224 offset:52224
    s_waitcnt lgkmcnt(0)
    v_mfma_f32_16x16x32_bf16 v[164:167], v[232:235], v[0:3], 0
    v_mfma_f32_16x16x32_bf16 v[172:175], v[232:235], v[32:35], 0
    v_mfma_f32_16x16x32_bf16 v[180:183], v[232:235], v[64:67], 0
    v_mfma_f32_16x16x32_bf16 v[188:191], v[232:235], v[96:99], 0
    s_nop 7
    ds_read_b128 v[232:235], v224 offset:52288
    s_waitcnt lgkmcnt(0)
    v_mfma_f32_16x16x32_bf16 v[164:167], v[232:235], v[4:7], v[164:167]
    v_mfma_f32_16x16x32_bf16 v[172:175], v[232:235], v[36:39], v[172:175]
    v_mfma_f32_16x16x32_bf16 v[180:183], v[232:235], v[68:71], v[180:183]
    v_mfma_f32_16x16x32_bf16 v[188:191], v[232:235], v[100:103], v[188:191]
    s_nop 7
    ds_read_b128 v[232:235], v224 offset:52352
    s_waitcnt lgkmcnt(0)
    v_mfma_f32_16x16x32_bf16 v[164:167], v[232:235], v[8:11], v[164:167]
    v_mfma_f32_16x16x32_bf16 v[172:175], v[232:235], v[40:43], v[172:175]
    v_mfma_f32_16x16x32_bf16 v[180:183], v[232:235], v[72:75], v[180:183]
    v_mfma_f32_16x16x32_bf16 v[188:191], v[232:235], v[104:107], v[188:191]
    s_nop 7
    ds_read_b128 v[232:235], v224 offset:52416
    s_waitcnt lgkmcnt(0)
    v_mfma_f32_16x16x32_bf16 v[164:167], v[232:235], v[12:15], v[164:167]
    v_mfma_f32_16x16x32_bf16 v[172:175], v[232:235], v[44:47], v[172:175]
    v_mfma_f32_16x16x32_bf16 v[180:183], v[232:235], v[76:79], v[180:183]
    v_mfma_f32_16x16x32_bf16 v[188:191], v[232:235], v[108:111], v[188:191]
    s_nop 7
    ds_read_b128 v[232:235], v224 offset:52480
    s_waitcnt lgkmcnt(0)
    v_mfma_f32_16x16x32_bf16 v[164:167], v[232:235], v[16:19], v[164:167]
    v_mfma_f32_16x16x32_bf16 v[172:175], v[232:235], v[48:51], v[172:175]
    v_mfma_f32_16x16x32_bf16 v[180:183], v[232:235], v[80:83], v[180:183]
    v_mfma_f32_16x16x32_bf16 v[188:191], v[232:235], v[112:115], v[188:191]
    s_nop 7
    ds_read_b128 v[232:235], v224 offset:52544
    s_waitcnt lgkmcnt(0)
    v_mfma_f32_16x16x32_bf16 v[164:167], v[232:235], v[20:23], v[164:167]
    v_mfma_f32_16x16x32_bf16 v[172:175], v[232:235], v[52:55], v[172:175]
    v_mfma_f32_16x16x32_bf16 v[180:183], v[232:235], v[84:87], v[180:183]
    v_mfma_f32_16x16x32_bf16 v[188:191], v[232:235], v[116:119], v[188:191]
    s_nop 7
    ds_read_b128 v[232:235], v224 offset:52608
    s_waitcnt lgkmcnt(0)
    v_mfma_f32_16x16x32_bf16 v[164:167], v[232:235], v[24:27], v[164:167]
    v_mfma_f32_16x16x32_bf16 v[172:175], v[232:235], v[56:59], v[172:175]
    v_mfma_f32_16x16x32_bf16 v[180:183], v[232:235], v[88:91], v[180:183]
    v_mfma_f32_16x16x32_bf16 v[188:191], v[232:235], v[120:123], v[188:191]
    s_nop 7
    ds_read_b128 v[232:235], v224 offset:52672
    s_waitcnt lgkmcnt(0)
    v_mfma_f32_16x16x32_bf16 v[164:167], v[232:235], v[28:31], v[164:167]
    v_mfma_f32_16x16x32_bf16 v[172:175], v[232:235], v[60:63], v[172:175]
    v_mfma_f32_16x16x32_bf16 v[180:183], v[232:235], v[92:95], v[180:183]
    v_mfma_f32_16x16x32_bf16 v[188:191], v[232:235], v[124:127], v[188:191]
    s_nop 7
    ds_read_b128 v[232:235], v224 offset:60928
    s_waitcnt lgkmcnt(0)
    v_mfma_f32_16x16x32_bf16 v[240:243], v[232:235], v[0:3], 0
    v_mfma_f32_16x16x32_bf16 v[244:247], v[232:235], v[32:35], 0
    v_mfma_f32_16x16x32_bf16 v[248:251], v[232:235], v[64:67], 0
    v_mfma_f32_16x16x32_bf16 v[252:255], v[232:235], v[96:99], 0
    s_nop 7
    ds_read_b128 v[232:235], v224 offset:60992
    s_waitcnt lgkmcnt(0)
    v_mfma_f32_16x16x32_bf16 v[240:243], v[232:235], v[4:7], v[240:243]
    v_mfma_f32_16x16x32_bf16 v[244:247], v[232:235], v[36:39], v[244:247]
    v_mfma_f32_16x16x32_bf16 v[248:251], v[232:235], v[68:71], v[248:251]
    v_mfma_f32_16x16x32_bf16 v[252:255], v[232:235], v[100:103], v[252:255]
    s_nop 7
    ds_read_b128 v[232:235], v224 offset:61056
    s_waitcnt lgkmcnt(0)
    v_mfma_f32_16x16x32_bf16 v[240:243], v[232:235], v[8:11], v[240:243]
    v_mfma_f32_16x16x32_bf16 v[244:247], v[232:235], v[40:43], v[244:247]
    v_mfma_f32_16x16x32_bf16 v[248:251], v[232:235], v[72:75], v[248:251]
    v_mfma_f32_16x16x32_bf16 v[252:255], v[232:235], v[104:107], v[252:255]
    s_nop 7
    ds_read_b128 v[232:235], v224 offset:61120
    s_waitcnt lgkmcnt(0)
    v_mfma_f32_16x16x32_bf16 v[240:243], v[232:235], v[12:15], v[240:243]
    v_mfma_f32_16x16x32_bf16 v[244:247], v[232:235], v[44:47], v[244:247]
    v_mfma_f32_16x16x32_bf16 v[248:251], v[232:235], v[76:79], v[248:251]
    v_mfma_f32_16x16x32_bf16 v[252:255], v[232:235], v[108:111], v[252:255]
    s_nop 7
    ds_read_b128 v[232:235], v224 offset:61184
    s_waitcnt lgkmcnt(0)
    v_mfma_f32_16x16x32_bf16 v[240:243], v[232:235], v[16:19], v[240:243]
    v_mfma_f32_16x16x32_bf16 v[244:247], v[232:235], v[48:51], v[244:247]
    v_mfma_f32_16x16x32_bf16 v[248:251], v[232:235], v[80:83], v[248:251]
    v_mfma_f32_16x16x32_bf16 v[252:255], v[232:235], v[112:115], v[252:255]
    s_nop 7
    ds_read_b128 v[232:235], v224 offset:61248
    s_waitcnt lgkmcnt(0)
    v_mfma_f32_16x16x32_bf16 v[240:243], v[232:235], v[20:23], v[240:243]
    v_mfma_f32_16x16x32_bf16 v[244:247], v[232:235], v[52:55], v[244:247]
    v_mfma_f32_16x16x32_bf16 v[248:251], v[232:235], v[84:87], v[248:251]
    v_mfma_f32_16x16x32_bf16 v[252:255], v[232:235], v[116:119], v[252:255]
    s_nop 7
    ds_read_b128 v[232:235], v224 offset:61312
    s_waitcnt lgkmcnt(0)
    v_mfma_f32_16x16x32_bf16 v[240:243], v[232:235], v[24:27], v[240:243]
    v_mfma_f32_16x16x32_bf16 v[244:247], v[232:235], v[56:59], v[244:247]
    v_mfma_f32_16x16x32_bf16 v[248:251], v[232:235], v[88:91], v[248:251]
    v_mfma_f32_16x16x32_bf16 v[252:255], v[232:235], v[120:123], v[252:255]
    s_nop 7
    ds_read_b128 v[232:235], v224 offset:61376
    s_waitcnt lgkmcnt(0)
    v_mfma_f32_16x16x32_bf16 v[240:243], v[232:235], v[28:31], v[240:243]
    v_mfma_f32_16x16x32_bf16 v[244:247], v[232:235], v[60:63], v[244:247]
    v_mfma_f32_16x16x32_bf16 v[248:251], v[232:235], v[92:95], v[248:251]
    v_mfma_f32_16x16x32_bf16 v[252:255], v[232:235], v[124:127], v[252:255]
    s_nop 7
    s_nop 7
    v_add_f32 v164, v164, v237
    v_add_f32 v165, v165, v237
    v_add_f32 v166, v166, v237
    v_add_f32 v167, v167, v237
    v_add_f32 v240, v240, v237
    v_add_f32 v241, v241, v237
    v_add_f32 v242, v242, v237
    v_add_f32 v243, v243, v237
    v_max3_f32 v236, v164, v165, v166
    v_max3_f32 v236, v236, v167, v240
    v_max3_f32 v236, v236, v241, v242
    v_max_f32 v236, v236, v243
    v_mov_b32 v232, v236
    s_nop 1
    v_permlane16_swap_b32 v236, v232
    s_nop 1
    v_max_f32 v236, v236, v232
    v_mov_b32 v232, v236
    s_nop 1
    v_permlane32_swap_b32 v236, v232
    s_nop 1
    v_max_f32 v236, v236, v232
    v_ceil_f32 v236, v236
    v_max_f32 v236, 0, v236
    v_sub_f32 v237, v237, v236
    v_sub_f32 v164, v164, v236
    v_sub_f32 v165, v165, v236
    v_sub_f32 v166, v166, v236
    v_sub_f32 v167, v167, v236
    v_sub_f32 v240, v240, v236
    v_sub_f32 v241, v241, v236
    v_sub_f32 v242, v242, v236
    v_sub_f32 v243, v243, v236
    v_min_f32 v232, 0x43480000, v236
    v_cvt_i32_f32 v232, v232
    v_sub_u32 v232, 0, v232
    v_ldexp_f32 v233, 1.0, v232
    v_mul_f32 v228, v228, v233
    v_lshlrev_b32 v236, 16, v160
    v_and_b32 v232, 0xffff0000, v160
    v_mul_f32 v236, v236, v233
    v_mul_f32 v232, v232, v233
    v_cvt_pk_bf16_f32 v160, v236, v232
    v_lshlrev_b32 v236, 16, v161
    v_and_b32 v232, 0xffff0000, v161
    v_mul_f32 v236, v236, v233
    v_mul_f32 v232, v232, v233
    v_cvt_pk_bf16_f32 v161, v236, v232
    v_lshlrev_b32 v236, 16, v162
    v_and_b32 v232, 0xffff0000, v162
    v_mul_f32 v236, v236, v233
    v_mul_f32 v232, v232, v233
    v_cvt_pk_bf16_f32 v162, v236, v232
    v_lshlrev_b32 v236, 16, v163
    v_and_b32 v232, 0xffff0000, v163
    v_mul_f32 v236, v236, v233
    v_mul_f32 v232, v232, v233
    v_cvt_pk_bf16_f32 v163, v236, v232
    v_lshlrev_b32 v236, 16, v128
    v_and_b32 v232, 0xffff0000, v128
    v_mul_f32 v236, v236, v233
    v_mul_f32 v232, v232, v233
    v_cvt_pk_bf16_f32 v128, v236, v232
    v_lshlrev_b32 v236, 16, v129
    v_and_b32 v232, 0xffff0000, v129
    v_mul_f32 v236, v236, v233
    v_mul_f32 v232, v232, v233
    v_cvt_pk_bf16_f32 v129, v236, v232
    v_lshlrev_b32 v236, 16, v130
    v_and_b32 v232, 0xffff0000, v130
    v_mul_f32 v236, v236, v233
    v_mul_f32 v232, v232, v233
    v_cvt_pk_bf16_f32 v130, v236, v232
    v_lshlrev_b32 v236, 16, v131
    v_and_b32 v232, 0xffff0000, v131
    v_mul_f32 v236, v236, v233
    v_mul_f32 v232, v232, v233
    v_cvt_pk_bf16_f32 v131, v236, v232
    v_accvgpr_read_b32 v236, a0
    v_accvgpr_read_b32 v232, a1
    v_mul_f32 v236, v236, v233
    v_mul_f32 v232, v232, v233
    v_accvgpr_write_b32 a0, v236
    v_accvgpr_write_b32 a1, v232
    v_accvgpr_read_b32 v236, a2
    v_accvgpr_read_b32 v232, a3
    v_mul_f32 v236, v236, v233
    v_mul_f32 v232, v232, v233
    v_accvgpr_write_b32 a2, v236
    v_accvgpr_write_b32 a3, v232
    v_accvgpr_read_b32 v236, a4
    v_accvgpr_read_b32 v232, a5
    v_mul_f32 v236, v236, v233
    v_mul_f32 v232, v232, v233
    v_accvgpr_write_b32 a4, v236
    v_accvgpr_write_b32 a5, v232
    v_accvgpr_read_b32 v236, a6
    v_accvgpr_read_b32 v232, a7
    v_mul_f32 v236, v236, v233
    v_mul_f32 v232, v232, v233
    v_accvgpr_write_b32 a6, v236
    v_accvgpr_write_b32 a7, v232
    v_accvgpr_read_b32 v236, a8
    v_accvgpr_read_b32 v232, a9
    v_mul_f32 v236, v236, v233
    v_mul_f32 v232, v232, v233
    v_accvgpr_write_b32 a8, v236
    v_accvgpr_write_b32 a9, v232
    v_accvgpr_read_b32 v236, a10
    v_accvgpr_read_b32 v232, a11
    v_mul_f32 v236, v236, v233
    v_mul_f32 v232, v232, v233
    v_accvgpr_write_b32 a10, v236
    v_accvgpr_write_b32 a11, v232
    v_accvgpr_read_b32 v236, a12
    v_accvgpr_read_b32 v232, a13
    v_mul_f32 v236, v236, v233
    v_mul_f32 v232, v232, v233
    v_accvgpr_write_b32 a12, v236
    v_accvgpr_write_b32 a13, v232
    v_accvgpr_read_b32 v236, a14
    v_accvgpr_read_b32 v232, a15
    v_mul_f32 v236, v236, v233
    v_mul_f32 v232, v232, v233
    v_accvgpr_write_b32 a14, v236
    v_accvgpr_write_b32 a15, v232
    v_accvgpr_read_b32 v236, a16
    v_accvgpr_read_b32 v232, a17
    v_mul_f32 v236, v236, v233
    v_mul_f32 v232, v232, v233
    v_accvgpr_write_b32 a16, v236
    v_accvgpr_write_b32 a17, v232
    v_accvgpr_read_b32 v236, a18
    v_accvgpr_read_b32 v232, a19
    v_mul_f32 v236, v236, v233
    v_mul_f32 v232, v232, v233
    v_accvgpr_write_b32 a18, v236
    v_accvgpr_write_b32 a19, v232
    v_accvgpr_read_b32 v236, a20
    v_accvgpr_read_b32 v232, a21
    v_mul_f32 v236, v236, v233
    v_mul_f32 v232, v232, v233
    v_accvgpr_write_b32 a20, v236
    v_accvgpr_write_b32 a21, v232
    v_accvgpr_read_b32 v236, a22
    v_accvgpr_read_b32 v232, a23
    v_mul_f32 v236, v236, v233
    v_mul_f32 v232, v232, v233
    v_accvgpr_write_b32 a22, v236
    v_accvgpr_write_b32 a23, v232
    v_accvgpr_read_b32 v236, a24
    v_accvgpr_read_b32 v232, a25
    v_mul_f32 v236, v236, v233
    v_mul_f32 v232, v232, v233
    v_accvgpr_write_b32 a24, v236
    v_accvgpr_write_b32 a25, v232
    v_accvgpr_read_b32 v236, a26
    v_accvgpr_read_b32 v232, a27
    v_mul_f32 v236, v236, v233
    v_mul_f32 v232, v232, v233
    v_accvgpr_write_b32 a26, v236
    v_accvgpr_write_b32 a27, v232
    v_accvgpr_read_b32 v236, a28
    v_accvgpr_read_b32 v232, a29
    v_mul_f32 v236, v236, v233
    v_mul_f32 v232, v232, v233
    v_accvgpr_write_b32 a28, v236
    v_accvgpr_write_b32 a29, v232
    v_accvgpr_read_b32 v236, a30
    v_accvgpr_read_b32 v232, a31
    v_mul_f32 v236, v236, v233
    v_mul_f32 v232, v232, v233
    v_accvgpr_write_b32 a30, v236
    v_accvgpr_write_b32 a31, v232
    v_accvgpr_read_b32 v236, a32
    v_accvgpr_read_b32 v232, a33
    v_mul_f32 v236, v236, v233
    v_mul_f32 v232, v232, v233
    v_accvgpr_write_b32 a32, v236
    v_accvgpr_write_b32 a33, v232
    v_accvgpr_read_b32 v236, a34
    v_accvgpr_read_b32 v232, a35
    v_mul_f32 v236, v236, v233
    v_mul_f32 v232, v232, v233
    v_accvgpr_write_b32 a34, v236
    v_accvgpr_write_b32 a35, v232
    v_accvgpr_read_b32 v236, a36
    v_accvgpr_read_b32 v232, a37
    v_mul_f32 v236, v236, v233
    v_mul_f32 v232, v232, v233
    v_accvgpr_write_b32 a36, v236
    v_accvgpr_write_b32 a37, v232
    v_accvgpr_read_b32 v236, a38
    v_accvgpr_read_b32 v232, a39
    v_mul_f32 v236, v236, v233
    v_mul_f32 v232, v232, v233
    v_accvgpr_write_b32 a38, v236
    v_accvgpr_write_b32 a39, v232
    v_accvgpr_read_b32 v236, a40
    v_accvgpr_read_b32 v232, a41
    v_mul_f32 v236, v236, v233
    v_mul_f32 v232, v232, v233
    v_accvgpr_write_b32 a40, v236
    v_accvgpr_write_b32 a41, v232
    v_accvgpr_read_b32 v236, a42
    v_accvgpr_read_b32 v232, a43
    v_mul_f32 v236, v236, v233
    v_mul_f32 v232, v232, v233
    v_accvgpr_write_b32 a42, v236
    v_accvgpr_write_b32 a43, v232
    v_accvgpr_read_b32 v236, a44
    v_accvgpr_read_b32 v232, a45
    v_mul_f32 v236, v236, v233
    v_mul_f32 v232, v232, v233
    v_accvgpr_write_b32 a44, v236
    v_accvgpr_write_b32 a45, v232
    v_accvgpr_read_b32 v236, a46
    v_accvgpr_read_b32 v232, a47
    v_mul_f32 v236, v236, v233
    v_mul_f32 v232, v232, v233
    v_accvgpr_write_b32 a46, v236
    v_accvgpr_write_b32 a47, v232
    v_accvgpr_read_b32 v236, a48
    v_accvgpr_read_b32 v232, a49
    v_mul_f32 v236, v236, v233
    v_mul_f32 v232, v232, v233
    v_accvgpr_write_b32 a48, v236
    v_accvgpr_write_b32 a49, v232
    v_accvgpr_read_b32 v236, a50
    v_accvgpr_read_b32 v232, a51
    v_mul_f32 v236, v236, v233
    v_mul_f32 v232, v232, v233
    v_accvgpr_write_b32 a50, v236
    v_accvgpr_write_b32 a51, v232
    v_accvgpr_read_b32 v236, a52
    v_accvgpr_read_b32 v232, a53
    v_mul_f32 v236, v236, v233
    v_mul_f32 v232, v232, v233
    v_accvgpr_write_b32 a52, v236
    v_accvgpr_write_b32 a53, v232
    v_accvgpr_read_b32 v236, a54
    v_accvgpr_read_b32 v232, a55
    v_mul_f32 v236, v236, v233
    v_mul_f32 v232, v232, v233
    v_accvgpr_write_b32 a54, v236
    v_accvgpr_write_b32 a55, v232
    v_accvgpr_read_b32 v236, a56
    v_accvgpr_read_b32 v232, a57
    v_mul_f32 v236, v236, v233
    v_mul_f32 v232, v232, v233
    v_accvgpr_write_b32 a56, v236
    v_accvgpr_write_b32 a57, v232
    v_accvgpr_read_b32 v236, a58
    v_accvgpr_read_b32 v232, a59
    v_mul_f32 v236, v236, v233
    v_mul_f32 v232, v232, v233
    v_accvgpr_write_b32 a58, v236
    v_accvgpr_write_b32 a59, v232
    v_accvgpr_read_b32 v236, a60
    v_accvgpr_read_b32 v232, a61
    v_mul_f32 v236, v236, v233
    v_mul_f32 v232, v232, v233
    v_accvgpr_write_b32 a60, v236
    v_accvgpr_write_b32 a61, v232
    v_accvgpr_read_b32 v236, a62
    v_accvgpr_read_b32 v232, a63
    v_mul_f32 v236, v236, v233
    v_mul_f32 v232, v232, v233
    v_accvgpr_write_b32 a62, v236
    v_accvgpr_write_b32 a63, v232
    v_add_f32 v172, v172, v238
    v_add_f32 v173, v173, v238
    v_add_f32 v174, v174, v238
    v_add_f32 v175, v175, v238
    v_add_f32 v244, v244, v238
    v_add_f32 v245, v245, v238
    v_add_f32 v246, v246, v238
    v_add_f32 v247, v247, v238
    v_max3_f32 v236, v172, v173, v174
    v_max3_f32 v236, v236, v175, v244
    v_max3_f32 v236, v236, v245, v246
    v_max_f32 v236, v236, v247
    v_mov_b32 v232, v236
    s_nop 1
    v_permlane16_swap_b32 v236, v232
    s_nop 1
    v_max_f32 v236, v236, v232
    v_mov_b32 v232, v236
    s_nop 1
    v_permlane32_swap_b32 v236, v232
    s_nop 1
    v_max_f32 v236, v236, v232
    v_ceil_f32 v236, v236
    v_max_f32 v236, 0, v236
    v_sub_f32 v238, v238, v236
    v_sub_f32 v172, v172, v236
    v_sub_f32 v173, v173, v236
    v_sub_f32 v174, v174, v236
    v_sub_f32 v175, v175, v236
    v_sub_f32 v244, v244, v236
    v_sub_f32 v245, v245, v236
    v_sub_f32 v246, v246, v236
    v_sub_f32 v247, v247, v236
    v_min_f32 v232, 0x43480000, v236
    v_cvt_i32_f32 v232, v232
    v_sub_u32 v232, 0, v232
    v_ldexp_f32 v233, 1.0, v232
    v_mul_f32 v229, v229, v233
    v_lshlrev_b32 v236, 16, v168
    v_and_b32 v232, 0xffff0000, v168
    v_mul_f32 v236, v236, v233
    v_mul_f32 v232, v232, v233
    v_cvt_pk_bf16_f32 v168, v236, v232
    v_lshlrev_b32 v236, 16, v169
    v_and_b32 v232, 0xffff0000, v169
    v_mul_f32 v236, v236, v233
    v_mul_f32 v232, v232, v233
    v_cvt_pk_bf16_f32 v169, v236, v232
    v_lshlrev_b32 v236, 16, v170
    v_and_b32 v232, 0xffff0000, v170
    v_mul_f32 v236, v236, v233
    v_mul_f32 v232, v232, v233
    v_cvt_pk_bf16_f32 v170, v236, v232
    v_lshlrev_b32 v236, 16, v171
    v_and_b32 v232, 0xffff0000, v171
    v_mul_f32 v236, v236, v233
    v_mul_f32 v232, v232, v233
    v_cvt_pk_bf16_f32 v171, v236, v232
    v_lshlrev_b32 v236, 16, v136
    v_and_b32 v232, 0xffff0000, v136
    v_mul_f32 v236, v236, v233
    v_mul_f32 v232, v232, v233
    v_cvt_pk_bf16_f32 v136, v236, v232
    v_lshlrev_b32 v236, 16, v137
    v_and_b32 v232, 0xffff0000, v137
    v_mul_f32 v236, v236, v233
    v_mul_f32 v232, v232, v233
    v_cvt_pk_bf16_f32 v137, v236, v232
    v_lshlrev_b32 v236, 16, v138
    v_and_b32 v232, 0xffff0000, v138
    v_mul_f32 v236, v236, v233
    v_mul_f32 v232, v232, v233
    v_cvt_pk_bf16_f32 v138, v236, v232
    v_lshlrev_b32 v236, 16, v139
    v_and_b32 v232, 0xffff0000, v139
    v_mul_f32 v236, v236, v233
    v_mul_f32 v232, v232, v233
    v_cvt_pk_bf16_f32 v139, v236, v232
    v_accvgpr_read_b32 v236, a64
    v_accvgpr_read_b32 v232, a65
    v_mul_f32 v236, v236, v233
    v_mul_f32 v232, v232, v233
    v_accvgpr_write_b32 a64, v236
    v_accvgpr_write_b32 a65, v232
    v_accvgpr_read_b32 v236, a66
    v_accvgpr_read_b32 v232, a67
    v_mul_f32 v236, v236, v233
    v_mul_f32 v232, v232, v233
    v_accvgpr_write_b32 a66, v236
    v_accvgpr_write_b32 a67, v232
    v_accvgpr_read_b32 v236, a68
    v_accvgpr_read_b32 v232, a69
    v_mul_f32 v236, v236, v233
    v_mul_f32 v232, v232, v233
    v_accvgpr_write_b32 a68, v236
    v_accvgpr_write_b32 a69, v232
    v_accvgpr_read_b32 v236, a70
    v_accvgpr_read_b32 v232, a71
    v_mul_f32 v236, v236, v233
    v_mul_f32 v232, v232, v233
    v_accvgpr_write_b32 a70, v236
    v_accvgpr_write_b32 a71, v232
    v_accvgpr_read_b32 v236, a72
    v_accvgpr_read_b32 v232, a73
    v_mul_f32 v236, v236, v233
    v_mul_f32 v232, v232, v233
    v_accvgpr_write_b32 a72, v236
    v_accvgpr_write_b32 a73, v232
    v_accvgpr_read_b32 v236, a74
    v_accvgpr_read_b32 v232, a75
    v_mul_f32 v236, v236, v233
    v_mul_f32 v232, v232, v233
    v_accvgpr_write_b32 a74, v236
    v_accvgpr_write_b32 a75, v232
    v_accvgpr_read_b32 v236, a76
    v_accvgpr_read_b32 v232, a77
    v_mul_f32 v236, v236, v233
    v_mul_f32 v232, v232, v233
    v_accvgpr_write_b32 a76, v236
    v_accvgpr_write_b32 a77, v232
    v_accvgpr_read_b32 v236, a78
    v_accvgpr_read_b32 v232, a79
    v_mul_f32 v236, v236, v233
    v_mul_f32 v232, v232, v233
    v_accvgpr_write_b32 a78, v236
    v_accvgpr_write_b32 a79, v232
    v_accvgpr_read_b32 v236, a80
    v_accvgpr_read_b32 v232, a81
    v_mul_f32 v236, v236, v233
    v_mul_f32 v232, v232, v233
    v_accvgpr_write_b32 a80, v236
    v_accvgpr_write_b32 a81, v232
    v_accvgpr_read_b32 v236, a82
    v_accvgpr_read_b32 v232, a83
    v_mul_f32 v236, v236, v233
    v_mul_f32 v232, v232, v233
    v_accvgpr_write_b32 a82, v236
    v_accvgpr_write_b32 a83, v232
    v_accvgpr_read_b32 v236, a84
    v_accvgpr_read_b32 v232, a85
    v_mul_f32 v236, v236, v233
    v_mul_f32 v232, v232, v233
    v_accvgpr_write_b32 a84, v236
    v_accvgpr_write_b32 a85, v232
    v_accvgpr_read_b32 v236, a86
    v_accvgpr_read_b32 v232, a87
    v_mul_f32 v236, v236, v233
    v_mul_f32 v232, v232, v233
    v_accvgpr_write_b32 a86, v236
    v_accvgpr_write_b32 a87, v232
    v_accvgpr_read_b32 v236, a88
    v_accvgpr_read_b32 v232, a89
    v_mul_f32 v236, v236, v233
    v_mul_f32 v232, v232, v233
    v_accvgpr_write_b32 a88, v236
    v_accvgpr_write_b32 a89, v232
    v_accvgpr_read_b32 v236, a90
    v_accvgpr_read_b32 v232, a91
    v_mul_f32 v236, v236, v233
    v_mul_f32 v232, v232, v233
    v_accvgpr_write_b32 a90, v236
    v_accvgpr_write_b32 a91, v232
    v_accvgpr_read_b32 v236, a92
    v_accvgpr_read_b32 v232, a93
    v_mul_f32 v236, v236, v233
    v_mul_f32 v232, v232, v233
    v_accvgpr_write_b32 a92, v236
    v_accvgpr_write_b32 a93, v232
    v_accvgpr_read_b32 v236, a94
    v_accvgpr_read_b32 v232, a95
    v_mul_f32 v236, v236, v233
    v_mul_f32 v232, v232, v233
    v_accvgpr_write_b32 a94, v236
    v_accvgpr_write_b32 a95, v232
    v_accvgpr_read_b32 v236, a96
    v_accvgpr_read_b32 v232, a97
    v_mul_f32 v236, v236, v233
    v_mul_f32 v232, v232, v233
    v_accvgpr_write_b32 a96, v236
    v_accvgpr_write_b32 a97, v232
    v_accvgpr_read_b32 v236, a98
    v_accvgpr_read_b32 v232, a99
    v_mul_f32 v236, v236, v233
    v_mul_f32 v232, v232, v233
    v_accvgpr_write_b32 a98, v236
    v_accvgpr_write_b32 a99, v232
    v_accvgpr_read_b32 v236, a100
    v_accvgpr_read_b32 v232, a101
    v_mul_f32 v236, v236, v233
    v_mul_f32 v232, v232, v233
    v_accvgpr_write_b32 a100, v236
    v_accvgpr_write_b32 a101, v232
    v_accvgpr_read_b32 v236, a102
    v_accvgpr_read_b32 v232, a103
    v_mul_f32 v236, v236, v233
    v_mul_f32 v232, v232, v233
    v_accvgpr_write_b32 a102, v236
    v_accvgpr_write_b32 a103, v232
    v_accvgpr_read_b32 v236, a104
    v_accvgpr_read_b32 v232, a105
    v_mul_f32 v236, v236, v233
    v_mul_f32 v232, v232, v233
    v_accvgpr_write_b32 a104, v236
    v_accvgpr_write_b32 a105, v232
    v_accvgpr_read_b32 v236, a106
    v_accvgpr_read_b32 v232, a107
    v_mul_f32 v236, v236, v233
    v_mul_f32 v232, v232, v233
    v_accvgpr_write_b32 a106, v236
    v_accvgpr_write_b32 a107, v232
    v_accvgpr_read_b32 v236, a108
    v_accvgpr_read_b32 v232, a109
    v_mul_f32 v236, v236, v233
    v_mul_f32 v232, v232, v233
    v_accvgpr_write_b32 a108, v236
    v_accvgpr_write_b32 a109, v232
    v_accvgpr_read_b32 v236, a110
    v_accvgpr_read_b32 v232, a111
    v_mul_f32 v236, v236, v233
    v_mul_f32 v232, v232, v233
    v_accvgpr_write_b32 a110, v236
    v_accvgpr_write_b32 a111, v232
    v_accvgpr_read_b32 v236, a112
    v_accvgpr_read_b32 v232, a113
    v_mul_f32 v236, v236, v233
    v_mul_f32 v232, v232, v233
    v_accvgpr_write_b32 a112, v236
    v_accvgpr_write_b32 a113, v232
    v_accvgpr_read_b32 v236, a114
    v_accvgpr_read_b32 v232, a115
    v_mul_f32 v236, v236, v233
    v_mul_f32 v232, v232, v233
    v_accvgpr_write_b32 a114, v236
    v_accvgpr_write_b32 a115, v232
    v_accvgpr_read_b32 v236, a116
    v_accvgpr_read_b32 v232, a117
    v_mul_f32 v236, v236, v233
    v_mul_f32 v232, v232, v233
    v_accvgpr_write_b32 a116, v236
    v_accvgpr_write_b32 a117, v232
    v_accvgpr_read_b32 v236, a118
    v_accvgpr_read_b32 v232, a119
    v_mul_f32 v236, v236, v233
    v_mul_f32 v232, v232, v233
    v_accvgpr_write_b32 a118, v236
    v_accvgpr_write_b32 a119, v232
    v_accvgpr_read_b32 v236, a120
    v_accvgpr_read_b32 v232, a121
    v_mul_f32 v236, v236, v233
    v_mul_f32 v232, v232, v233
    v_accvgpr_write_b32 a120, v236
    v_accvgpr_write_b32 a121, v232
    v_accvgpr_read_b32 v236, a122
    v_accvgpr_read_b32 v232, a123
    v_mul_f32 v236, v236, v233
    v_mul_f32 v232, v232, v233
    v_accvgpr_write_b32 a122, v236
    v_accvgpr_write_b32 a123, v232
    v_accvgpr_read_b32 v236, a124
    v_accvgpr_read_b32 v232, a125
    v_mul_f32 v236, v236, v233
    v_mul_f32 v232, v232, v233
    v_accvgpr_write_b32 a124, v236
    v_accvgpr_write_b32 a125, v232
    v_accvgpr_read_b32 v236, a126
    v_accvgpr_read_b32 v232, a127
    v_mul_f32 v236, v236, v233
    v_mul_f32 v232, v232, v233
    v_accvgpr_write_b32 a126, v236
    v_accvgpr_write_b32 a127, v232
    v_add_f32 v180, v180, v239
    v_add_f32 v181, v181, v239
    v_add_f32 v182, v182, v239
    v_add_f32 v183, v183, v239
    v_add_f32 v248, v248, v239
    v_add_f32 v249, v249, v239
    v_add_f32 v250, v250, v239
    v_add_f32 v251, v251, v239
    v_max3_f32 v236, v180, v181, v182
    v_max3_f32 v236, v236, v183, v248
    v_max3_f32 v236, v236, v249, v250
    v_max_f32 v236, v236, v251
    v_mov_b32 v232, v236
    s_nop 1
    v_permlane16_swap_b32 v236, v232
    s_nop 1
    v_max_f32 v236, v236, v232
    v_mov_b32 v232, v236
    s_nop 1
    v_permlane32_swap_b32 v236, v232
    s_nop 1
    v_max_f32 v236, v236, v232
    v_ceil_f32 v236, v236
    v_max_f32 v236, 0, v236
    v_sub_f32 v239, v239, v236
    v_sub_f32 v180, v180, v236
    v_sub_f32 v181, v181, v236
    v_sub_f32 v182, v182, v236
    v_sub_f32 v183, v183, v236
    v_sub_f32 v248, v248, v236
    v_sub_f32 v249, v249, v236
    v_sub_f32 v250, v250, v236
    v_sub_f32 v251, v251, v236
    v_min_f32 v232, 0x43480000, v236
    v_cvt_i32_f32 v232, v232
    v_sub_u32 v232, 0, v232
    v_ldexp_f32 v233, 1.0, v232
    v_mul_f32 v230, v230, v233
    v_lshlrev_b32 v236, 16, v176
    v_and_b32 v232, 0xffff0000, v176
    v_mul_f32 v236, v236, v233
    v_mul_f32 v232, v232, v233
    v_cvt_pk_bf16_f32 v176, v236, v232
    v_lshlrev_b32 v236, 16, v177
    v_and_b32 v232, 0xffff0000, v177
    v_mul_f32 v236, v236, v233
    v_mul_f32 v232, v232, v233
    v_cvt_pk_bf16_f32 v177, v236, v232
    v_lshlrev_b32 v236, 16, v178
    v_and_b32 v232, 0xffff0000, v178
    v_mul_f32 v236, v236, v233
    v_mul_f32 v232, v232, v233
    v_cvt_pk_bf16_f32 v178, v236, v232
    v_lshlrev_b32 v236, 16, v179
    v_and_b32 v232, 0xffff0000, v179
    v_mul_f32 v236, v236, v233
    v_mul_f32 v232, v232, v233
    v_cvt_pk_bf16_f32 v179, v236, v232
    v_lshlrev_b32 v236, 16, v144
    v_and_b32 v232, 0xffff0000, v144
    v_mul_f32 v236, v236, v233
    v_mul_f32 v232, v232, v233
    v_cvt_pk_bf16_f32 v144, v236, v232
    v_lshlrev_b32 v236, 16, v145
    v_and_b32 v232, 0xffff0000, v145
    v_mul_f32 v236, v236, v233
    v_mul_f32 v232, v232, v233
    v_cvt_pk_bf16_f32 v145, v236, v232
    v_lshlrev_b32 v236, 16, v146
    v_and_b32 v232, 0xffff0000, v146
    v_mul_f32 v236, v236, v233
    v_mul_f32 v232, v232, v233
    v_cvt_pk_bf16_f32 v146, v236, v232
    v_lshlrev_b32 v236, 16, v147
    v_and_b32 v232, 0xffff0000, v147
    v_mul_f32 v236, v236, v233
    v_mul_f32 v232, v232, v233
    v_cvt_pk_bf16_f32 v147, v236, v232
    v_accvgpr_read_b32 v236, a128
    v_accvgpr_read_b32 v232, a129
    v_mul_f32 v236, v236, v233
    v_mul_f32 v232, v232, v233
    v_accvgpr_write_b32 a128, v236
    v_accvgpr_write_b32 a129, v232
    v_accvgpr_read_b32 v236, a130
    v_accvgpr_read_b32 v232, a131
    v_mul_f32 v236, v236, v233
    v_mul_f32 v232, v232, v233
    v_accvgpr_write_b32 a130, v236
    v_accvgpr_write_b32 a131, v232
    v_accvgpr_read_b32 v236, a132
    v_accvgpr_read_b32 v232, a133
    v_mul_f32 v236, v236, v233
    v_mul_f32 v232, v232, v233
    v_accvgpr_write_b32 a132, v236
    v_accvgpr_write_b32 a133, v232
    v_accvgpr_read_b32 v236, a134
    v_accvgpr_read_b32 v232, a135
    v_mul_f32 v236, v236, v233
    v_mul_f32 v232, v232, v233
    v_accvgpr_write_b32 a134, v236
    v_accvgpr_write_b32 a135, v232
    v_accvgpr_read_b32 v236, a136
    v_accvgpr_read_b32 v232, a137
    v_mul_f32 v236, v236, v233
    v_mul_f32 v232, v232, v233
    v_accvgpr_write_b32 a136, v236
    v_accvgpr_write_b32 a137, v232
    v_accvgpr_read_b32 v236, a138
    v_accvgpr_read_b32 v232, a139
    v_mul_f32 v236, v236, v233
    v_mul_f32 v232, v232, v233
    v_accvgpr_write_b32 a138, v236
    v_accvgpr_write_b32 a139, v232
    v_accvgpr_read_b32 v236, a140
    v_accvgpr_read_b32 v232, a141
    v_mul_f32 v236, v236, v233
    v_mul_f32 v232, v232, v233
    v_accvgpr_write_b32 a140, v236
    v_accvgpr_write_b32 a141, v232
    v_accvgpr_read_b32 v236, a142
    v_accvgpr_read_b32 v232, a143
    v_mul_f32 v236, v236, v233
    v_mul_f32 v232, v232, v233
    v_accvgpr_write_b32 a142, v236
    v_accvgpr_write_b32 a143, v232
    v_accvgpr_read_b32 v236, a144
    v_accvgpr_read_b32 v232, a145
    v_mul_f32 v236, v236, v233
    v_mul_f32 v232, v232, v233
    v_accvgpr_write_b32 a144, v236
    v_accvgpr_write_b32 a145, v232
    v_accvgpr_read_b32 v236, a146
    v_accvgpr_read_b32 v232, a147
    v_mul_f32 v236, v236, v233
    v_mul_f32 v232, v232, v233
    v_accvgpr_write_b32 a146, v236
    v_accvgpr_write_b32 a147, v232
    v_accvgpr_read_b32 v236, a148
    v_accvgpr_read_b32 v232, a149
    v_mul_f32 v236, v236, v233
    v_mul_f32 v232, v232, v233
    v_accvgpr_write_b32 a148, v236
    v_accvgpr_write_b32 a149, v232
    v_accvgpr_read_b32 v236, a150
    v_accvgpr_read_b32 v232, a151
    v_mul_f32 v236, v236, v233
    v_mul_f32 v232, v232, v233
    v_accvgpr_write_b32 a150, v236
    v_accvgpr_write_b32 a151, v232
    v_accvgpr_read_b32 v236, a152
    v_accvgpr_read_b32 v232, a153
    v_mul_f32 v236, v236, v233
    v_mul_f32 v232, v232, v233
    v_accvgpr_write_b32 a152, v236
    v_accvgpr_write_b32 a153, v232
    v_accvgpr_read_b32 v236, a154
    v_accvgpr_read_b32 v232, a155
    v_mul_f32 v236, v236, v233
    v_mul_f32 v232, v232, v233
    v_accvgpr_write_b32 a154, v236
    v_accvgpr_write_b32 a155, v232
    v_accvgpr_read_b32 v236, a156
    v_accvgpr_read_b32 v232, a157
    v_mul_f32 v236, v236, v233
    v_mul_f32 v232, v232, v233
    v_accvgpr_write_b32 a156, v236
    v_accvgpr_write_b32 a157, v232
    v_accvgpr_read_b32 v236, a158
    v_accvgpr_read_b32 v232, a159
    v_mul_f32 v236, v236, v233
    v_mul_f32 v232, v232, v233
    v_accvgpr_write_b32 a158, v236
    v_accvgpr_write_b32 a159, v232
    v_accvgpr_read_b32 v236, a160
    v_accvgpr_read_b32 v232, a161
    v_mul_f32 v236, v236, v233
    v_mul_f32 v232, v232, v233
    v_accvgpr_write_b32 a160, v236
    v_accvgpr_write_b32 a161, v232
    v_accvgpr_read_b32 v236, a162
    v_accvgpr_read_b32 v232, a163
    v_mul_f32 v236, v236, v233
    v_mul_f32 v232, v232, v233
    v_accvgpr_write_b32 a162, v236
    v_accvgpr_write_b32 a163, v232
    v_accvgpr_read_b32 v236, a164
    v_accvgpr_read_b32 v232, a165
    v_mul_f32 v236, v236, v233
    v_mul_f32 v232, v232, v233
    v_accvgpr_write_b32 a164, v236
    v_accvgpr_write_b32 a165, v232
    v_accvgpr_read_b32 v236, a166
    v_accvgpr_read_b32 v232, a167
    v_mul_f32 v236, v236, v233
    v_mul_f32 v232, v232, v233
    v_accvgpr_write_b32 a166, v236
    v_accvgpr_write_b32 a167, v232
    v_accvgpr_read_b32 v236, a168
    v_accvgpr_read_b32 v232, a169
    v_mul_f32 v236, v236, v233
    v_mul_f32 v232, v232, v233
    v_accvgpr_write_b32 a168, v236
    v_accvgpr_write_b32 a169, v232
    v_accvgpr_read_b32 v236, a170
    v_accvgpr_read_b32 v232, a171
    v_mul_f32 v236, v236, v233
    v_mul_f32 v232, v232, v233
    v_accvgpr_write_b32 a170, v236
    v_accvgpr_write_b32 a171, v232
    v_accvgpr_read_b32 v236, a172
    v_accvgpr_read_b32 v232, a173
    v_mul_f32 v236, v236, v233
    v_mul_f32 v232, v232, v233
    v_accvgpr_write_b32 a172, v236
    v_accvgpr_write_b32 a173, v232
    v_accvgpr_read_b32 v236, a174
    v_accvgpr_read_b32 v232, a175
    v_mul_f32 v236, v236, v233
    v_mul_f32 v232, v232, v233
    v_accvgpr_write_b32 a174, v236
    v_accvgpr_write_b32 a175, v232
    v_accvgpr_read_b32 v236, a176
    v_accvgpr_read_b32 v232, a177
    v_mul_f32 v236, v236, v233
    v_mul_f32 v232, v232, v233
    v_accvgpr_write_b32 a176, v236
    v_accvgpr_write_b32 a177, v232
    v_accvgpr_read_b32 v236, a178
    v_accvgpr_read_b32 v232, a179
    v_mul_f32 v236, v236, v233
    v_mul_f32 v232, v232, v233
    v_accvgpr_write_b32 a178, v236
    v_accvgpr_write_b32 a179, v232
    v_accvgpr_read_b32 v236, a180
    v_accvgpr_read_b32 v232, a181
    v_mul_f32 v236, v236, v233
    v_mul_f32 v232, v232, v233
    v_accvgpr_write_b32 a180, v236
    v_accvgpr_write_b32 a181, v232
    v_accvgpr_read_b32 v236, a182
    v_accvgpr_read_b32 v232, a183
    v_mul_f32 v236, v236, v233
    v_mul_f32 v232, v232, v233
    v_accvgpr_write_b32 a182, v236
    v_accvgpr_write_b32 a183, v232
    v_accvgpr_read_b32 v236, a184
    v_accvgpr_read_b32 v232, a185
    v_mul_f32 v236, v236, v233
    v_mul_f32 v232, v232, v233
    v_accvgpr_write_b32 a184, v236
    v_accvgpr_write_b32 a185, v232
    v_accvgpr_read_b32 v236, a186
    v_accvgpr_read_b32 v232, a187
    v_mul_f32 v236, v236, v233
    v_mul_f32 v232, v232, v233
    v_accvgpr_write_b32 a186, v236
    v_accvgpr_write_b32 a187, v232
    v_accvgpr_read_b32 v236, a188
    v_accvgpr_read_b32 v232, a189
    v_mul_f32 v236, v236, v233
    v_mul_f32 v232, v232, v233
    v_accvgpr_write_b32 a188, v236
    v_accvgpr_write_b32 a189, v232
    v_accvgpr_read_b32 v236, a190
    v_accvgpr_read_b32 v232, a191
    v_mul_f32 v236, v236, v233
    v_mul_f32 v232, v232, v233
    v_accvgpr_write_b32 a190, v236
    v_accvgpr_write_b32 a191, v232
    v_add_f32 v188, v188, v227
    v_add_f32 v189, v189, v227
    v_add_f32 v190, v190, v227
    v_add_f32 v191, v191, v227
    v_add_f32 v252, v252, v227
    v_add_f32 v253, v253, v227
    v_add_f32 v254, v254, v227
    v_add_f32 v255, v255, v227
    v_max3_f32 v236, v188, v189, v190
    v_max3_f32 v236, v236, v191, v252
    v_max3_f32 v236, v236, v253, v254
    v_max_f32 v236, v236, v255
    v_mov_b32 v232, v236
    s_nop 1
    v_permlane16_swap_b32 v236, v232
    s_nop 1
    v_max_f32 v236, v236, v232
    v_mov_b32 v232, v236
    s_nop 1
    v_permlane32_swap_b32 v236, v232
    s_nop 1
    v_max_f32 v236, v236, v232
    v_ceil_f32 v236, v236
    v_max_f32 v236, 0, v236
    v_sub_f32 v227, v227, v236
    v_sub_f32 v188, v188, v236
    v_sub_f32 v189, v189, v236
    v_sub_f32 v190, v190, v236
    v_sub_f32 v191, v191, v236
    v_sub_f32 v252, v252, v236
    v_sub_f32 v253, v253, v236
    v_sub_f32 v254, v254, v236
    v_sub_f32 v255, v255, v236
    v_min_f32 v232, 0x43480000, v236
    v_cvt_i32_f32 v232, v232
    v_sub_u32 v232, 0, v232
    v_ldexp_f32 v233, 1.0, v232
    v_mul_f32 v231, v231, v233
    v_lshlrev_b32 v236, 16, v184
    v_and_b32 v232, 0xffff0000, v184
    v_mul_f32 v236, v236, v233
    v_mul_f32 v232, v232, v233
    v_cvt_pk_bf16_f32 v184, v236, v232
    v_lshlrev_b32 v236, 16, v185
    v_and_b32 v232, 0xffff0000, v185
    v_mul_f32 v236, v236, v233
    v_mul_f32 v232, v232, v233
    v_cvt_pk_bf16_f32 v185, v236, v232
    v_lshlrev_b32 v236, 16, v186
    v_and_b32 v232, 0xffff0000, v186
    v_mul_f32 v236, v236, v233
    v_mul_f32 v232, v232, v233
    v_cvt_pk_bf16_f32 v186, v236, v232
    v_lshlrev_b32 v236, 16, v187
    v_and_b32 v232, 0xffff0000, v187
    v_mul_f32 v236, v236, v233
    v_mul_f32 v232, v232, v233
    v_cvt_pk_bf16_f32 v187, v236, v232
    v_lshlrev_b32 v236, 16, v152
    v_and_b32 v232, 0xffff0000, v152
    v_mul_f32 v236, v236, v233
    v_mul_f32 v232, v232, v233
    v_cvt_pk_bf16_f32 v152, v236, v232
    v_lshlrev_b32 v236, 16, v153
    v_and_b32 v232, 0xffff0000, v153
    v_mul_f32 v236, v236, v233
    v_mul_f32 v232, v232, v233
    v_cvt_pk_bf16_f32 v153, v236, v232
    v_lshlrev_b32 v236, 16, v154
    v_and_b32 v232, 0xffff0000, v154
    v_mul_f32 v236, v236, v233
    v_mul_f32 v232, v232, v233
    v_cvt_pk_bf16_f32 v154, v236, v232
    v_lshlrev_b32 v236, 16, v155
    v_and_b32 v232, 0xffff0000, v155
    v_mul_f32 v236, v236, v233
    v_mul_f32 v232, v232, v233
    v_cvt_pk_bf16_f32 v155, v236, v232
    v_accvgpr_read_b32 v236, a192
    v_accvgpr_read_b32 v232, a193
    v_mul_f32 v236, v236, v233
    v_mul_f32 v232, v232, v233
    v_accvgpr_write_b32 a192, v236
    v_accvgpr_write_b32 a193, v232
    v_accvgpr_read_b32 v236, a194
    v_accvgpr_read_b32 v232, a195
    v_mul_f32 v236, v236, v233
    v_mul_f32 v232, v232, v233
    v_accvgpr_write_b32 a194, v236
    v_accvgpr_write_b32 a195, v232
    v_accvgpr_read_b32 v236, a196
    v_accvgpr_read_b32 v232, a197
    v_mul_f32 v236, v236, v233
    v_mul_f32 v232, v232, v233
    v_accvgpr_write_b32 a196, v236
    v_accvgpr_write_b32 a197, v232
    v_accvgpr_read_b32 v236, a198
    v_accvgpr_read_b32 v232, a199
    v_mul_f32 v236, v236, v233
    v_mul_f32 v232, v232, v233
    v_accvgpr_write_b32 a198, v236
    v_accvgpr_write_b32 a199, v232
    v_accvgpr_read_b32 v236, a200
    v_accvgpr_read_b32 v232, a201
    v_mul_f32 v236, v236, v233
    v_mul_f32 v232, v232, v233
    v_accvgpr_write_b32 a200, v236
    v_accvgpr_write_b32 a201, v232
    v_accvgpr_read_b32 v236, a202
    v_accvgpr_read_b32 v232, a203
    v_mul_f32 v236, v236, v233
    v_mul_f32 v232, v232, v233
    v_accvgpr_write_b32 a202, v236
    v_accvgpr_write_b32 a203, v232
    v_accvgpr_read_b32 v236, a204
    v_accvgpr_read_b32 v232, a205
    v_mul_f32 v236, v236, v233
    v_mul_f32 v232, v232, v233
    v_accvgpr_write_b32 a204, v236
    v_accvgpr_write_b32 a205, v232
    v_accvgpr_read_b32 v236, a206
    v_accvgpr_read_b32 v232, a207
    v_mul_f32 v236, v236, v233
    v_mul_f32 v232, v232, v233
    v_accvgpr_write_b32 a206, v236
    v_accvgpr_write_b32 a207, v232
    v_accvgpr_read_b32 v236, a208
    v_accvgpr_read_b32 v232, a209
    v_mul_f32 v236, v236, v233
    v_mul_f32 v232, v232, v233
    v_accvgpr_write_b32 a208, v236
    v_accvgpr_write_b32 a209, v232
    v_accvgpr_read_b32 v236, a210
    v_accvgpr_read_b32 v232, a211
    v_mul_f32 v236, v236, v233
    v_mul_f32 v232, v232, v233
    v_accvgpr_write_b32 a210, v236
    v_accvgpr_write_b32 a211, v232
    v_accvgpr_read_b32 v236, a212
    v_accvgpr_read_b32 v232, a213
    v_mul_f32 v236, v236, v233
    v_mul_f32 v232, v232, v233
    v_accvgpr_write_b32 a212, v236
    v_accvgpr_write_b32 a213, v232
    v_accvgpr_read_b32 v236, a214
    v_accvgpr_read_b32 v232, a215
    v_mul_f32 v236, v236, v233
    v_mul_f32 v232, v232, v233
    v_accvgpr_write_b32 a214, v236
    v_accvgpr_write_b32 a215, v232
    v_accvgpr_read_b32 v236, a216
    v_accvgpr_read_b32 v232, a217
    v_mul_f32 v236, v236, v233
    v_mul_f32 v232, v232, v233
    v_accvgpr_write_b32 a216, v236
    v_accvgpr_write_b32 a217, v232
    v_accvgpr_read_b32 v236, a218
    v_accvgpr_read_b32 v232, a219
    v_mul_f32 v236, v236, v233
    v_mul_f32 v232, v232, v233
    v_accvgpr_write_b32 a218, v236
    v_accvgpr_write_b32 a219, v232
    v_accvgpr_read_b32 v236, a220
    v_accvgpr_read_b32 v232, a221
    v_mul_f32 v236, v236, v233
    v_mul_f32 v232, v232, v233
    v_accvgpr_write_b32 a220, v236
    v_accvgpr_write_b32 a221, v232
    v_accvgpr_read_b32 v236, a222
    v_accvgpr_read_b32 v232, a223
    v_mul_f32 v236, v236, v233
    v_mul_f32 v232, v232, v233
    v_accvgpr_write_b32 a222, v236
    v_accvgpr_write_b32 a223, v232
    v_accvgpr_read_b32 v236, a224
    v_accvgpr_read_b32 v232, a225
    v_mul_f32 v236, v236, v233
    v_mul_f32 v232, v232, v233
    v_accvgpr_write_b32 a224, v236
    v_accvgpr_write_b32 a225, v232
    v_accvgpr_read_b32 v236, a226
    v_accvgpr_read_b32 v232, a227
    v_mul_f32 v236, v236, v233
    v_mul_f32 v232, v232, v233
    v_accvgpr_write_b32 a226, v236
    v_accvgpr_write_b32 a227, v232
    v_accvgpr_read_b32 v236, a228
    v_accvgpr_read_b32 v232, a229
    v_mul_f32 v236, v236, v233
    v_mul_f32 v232, v232, v233
    v_accvgpr_write_b32 a228, v236
    v_accvgpr_write_b32 a229, v232
    v_accvgpr_read_b32 v236, a230
    v_accvgpr_read_b32 v232, a231
    v_mul_f32 v236, v236, v233
    v_mul_f32 v232, v232, v233
    v_accvgpr_write_b32 a230, v236
    v_accvgpr_write_b32 a231, v232
    v_accvgpr_read_b32 v236, a232
    v_accvgpr_read_b32 v232, a233
    v_mul_f32 v236, v236, v233
    v_mul_f32 v232, v232, v233
    v_accvgpr_write_b32 a232, v236
    v_accvgpr_write_b32 a233, v232
    v_accvgpr_read_b32 v236, a234
    v_accvgpr_read_b32 v232, a235
    v_mul_f32 v236, v236, v233
    v_mul_f32 v232, v232, v233
    v_accvgpr_write_b32 a234, v236
    v_accvgpr_write_b32 a235, v232
    v_accvgpr_read_b32 v236, a236
    v_accvgpr_read_b32 v232, a237
    v_mul_f32 v236, v236, v233
    v_mul_f32 v232, v232, v233
    v_accvgpr_write_b32 a236, v236
    v_accvgpr_write_b32 a237, v232
    v_accvgpr_read_b32 v236, a238
    v_accvgpr_read_b32 v232, a239
    v_mul_f32 v236, v236, v233
    v_mul_f32 v232, v232, v233
    v_accvgpr_write_b32 a238, v236
    v_accvgpr_write_b32 a239, v232
    v_accvgpr_read_b32 v236, a240
    v_accvgpr_read_b32 v232, a241
    v_mul_f32 v236, v236, v233
    v_mul_f32 v232, v232, v233
    v_accvgpr_write_b32 a240, v236
    v_accvgpr_write_b32 a241, v232
    v_accvgpr_read_b32 v236, a242
    v_accvgpr_read_b32 v232, a243
    v_mul_f32 v236, v236, v233
    v_mul_f32 v232, v232, v233
    v_accvgpr_write_b32 a242, v236
    v_accvgpr_write_b32 a243, v232
    v_accvgpr_read_b32 v236, a244
    v_accvgpr_read_b32 v232, a245
    v_mul_f32 v236, v236, v233
    v_mul_f32 v232, v232, v233
    v_accvgpr_write_b32 a244, v236
    v_accvgpr_write_b32 a245, v232
    v_accvgpr_read_b32 v236, a246
    v_accvgpr_read_b32 v232, a247
    v_mul_f32 v236, v236, v233
    v_mul_f32 v232, v232, v233
    v_accvgpr_write_b32 a246, v236
    v_accvgpr_write_b32 a247, v232
    v_accvgpr_read_b32 v236, a248
    v_accvgpr_read_b32 v232, a249
    v_mul_f32 v236, v236, v233
    v_mul_f32 v232, v232, v233
    v_accvgpr_write_b32 a248, v236
    v_accvgpr_write_b32 a249, v232
    v_accvgpr_read_b32 v236, a250
    v_accvgpr_read_b32 v232, a251
    v_mul_f32 v236, v236, v233
    v_mul_f32 v232, v232, v233
    v_accvgpr_write_b32 a250, v236
    v_accvgpr_write_b32 a251, v232
    v_accvgpr_read_b32 v236, a252
    v_accvgpr_read_b32 v232, a253
    v_mul_f32 v236, v236, v233
    v_mul_f32 v232, v232, v233
    v_accvgpr_write_b32 a252, v236
    v_accvgpr_write_b32 a253, v232
    v_accvgpr_read_b32 v236, a254
    v_accvgpr_read_b32 v232, a255
    v_mul_f32 v236, v236, v233
    v_mul_f32 v232, v232, v233
    v_accvgpr_write_b32 a254, v236
    v_accvgpr_write_b32 a255, v232
    v_exp_f32 v164, v164
    v_exp_f32 v165, v165
    v_exp_f32 v166, v166
    v_exp_f32 v167, v167
    v_exp_f32 v240, v240
    v_exp_f32 v241, v241
    v_exp_f32 v242, v242
    v_exp_f32 v243, v243
    v_exp_f32 v172, v172
    v_exp_f32 v173, v173
    v_exp_f32 v174, v174
    v_exp_f32 v175, v175
    v_exp_f32 v244, v244
    v_exp_f32 v245, v245
    v_exp_f32 v246, v246
    v_exp_f32 v247, v247
    v_exp_f32 v180, v180
    v_exp_f32 v181, v181
    v_exp_f32 v182, v182
    v_exp_f32 v183, v183
    v_exp_f32 v248, v248
    v_exp_f32 v249, v249
    v_exp_f32 v250, v250
    v_exp_f32 v251, v251
    v_exp_f32 v188, v188
    v_exp_f32 v189, v189
    v_exp_f32 v190, v190
    v_exp_f32 v191, v191
    v_exp_f32 v252, v252
    v_exp_f32 v253, v253
    v_exp_f32 v254, v254
    v_exp_f32 v255, v255
    s_nop 0
    v_add_f32 v232, v164, v165
    v_add_f32 v232, v232, v166
    v_add_f32 v232, v232, v167
    v_add_f32 v232, v232, v240
    v_add_f32 v232, v232, v241
    v_add_f32 v232, v232, v242
    v_add_f32 v232, v232, v243
    v_add_f32 v233, v172, v173
    v_add_f32 v233, v233, v174
    v_add_f32 v233, v233, v175
    v_add_f32 v233, v233, v244
    v_add_f32 v233, v233, v245
    v_add_f32 v233, v233, v246
    v_add_f32 v233, v233, v247
    v_add_f32 v234, v180, v181
    v_add_f32 v234, v234, v182
    v_add_f32 v234, v234, v183
    v_add_f32 v234, v234, v248
    v_add_f32 v234, v234, v249
    v_add_f32 v234, v234, v250
    v_add_f32 v234, v234, v251
    v_add_f32 v235, v188, v189
    v_add_f32 v235, v235, v190
    v_add_f32 v235, v235, v191
    v_add_f32 v235, v235, v252
    v_add_f32 v235, v235, v253
    v_add_f32 v235, v235, v254
    v_add_f32 v235, v235, v255
    v_cvt_pk_bf16_f32 v164, v164, v165
    v_cvt_pk_bf16_f32 v165, v166, v167
    v_cvt_pk_bf16_f32 v166, v240, v241
    v_cvt_pk_bf16_f32 v167, v242, v243
    v_cvt_pk_bf16_f32 v172, v172, v173
    v_cvt_pk_bf16_f32 v173, v174, v175
    v_cvt_pk_bf16_f32 v174, v244, v245
    v_cvt_pk_bf16_f32 v175, v246, v247
    v_cvt_pk_bf16_f32 v180, v180, v181
    v_cvt_pk_bf16_f32 v181, v182, v183
    v_cvt_pk_bf16_f32 v182, v248, v249
    v_cvt_pk_bf16_f32 v183, v250, v251
    v_cvt_pk_bf16_f32 v188, v188, v189
    v_cvt_pk_bf16_f32 v189, v190, v191
    v_cvt_pk_bf16_f32 v190, v252, v253
    v_cvt_pk_bf16_f32 v191, v254, v255
    s_nop 1
    s_branch L_back31
.section .rodata,"a"
.p2align 6
.amdhsa_kernel standalone__mha_softmax__near_ridge_kernel
  .amdhsa_next_free_vgpr 512
  .amdhsa_next_free_sgpr 100
  .amdhsa_accum_offset 256
  .amdhsa_group_segment_fixed_size 0
  .amdhsa_kernarg_size 48
  .amdhsa_user_sgpr_count 2
  .amdhsa_user_sgpr_kernarg_segment_ptr 1
  .amdhsa_system_sgpr_workgroup_id_x 1
.end_amdhsa_kernel
```
